```python
import torch

def _softmax(x, axis=-1):
    return torch.softmax(x, dim=axis)
def _gelu(x):
    return torch.nn.functional.gelu(x, approximate="tanh")
def _silu(x):
    return torch.nn.functional.silu(x)
def _sigmoid(x):
    return torch.sigmoid(x)
def _layernorm(x, axis=-1, eps=1e-5):
    m = x.mean(dim=axis, keepdim=True)
    v = x.var(dim=axis, keepdim=True, unbiased=False)
    return (x - m) / torch.sqrt(v + eps)
def _scatter_add(tgt, idx, src, axis=0):
    return tgt.clone().index_add_(axis, idx, src)
def _segment_sum(src, seg, n):
    out = torch.zeros((n,) + src.shape[1:], dtype=src.dtype)
    return out.index_add_(0, seg, src)
def _pad(x, pw):
    flat = tuple(v for pair in reversed(pw) for v in pair)
    return torch.nn.functional.pad(x, flat)

kernel_name = 'interleave_layers__ssm_conv_s4d__dense_activation_mish__prompt'

def setup_inputs():

    _w = (lambda a: (lambda t: t.to(torch.bfloat16) if t.is_floating_point() else t)(torch.as_tensor(a)))
    def _A_setup():
        Bsz, L, D, N = 1, 2048, 512, 128
        return {
            "u": _w((lambda *s: torch.randn(*s, dtype=torch.bfloat16) * 0.05)(Bsz, L, D)),
            "log_A_real": _w((lambda *s: torch.randn(*s, dtype=torch.bfloat16) * 3.2)(D, N) * 0.5),
            "A_imag": _w((lambda *s: torch.randn(*s, dtype=torch.bfloat16) * 0.05)(D, N) * 3.14),
            "C_real": _w((lambda *s: torch.randn(*s, dtype=torch.bfloat16) * 0.05)(D, N) / N ** 0.5),
            "C_imag": _w((lambda *s: torch.randn(*s, dtype=torch.bfloat16) * 0.05)(D, N) / N ** 0.5),
            "log_dt": _w((lambda *s: torch.randn(*s, dtype=torch.bfloat16) * 0.05)(D) * 0.5 - 4.0),
            "D_skip": _w((lambda *s: torch.randn(*s, dtype=torch.bfloat16) * 0.05)(D)),
        }
    _A_in = _A_setup()

    def _B_setup():
        B, S, D, F = 1, 2048, 512, 1792
        return {
            "x": _w((lambda *s: torch.randn(*s, dtype=torch.bfloat16) * 0.05)(B, S, D)),
            "w1": _w((lambda *s: torch.randn(*s, dtype=torch.bfloat16) * 0.8)(D, F) * (D ** -0.5)),
            "b1": _w((lambda *s: torch.randn(*s, dtype=torch.bfloat16) * 0.2)(F)),
            "w2": _w((lambda *s: torch.randn(*s, dtype=torch.bfloat16) * 0.2)(F, D) * (F ** -0.5)),
        }
    _B_in = _B_setup()

    return {
        "A_u": _A_in["u"],
        "A_log_A_real": _A_in["log_A_real"],
        "A_A_imag": _A_in["A_imag"],
        "A_C_real": _A_in["C_real"],
        "A_C_imag": _A_in["C_imag"],
        "A_log_dt": _A_in["log_dt"],
        "A_D_skip": _A_in["D_skip"],
        "B_x": _B_in["x"],
        "B_w1": _B_in["w1"],
        "B_b1": _B_in["b1"],
        "B_w2": _B_in["w2"],
    }

def reference(A_u, A_log_A_real, A_A_imag, A_C_real, A_C_imag, A_log_dt, A_D_skip, B_x, B_w1, B_b1, B_w2):
    def _A_ref(u, log_A_real, A_imag, C_real, C_imag, log_dt, D_skip):
        L = u.shape[1]
        dt = torch.exp(log_dt)
        A = -torch.exp(log_A_real) + 1j * A_imag
        C = (C_real + 1j * C_imag) * dt[:, None]
        pos = (lambda x, dt: x.to(dt))(torch.arange(L), log_dt.dtype)
        P = torch.exp((A * dt[:, None])[:, :, None] * pos[None, None, :])
        K = 2.0 * torch.einsum("dn,dnl->dl", C, P).real
        L2 = 2 * L
        u_t = (lambda x, *d: x.permute(*d))(u, 0, 2, 1)
        Kf = (lambda x, *a, **k: torch.fft.rfft(x.float(), *a, **k))(K, L2)
        Uf = (lambda x, *a, **k: torch.fft.rfft(x.float(), *a, **k))(u_t, L2)
        y = (lambda x, *a, **k: torch.fft.irfft(x, *a, **k).to(torch.bfloat16))(Uf * Kf[None, :, :], L2)[:, :, :L]
        y = (lambda x, *d: x.permute(*d))(y, 0, 2, 1)
        return y + u * D_skip[None, None, :]

    def _B_ref(x, w1, b1, w2):
        h = torch.einsum("bsd,df->bsf", x, w1) + b1
        sp = torch.log1p(torch.exp(-torch.abs(h))) + torch.where(h > 0, h, torch.zeros_like(h))
        act = h * torch.tanh(sp)
        return torch.einsum("bsf,fd->bsd", act, w2)

    x = A_u
    x = x + _A_ref(_layernorm(x, axis=-1), A_log_A_real, A_A_imag, A_C_real, A_C_imag, A_log_dt, A_D_skip)
    x = x + _B_ref(_layernorm(x, axis=-1), B_w1, B_b1, B_w2)
    x = x + _A_ref(_layernorm(x, axis=-1), A_log_A_real, A_A_imag, A_C_real, A_C_imag, A_log_dt, A_D_skip)
    x = x + _B_ref(_layernorm(x, axis=-1), B_w1, B_b1, B_w2)
    return x
```

```asm
; @launch kernel=main_kernel grid=(256,1,1) block=(256,1,1) lds=163840
.amdgcn_target "amdgcn-amd-amdhsa--gfx950"
.text
.globl main_kernel
.p2align 8
.type main_kernel,@function
main_kernel:
    s_cmp_ge_u32 s2, 256
    s_cbranch_scc1 L_m_end
    s_load_dwordx4 s[96:99], s[0:1], 96
    s_load_dwordx16 s[76:91], s[0:1], 0
    s_load_dwordx8 s[36:43], s[0:1], 64
    s_getpc_b64 s[56:57]
L_m_pc:
    s_sub_u32 s56, s56, L_m_pc-main_kernel
    s_subb_u32 s57, s57, 0
    s_bfe_u32 s58, s2, 0x30003
    s_mul_i32 s58, s58, 2048
    v_lshl_add_u32 v148, v0, 3, s58
    global_load_dword a255, v148, s[56:57]
    v_and_b32 v1, 63, v0
    v_lshrrev_b32 v28, 6, v0
    v_lshlrev_b32 v2, 4, v1
    v_readfirstlane_b32 s3, v28
    v_mov_b32 v24, 0
    v_mov_b32 v25, 0
    v_mov_b32 v26, 0
    v_mov_b32 v27, 0
    v_lshrrev_b32 v120, 3, v0
    v_mul_u32_u24 v10, 32896, v120
    v_and_b32 v121, 7, v0
    v_lshl_add_u32 v10, v121, 4, v10
    s_lshl_b32 s7, s2, 7
    s_add_u32 s7, s7, 2162688
    s_lshl_b32 s58, s2, 9
    v_lshl_add_u32 v29, v1, 3, s58
    s_lshl_b32 s61, s2, 2
    s_mov_b32 s28, 3000
    s_mov_b32 s72, 0
    s_mov_b32 s73, 0
    s_mov_b32 s74, 0
    s_mov_b32 s54, 0x20000000
    s_mov_b32 s55, 0x60000000
    s_mov_b32 s51, 0x20000
    s_waitcnt lgkmcnt(0)
    s_mov_b32 s44, s98
    s_and_b32 s45, s99, 0xffff
    s_mov_b32 s46, 50331648
    s_mov_b32 s47, 0x20000
    s_mov_b64 s[24:25], s[88:89]
    s_mov_b32 s88, s36
    s_and_b32 s89, s37, 0xffff
    s_mov_b32 s90, 1835008
    s_mov_b32 s91, 0x20000
    s_cmp_eq_u32 s3, 0
    s_cbranch_scc1 L_m_o1
    s_sleep 2
    global_load_dwordx2 v[32:33], v29, s[78:79]
    global_load_dwordx2 v[34:35], v29, s[80:81]
    global_load_dwordx2 v[36:37], v29, s[82:83]
    global_load_dwordx2 v[38:39], v29, s[84:85]
L_m_o1:
    s_cmp_eq_u32 s3, 0
    s_cbranch_scc0 L_m_o2
    s_mul_i32 s72, s2, 8448
    s_add_u32 s73, s72, 4224
    buffer_store_dwordx4 v[24:27], v2, s[44:47], s72 offen offset:0 sc1
    buffer_store_dwordx4 v[24:27], v2, s[44:47], s72 offen offset:1024 sc1
    buffer_store_dwordx4 v[24:27], v2, s[44:47], s72 offen offset:2048 sc1
    buffer_store_dwordx4 v[24:27], v2, s[44:47], s72 offen offset:3072 sc1
    buffer_store_dwordx4 v[24:27], v2, s[44:47], s73 offen offset:0 sc1
    buffer_store_dwordx4 v[24:27], v2, s[44:47], s73 offen offset:1024 sc1
    buffer_store_dwordx4 v[24:27], v2, s[44:47], s73 offen offset:2048 sc1
    buffer_store_dwordx4 v[24:27], v2, s[44:47], s73 offen offset:3072 sc1
    s_lshl_b32 s74, s2, 6
    v_lshrrev_b32 v30, 3, v1
    v_min_u32 v31, 1, v30
    v_mul_u32_u24 v31, s74, v31
    v_lshl_add_u32 v30, v30, 15, v31
    v_lshl_add_u32 v30, v121, 4, v30
    s_add_u32 s74, s74, 8650752
    s_mov_b32 exec_lo, 0xffffff0f
    s_mov_b32 exec_hi, 0
    buffer_store_dwordx4 v[24:27], v30, s[44:47], s74 offen sc1
    s_mov_b64 exec, -1
    s_mov_b32 s48, s76
    s_and_b32 s49, s77, 0xffff
    s_mov_b32 s50, 2097152
    s_lshl_b32 s56, s2, 13
    s_add_u32 s57, s56, 4096
    v_lshrrev_b32 v30, 4, v1
    v_mul_u32_u24 v30, 768, v30
    v_add_u32 v30, v30, v2
    buffer_load_dwordx4 v[40:43], v30, s[48:51], s56 offen offset:0
    buffer_load_dwordx4 v[44:47], v30, s[48:51], s56 offen offset:256
    buffer_load_dwordx4 v[48:51], v30, s[48:51], s56 offen offset:512
    buffer_load_dwordx4 v[52:55], v30, s[48:51], s56 offen offset:768
    buffer_load_dwordx4 v[56:59], v30, s[48:51], s57 offen offset:0
    buffer_load_dwordx4 v[60:63], v30, s[48:51], s57 offen offset:256
    buffer_load_dwordx4 v[64:67], v30, s[48:51], s57 offen offset:512
    buffer_load_dwordx4 v[68:71], v30, s[48:51], s57 offen offset:768
    s_and_b32 s56, s2, 15
    s_lshl_b32 s56, s56, 4
    v_mov_b32 v28, s56
    v_mov_b32 v29, 1
L_m_o2:
    s_load_dword s27, s[24:25], s61
    s_load_dword s26, s[86:87], s61
    s_and_b32 s56, s2, 0xe0
    s_and_b32 s57, s2, 3
    s_lshl_b32 s57, s57, 3
    s_bfe_u32 s58, s2, 0x30002
    s_add_u32 s56, s56, s57
    s_add_u32 s56, s56, s58
    s_lshl_b32 s6, s56, 4
    s_and_b32 s4, s2, 7
    s_lshl_b32 s4, s4, 2
    s_bfe_u32 s56, s2, 0x20003
    s_add_u32 s4, s4, s56
    s_lshr_b32 s5, s2, 5
    s_mul_i32 s11, s4, 114688
    s_add_u32 s11, s11, 20971520
    s_mul_i32 s56, s5, 7
    s_add_u32 s56, s56, s3
    s_lshl_b32 s56, s56, 11
    s_add_u32 s9, s11, s56
    s_cmp_eq_u32 s3, 3
    s_cselect_b32 s56, s46, 8192
    s_add_u32 s10, s9, s56
    s_mul_i32 s56, s3, 28672
    s_add_u32 s11, s11, s56
    s_lshr_b32 s59, s3, 1
    s_and_b32 s60, s3, 1
    s_lshl_b32 s15, s2, 3
    s_add_u32 s15, s15, s3
    s_lshl_b32 s15, s15, 10
    s_add_u32 s15, s15, 9437184
    s_add_u32 s16, s15, 4096
    s_mul_i32 s8, s4, 32896
    s_lshl_b32 s56, s3, 10
    s_add_u32 s8, s8, s56
    s_lshl_b32 s56, s4, 2
    s_add_u32 s56, s56, s3
    s_mul_i32 s12, s56, 8448
    s_lshl_b32 s57, s5, 9
    s_add_u32 s12, s12, s57
    s_and_b32 s13, s56, 31
    s_lshl_b32 s13, s13, 5
    s_lshr_b32 s57, s56, 5
    s_lshl_b32 s57, s57, 12
    s_add_u32 s13, s13, s57
    s_lshl_b32 s14, s56, 13
    s_lshl_b32 s57, s5, 7
    s_add_u32 s14, s14, s57
    s_mov_b32 s18, 0x05040100
    s_mov_b32 s19, 0x07060302
    s_mov_b32 s20, 0x3b000000
    s_mov_b32 s22, 0x3727c5ac
    s_mov_b32 s23, 0x3fb8aa3b
    s_mov_b32 s29, 0x3f317218
    s_mov_b32 s76, s38
    s_mov_b32 s77, s39
    s_mov_b32 s38, 0x3f803f80
    s_mov_b32 s39, 0x41000000
    s_mov_b32 s48, s42
    s_and_b32 s49, s43, 0xffff
    s_mov_b32 s50, 2097152
    v_lshrrev_b32 v255, 2, v1
    v_mul_u32_u24 v255, 3520, v255
    v_add_u32 v255, v255, v2
    s_cmp_eq_u32 s3, 0
    s_cbranch_scc1 L_m_o3
    v_min_u32 v64, 55, v1
    s_mul_i32 s56, s5, 448
    v_lshl_add_u32 v65, v64, 3, s56
    global_load_dwordx2 v[66:67], v65, s[76:77]
L_m_o3:
    s_cmp_eq_u32 s3, 0
    s_cbranch_scc0 L_m_o4
    s_waitcnt vmcnt(8)
    s_mov_b64 exec, 1
    global_atomic_add v28, v29, s[96:97] sc1
    s_mov_b64 exec, -1
    s_mov_b32 s56, s7
    buffer_store_dwordx4 v[24:27], v10, s[44:47], s56 offen sc1
    s_add_u32 s56, s56, 263168
    buffer_store_dwordx4 v[24:27], v10, s[44:47], s56 offen sc1
    s_add_u32 s56, s56, 263168
    buffer_store_dwordx4 v[24:27], v10, s[44:47], s56 offen sc1
    s_add_u32 s56, s56, 263168
    buffer_store_dwordx4 v[24:27], v10, s[44:47], s56 offen sc1
    s_add_u32 s56, s56, 263168
    buffer_store_dwordx4 v[24:27], v10, s[44:47], s56 offen sc1
    s_add_u32 s56, s56, 263168
    buffer_store_dwordx4 v[24:27], v10, s[44:47], s56 offen sc1
    s_add_u32 s56, s56, 263168
    buffer_store_dwordx4 v[24:27], v10, s[44:47], s56 offen sc1
    s_add_u32 s56, s56, 263168
    buffer_store_dwordx4 v[24:27], v10, s[44:47], s56 offen sc1
    s_and_b32 s56, s2, 3
    s_mul_i32 s56, s56, 458736
    s_lshl_b32 s57, s2, 4
    s_add_u32 s56, s56, s57
    s_cmp_lt_u32 s2, 224
    s_cselect_b32 s56, s56, s90
    s_mov_b32 m0, 4096
    s_nop 0
    buffer_load_dwordx4 v255, s[88:91], s56 offen lds
    s_mov_b32 m0, 5120
    s_add_u32 s56, s56, 57344
    buffer_load_dwordx4 v255, s[88:91], s56 offen lds
    s_mov_b32 m0, 6144
    s_add_u32 s56, s56, 57344
    buffer_load_dwordx4 v255, s[88:91], s56 offen lds
    s_mov_b32 m0, 7168
    s_add_u32 s56, s56, 57344
    buffer_load_dwordx4 v255, s[88:91], s56 offen lds
    s_mov_b32 m0, 8192
    s_add_u32 s56, s56, 57344
    buffer_load_dwordx4 v255, s[88:91], s56 offen lds
    s_mov_b32 m0, 9216
    s_add_u32 s56, s56, 57344
    buffer_load_dwordx4 v255, s[88:91], s56 offen lds
    s_mov_b32 m0, 10240
    s_add_u32 s56, s56, 57344
    buffer_load_dwordx4 v255, s[88:91], s56 offen lds
    s_mov_b32 m0, 11264
    s_add_u32 s56, s56, 57344
    buffer_load_dwordx4 v255, s[88:91], s56 offen lds
L_m_o4:
    v_mul_u32_u24 v5, 4224, v0
    v_lshlrev_b32 v6, 5, v0
    v_lshrrev_b32 v116, 4, v1
    v_and_b32 v117, 15, v1
    v_bfe_u32 v118, v1, 2, 2
    v_and_b32 v119, 3, v1
    v_mul_u32_u24 v3, 4160, v118
    v_lshl_add_u32 v3, v116, 4, v3
    v_lshl_add_u32 v3, v119, 3, v3
    s_mul_i32 s56, s59, 16640
    s_lshl_b32 s57, s60, 8
    s_add_u32 s56, s56, s57
    s_add_u32 s56, s56, 97800
    v_add_u32 v3, s56, v3
    v_lshlrev_b32 v4, 5, v117
    v_lshlrev_b32 v120, 4, v116
    v_sub_u32 v4, v4, v120
    s_mul_i32 s56, s59, 4608
    s_sub_u32 s56, s56, s57
    s_add_u32 s56, s56, 131408
    v_add_u32 v4, s56, v4
    v_lshlrev_b32 v7, 3, v0
    v_add_u32 v7, 131584, v7
    v_lshl_add_u32 v120, v116, 2, v117
    v_and_b32 v120, 15, v120
    v_lshlrev_b32 v120, 4, v120
    v_lshl_add_u32 v8, v116, 8, v120
    s_lshl_b32 s56, s3, 12
    s_add_u32 s56, s56, 140288
    v_add_u32 v8, s56, v8
    v_lshrrev_b32 v120, 2, v1
    v_lshl_add_u32 v120, v119, 2, v120
    v_and_b32 v120, 15, v120
    v_lshlrev_b32 v120, 4, v120
    v_lshl_add_u32 v9, v119, 8, v120
    s_lshl_b32 s56, s3, 10
    s_add_u32 s56, s56, 140288
    v_add_u32 v9, s56, v9
    s_lshl_b32 s56, s3, 13
    s_lshl_b32 s57, s3, 10
    s_add_u32 s57, s57, 98304
    v_add_u32 v11, s57, v2
    v_bfe_u32 v122, v1, 3, 1
    v_bfe_u32 v123, v1, 2, 1
    v_lshrrev_b32 v124, 5, v1
    v_lshlrev_b32 v120, 7, v122
    v_lshl_add_u32 v120, v123, 3, v120
    v_lshl_add_u32 v120, v119, 4, v120
    v_add_u32 v120, 98304, v120
    v_lshl_add_u32 v12, v124, 9, v120
    v_bfe_u32 v125, v1, 4, 1
    v_lshl_add_u32 v12, v125, 6, v12
    v_lshl_add_u32 v120, v116, 9, v120
    s_mul_i32 s57, s3, 31744
    v_add_u32 v13, s57, v2
    s_cmp_eq_u32 s3, 3
    s_cselect_b64 vcc, -1, 0
    v_cndmask_b32 v13, v13, v120, vcc
    s_lshl_b32 s57, s3, 7
    s_add_u32 s57, s57, 95232
    v_lshl_add_u32 v14, v124, 4, s57
    v_and_b32 v120, 31, v1
    v_mov_b32 v125, 97024
    v_lshl_add_u32 v15, v120, 3, v125
    v_lshrrev_b32 v125, 3, v120
    v_lshlrev_b32 v125, 8, v125
    v_lshl_add_u32 v125, v124, 7, v125
    s_add_u32 s57, s56, 131072
    v_add_u32 v125, s57, v125
    v_lshl_add_u32 v16, v121, 4, v125
    v_add_u32 v120, 2, v121
    v_and_b32 v120, 7, v120
    v_lshl_add_u32 v17, v120, 4, v125
    v_lshl_add_u32 v125, v122, 2, v116
    v_and_b32 v120, 2, v121
    v_add_u32 v120, v120, v125
    v_and_b32 v120, 7, v120
    v_lshlrev_b32 v120, 4, v120
    v_and_b32 v123, 1, v121
    v_lshl_add_u32 v120, v123, 7, v120
    v_lshrrev_b32 v123, 1, v121
    v_lshl_add_u32 v120, v123, 11, v120
    s_lshl_b32 s57, s3, 8
    s_add_u32 s57, s57, 131072
    v_add_u32 v18, s57, v120
    v_lshl_add_u32 v120, v121, 2, v116
    v_lshlrev_b32 v120, 7, v120
    v_lshl_add_u32 v120, v122, 4, v120
    s_lshl_b32 s57, s5, 12
    s_lshl_b32 s58, s3, 5
    s_add_u32 s57, s57, s58
    s_add_u32 s57, s57, 98304
    v_add_u32 v19, s57, v120
    v_mul_u32_u24 v20, 4224, v122
    v_lshl_add_u32 v20, v116, 7, v20
    v_lshl_add_u32 v20, v121, 4, v20
    v_lshlrev_b32 v21, 10, v116
    v_lshl_add_u32 v21, v122, 4, v21
    v_lshl_add_u32 v21, v121, 2, v21
    v_lshlrev_b32 v22, 10, v125
    v_lshl_add_u32 v22, v121, 4, v22
    v_and_b32 v120, 1, v1
    v_cmp_ne_u32 s[30:31], 0, v120
    v_and_b32 v120, 2, v1
    v_cmp_ne_u32 s[32:33], 0, v120
    v_cmp_eq_u32 s[34:35], v118, v116
    v_cmp_eq_u32 s[52:53], 1, v121
    v_lshlrev_b32 v126, 3, v0
    v_add_u32 v128, -1, v126
    v_add_u32 v129, 0, v126
    v_add_u32 v130, 1, v126
    v_add_u32 v131, 2, v126
    v_add_u32 v132, 3, v126
    v_add_u32 v133, 4, v126
    v_add_u32 v134, 5, v126
    v_add_u32 v135, 6, v126
    v_add_u32 v136, 7, v126
    v_max_i32 v128, 0, v128
    v_cvt_f32_u32 v146, v128
    v_cvt_f32_u32 v147, v129
    v_cvt_f32_u32 v148, v130
    v_cvt_f32_u32 v149, v131
    v_cvt_f32_u32 v150, v132
    v_cvt_f32_u32 v151, v133
    v_cvt_f32_u32 v152, v134
    v_cvt_f32_u32 v153, v135
    v_cvt_f32_u32 v154, v136
    v_cmp_gt_u32 vcc, 32, v0
    v_cvt_pk_bf16_f32 v127, v146, v147
    v_and_b32 v146, 0xffff, v127
    v_lshrrev_b32 v147, 16, v127
    v_cvt_pk_bf16_f32 v127, v148, v149
    v_and_b32 v148, 0xffff, v127
    v_lshrrev_b32 v149, 16, v127
    v_cvt_pk_bf16_f32 v127, v150, v151
    v_and_b32 v150, 0xffff, v127
    v_lshrrev_b32 v151, 16, v127
    v_cvt_pk_bf16_f32 v127, v152, v153
    v_and_b32 v152, 0xffff, v127
    v_lshrrev_b32 v153, 16, v127
    v_cvt_pk_bf16_f32 v127, v154, v154
    v_and_b32 v154, 0xffff, v127
    v_subrev_u32 v146, 17024, v146
    v_cndmask_b32 v128, v146, v128, vcc
    v_lshlrev_b32 v128, 1, v128
    v_subrev_u32 v147, 17024, v147
    v_cndmask_b32 v129, v147, v129, vcc
    v_lshlrev_b32 v129, 1, v129
    v_subrev_u32 v148, 17024, v148
    v_cndmask_b32 v130, v148, v130, vcc
    v_lshlrev_b32 v130, 1, v130
    v_subrev_u32 v149, 17024, v149
    v_cndmask_b32 v131, v149, v131, vcc
    v_lshlrev_b32 v131, 1, v131
    v_subrev_u32 v150, 17024, v150
    v_cndmask_b32 v132, v150, v132, vcc
    v_lshlrev_b32 v132, 1, v132
    v_subrev_u32 v151, 17024, v151
    v_cndmask_b32 v133, v151, v133, vcc
    v_lshlrev_b32 v133, 1, v133
    v_subrev_u32 v152, 17024, v152
    v_cndmask_b32 v134, v152, v134, vcc
    v_lshlrev_b32 v134, 1, v134
    v_subrev_u32 v153, 17024, v153
    v_cndmask_b32 v135, v153, v135, vcc
    v_lshlrev_b32 v135, 1, v135
    v_subrev_u32 v154, 17024, v154
    v_cndmask_b32 v136, v154, v136, vcc
    v_lshlrev_b32 v136, 1, v136
    v_mul_u32_u24 v137, 33280, v124
    v_add_u32 v137, v137, v2
    v_add_u32 v137, 21504, v137
    v_mul_u32_u24 v138, 528, v117
    v_lshl_add_u32 v138, v116, 4, v138
    s_mul_i32 s56, s59, 33792
    s_add_u32 s56, s56, 21504
    v_add_u32 v138, s56, v138
    s_mul_i32 s56, s60, 8448
    s_add_u32 s56, s56, 16896
    v_add_u32 v139, s56, v138
    s_lshl_b32 s56, s60, 4
    v_add_u32 v126, s56, v117
    s_lshl_b32 s56, s59, 11
    s_add_u32 s56, s56, 0
    v_lshlrev_b32 v140, 4, v126
    v_lshl_add_u32 v140, v116, 3, v140
    v_lshlrev_b32 v127, 3, v126
    v_add_u32 v127, 512, v127
    v_cmp_eq_u32 vcc, 2, v116
    s_nop 1
    v_cndmask_b32 v140, v140, v127, vcc
    v_add_u32 v141, 4, v140
    v_lshlrev_b32 v127, 2, v126
    v_add_u32 v127, 768, v127
    v_cmp_eq_u32 vcc, 3, v116
    s_nop 1
    v_cndmask_b32 v140, v140, v127, vcc
    v_add_u32 v127, 128, v127
    v_cndmask_b32 v141, v141, v127, vcc
    v_add_u32 v140, s56, v140
    v_add_u32 v141, s56, v141
    v_lshlrev_b32 v142, 1, v126
    v_lshl_add_u32 v142, v116, 8, v142
    s_add_u32 s56, s56, 1024
    v_add_u32 v142, s56, v142
    v_lshlrev_b32 v144, 4, v0
    v_add_u32 v143, 97824, v144
    s_lshl_b32 s63, s59, 2
    v_cmp_lt_u32 s[68:69], 31, v1
    v_mov_b32 v120, 0
    v_mov_b32 v121, 0
    v_mov_b32 v122, 0
    v_mov_b32 v123, 0
    v_lshrrev_b32 v124, 5, v1
    v_mul_u32_u24 v124, 4608, v124
    v_and_b32 v125, 31, v1
    v_lshl_add_u32 v124, v125, 4, v124
    v_add_u32 v124, 131072, v124
    ds_write_b128 v124, v[120:123]
    v_bfe_u32 v124, v1, 2, 3
    v_mul_u32_u24 v124, 4160, v124
    v_and_b32 v125, 3, v1
    v_lshl_add_u32 v124, v125, 4, v124
    v_add_u32 v124, 97792, v124
    ds_write_b128 v124, v[120:123]
    s_waitcnt lgkmcnt(0)
    v_mov_b32 v126, s26
    s_lshl_b32 s24, s27, 16
    s_mov_b32 s25, s24
    s_and_b32 s26, s27, 0xffff0000
    s_mov_b32 s27, s26
    v_lshlrev_b32 v127, 16, v126
    v_and_b32 v126, 0xffff0000, v126
    v_cndmask_b32 v126, v127, v126, s[68:69]
    s_mov_b32 s67, 0x32a57060
    v_mul_f32 v127, s23, v126
    v_fma_f32 v147, v126, s23, -v127
    v_fma_f32 v147, v126, s67, v147
    v_exp_f32 v145, v127
    v_mul_f32 v147, s29, v147
    v_fma_f32 v145, v145, v147, v145
    v_cvt_pk_bf16_f32 v145, v145, v145
    v_and_b32 v145, 0xffff0000, v145
    s_cmp_eq_u32 s3, 1
    s_cbranch_scc1 L_m_w1_5
    s_cmp_eq_u32 s3, 2
    s_cbranch_scc1 L_m_w2_6
    s_cmp_eq_u32 s3, 3
    s_cbranch_scc1 L_m_w3_7
    s_mov_b32 s80, s40
    s_and_b32 s81, s41, 0xffff
    s_mov_b32 s82, 1835008
    s_mov_b32 s83, 0x20000
    s_and_b32 s56, s2, 1
    s_mul_i32 s56, s56, -7680
    s_lshl_b32 s57, s2, 13
    s_add_u32 s56, s56, s57
    v_lshrrev_b32 v30, 5, v1
    v_mul_u32_u24 v30, 7680, v30
    v_add_u32 v30, v30, v2
    s_mov_b32 m0, 12288
    s_nop 0
    buffer_load_dwordx4 v30, s[80:83], s56 offen lds
    s_mov_b32 m0, 13376
    s_add_u32 s56, s56, 1024
    buffer_load_dwordx4 v30, s[80:83], s56 offen lds
    s_mov_b32 m0, 14464
    s_add_u32 s56, s56, 1024
    buffer_load_dwordx4 v30, s[80:83], s56 offen lds
    s_mov_b32 m0, 15552
    s_add_u32 s56, s56, 1024
    buffer_load_dwordx4 v30, s[80:83], s56 offen lds
    s_mov_b32 m0, 16640
    s_add_u32 s56, s56, 1024
    buffer_load_dwordx4 v30, s[80:83], s56 offen lds
    s_mov_b32 m0, 17728
    s_add_u32 s56, s56, 1024
    buffer_load_dwordx4 v30, s[80:83], s56 offen lds
    s_mov_b32 m0, 18816
    s_add_u32 s56, s56, 1024
    buffer_load_dwordx4 v30, s[80:83], s56 offen lds
    s_mov_b32 m0, 19904
    s_add_u32 s56, s56, 1024
    buffer_load_dwordx4 v30, s[80:83], s56 offen lds
    v_bfe_u32 v30, v1, 3, 1
    v_lshlrev_b32 v30, 9, v30
    v_lshl_add_u32 v30, v116, 7, v30
    v_and_b32 v31, 7, v1
    v_lshl_add_u32 v30, v31, 4, v30
    v_lshlrev_b32 v34, 3, v116
    v_lshl_add_u32 v34, v117, 5, v34
    v_mov_b32 v76, s22
    s_waitcnt vmcnt(32)
    v_dot2_f32_bf16 v72, v40, s38, 0
    v_dot2_f32_bf16 v73, v40, v40, 0
    v_dot2_f32_bf16 v72, v41, s38, v72
    v_dot2_f32_bf16 v73, v41, v41, v73
    v_dot2_f32_bf16 v72, v42, s38, v72
    v_dot2_f32_bf16 v73, v42, v42, v73
    v_dot2_f32_bf16 v72, v43, s38, v72
    v_dot2_f32_bf16 v73, v43, v43, v73
    s_waitcnt vmcnt(31)
    v_dot2_f32_bf16 v72, v44, s38, v72
    v_dot2_f32_bf16 v73, v44, v44, v73
    v_dot2_f32_bf16 v72, v45, s38, v72
    v_dot2_f32_bf16 v73, v45, v45, v73
    v_dot2_f32_bf16 v72, v46, s38, v72
    v_dot2_f32_bf16 v73, v46, v46, v73
    v_dot2_f32_bf16 v72, v47, s38, v72
    v_dot2_f32_bf16 v73, v47, v47, v73
    s_waitcnt vmcnt(30)
    v_dot2_f32_bf16 v72, v48, s38, v72
    v_dot2_f32_bf16 v73, v48, v48, v73
    v_dot2_f32_bf16 v72, v49, s38, v72
    v_dot2_f32_bf16 v73, v49, v49, v73
    v_dot2_f32_bf16 v72, v50, s38, v72
    v_dot2_f32_bf16 v73, v50, v50, v73
    v_dot2_f32_bf16 v72, v51, s38, v72
    v_dot2_f32_bf16 v73, v51, v51, v73
    s_waitcnt vmcnt(29)
    v_dot2_f32_bf16 v72, v52, s38, v72
    v_dot2_f32_bf16 v73, v52, v52, v73
    v_dot2_f32_bf16 v72, v53, s38, v72
    v_dot2_f32_bf16 v73, v53, v53, v73
    v_dot2_f32_bf16 v72, v54, s38, v72
    v_dot2_f32_bf16 v73, v54, v54, v73
    v_dot2_f32_bf16 v72, v55, s38, v72
    v_dot2_f32_bf16 v73, v55, v55, v73
    s_waitcnt vmcnt(28)
    v_dot2_f32_bf16 v74, v56, s38, 0
    v_dot2_f32_bf16 v75, v56, v56, 0
    v_dot2_f32_bf16 v74, v57, s38, v74
    v_dot2_f32_bf16 v75, v57, v57, v75
    v_dot2_f32_bf16 v74, v58, s38, v74
    v_dot2_f32_bf16 v75, v58, v58, v75
    v_dot2_f32_bf16 v74, v59, s38, v74
    v_dot2_f32_bf16 v75, v59, v59, v75
    s_waitcnt vmcnt(27)
    v_dot2_f32_bf16 v74, v60, s38, v74
    v_dot2_f32_bf16 v75, v60, v60, v75
    v_dot2_f32_bf16 v74, v61, s38, v74
    v_dot2_f32_bf16 v75, v61, v61, v75
    v_dot2_f32_bf16 v74, v62, s38, v74
    v_dot2_f32_bf16 v75, v62, v62, v75
    v_dot2_f32_bf16 v74, v63, s38, v74
    v_dot2_f32_bf16 v75, v63, v63, v75
    s_waitcnt vmcnt(26)
    v_dot2_f32_bf16 v74, v64, s38, v74
    v_dot2_f32_bf16 v75, v64, v64, v75
    v_dot2_f32_bf16 v74, v65, s38, v74
    v_dot2_f32_bf16 v75, v65, v65, v75
    v_dot2_f32_bf16 v74, v66, s38, v74
    v_dot2_f32_bf16 v75, v66, v66, v75
    v_dot2_f32_bf16 v74, v67, s38, v74
    v_dot2_f32_bf16 v75, v67, v67, v75
    s_waitcnt vmcnt(25)
    v_dot2_f32_bf16 v74, v68, s38, v74
    v_dot2_f32_bf16 v75, v68, v68, v75
    v_dot2_f32_bf16 v74, v69, s38, v74
    v_dot2_f32_bf16 v75, v69, v69, v75
    v_dot2_f32_bf16 v74, v70, s38, v74
    v_dot2_f32_bf16 v75, v70, v70, v75
    v_dot2_f32_bf16 v74, v71, s38, v74
    v_dot2_f32_bf16 v75, v71, v71, v75
    v_add_f32_dpp v72, v72, v72 quad_perm:[1,0,3,2] row_mask:0xf bank_mask:0xf
    v_add_f32_dpp v73, v73, v73 quad_perm:[1,0,3,2] row_mask:0xf bank_mask:0xf
    v_add_f32_dpp v74, v74, v74 quad_perm:[1,0,3,2] row_mask:0xf bank_mask:0xf
    v_add_f32_dpp v75, v75, v75 quad_perm:[1,0,3,2] row_mask:0xf bank_mask:0xf
    v_add_f32_dpp v72, v72, v72 quad_perm:[2,3,0,1] row_mask:0xf bank_mask:0xf
    v_add_f32_dpp v73, v73, v73 quad_perm:[2,3,0,1] row_mask:0xf bank_mask:0xf
    v_add_f32_dpp v74, v74, v74 quad_perm:[2,3,0,1] row_mask:0xf bank_mask:0xf
    v_add_f32_dpp v75, v75, v75 quad_perm:[2,3,0,1] row_mask:0xf bank_mask:0xf
    v_add_f32_dpp v72, v72, v72 row_half_mirror row_mask:0xf bank_mask:0xf
    v_add_f32_dpp v73, v73, v73 row_half_mirror row_mask:0xf bank_mask:0xf
    v_add_f32_dpp v74, v74, v74 row_half_mirror row_mask:0xf bank_mask:0xf
    v_add_f32_dpp v75, v75, v75 row_half_mirror row_mask:0xf bank_mask:0xf
    v_add_f32_dpp v72, v72, v72 row_mirror row_mask:0xf bank_mask:0xf
    v_add_f32_dpp v73, v73, v73 row_mirror row_mask:0xf bank_mask:0xf
    v_add_f32_dpp v74, v74, v74 row_mirror row_mask:0xf bank_mask:0xf
    v_add_f32_dpp v75, v75, v75 row_mirror row_mask:0xf bank_mask:0xf
    v_cndmask_b32 v72, v72, v74, s[30:31]
    v_cndmask_b32 v73, v73, v75, s[30:31]
    v_mul_f32 v75, s20, v72
    v_fma_f32 v74, v73, s20, v76
    v_fma_f32 v74, -v75, v75, v74
    v_max_f32 v74, s22, v74
    v_rsq_f32 v74, v74
    s_mov_b32 exec_lo, 0x30003
    s_mov_b32 exec_hi, 0x30003
    v_mul_f32 v75, -v75, v74
    s_waitcnt vmcnt(16)
    buffer_store_dwordx2 v[74:75], v34, s[44:47], s74 offen sc1
    s_mov_b64 exec, -1
    v_permlane16_swap_b32 v40, v41
    v_permlane16_swap_b32 v42, v43
    s_nop 1
    v_permlane32_swap_b32 v40, v42
    v_permlane32_swap_b32 v41, v43
    v_permlane16_swap_b32 v44, v45
    v_permlane16_swap_b32 v46, v47
    v_cmp_gt_f32 vcc, s54, |v40|
    v_and_b32 v31, 0xffff, v40
    v_or_b32 v31, s54, v31
    v_cndmask_b32 v40, v40, v31, vcc
    v_permlane32_swap_b32 v44, v46
    v_permlane32_swap_b32 v45, v47
    buffer_store_dwordx4 v[40:43], v30, s[44:47], s72 offen offset:0 sc1
    v_permlane16_swap_b32 v48, v49
    v_permlane16_swap_b32 v50, v51
    v_cmp_gt_f32 vcc, s54, |v44|
    v_and_b32 v31, 0xffff, v44
    v_or_b32 v31, s54, v31
    v_cndmask_b32 v44, v44, v31, vcc
    v_permlane32_swap_b32 v48, v50
    v_permlane32_swap_b32 v49, v51
    buffer_store_dwordx4 v[44:47], v30, s[44:47], s72 offen offset:1024 sc1
    v_permlane16_swap_b32 v52, v53
    v_permlane16_swap_b32 v54, v55
    v_cmp_gt_f32 vcc, s54, |v48|
    v_and_b32 v31, 0xffff, v48
    v_or_b32 v31, s54, v31
    v_cndmask_b32 v48, v48, v31, vcc
    v_permlane32_swap_b32 v52, v54
    v_permlane32_swap_b32 v53, v55
    buffer_store_dwordx4 v[48:51], v30, s[44:47], s72 offen offset:2048 sc1
    v_permlane16_swap_b32 v56, v57
    v_permlane16_swap_b32 v58, v59
    v_cmp_gt_f32 vcc, s54, |v52|
    v_and_b32 v31, 0xffff, v52
    v_or_b32 v31, s54, v31
    v_cndmask_b32 v52, v52, v31, vcc
    v_permlane32_swap_b32 v56, v58
    v_permlane32_swap_b32 v57, v59
    buffer_store_dwordx4 v[52:55], v30, s[44:47], s72 offen offset:3072 sc1
    v_permlane16_swap_b32 v60, v61
    v_permlane16_swap_b32 v62, v63
    v_cmp_gt_f32 vcc, s54, |v56|
    v_and_b32 v31, 0xffff, v56
    v_or_b32 v31, s54, v31
    v_cndmask_b32 v56, v56, v31, vcc
    v_permlane32_swap_b32 v60, v62
    v_permlane32_swap_b32 v61, v63
    buffer_store_dwordx4 v[56:59], v30, s[44:47], s73 offen offset:0 sc1
    v_permlane16_swap_b32 v64, v65
    v_permlane16_swap_b32 v66, v67
    v_cmp_gt_f32 vcc, s54, |v60|
    v_and_b32 v31, 0xffff, v60
    v_or_b32 v31, s54, v31
    v_cndmask_b32 v60, v60, v31, vcc
    v_permlane32_swap_b32 v64, v66
    v_permlane32_swap_b32 v65, v67
    buffer_store_dwordx4 v[60:63], v30, s[44:47], s73 offen offset:1024 sc1
    v_permlane16_swap_b32 v68, v69
    v_permlane16_swap_b32 v70, v71
    v_cmp_gt_f32 vcc, s54, |v64|
    v_and_b32 v31, 0xffff, v64
    v_or_b32 v31, s54, v31
    v_cndmask_b32 v64, v64, v31, vcc
    v_permlane32_swap_b32 v68, v70
    v_permlane32_swap_b32 v69, v71
    buffer_store_dwordx4 v[64:67], v30, s[44:47], s73 offen offset:2048 sc1
    v_cmp_gt_f32 vcc, s54, |v68|
    v_and_b32 v31, 0xffff, v68
    v_or_b32 v31, s54, v31
    v_cndmask_b32 v68, v68, v31, vcc
    buffer_store_dwordx4 v[68:71], v30, s[44:47], s73 offen offset:3072 sc1
    v_lshrrev_b32 v32, 5, v1
    v_lshl_add_u32 v32, v32, 3, v118
    v_lshlrev_b32 v32, 6, v32
    v_bfe_u32 v33, v1, 4, 1
    v_lshl_add_u32 v32, v33, 5, v32
    v_lshl_add_u32 v32, v119, 3, v32
    s_lshl_b32 s56, s2, 13
    s_add_u32 s56, s56, 16777216
    s_cmp_lt_u32 s2, 224
    s_cselect_b32 s56, s56, s46
    s_add_u32 s57, s56, 4096
    s_lshl_b32 s58, s2, 7
    s_add_u32 s58, s58, 8749056
    s_waitcnt vmcnt(17)
    ds_read_b64_tr_b16 v[160:161], v32 offset:4096
    ds_read_b64_tr_b16 v[162:163], v32 offset:4352
    ds_read_b64_tr_b16 v[164:165], v32 offset:5120
    ds_read_b64_tr_b16 v[166:167], v32 offset:5376
    ds_read_b64_tr_b16 v[168:169], v32 offset:6144
    ds_read_b64_tr_b16 v[170:171], v32 offset:6400
    ds_read_b64_tr_b16 v[172:173], v32 offset:7168
    ds_read_b64_tr_b16 v[174:175], v32 offset:7424
    ds_read_b64_tr_b16 v[176:177], v32 offset:8192
    ds_read_b64_tr_b16 v[178:179], v32 offset:8448
    ds_read_b64_tr_b16 v[180:181], v32 offset:9216
    ds_read_b64_tr_b16 v[182:183], v32 offset:9472
    ds_read_b64_tr_b16 v[184:185], v32 offset:10240
    ds_read_b64_tr_b16 v[186:187], v32 offset:10496
    ds_read_b64_tr_b16 v[188:189], v32 offset:11264
    ds_read_b64_tr_b16 v[190:191], v32 offset:11520
    s_waitcnt lgkmcnt(14)
    buffer_store_dwordx4 v[160:163], v2, s[44:47], s56 offen offset:0 sc1
    s_waitcnt lgkmcnt(12)
    buffer_store_dwordx4 v[164:167], v2, s[44:47], s56 offen offset:1024 sc1
    s_waitcnt lgkmcnt(10)
    buffer_store_dwordx4 v[168:171], v2, s[44:47], s56 offen offset:2048 sc1
    s_waitcnt lgkmcnt(8)
    buffer_store_dwordx4 v[172:175], v2, s[44:47], s56 offen offset:3072 sc1
    s_waitcnt lgkmcnt(6)
    buffer_store_dwordx4 v[176:179], v2, s[44:47], s57 offen offset:0 sc1
    s_waitcnt lgkmcnt(4)
    buffer_store_dwordx4 v[180:183], v2, s[44:47], s57 offen offset:1024 sc1
    s_waitcnt lgkmcnt(2)
    buffer_store_dwordx4 v[184:187], v2, s[44:47], s57 offen offset:2048 sc1
    s_waitcnt lgkmcnt(0)
    buffer_store_dwordx4 v[188:191], v2, s[44:47], s57 offen offset:3072 sc1
    v_dot2_f32_bf16 v120, v160, s38, 0
    v_dot2_f32_bf16 v121, v161, s38, 0
    v_dot2_f32_bf16 v120, v162, s38, v120
    v_dot2_f32_bf16 v121, v163, s38, v121
    v_dot2_f32_bf16 v120, v164, s38, v120
    v_dot2_f32_bf16 v121, v165, s38, v121
    v_dot2_f32_bf16 v120, v166, s38, v120
    v_dot2_f32_bf16 v121, v167, s38, v121
    v_dot2_f32_bf16 v120, v168, s38, v120
    v_dot2_f32_bf16 v121, v169, s38, v121
    v_dot2_f32_bf16 v120, v170, s38, v120
    v_dot2_f32_bf16 v121, v171, s38, v121
    v_dot2_f32_bf16 v120, v172, s38, v120
    v_dot2_f32_bf16 v121, v173, s38, v121
    v_dot2_f32_bf16 v120, v174, s38, v120
    v_dot2_f32_bf16 v121, v175, s38, v121
    v_dot2_f32_bf16 v120, v176, s38, v120
    v_dot2_f32_bf16 v121, v177, s38, v121
    v_dot2_f32_bf16 v120, v178, s38, v120
    v_dot2_f32_bf16 v121, v179, s38, v121
    v_dot2_f32_bf16 v120, v180, s38, v120
    v_dot2_f32_bf16 v121, v181, s38, v121
    v_dot2_f32_bf16 v120, v182, s38, v120
    v_dot2_f32_bf16 v121, v183, s38, v121
    v_dot2_f32_bf16 v120, v184, s38, v120
    v_dot2_f32_bf16 v121, v185, s38, v121
    v_dot2_f32_bf16 v120, v186, s38, v120
    v_dot2_f32_bf16 v121, v187, s38, v121
    v_dot2_f32_bf16 v120, v188, s38, v120
    v_dot2_f32_bf16 v121, v189, s38, v121
    v_dot2_f32_bf16 v120, v190, s38, v120
    v_dot2_f32_bf16 v121, v191, s38, v121
    v_lshlrev_b32 v31, 2, v1
    s_nop 1
    v_add_f32 v120, v120, v121
    v_mov_b32 v121, v120
    s_nop 1
    v_permlane32_swap_b32 v120, v121
    v_add_f32 v120, v120, v121
    v_max_u32 v120, s54, v120
    v_max_i32 v120, 0xa0000000, v120
    s_mov_b32 exec_hi, 0
    buffer_store_dword v120, v31, s[44:47], s58 offen sc1
    s_mov_b64 exec, -1
    s_branch L_m_j8
L_m_w1_5:
    s_waitcnt vmcnt(1)
    v_lshlrev_b32 v72, 16, v32
    v_and_b32 v73, 0xffff0000, v32
    v_lshlrev_b32 v74, 16, v33
    v_and_b32 v75, 0xffff0000, v33
    v_lshlrev_b32 v76, 16, v34
    v_and_b32 v77, 0xffff0000, v34
    v_lshlrev_b32 v78, 16, v35
    v_and_b32 v79, 0xffff0000, v35
    v_mul_f32 v88, s23, v72
    v_mul_f32 v89, s23, v73
    v_mul_f32 v90, s23, v74
    v_mul_f32 v91, s23, v75
    v_fma_f32 v92, v72, s23, -v88
    v_fma_f32 v93, v73, s23, -v89
    v_fma_f32 v94, v74, s23, -v90
    v_fma_f32 v95, v75, s23, -v91
    v_fma_f32 v92, v72, s67, v92
    v_fma_f32 v93, v73, s67, v93
    v_fma_f32 v94, v74, s67, v94
    v_fma_f32 v95, v75, s67, v95
    v_exp_f32 v72, v88
    v_exp_f32 v73, v89
    v_exp_f32 v74, v90
    v_exp_f32 v75, v91
    v_mul_f32 v92, s29, v92
    v_mul_f32 v93, s29, v93
    v_mul_f32 v94, s29, v94
    v_mul_f32 v95, s29, v95
    v_fma_f32 v72, v72, v92, v72
    v_fma_f32 v73, v73, v93, v73
    v_fma_f32 v74, v74, v94, v74
    v_fma_f32 v75, v75, v95, v75
    v_cvt_pk_bf16_f32 v88, v72, v73
    v_cvt_pk_bf16_f32 v89, v74, v75
    v_mul_f32 v76, v76, v145
    v_mul_f32 v77, v77, v145
    v_mul_f32 v78, v78, v145
    v_mul_f32 v79, v79, v145
    v_lshlrev_b32 v72, 16, v88
    v_and_b32 v73, 0xffff0000, v88
    v_lshlrev_b32 v74, 16, v89
    v_and_b32 v75, 0xffff0000, v89
    v_mul_f32 v72, v72, v145
    v_mul_f32 v73, v73, v145
    v_mul_f32 v74, v74, v145
    v_mul_f32 v75, v75, v145
    v_mul_f32 v76, 0.15915494, v76
    v_mul_f32 v77, 0.15915494, v77
    v_mul_f32 v78, 0.15915494, v78
    v_mul_f32 v79, 0.15915494, v79
    v_mul_f32 v72, 0xbfb8aa3b, v72
    v_mul_f32 v73, 0xbfb8aa3b, v73
    v_mul_f32 v74, 0xbfb8aa3b, v74
    v_mul_f32 v75, 0xbfb8aa3b, v75
    v_mov_b32 v104, 1.0
    v_mov_b32 v108, 0
    v_mov_b32 v105, 1.0
    v_mov_b32 v109, 0
    v_mov_b32 v106, 1.0
    v_mov_b32 v110, 0
    v_mov_b32 v107, 1.0
    v_mov_b32 v111, 0
    v_cvt_pk_f16_f32 v148, v104, v108
    v_cvt_pk_f16_f32 v149, v105, v109
    v_cvt_pk_f16_f32 v150, v106, v110
    v_cvt_pk_f16_f32 v151, v107, v111
    ds_write_b128 v137, v[148:151] offset:16896
    s_getpc_b64 s[56:57]
L_m_pc9:
    s_sub_u32 s56, s56, L_m_pc9-main_kernel
    s_subb_u32 s57, s57, 0
    s_bfe_u32 s58, s2, 0x50003
    s_mul_i32 s58, s58, 3072
    s_add_u32 s58, s58, 15360
    v_lshl_add_u32 v31, v0, 4, s58
    v_min_u32 v31, L_code_end-main_kernel-16, v31
    global_load_dword a255, v31, s[56:57]
    v_mul_f32 v116, s39, v76
    v_mul_f32 v117, s39, v77
    v_mul_f32 v118, s39, v78
    v_mul_f32 v119, s39, v79
    v_mul_f32 v112, s39, v72
    v_mul_f32 v113, s39, v73
    v_mul_f32 v114, s39, v74
    v_mul_f32 v115, s39, v75
    v_fract_f32 v116, v116
    v_fract_f32 v117, v117
    v_fract_f32 v118, v118
    v_fract_f32 v119, v119
    v_exp_f32 v112, v112
    v_exp_f32 v113, v113
    v_exp_f32 v114, v114
    v_exp_f32 v115, v115
    v_cos_f32 v88, v116
    v_cos_f32 v89, v117
    v_cos_f32 v90, v118
    v_cos_f32 v91, v119
    v_sin_f32 v92, v116
    v_sin_f32 v93, v117
    v_sin_f32 v94, v118
    v_sin_f32 v95, v119
    v_pk_mul_f32 v[88:89], v[88:89], v[112:113]
    v_pk_mul_f32 v[90:91], v[90:91], v[114:115]
    v_pk_mul_f32 v[92:93], v[92:93], v[112:113]
    v_pk_mul_f32 v[94:95], v[94:95], v[114:115]
    v_cvt_pk_f16_f32 v152, v88, v92
    v_cvt_pk_f16_f32 v153, v89, v93
    v_cvt_pk_f16_f32 v154, v90, v94
    v_cvt_pk_f16_f32 v155, v91, v95
    ds_write_b128 v137, v[152:155] offset:17424
    s_waitcnt vmcnt(1)
    v_lshlrev_b32 v68, 16, v66
    v_and_b32 v69, 0xffff0000, v66
    v_lshlrev_b32 v70, 16, v67
    v_and_b32 v71, 0xffff0000, v67
    v_mul_f32 v68, s23, v68
    v_mul_f32 v69, s23, v69
    v_mul_f32 v70, s23, v70
    v_mul_f32 v71, s23, v71
    v_lshlrev_b32 v64, 4, v64
    v_add_u32 v64, 96128, v64
    ds_write_b128 v64, v[68:71]
    v_pk_mul_f32 v[112:113], v[92:93], v[92:93]
    v_pk_mul_f32 v[116:117], v[88:89], v[92:93]
    v_pk_mul_f32 v[114:115], v[94:95], v[94:95]
    v_pk_mul_f32 v[118:119], v[90:91], v[94:95]
    v_pk_fma_f32 v[104:105], v[88:89], v[88:89], v[112:113] neg_lo:[0,0,1] neg_hi:[0,0,1]
    v_pk_fma_f32 v[108:109], v[92:93], v[88:89], v[116:117]
    v_pk_fma_f32 v[106:107], v[90:91], v[90:91], v[114:115] neg_lo:[0,0,1] neg_hi:[0,0,1]
    v_pk_fma_f32 v[110:111], v[94:95], v[90:91], v[118:119]
    v_cvt_pk_f16_f32 v156, v104, v108
    v_cvt_pk_f16_f32 v157, v105, v109
    v_cvt_pk_f16_f32 v158, v106, v110
    v_cvt_pk_f16_f32 v159, v107, v111
    ds_write_b128 v137, v[156:159] offset:17952
    v_pk_mul_f32 v[112:113], v[108:109], v[92:93]
    v_pk_mul_f32 v[116:117], v[104:105], v[92:93]
    v_pk_mul_f32 v[114:115], v[110:111], v[94:95]
    v_pk_mul_f32 v[118:119], v[106:107], v[94:95]
    v_pk_fma_f32 v[104:105], v[104:105], v[88:89], v[112:113] neg_lo:[0,0,1] neg_hi:[0,0,1]
    v_pk_fma_f32 v[108:109], v[108:109], v[88:89], v[116:117]
    v_pk_fma_f32 v[106:107], v[106:107], v[90:91], v[114:115] neg_lo:[0,0,1] neg_hi:[0,0,1]
    v_pk_fma_f32 v[110:111], v[110:111], v[90:91], v[118:119]
    v_cvt_pk_f16_f32 v148, v104, v108
    v_cvt_pk_f16_f32 v149, v105, v109
    v_cvt_pk_f16_f32 v150, v106, v110
    v_cvt_pk_f16_f32 v151, v107, v111
    ds_write_b128 v137, v[148:151] offset:18480
    v_pk_mul_f32 v[112:113], v[108:109], v[92:93]
    v_pk_mul_f32 v[116:117], v[104:105], v[92:93]
    v_pk_mul_f32 v[114:115], v[110:111], v[94:95]
    v_pk_mul_f32 v[118:119], v[106:107], v[94:95]
    v_pk_fma_f32 v[104:105], v[104:105], v[88:89], v[112:113] neg_lo:[0,0,1] neg_hi:[0,0,1]
    v_pk_fma_f32 v[108:109], v[108:109], v[88:89], v[116:117]
    v_pk_fma_f32 v[106:107], v[106:107], v[90:91], v[114:115] neg_lo:[0,0,1] neg_hi:[0,0,1]
    v_pk_fma_f32 v[110:111], v[110:111], v[90:91], v[118:119]
    v_cvt_pk_f16_f32 v152, v104, v108
    v_cvt_pk_f16_f32 v153, v105, v109
    v_cvt_pk_f16_f32 v154, v106, v110
    v_cvt_pk_f16_f32 v155, v107, v111
    ds_write_b128 v137, v[152:155] offset:19008
    v_pk_mul_f32 v[112:113], v[108:109], v[92:93]
    v_pk_mul_f32 v[116:117], v[104:105], v[92:93]
    v_pk_mul_f32 v[114:115], v[110:111], v[94:95]
    v_pk_mul_f32 v[118:119], v[106:107], v[94:95]
    v_pk_fma_f32 v[104:105], v[104:105], v[88:89], v[112:113] neg_lo:[0,0,1] neg_hi:[0,0,1]
    v_pk_fma_f32 v[108:109], v[108:109], v[88:89], v[116:117]
    v_pk_fma_f32 v[106:107], v[106:107], v[90:91], v[114:115] neg_lo:[0,0,1] neg_hi:[0,0,1]
    v_pk_fma_f32 v[110:111], v[110:111], v[90:91], v[118:119]
    v_cvt_pk_f16_f32 v156, v104, v108
    v_cvt_pk_f16_f32 v157, v105, v109
    v_cvt_pk_f16_f32 v158, v106, v110
    v_cvt_pk_f16_f32 v159, v107, v111
    ds_write_b128 v137, v[156:159] offset:19536
    v_pk_mul_f32 v[112:113], v[108:109], v[92:93]
    v_pk_mul_f32 v[116:117], v[104:105], v[92:93]
    v_pk_mul_f32 v[114:115], v[110:111], v[94:95]
    v_pk_mul_f32 v[118:119], v[106:107], v[94:95]
    v_pk_fma_f32 v[104:105], v[104:105], v[88:89], v[112:113] neg_lo:[0,0,1] neg_hi:[0,0,1]
    v_pk_fma_f32 v[108:109], v[108:109], v[88:89], v[116:117]
    v_pk_fma_f32 v[106:107], v[106:107], v[90:91], v[114:115] neg_lo:[0,0,1] neg_hi:[0,0,1]
    v_pk_fma_f32 v[110:111], v[110:111], v[90:91], v[118:119]
    v_cvt_pk_f16_f32 v148, v104, v108
    v_cvt_pk_f16_f32 v149, v105, v109
    v_cvt_pk_f16_f32 v150, v106, v110
    v_cvt_pk_f16_f32 v151, v107, v111
    ds_write_b128 v137, v[148:151] offset:20064
    v_pk_mul_f32 v[112:113], v[108:109], v[92:93]
    v_pk_mul_f32 v[116:117], v[104:105], v[92:93]
    v_pk_mul_f32 v[114:115], v[110:111], v[94:95]
    v_pk_mul_f32 v[118:119], v[106:107], v[94:95]
    v_pk_fma_f32 v[104:105], v[104:105], v[88:89], v[112:113] neg_lo:[0,0,1] neg_hi:[0,0,1]
    v_pk_fma_f32 v[108:109], v[108:109], v[88:89], v[116:117]
    v_pk_fma_f32 v[106:107], v[106:107], v[90:91], v[114:115] neg_lo:[0,0,1] neg_hi:[0,0,1]
    v_pk_fma_f32 v[110:111], v[110:111], v[90:91], v[118:119]
    v_cvt_pk_f16_f32 v152, v104, v108
    v_cvt_pk_f16_f32 v153, v105, v109
    v_cvt_pk_f16_f32 v154, v106, v110
    v_cvt_pk_f16_f32 v155, v107, v111
    ds_write_b128 v137, v[152:155] offset:20592
    v_pk_mul_f32 v[112:113], v[108:109], v[92:93]
    v_pk_mul_f32 v[116:117], v[104:105], v[92:93]
    v_pk_mul_f32 v[114:115], v[110:111], v[94:95]
    v_pk_mul_f32 v[118:119], v[106:107], v[94:95]
    v_pk_fma_f32 v[104:105], v[104:105], v[88:89], v[112:113] neg_lo:[0,0,1] neg_hi:[0,0,1]
    v_pk_fma_f32 v[108:109], v[108:109], v[88:89], v[116:117]
    v_pk_fma_f32 v[106:107], v[106:107], v[90:91], v[114:115] neg_lo:[0,0,1] neg_hi:[0,0,1]
    v_pk_fma_f32 v[110:111], v[110:111], v[90:91], v[118:119]
    v_cvt_pk_f16_f32 v156, v104, v108
    v_cvt_pk_f16_f32 v157, v105, v109
    v_cvt_pk_f16_f32 v158, v106, v110
    v_cvt_pk_f16_f32 v159, v107, v111
    ds_write_b128 v137, v[156:159] offset:21120
    v_pk_mul_f32 v[112:113], v[108:109], v[92:93]
    v_pk_mul_f32 v[116:117], v[104:105], v[92:93]
    v_pk_mul_f32 v[114:115], v[110:111], v[94:95]
    v_pk_mul_f32 v[118:119], v[106:107], v[94:95]
    v_pk_fma_f32 v[104:105], v[104:105], v[88:89], v[112:113] neg_lo:[0,0,1] neg_hi:[0,0,1]
    v_pk_fma_f32 v[108:109], v[108:109], v[88:89], v[116:117]
    v_pk_fma_f32 v[106:107], v[106:107], v[90:91], v[114:115] neg_lo:[0,0,1] neg_hi:[0,0,1]
    v_pk_fma_f32 v[110:111], v[110:111], v[90:91], v[118:119]
    v_cvt_pk_f16_f32 v148, v104, v108
    v_cvt_pk_f16_f32 v149, v105, v109
    v_cvt_pk_f16_f32 v150, v106, v110
    v_cvt_pk_f16_f32 v151, v107, v111
    ds_write_b128 v137, v[148:151] offset:21648
    v_pk_mul_f32 v[112:113], v[108:109], v[92:93]
    v_pk_mul_f32 v[116:117], v[104:105], v[92:93]
    v_pk_mul_f32 v[114:115], v[110:111], v[94:95]
    v_pk_mul_f32 v[118:119], v[106:107], v[94:95]
    v_pk_fma_f32 v[104:105], v[104:105], v[88:89], v[112:113] neg_lo:[0,0,1] neg_hi:[0,0,1]
    v_pk_fma_f32 v[108:109], v[108:109], v[88:89], v[116:117]
    v_pk_fma_f32 v[106:107], v[106:107], v[90:91], v[114:115] neg_lo:[0,0,1] neg_hi:[0,0,1]
    v_pk_fma_f32 v[110:111], v[110:111], v[90:91], v[118:119]
    v_cvt_pk_f16_f32 v152, v104, v108
    v_cvt_pk_f16_f32 v153, v105, v109
    v_cvt_pk_f16_f32 v154, v106, v110
    v_cvt_pk_f16_f32 v155, v107, v111
    ds_write_b128 v137, v[152:155] offset:22176
    v_pk_mul_f32 v[112:113], v[108:109], v[92:93]
    v_pk_mul_f32 v[116:117], v[104:105], v[92:93]
    v_pk_mul_f32 v[114:115], v[110:111], v[94:95]
    v_pk_mul_f32 v[118:119], v[106:107], v[94:95]
    v_pk_fma_f32 v[104:105], v[104:105], v[88:89], v[112:113] neg_lo:[0,0,1] neg_hi:[0,0,1]
    v_pk_fma_f32 v[108:109], v[108:109], v[88:89], v[116:117]
    v_pk_fma_f32 v[106:107], v[106:107], v[90:91], v[114:115] neg_lo:[0,0,1] neg_hi:[0,0,1]
    v_pk_fma_f32 v[110:111], v[110:111], v[90:91], v[118:119]
    v_cvt_pk_f16_f32 v156, v104, v108
    v_cvt_pk_f16_f32 v157, v105, v109
    v_cvt_pk_f16_f32 v158, v106, v110
    v_cvt_pk_f16_f32 v159, v107, v111
    ds_write_b128 v137, v[156:159] offset:22704
    v_pk_mul_f32 v[112:113], v[108:109], v[92:93]
    v_pk_mul_f32 v[116:117], v[104:105], v[92:93]
    v_pk_mul_f32 v[114:115], v[110:111], v[94:95]
    v_pk_mul_f32 v[118:119], v[106:107], v[94:95]
    v_pk_fma_f32 v[104:105], v[104:105], v[88:89], v[112:113] neg_lo:[0,0,1] neg_hi:[0,0,1]
    v_pk_fma_f32 v[108:109], v[108:109], v[88:89], v[116:117]
    v_pk_fma_f32 v[106:107], v[106:107], v[90:91], v[114:115] neg_lo:[0,0,1] neg_hi:[0,0,1]
    v_pk_fma_f32 v[110:111], v[110:111], v[90:91], v[118:119]
    v_cvt_pk_f16_f32 v148, v104, v108
    v_cvt_pk_f16_f32 v149, v105, v109
    v_cvt_pk_f16_f32 v150, v106, v110
    v_cvt_pk_f16_f32 v151, v107, v111
    ds_write_b128 v137, v[148:151] offset:23232
    v_pk_mul_f32 v[112:113], v[108:109], v[92:93]
    v_pk_mul_f32 v[116:117], v[104:105], v[92:93]
    v_pk_mul_f32 v[114:115], v[110:111], v[94:95]
    v_pk_mul_f32 v[118:119], v[106:107], v[94:95]
    v_pk_fma_f32 v[104:105], v[104:105], v[88:89], v[112:113] neg_lo:[0,0,1] neg_hi:[0,0,1]
    v_pk_fma_f32 v[108:109], v[108:109], v[88:89], v[116:117]
    v_pk_fma_f32 v[106:107], v[106:107], v[90:91], v[114:115] neg_lo:[0,0,1] neg_hi:[0,0,1]
    v_pk_fma_f32 v[110:111], v[110:111], v[90:91], v[118:119]
    v_cvt_pk_f16_f32 v152, v104, v108
    v_cvt_pk_f16_f32 v153, v105, v109
    v_cvt_pk_f16_f32 v154, v106, v110
    v_cvt_pk_f16_f32 v155, v107, v111
    ds_write_b128 v137, v[152:155] offset:23760
    v_pk_mul_f32 v[112:113], v[108:109], v[92:93]
    v_pk_mul_f32 v[116:117], v[104:105], v[92:93]
    v_pk_mul_f32 v[114:115], v[110:111], v[94:95]
    v_pk_mul_f32 v[118:119], v[106:107], v[94:95]
    v_pk_fma_f32 v[104:105], v[104:105], v[88:89], v[112:113] neg_lo:[0,0,1] neg_hi:[0,0,1]
    v_pk_fma_f32 v[108:109], v[108:109], v[88:89], v[116:117]
    v_pk_fma_f32 v[106:107], v[106:107], v[90:91], v[114:115] neg_lo:[0,0,1] neg_hi:[0,0,1]
    v_pk_fma_f32 v[110:111], v[110:111], v[90:91], v[118:119]
    v_cvt_pk_f16_f32 v156, v104, v108
    v_cvt_pk_f16_f32 v157, v105, v109
    v_cvt_pk_f16_f32 v158, v106, v110
    v_cvt_pk_f16_f32 v159, v107, v111
    ds_write_b128 v137, v[156:159] offset:24288
    v_pk_mul_f32 v[112:113], v[108:109], v[92:93]
    v_pk_mul_f32 v[116:117], v[104:105], v[92:93]
    v_pk_mul_f32 v[114:115], v[110:111], v[94:95]
    v_pk_mul_f32 v[118:119], v[106:107], v[94:95]
    v_pk_fma_f32 v[104:105], v[104:105], v[88:89], v[112:113] neg_lo:[0,0,1] neg_hi:[0,0,1]
    v_pk_fma_f32 v[108:109], v[108:109], v[88:89], v[116:117]
    v_pk_fma_f32 v[106:107], v[106:107], v[90:91], v[114:115] neg_lo:[0,0,1] neg_hi:[0,0,1]
    v_pk_fma_f32 v[110:111], v[110:111], v[90:91], v[118:119]
    v_cvt_pk_f16_f32 v148, v104, v108
    v_cvt_pk_f16_f32 v149, v105, v109
    v_cvt_pk_f16_f32 v150, v106, v110
    v_cvt_pk_f16_f32 v151, v107, v111
    ds_write_b128 v137, v[148:151] offset:24816
    v_pk_mul_f32 v[112:113], v[108:109], v[92:93]
    v_pk_mul_f32 v[116:117], v[104:105], v[92:93]
    v_pk_mul_f32 v[114:115], v[110:111], v[94:95]
    v_pk_mul_f32 v[118:119], v[106:107], v[94:95]
    v_pk_fma_f32 v[104:105], v[104:105], v[88:89], v[112:113] neg_lo:[0,0,1] neg_hi:[0,0,1]
    v_pk_fma_f32 v[108:109], v[108:109], v[88:89], v[116:117]
    v_pk_fma_f32 v[106:107], v[106:107], v[90:91], v[114:115] neg_lo:[0,0,1] neg_hi:[0,0,1]
    v_pk_fma_f32 v[110:111], v[110:111], v[90:91], v[118:119]
    v_cvt_pk_f16_f32 v152, v104, v108
    v_cvt_pk_f16_f32 v153, v105, v109
    v_cvt_pk_f16_f32 v154, v106, v110
    v_cvt_pk_f16_f32 v155, v107, v111
    ds_write_b128 v137, v[152:155] offset:25344
    v_pk_mul_f32 v[112:113], v[108:109], v[92:93]
    v_pk_mul_f32 v[116:117], v[104:105], v[92:93]
    v_pk_mul_f32 v[114:115], v[110:111], v[94:95]
    v_pk_mul_f32 v[118:119], v[106:107], v[94:95]
    v_pk_fma_f32 v[104:105], v[104:105], v[88:89], v[112:113] neg_lo:[0,0,1] neg_hi:[0,0,1]
    v_pk_fma_f32 v[108:109], v[108:109], v[88:89], v[116:117]
    v_pk_fma_f32 v[106:107], v[106:107], v[90:91], v[114:115] neg_lo:[0,0,1] neg_hi:[0,0,1]
    v_pk_fma_f32 v[110:111], v[110:111], v[90:91], v[118:119]
    v_cvt_pk_f16_f32 v156, v104, v108
    v_cvt_pk_f16_f32 v157, v105, v109
    v_cvt_pk_f16_f32 v158, v106, v110
    v_cvt_pk_f16_f32 v159, v107, v111
    ds_write_b128 v137, v[156:159] offset:25872
    v_pk_mul_f32 v[112:113], v[108:109], v[92:93]
    v_pk_mul_f32 v[116:117], v[104:105], v[92:93]
    v_pk_mul_f32 v[114:115], v[110:111], v[94:95]
    v_pk_mul_f32 v[118:119], v[106:107], v[94:95]
    v_pk_fma_f32 v[104:105], v[104:105], v[88:89], v[112:113] neg_lo:[0,0,1] neg_hi:[0,0,1]
    v_pk_fma_f32 v[108:109], v[108:109], v[88:89], v[116:117]
    v_pk_fma_f32 v[106:107], v[106:107], v[90:91], v[114:115] neg_lo:[0,0,1] neg_hi:[0,0,1]
    v_pk_fma_f32 v[110:111], v[110:111], v[90:91], v[118:119]
    v_cvt_pk_f16_f32 v148, v104, v108
    v_cvt_pk_f16_f32 v149, v105, v109
    v_cvt_pk_f16_f32 v150, v106, v110
    v_cvt_pk_f16_f32 v151, v107, v111
    ds_write_b128 v137, v[148:151] offset:26400
    v_pk_mul_f32 v[112:113], v[108:109], v[92:93]
    v_pk_mul_f32 v[116:117], v[104:105], v[92:93]
    v_pk_mul_f32 v[114:115], v[110:111], v[94:95]
    v_pk_mul_f32 v[118:119], v[106:107], v[94:95]
    v_pk_fma_f32 v[104:105], v[104:105], v[88:89], v[112:113] neg_lo:[0,0,1] neg_hi:[0,0,1]
    v_pk_fma_f32 v[108:109], v[108:109], v[88:89], v[116:117]
    v_pk_fma_f32 v[106:107], v[106:107], v[90:91], v[114:115] neg_lo:[0,0,1] neg_hi:[0,0,1]
    v_pk_fma_f32 v[110:111], v[110:111], v[90:91], v[118:119]
    v_cvt_pk_f16_f32 v152, v104, v108
    v_cvt_pk_f16_f32 v153, v105, v109
    v_cvt_pk_f16_f32 v154, v106, v110
    v_cvt_pk_f16_f32 v155, v107, v111
    ds_write_b128 v137, v[152:155] offset:26928
    v_pk_mul_f32 v[112:113], v[108:109], v[92:93]
    v_pk_mul_f32 v[116:117], v[104:105], v[92:93]
    v_pk_mul_f32 v[114:115], v[110:111], v[94:95]
    v_pk_mul_f32 v[118:119], v[106:107], v[94:95]
    v_pk_fma_f32 v[104:105], v[104:105], v[88:89], v[112:113] neg_lo:[0,0,1] neg_hi:[0,0,1]
    v_pk_fma_f32 v[108:109], v[108:109], v[88:89], v[116:117]
    v_pk_fma_f32 v[106:107], v[106:107], v[90:91], v[114:115] neg_lo:[0,0,1] neg_hi:[0,0,1]
    v_pk_fma_f32 v[110:111], v[110:111], v[90:91], v[118:119]
    v_cvt_pk_f16_f32 v156, v104, v108
    v_cvt_pk_f16_f32 v157, v105, v109
    v_cvt_pk_f16_f32 v158, v106, v110
    v_cvt_pk_f16_f32 v159, v107, v111
    ds_write_b128 v137, v[156:159] offset:27456
    s_branch L_m_j8
L_m_w2_6:
    s_waitcnt vmcnt(1)
    v_lshlrev_b32 v72, 16, v32
    v_and_b32 v73, 0xffff0000, v32
    v_lshlrev_b32 v74, 16, v33
    v_and_b32 v75, 0xffff0000, v33
    v_lshlrev_b32 v76, 16, v34
    v_and_b32 v77, 0xffff0000, v34
    v_lshlrev_b32 v78, 16, v35
    v_and_b32 v79, 0xffff0000, v35
    v_lshlrev_b32 v80, 16, v36
    v_and_b32 v81, 0xffff0000, v36
    v_lshlrev_b32 v82, 16, v37
    v_and_b32 v83, 0xffff0000, v37
    v_lshlrev_b32 v84, 16, v38
    v_and_b32 v85, 0xffff0000, v38
    v_lshlrev_b32 v86, 16, v39
    v_and_b32 v87, 0xffff0000, v39
    v_mul_f32 v88, s23, v72
    v_mul_f32 v89, s23, v73
    v_mul_f32 v90, s23, v74
    v_mul_f32 v91, s23, v75
    v_fma_f32 v92, v72, s23, -v88
    v_fma_f32 v93, v73, s23, -v89
    v_fma_f32 v94, v74, s23, -v90
    v_fma_f32 v95, v75, s23, -v91
    v_fma_f32 v92, v72, s67, v92
    v_fma_f32 v93, v73, s67, v93
    v_fma_f32 v94, v74, s67, v94
    v_fma_f32 v95, v75, s67, v95
    v_exp_f32 v72, v88
    v_exp_f32 v73, v89
    v_exp_f32 v74, v90
    v_exp_f32 v75, v91
    v_mul_f32 v92, s29, v92
    v_mul_f32 v93, s29, v93
    v_mul_f32 v94, s29, v94
    v_mul_f32 v95, s29, v95
    v_fma_f32 v72, v72, v92, v72
    v_fma_f32 v73, v73, v93, v73
    v_fma_f32 v74, v74, v94, v74
    v_fma_f32 v75, v75, v95, v75
    v_max3_f32 v96, |v80|, |v81|, |v82|
    v_max3_f32 v97, |v84|, |v85|, |v86|
    v_max3_f32 v96, v96, |v83|, |v87|
    v_max_f32 v96, v96, v97
    v_cvt_pk_bf16_f32 v88, v72, v73
    v_cvt_pk_bf16_f32 v89, v74, v75
    v_max_u32_dpp v96, v96, v96 row_shr:1 row_mask:0xf bank_mask:0xf
    v_lshlrev_b32 v72, 16, v88
    v_and_b32 v73, 0xffff0000, v88
    v_lshlrev_b32 v74, 16, v89
    v_and_b32 v75, 0xffff0000, v89
    v_max_u32_dpp v96, v96, v96 row_shr:2 row_mask:0xf bank_mask:0xf
    v_mul_f32 v72, v72, v145
    v_mul_f32 v73, v73, v145
    v_mul_f32 v74, v74, v145
    v_mul_f32 v75, v75, v145
    v_max_u32_dpp v96, v96, v96 row_shr:4 row_mask:0xf bank_mask:0xf
    v_mul_f32 v76, v76, v145
    v_mul_f32 v77, v77, v145
    v_mul_f32 v78, v78, v145
    v_mul_f32 v79, v79, v145
    v_max_u32_dpp v96, v96, v96 row_shr:8 row_mask:0xf bank_mask:0xf
    v_mul_f32 v72, 0xbfb8aa3b, v72
    v_mul_f32 v73, 0xbfb8aa3b, v73
    v_mul_f32 v74, 0xbfb8aa3b, v74
    v_mul_f32 v75, 0xbfb8aa3b, v75
    v_max_u32_dpp v96, v96, v96 row_bcast:15 row_mask:0xa bank_mask:0xf
    v_mul_f32 v76, 0.15915494, v76
    v_mul_f32 v77, 0.15915494, v77
    v_mul_f32 v78, 0.15915494, v78
    v_mul_f32 v79, 0.15915494, v79
    v_readlane_b32 s56, v96, 31
    v_readlane_b32 s57, v96, 63
    s_nop 0
    v_mov_b32 v96, s56
    v_mov_b32 v97, s57
    v_cndmask_b32 v96, v96, v97, s[68:69]
    v_lshrrev_b32 v96, 23, v96
    v_max_u32 v96, 1, v96
    v_min_u32 v96, 253, v96
    v_sub_u32 v97, 254, v96
    v_lshlrev_b32 v97, 23, v97
    v_add_u32 v96, 1, v96
    v_lshlrev_b32 v96, 23, v96
    v_mul_f32 v146, v96, v145
    v_mul_f32 v80, v97, v80
    v_mul_f32 v81, v97, v81
    v_mul_f32 v82, v97, v82
    v_mul_f32 v83, v97, v83
    v_mul_f32 v84, v97, v84
    v_mul_f32 v85, v97, v85
    v_mul_f32 v86, v97, v86
    v_mul_f32 v87, v97, v87
    v_lshrrev_b32 v31, 5, v1
    v_lshlrev_b32 v31, 2, v31
    ds_write_b32 v31, v146 offset:21248
    v_mul_f32 v116, 1.0, v76
    v_mul_f32 v117, 1.0, v77
    v_mul_f32 v118, 1.0, v78
    v_mul_f32 v119, 1.0, v79
    v_mul_f32 v112, 1.0, v72
    v_mul_f32 v113, 1.0, v73
    v_mul_f32 v114, 1.0, v74
    v_mul_f32 v115, 1.0, v75
    v_fract_f32 v116, v116
    v_fract_f32 v117, v117
    v_fract_f32 v118, v118
    v_fract_f32 v119, v119
    v_exp_f32 v112, v112
    v_exp_f32 v113, v113
    v_exp_f32 v114, v114
    v_exp_f32 v115, v115
    v_cos_f32 v88, v116
    v_cos_f32 v89, v117
    v_cos_f32 v90, v118
    v_cos_f32 v91, v119
    v_sin_f32 v92, v116
    v_sin_f32 v93, v117
    v_sin_f32 v94, v118
    v_sin_f32 v95, v119
    v_pk_mul_f32 v[88:89], v[88:89], v[112:113]
    v_pk_mul_f32 v[90:91], v[90:91], v[114:115]
    v_pk_mul_f32 v[92:93], v[92:93], v[112:113]
    v_pk_mul_f32 v[94:95], v[94:95], v[114:115]
    v_mul_f32 v116, 0x43800000, v76
    v_mul_f32 v117, 0x43800000, v77
    v_mul_f32 v118, 0x43800000, v78
    v_mul_f32 v119, 0x43800000, v79
    v_mul_f32 v112, 0x43800000, v72
    v_mul_f32 v113, 0x43800000, v73
    v_mul_f32 v114, 0x43800000, v74
    v_mul_f32 v115, 0x43800000, v75
    v_fract_f32 v116, v116
    v_fract_f32 v117, v117
    v_fract_f32 v118, v118
    v_fract_f32 v119, v119
    v_exp_f32 v112, v112
    v_exp_f32 v113, v113
    v_exp_f32 v114, v114
    v_exp_f32 v115, v115
    v_cos_f32 v96, v116
    v_cos_f32 v97, v117
    v_cos_f32 v98, v118
    v_cos_f32 v99, v119
    v_sin_f32 v100, v116
    v_sin_f32 v101, v117
    v_sin_f32 v102, v118
    v_sin_f32 v103, v119
    v_pk_mul_f32 v[96:97], v[96:97], v[112:113]
    v_pk_mul_f32 v[98:99], v[98:99], v[114:115]
    v_pk_mul_f32 v[100:101], v[100:101], v[112:113]
    v_pk_mul_f32 v[102:103], v[102:103], v[114:115]
    v_cvt_pk_f16_f32 v148, v80, -v84
    v_cvt_pk_f16_f32 v149, v81, -v85
    v_cvt_pk_f16_f32 v150, v82, -v86
    v_cvt_pk_f16_f32 v151, v83, -v87
    ds_write_b128 v137, v[148:151] offset:0
    s_getpc_b64 s[56:57]
L_m_pc10:
    s_sub_u32 s56, s56, L_m_pc10-main_kernel
    s_subb_u32 s57, s57, 0
    s_bfe_u32 s58, s2, 0x50003
    s_mul_i32 s58, s58, 3072
    s_add_u32 s58, s58, 15360
    v_lshl_add_u32 v31, v0, 4, s58
    v_min_u32 v31, L_code_end-main_kernel-16, v31
    global_load_dword a255, v31, s[56:57]
    v_pk_mul_f32 v[48:49], v[84:85], v[100:101]
    v_pk_mul_f32 v[52:53], v[80:81], v[100:101]
    v_pk_mul_f32 v[50:51], v[86:87], v[102:103]
    v_pk_mul_f32 v[54:55], v[82:83], v[102:103]
    v_pk_fma_f32 v[40:41], v[80:81], v[96:97], v[48:49] neg_lo:[0,0,1] neg_hi:[0,0,1]
    v_pk_fma_f32 v[44:45], v[84:85], v[96:97], v[52:53]
    v_pk_fma_f32 v[42:43], v[82:83], v[98:99], v[50:51] neg_lo:[0,0,1] neg_hi:[0,0,1]
    v_pk_fma_f32 v[46:47], v[86:87], v[98:99], v[54:55]
    v_cvt_pk_f16_f32 v152, v40, -v44
    v_cvt_pk_f16_f32 v153, v41, -v45
    v_cvt_pk_f16_f32 v154, v42, -v46
    v_cvt_pk_f16_f32 v155, v43, -v47
    ds_write_b128 v137, v[152:155] offset:4224
    v_pk_mul_f32 v[112:113], v[84:85], v[92:93]
    v_pk_mul_f32 v[116:117], v[80:81], v[92:93]
    v_pk_mul_f32 v[114:115], v[86:87], v[94:95]
    v_pk_mul_f32 v[118:119], v[82:83], v[94:95]
    v_pk_fma_f32 v[104:105], v[80:81], v[88:89], v[112:113] neg_lo:[0,0,1] neg_hi:[0,0,1]
    v_pk_fma_f32 v[108:109], v[84:85], v[88:89], v[116:117]
    v_pk_fma_f32 v[106:107], v[82:83], v[90:91], v[114:115] neg_lo:[0,0,1] neg_hi:[0,0,1]
    v_pk_fma_f32 v[110:111], v[86:87], v[90:91], v[118:119]
    v_cvt_pk_f16_f32 v156, v104, -v108
    v_cvt_pk_f16_f32 v157, v105, -v109
    v_cvt_pk_f16_f32 v158, v106, -v110
    v_cvt_pk_f16_f32 v159, v107, -v111
    ds_write_b128 v137, v[156:159] offset:528
    v_pk_mul_f32 v[112:113], v[108:109], v[92:93]
    v_pk_mul_f32 v[116:117], v[104:105], v[92:93]
    v_pk_mul_f32 v[114:115], v[110:111], v[94:95]
    v_pk_mul_f32 v[118:119], v[106:107], v[94:95]
    v_pk_fma_f32 v[104:105], v[104:105], v[88:89], v[112:113] neg_lo:[0,0,1] neg_hi:[0,0,1]
    v_pk_fma_f32 v[108:109], v[108:109], v[88:89], v[116:117]
    v_pk_fma_f32 v[106:107], v[106:107], v[90:91], v[114:115] neg_lo:[0,0,1] neg_hi:[0,0,1]
    v_pk_fma_f32 v[110:111], v[110:111], v[90:91], v[118:119]
    v_cvt_pk_f16_f32 v148, v104, -v108
    v_cvt_pk_f16_f32 v149, v105, -v109
    v_cvt_pk_f16_f32 v150, v106, -v110
    v_cvt_pk_f16_f32 v151, v107, -v111
    ds_write_b128 v137, v[148:151] offset:1056
    v_pk_mul_f32 v[48:49], v[108:109], v[100:101]
    v_pk_mul_f32 v[52:53], v[104:105], v[100:101]
    v_pk_mul_f32 v[50:51], v[110:111], v[102:103]
    v_pk_mul_f32 v[54:55], v[106:107], v[102:103]
    v_pk_fma_f32 v[40:41], v[104:105], v[96:97], v[48:49] neg_lo:[0,0,1] neg_hi:[0,0,1]
    v_pk_fma_f32 v[44:45], v[108:109], v[96:97], v[52:53]
    v_pk_fma_f32 v[42:43], v[106:107], v[98:99], v[50:51] neg_lo:[0,0,1] neg_hi:[0,0,1]
    v_pk_fma_f32 v[46:47], v[110:111], v[98:99], v[54:55]
    v_cvt_pk_f16_f32 v152, v40, -v44
    v_cvt_pk_f16_f32 v153, v41, -v45
    v_cvt_pk_f16_f32 v154, v42, -v46
    v_cvt_pk_f16_f32 v155, v43, -v47
    ds_write_b128 v137, v[152:155] offset:4752
    v_pk_mul_f32 v[112:113], v[108:109], v[92:93]
    v_pk_mul_f32 v[116:117], v[104:105], v[92:93]
    v_pk_mul_f32 v[114:115], v[110:111], v[94:95]
    v_pk_mul_f32 v[118:119], v[106:107], v[94:95]
    v_pk_fma_f32 v[104:105], v[104:105], v[88:89], v[112:113] neg_lo:[0,0,1] neg_hi:[0,0,1]
    v_pk_fma_f32 v[108:109], v[108:109], v[88:89], v[116:117]
    v_pk_fma_f32 v[106:107], v[106:107], v[90:91], v[114:115] neg_lo:[0,0,1] neg_hi:[0,0,1]
    v_pk_fma_f32 v[110:111], v[110:111], v[90:91], v[118:119]
    v_cvt_pk_f16_f32 v156, v104, -v108
    v_cvt_pk_f16_f32 v157, v105, -v109
    v_cvt_pk_f16_f32 v158, v106, -v110
    v_cvt_pk_f16_f32 v159, v107, -v111
    ds_write_b128 v137, v[156:159] offset:1584
    v_pk_mul_f32 v[112:113], v[108:109], v[92:93]
    v_pk_mul_f32 v[116:117], v[104:105], v[92:93]
    v_pk_mul_f32 v[114:115], v[110:111], v[94:95]
    v_pk_mul_f32 v[118:119], v[106:107], v[94:95]
    v_pk_fma_f32 v[104:105], v[104:105], v[88:89], v[112:113] neg_lo:[0,0,1] neg_hi:[0,0,1]
    v_pk_fma_f32 v[108:109], v[108:109], v[88:89], v[116:117]
    v_pk_fma_f32 v[106:107], v[106:107], v[90:91], v[114:115] neg_lo:[0,0,1] neg_hi:[0,0,1]
    v_pk_fma_f32 v[110:111], v[110:111], v[90:91], v[118:119]
    v_cvt_pk_f16_f32 v148, v104, -v108
    v_cvt_pk_f16_f32 v149, v105, -v109
    v_cvt_pk_f16_f32 v150, v106, -v110
    v_cvt_pk_f16_f32 v151, v107, -v111
    ds_write_b128 v137, v[148:151] offset:2112
    v_pk_mul_f32 v[48:49], v[108:109], v[100:101]
    v_pk_mul_f32 v[52:53], v[104:105], v[100:101]
    v_pk_mul_f32 v[50:51], v[110:111], v[102:103]
    v_pk_mul_f32 v[54:55], v[106:107], v[102:103]
    v_pk_fma_f32 v[40:41], v[104:105], v[96:97], v[48:49] neg_lo:[0,0,1] neg_hi:[0,0,1]
    v_pk_fma_f32 v[44:45], v[108:109], v[96:97], v[52:53]
    v_pk_fma_f32 v[42:43], v[106:107], v[98:99], v[50:51] neg_lo:[0,0,1] neg_hi:[0,0,1]
    v_pk_fma_f32 v[46:47], v[110:111], v[98:99], v[54:55]
    v_cvt_pk_f16_f32 v152, v40, -v44
    v_cvt_pk_f16_f32 v153, v41, -v45
    v_cvt_pk_f16_f32 v154, v42, -v46
    v_cvt_pk_f16_f32 v155, v43, -v47
    ds_write_b128 v137, v[152:155] offset:5280
    v_pk_mul_f32 v[112:113], v[108:109], v[92:93]
    v_pk_mul_f32 v[116:117], v[104:105], v[92:93]
    v_pk_mul_f32 v[114:115], v[110:111], v[94:95]
    v_pk_mul_f32 v[118:119], v[106:107], v[94:95]
    v_pk_fma_f32 v[104:105], v[104:105], v[88:89], v[112:113] neg_lo:[0,0,1] neg_hi:[0,0,1]
    v_pk_fma_f32 v[108:109], v[108:109], v[88:89], v[116:117]
    v_pk_fma_f32 v[106:107], v[106:107], v[90:91], v[114:115] neg_lo:[0,0,1] neg_hi:[0,0,1]
    v_pk_fma_f32 v[110:111], v[110:111], v[90:91], v[118:119]
    v_cvt_pk_f16_f32 v156, v104, -v108
    v_cvt_pk_f16_f32 v157, v105, -v109
    v_cvt_pk_f16_f32 v158, v106, -v110
    v_cvt_pk_f16_f32 v159, v107, -v111
    ds_write_b128 v137, v[156:159] offset:2640
    v_pk_mul_f32 v[112:113], v[108:109], v[92:93]
    v_pk_mul_f32 v[116:117], v[104:105], v[92:93]
    v_pk_mul_f32 v[114:115], v[110:111], v[94:95]
    v_pk_mul_f32 v[118:119], v[106:107], v[94:95]
    v_pk_fma_f32 v[104:105], v[104:105], v[88:89], v[112:113] neg_lo:[0,0,1] neg_hi:[0,0,1]
    v_pk_fma_f32 v[108:109], v[108:109], v[88:89], v[116:117]
    v_pk_fma_f32 v[106:107], v[106:107], v[90:91], v[114:115] neg_lo:[0,0,1] neg_hi:[0,0,1]
    v_pk_fma_f32 v[110:111], v[110:111], v[90:91], v[118:119]
    v_cvt_pk_f16_f32 v148, v104, -v108
    v_cvt_pk_f16_f32 v149, v105, -v109
    v_cvt_pk_f16_f32 v150, v106, -v110
    v_cvt_pk_f16_f32 v151, v107, -v111
    ds_write_b128 v137, v[148:151] offset:3168
    v_pk_mul_f32 v[48:49], v[108:109], v[100:101]
    v_pk_mul_f32 v[52:53], v[104:105], v[100:101]
    v_pk_mul_f32 v[50:51], v[110:111], v[102:103]
    v_pk_mul_f32 v[54:55], v[106:107], v[102:103]
    v_pk_fma_f32 v[40:41], v[104:105], v[96:97], v[48:49] neg_lo:[0,0,1] neg_hi:[0,0,1]
    v_pk_fma_f32 v[44:45], v[108:109], v[96:97], v[52:53]
    v_pk_fma_f32 v[42:43], v[106:107], v[98:99], v[50:51] neg_lo:[0,0,1] neg_hi:[0,0,1]
    v_pk_fma_f32 v[46:47], v[110:111], v[98:99], v[54:55]
    v_cvt_pk_f16_f32 v152, v40, -v44
    v_cvt_pk_f16_f32 v153, v41, -v45
    v_cvt_pk_f16_f32 v154, v42, -v46
    v_cvt_pk_f16_f32 v155, v43, -v47
    ds_write_b128 v137, v[152:155] offset:5808
    v_pk_mul_f32 v[112:113], v[108:109], v[92:93]
    v_pk_mul_f32 v[116:117], v[104:105], v[92:93]
    v_pk_mul_f32 v[114:115], v[110:111], v[94:95]
    v_pk_mul_f32 v[118:119], v[106:107], v[94:95]
    v_pk_fma_f32 v[104:105], v[104:105], v[88:89], v[112:113] neg_lo:[0,0,1] neg_hi:[0,0,1]
    v_pk_fma_f32 v[108:109], v[108:109], v[88:89], v[116:117]
    v_pk_fma_f32 v[106:107], v[106:107], v[90:91], v[114:115] neg_lo:[0,0,1] neg_hi:[0,0,1]
    v_pk_fma_f32 v[110:111], v[110:111], v[90:91], v[118:119]
    v_cvt_pk_f16_f32 v156, v104, -v108
    v_cvt_pk_f16_f32 v157, v105, -v109
    v_cvt_pk_f16_f32 v158, v106, -v110
    v_cvt_pk_f16_f32 v159, v107, -v111
    ds_write_b128 v137, v[156:159] offset:3696
    v_mul_f32 v116, s39, v76
    v_mul_f32 v117, s39, v77
    v_mul_f32 v118, s39, v78
    v_mul_f32 v119, s39, v79
    v_mul_f32 v112, s39, v72
    v_mul_f32 v113, s39, v73
    v_mul_f32 v114, s39, v74
    v_mul_f32 v115, s39, v75
    v_fract_f32 v116, v116
    v_fract_f32 v117, v117
    v_fract_f32 v118, v118
    v_fract_f32 v119, v119
    v_exp_f32 v112, v112
    v_exp_f32 v113, v113
    v_exp_f32 v114, v114
    v_exp_f32 v115, v115
    v_cos_f32 v96, v116
    v_cos_f32 v97, v117
    v_cos_f32 v98, v118
    v_cos_f32 v99, v119
    v_sin_f32 v100, v116
    v_sin_f32 v101, v117
    v_sin_f32 v102, v118
    v_sin_f32 v103, v119
    v_pk_mul_f32 v[96:97], v[96:97], v[112:113]
    v_pk_mul_f32 v[98:99], v[98:99], v[114:115]
    v_pk_mul_f32 v[100:101], v[100:101], v[112:113]
    v_pk_mul_f32 v[102:103], v[102:103], v[114:115]
    s_mov_b32 s56, 0x43280000
    v_mul_f32 v116, s56, v76
    v_mul_f32 v117, s56, v77
    v_mul_f32 v118, s56, v78
    v_mul_f32 v119, s56, v79
    v_mul_f32 v112, s56, v72
    v_mul_f32 v113, s56, v73
    v_mul_f32 v114, s56, v74
    v_mul_f32 v115, s56, v75
    v_fract_f32 v116, v116
    v_fract_f32 v117, v117
    v_fract_f32 v118, v118
    v_fract_f32 v119, v119
    v_exp_f32 v112, v112
    v_exp_f32 v113, v113
    v_exp_f32 v114, v114
    v_exp_f32 v115, v115
    v_cos_f32 v104, v116
    v_cos_f32 v105, v117
    v_cos_f32 v106, v118
    v_cos_f32 v107, v119
    v_sin_f32 v108, v116
    v_sin_f32 v109, v117
    v_sin_f32 v110, v118
    v_sin_f32 v111, v119
    v_pk_mul_f32 v[104:105], v[104:105], v[112:113]
    v_pk_mul_f32 v[106:107], v[106:107], v[114:115]
    v_pk_mul_f32 v[108:109], v[108:109], v[112:113]
    v_pk_mul_f32 v[110:111], v[110:111], v[114:115]
    v_cvt_pk_f16_f32 v148, v104, v108
    v_cvt_pk_f16_f32 v149, v105, v109
    v_cvt_pk_f16_f32 v150, v106, v110
    v_cvt_pk_f16_f32 v151, v107, v111
    ds_write_b128 v137, v[148:151] offset:27984
    v_pk_mul_f32 v[112:113], v[108:109], v[100:101]
    v_pk_mul_f32 v[116:117], v[104:105], v[100:101]
    v_pk_mul_f32 v[114:115], v[110:111], v[102:103]
    v_pk_mul_f32 v[118:119], v[106:107], v[102:103]
    v_pk_fma_f32 v[104:105], v[104:105], v[96:97], v[112:113] neg_lo:[0,0,1] neg_hi:[0,0,1]
    v_pk_fma_f32 v[108:109], v[108:109], v[96:97], v[116:117]
    v_pk_fma_f32 v[106:107], v[106:107], v[98:99], v[114:115] neg_lo:[0,0,1] neg_hi:[0,0,1]
    v_pk_fma_f32 v[110:111], v[110:111], v[98:99], v[118:119]
    v_cvt_pk_f16_f32 v152, v104, v108
    v_cvt_pk_f16_f32 v153, v105, v109
    v_cvt_pk_f16_f32 v154, v106, v110
    v_cvt_pk_f16_f32 v155, v107, v111
    ds_write_b128 v137, v[152:155] offset:28512
    v_pk_mul_f32 v[112:113], v[108:109], v[100:101]
    v_pk_mul_f32 v[116:117], v[104:105], v[100:101]
    v_pk_mul_f32 v[114:115], v[110:111], v[102:103]
    v_pk_mul_f32 v[118:119], v[106:107], v[102:103]
    v_pk_fma_f32 v[104:105], v[104:105], v[96:97], v[112:113] neg_lo:[0,0,1] neg_hi:[0,0,1]
    v_pk_fma_f32 v[108:109], v[108:109], v[96:97], v[116:117]
    v_pk_fma_f32 v[106:107], v[106:107], v[98:99], v[114:115] neg_lo:[0,0,1] neg_hi:[0,0,1]
    v_pk_fma_f32 v[110:111], v[110:111], v[98:99], v[118:119]
    v_cvt_pk_f16_f32 v156, v104, v108
    v_cvt_pk_f16_f32 v157, v105, v109
    v_cvt_pk_f16_f32 v158, v106, v110
    v_cvt_pk_f16_f32 v159, v107, v111
    ds_write_b128 v137, v[156:159] offset:29040
    v_pk_mul_f32 v[112:113], v[108:109], v[100:101]
    v_pk_mul_f32 v[116:117], v[104:105], v[100:101]
    v_pk_mul_f32 v[114:115], v[110:111], v[102:103]
    v_pk_mul_f32 v[118:119], v[106:107], v[102:103]
    v_pk_fma_f32 v[104:105], v[104:105], v[96:97], v[112:113] neg_lo:[0,0,1] neg_hi:[0,0,1]
    v_pk_fma_f32 v[108:109], v[108:109], v[96:97], v[116:117]
    v_pk_fma_f32 v[106:107], v[106:107], v[98:99], v[114:115] neg_lo:[0,0,1] neg_hi:[0,0,1]
    v_pk_fma_f32 v[110:111], v[110:111], v[98:99], v[118:119]
    v_cvt_pk_f16_f32 v148, v104, v108
    v_cvt_pk_f16_f32 v149, v105, v109
    v_cvt_pk_f16_f32 v150, v106, v110
    v_cvt_pk_f16_f32 v151, v107, v111
    ds_write_b128 v137, v[148:151] offset:29568
    s_branch L_m_j8
L_m_w3_7:
    s_waitcnt vmcnt(1)
    v_lshlrev_b32 v72, 16, v32
    v_and_b32 v73, 0xffff0000, v32
    v_lshlrev_b32 v74, 16, v33
    v_and_b32 v75, 0xffff0000, v33
    v_lshlrev_b32 v76, 16, v34
    v_and_b32 v77, 0xffff0000, v34
    v_lshlrev_b32 v78, 16, v35
    v_and_b32 v79, 0xffff0000, v35
    v_lshlrev_b32 v80, 16, v36
    v_and_b32 v81, 0xffff0000, v36
    v_lshlrev_b32 v82, 16, v37
    v_and_b32 v83, 0xffff0000, v37
    v_lshlrev_b32 v84, 16, v38
    v_and_b32 v85, 0xffff0000, v38
    v_lshlrev_b32 v86, 16, v39
    v_and_b32 v87, 0xffff0000, v39
    v_mul_f32 v88, s23, v72
    v_mul_f32 v89, s23, v73
    v_mul_f32 v90, s23, v74
    v_mul_f32 v91, s23, v75
    v_fma_f32 v92, v72, s23, -v88
    v_fma_f32 v93, v73, s23, -v89
    v_fma_f32 v94, v74, s23, -v90
    v_fma_f32 v95, v75, s23, -v91
    v_fma_f32 v92, v72, s67, v92
    v_fma_f32 v93, v73, s67, v93
    v_fma_f32 v94, v74, s67, v94
    v_fma_f32 v95, v75, s67, v95
    v_exp_f32 v72, v88
    v_exp_f32 v73, v89
    v_exp_f32 v74, v90
    v_exp_f32 v75, v91
    v_mul_f32 v92, s29, v92
    v_mul_f32 v93, s29, v93
    v_mul_f32 v94, s29, v94
    v_mul_f32 v95, s29, v95
    v_fma_f32 v72, v72, v92, v72
    v_fma_f32 v73, v73, v93, v73
    v_fma_f32 v74, v74, v94, v74
    v_fma_f32 v75, v75, v95, v75
    v_max3_f32 v96, |v80|, |v81|, |v82|
    v_max3_f32 v97, |v84|, |v85|, |v86|
    v_max3_f32 v96, v96, |v83|, |v87|
    v_max_f32 v96, v96, v97
    v_cvt_pk_bf16_f32 v88, v72, v73
    v_cvt_pk_bf16_f32 v89, v74, v75
    v_max_u32_dpp v96, v96, v96 row_shr:1 row_mask:0xf bank_mask:0xf
    v_lshlrev_b32 v72, 16, v88
    v_and_b32 v73, 0xffff0000, v88
    v_lshlrev_b32 v74, 16, v89
    v_and_b32 v75, 0xffff0000, v89
    v_max_u32_dpp v96, v96, v96 row_shr:2 row_mask:0xf bank_mask:0xf
    v_mul_f32 v72, v72, v145
    v_mul_f32 v73, v73, v145
    v_mul_f32 v74, v74, v145
    v_mul_f32 v75, v75, v145
    v_max_u32_dpp v96, v96, v96 row_shr:4 row_mask:0xf bank_mask:0xf
    v_mul_f32 v76, v76, v145
    v_mul_f32 v77, v77, v145
    v_mul_f32 v78, v78, v145
    v_mul_f32 v79, v79, v145
    v_max_u32_dpp v96, v96, v96 row_shr:8 row_mask:0xf bank_mask:0xf
    v_mul_f32 v72, 0xbfb8aa3b, v72
    v_mul_f32 v73, 0xbfb8aa3b, v73
    v_mul_f32 v74, 0xbfb8aa3b, v74
    v_mul_f32 v75, 0xbfb8aa3b, v75
    v_max_u32_dpp v96, v96, v96 row_bcast:15 row_mask:0xa bank_mask:0xf
    v_mul_f32 v76, 0.15915494, v76
    v_mul_f32 v77, 0.15915494, v77
    v_mul_f32 v78, 0.15915494, v78
    v_mul_f32 v79, 0.15915494, v79
    v_readlane_b32 s56, v96, 31
    v_readlane_b32 s57, v96, 63
    s_nop 0
    v_mov_b32 v96, s56
    v_mov_b32 v97, s57
    v_cndmask_b32 v96, v96, v97, s[68:69]
    v_lshrrev_b32 v96, 23, v96
    v_max_u32 v96, 1, v96
    v_min_u32 v96, 253, v96
    v_sub_u32 v97, 254, v96
    v_lshlrev_b32 v97, 23, v97
    v_add_u32 v96, 1, v96
    v_lshlrev_b32 v96, 23, v96
    v_mul_f32 v146, v96, v145
    v_mul_f32 v80, v97, v80
    v_mul_f32 v81, v97, v81
    v_mul_f32 v82, v97, v82
    v_mul_f32 v83, v97, v83
    v_mul_f32 v84, v97, v84
    v_mul_f32 v85, v97, v85
    v_mul_f32 v86, v97, v86
    v_mul_f32 v87, v97, v87
    v_mul_f32 v116, 4.0, v76
    v_mul_f32 v117, 4.0, v77
    v_mul_f32 v118, 4.0, v78
    v_mul_f32 v119, 4.0, v79
    v_mul_f32 v112, 4.0, v72
    v_mul_f32 v113, 4.0, v73
    v_mul_f32 v114, 4.0, v74
    v_mul_f32 v115, 4.0, v75
    v_fract_f32 v116, v116
    v_fract_f32 v117, v117
    v_fract_f32 v118, v118
    v_fract_f32 v119, v119
    v_exp_f32 v112, v112
    v_exp_f32 v113, v113
    v_exp_f32 v114, v114
    v_exp_f32 v115, v115
    v_cos_f32 v88, v116
    v_cos_f32 v89, v117
    v_cos_f32 v90, v118
    v_cos_f32 v91, v119
    v_sin_f32 v92, v116
    v_sin_f32 v93, v117
    v_sin_f32 v94, v118
    v_sin_f32 v95, v119
    v_pk_mul_f32 v[88:89], v[88:89], v[112:113]
    v_pk_mul_f32 v[90:91], v[90:91], v[114:115]
    v_pk_mul_f32 v[92:93], v[92:93], v[112:113]
    v_pk_mul_f32 v[94:95], v[94:95], v[114:115]
    v_mul_f32 v116, 0x43800000, v76
    v_mul_f32 v117, 0x43800000, v77
    v_mul_f32 v118, 0x43800000, v78
    v_mul_f32 v119, 0x43800000, v79
    v_mul_f32 v112, 0x43800000, v72
    v_mul_f32 v113, 0x43800000, v73
    v_mul_f32 v114, 0x43800000, v74
    v_mul_f32 v115, 0x43800000, v75
    v_fract_f32 v116, v116
    v_fract_f32 v117, v117
    v_fract_f32 v118, v118
    v_fract_f32 v119, v119
    v_exp_f32 v112, v112
    v_exp_f32 v113, v113
    v_exp_f32 v114, v114
    v_exp_f32 v115, v115
    v_cos_f32 v96, v116
    v_cos_f32 v97, v117
    v_cos_f32 v98, v118
    v_cos_f32 v99, v119
    v_sin_f32 v100, v116
    v_sin_f32 v101, v117
    v_sin_f32 v102, v118
    v_sin_f32 v103, v119
    v_pk_mul_f32 v[96:97], v[96:97], v[112:113]
    v_pk_mul_f32 v[98:99], v[98:99], v[114:115]
    v_pk_mul_f32 v[100:101], v[100:101], v[112:113]
    v_pk_mul_f32 v[102:103], v[102:103], v[114:115]
    v_pk_mul_f32 v[112:113], v[84:85], v[100:101]
    v_pk_mul_f32 v[116:117], v[80:81], v[100:101]
    v_pk_mul_f32 v[114:115], v[86:87], v[102:103]
    v_pk_mul_f32 v[118:119], v[82:83], v[102:103]
    v_pk_fma_f32 v[104:105], v[80:81], v[96:97], v[112:113] neg_lo:[0,0,1] neg_hi:[0,0,1]
    v_pk_fma_f32 v[108:109], v[84:85], v[96:97], v[116:117]
    v_pk_fma_f32 v[106:107], v[82:83], v[98:99], v[114:115] neg_lo:[0,0,1] neg_hi:[0,0,1]
    v_pk_fma_f32 v[110:111], v[86:87], v[98:99], v[118:119]
    v_pk_mul_f32 v[112:113], v[108:109], v[100:101]
    v_pk_mul_f32 v[116:117], v[104:105], v[100:101]
    v_pk_mul_f32 v[114:115], v[110:111], v[102:103]
    v_pk_mul_f32 v[118:119], v[106:107], v[102:103]
    v_pk_fma_f32 v[104:105], v[104:105], v[96:97], v[112:113] neg_lo:[0,0,1] neg_hi:[0,0,1]
    v_pk_fma_f32 v[108:109], v[108:109], v[96:97], v[116:117]
    v_pk_fma_f32 v[106:107], v[106:107], v[98:99], v[114:115] neg_lo:[0,0,1] neg_hi:[0,0,1]
    v_pk_fma_f32 v[110:111], v[110:111], v[98:99], v[118:119]
    v_cvt_pk_f16_f32 v152, v104, -v108
    v_cvt_pk_f16_f32 v153, v105, -v109
    v_cvt_pk_f16_f32 v154, v106, -v110
    v_cvt_pk_f16_f32 v155, v107, -v111
    ds_write_b128 v137, v[152:155] offset:6336
    s_getpc_b64 s[56:57]
L_m_pc11:
    s_sub_u32 s56, s56, L_m_pc11-main_kernel
    s_subb_u32 s57, s57, 0
    s_bfe_u32 s58, s2, 0x50003
    s_mul_i32 s58, s58, 3072
    s_add_u32 s58, s58, 15360
    v_lshl_add_u32 v31, v0, 4, s58
    v_min_u32 v31, L_code_end-main_kernel-16, v31
    global_load_dword a255, v31, s[56:57]
    v_pk_mul_f32 v[120:121], v[108:109], v[92:93]
    v_pk_mul_f32 v[124:125], v[104:105], v[92:93]
    v_pk_mul_f32 v[122:123], v[110:111], v[94:95]
    v_pk_mul_f32 v[126:127], v[106:107], v[94:95]
    v_pk_fma_f32 v[80:81], v[104:105], v[88:89], v[120:121] neg_lo:[0,0,1] neg_hi:[0,0,1]
    v_pk_fma_f32 v[84:85], v[108:109], v[88:89], v[124:125]
    v_pk_fma_f32 v[82:83], v[106:107], v[90:91], v[122:123] neg_lo:[0,0,1] neg_hi:[0,0,1]
    v_pk_fma_f32 v[86:87], v[110:111], v[90:91], v[126:127]
    v_cvt_pk_f16_f32 v156, v80, -v84
    v_cvt_pk_f16_f32 v157, v81, -v85
    v_cvt_pk_f16_f32 v158, v82, -v86
    v_cvt_pk_f16_f32 v159, v83, -v87
    ds_write_b128 v137, v[156:159] offset:6864
    v_pk_mul_f32 v[112:113], v[108:109], v[100:101]
    v_pk_mul_f32 v[116:117], v[104:105], v[100:101]
    v_pk_mul_f32 v[114:115], v[110:111], v[102:103]
    v_pk_mul_f32 v[118:119], v[106:107], v[102:103]
    v_pk_fma_f32 v[104:105], v[104:105], v[96:97], v[112:113] neg_lo:[0,0,1] neg_hi:[0,0,1]
    v_pk_fma_f32 v[108:109], v[108:109], v[96:97], v[116:117]
    v_pk_fma_f32 v[106:107], v[106:107], v[98:99], v[114:115] neg_lo:[0,0,1] neg_hi:[0,0,1]
    v_pk_fma_f32 v[110:111], v[110:111], v[98:99], v[118:119]
    v_cvt_pk_f16_f32 v148, v104, -v108
    v_cvt_pk_f16_f32 v149, v105, -v109
    v_cvt_pk_f16_f32 v150, v106, -v110
    v_cvt_pk_f16_f32 v151, v107, -v111
    ds_write_b128 v137, v[148:151] offset:7392
    v_pk_mul_f32 v[120:121], v[108:109], v[92:93]
    v_pk_mul_f32 v[124:125], v[104:105], v[92:93]
    v_pk_mul_f32 v[122:123], v[110:111], v[94:95]
    v_pk_mul_f32 v[126:127], v[106:107], v[94:95]
    v_pk_fma_f32 v[80:81], v[104:105], v[88:89], v[120:121] neg_lo:[0,0,1] neg_hi:[0,0,1]
    v_pk_fma_f32 v[84:85], v[108:109], v[88:89], v[124:125]
    v_pk_fma_f32 v[82:83], v[106:107], v[90:91], v[122:123] neg_lo:[0,0,1] neg_hi:[0,0,1]
    v_pk_fma_f32 v[86:87], v[110:111], v[90:91], v[126:127]
    v_cvt_pk_f16_f32 v152, v80, -v84
    v_cvt_pk_f16_f32 v153, v81, -v85
    v_cvt_pk_f16_f32 v154, v82, -v86
    v_cvt_pk_f16_f32 v155, v83, -v87
    ds_write_b128 v137, v[152:155] offset:7920
    v_pk_mul_f32 v[112:113], v[108:109], v[100:101]
    v_pk_mul_f32 v[116:117], v[104:105], v[100:101]
    v_pk_mul_f32 v[114:115], v[110:111], v[102:103]
    v_pk_mul_f32 v[118:119], v[106:107], v[102:103]
    v_pk_fma_f32 v[104:105], v[104:105], v[96:97], v[112:113] neg_lo:[0,0,1] neg_hi:[0,0,1]
    v_pk_fma_f32 v[108:109], v[108:109], v[96:97], v[116:117]
    v_pk_fma_f32 v[106:107], v[106:107], v[98:99], v[114:115] neg_lo:[0,0,1] neg_hi:[0,0,1]
    v_pk_fma_f32 v[110:111], v[110:111], v[98:99], v[118:119]
    v_cvt_pk_f16_f32 v156, v104, -v108
    v_cvt_pk_f16_f32 v157, v105, -v109
    v_cvt_pk_f16_f32 v158, v106, -v110
    v_cvt_pk_f16_f32 v159, v107, -v111
    ds_write_b128 v137, v[156:159] offset:8448
    v_pk_mul_f32 v[112:113], v[108:109], v[100:101]
    v_pk_mul_f32 v[116:117], v[104:105], v[100:101]
    v_pk_mul_f32 v[114:115], v[110:111], v[102:103]
    v_pk_mul_f32 v[118:119], v[106:107], v[102:103]
    v_pk_fma_f32 v[104:105], v[104:105], v[96:97], v[112:113] neg_lo:[0,0,1] neg_hi:[0,0,1]
    v_pk_fma_f32 v[108:109], v[108:109], v[96:97], v[116:117]
    v_pk_fma_f32 v[106:107], v[106:107], v[98:99], v[114:115] neg_lo:[0,0,1] neg_hi:[0,0,1]
    v_pk_fma_f32 v[110:111], v[110:111], v[98:99], v[118:119]
    v_cvt_pk_f16_f32 v148, v104, -v108
    v_cvt_pk_f16_f32 v149, v105, -v109
    v_cvt_pk_f16_f32 v150, v106, -v110
    v_cvt_pk_f16_f32 v151, v107, -v111
    ds_write_b128 v137, v[148:151] offset:8976
    v_pk_mul_f32 v[112:113], v[108:109], v[100:101]
    v_pk_mul_f32 v[116:117], v[104:105], v[100:101]
    v_pk_mul_f32 v[114:115], v[110:111], v[102:103]
    v_pk_mul_f32 v[118:119], v[106:107], v[102:103]
    v_pk_fma_f32 v[104:105], v[104:105], v[96:97], v[112:113] neg_lo:[0,0,1] neg_hi:[0,0,1]
    v_pk_fma_f32 v[108:109], v[108:109], v[96:97], v[116:117]
    v_pk_fma_f32 v[106:107], v[106:107], v[98:99], v[114:115] neg_lo:[0,0,1] neg_hi:[0,0,1]
    v_pk_fma_f32 v[110:111], v[110:111], v[98:99], v[118:119]
    v_cvt_pk_f16_f32 v152, v104, -v108
    v_cvt_pk_f16_f32 v153, v105, -v109
    v_cvt_pk_f16_f32 v154, v106, -v110
    v_cvt_pk_f16_f32 v155, v107, -v111
    ds_write_b128 v137, v[152:155] offset:9504
    v_pk_mul_f32 v[112:113], v[108:109], v[100:101]
    v_pk_mul_f32 v[116:117], v[104:105], v[100:101]
    v_pk_mul_f32 v[114:115], v[110:111], v[102:103]
    v_pk_mul_f32 v[118:119], v[106:107], v[102:103]
    v_pk_fma_f32 v[104:105], v[104:105], v[96:97], v[112:113] neg_lo:[0,0,1] neg_hi:[0,0,1]
    v_pk_fma_f32 v[108:109], v[108:109], v[96:97], v[116:117]
    v_pk_fma_f32 v[106:107], v[106:107], v[98:99], v[114:115] neg_lo:[0,0,1] neg_hi:[0,0,1]
    v_pk_fma_f32 v[110:111], v[110:111], v[98:99], v[118:119]
    v_cvt_pk_f16_f32 v156, v104, -v108
    v_cvt_pk_f16_f32 v157, v105, -v109
    v_cvt_pk_f16_f32 v158, v106, -v110
    v_cvt_pk_f16_f32 v159, v107, -v111
    ds_write_b128 v137, v[156:159] offset:10032
    v_pk_mul_f32 v[112:113], v[108:109], v[100:101]
    v_pk_mul_f32 v[116:117], v[104:105], v[100:101]
    v_pk_mul_f32 v[114:115], v[110:111], v[102:103]
    v_pk_mul_f32 v[118:119], v[106:107], v[102:103]
    v_pk_fma_f32 v[104:105], v[104:105], v[96:97], v[112:113] neg_lo:[0,0,1] neg_hi:[0,0,1]
    v_pk_fma_f32 v[108:109], v[108:109], v[96:97], v[116:117]
    v_pk_fma_f32 v[106:107], v[106:107], v[98:99], v[114:115] neg_lo:[0,0,1] neg_hi:[0,0,1]
    v_pk_fma_f32 v[110:111], v[110:111], v[98:99], v[118:119]
    v_cvt_pk_f16_f32 v148, v104, -v108
    v_cvt_pk_f16_f32 v149, v105, -v109
    v_cvt_pk_f16_f32 v150, v106, -v110
    v_cvt_pk_f16_f32 v151, v107, -v111
    ds_write_b128 v137, v[148:151] offset:10560
    v_pk_mul_f32 v[112:113], v[92:93], v[92:93]
    v_pk_mul_f32 v[116:117], v[88:89], v[92:93]
    v_pk_mul_f32 v[114:115], v[94:95], v[94:95]
    v_pk_mul_f32 v[118:119], v[90:91], v[94:95]
    v_pk_fma_f32 v[96:97], v[88:89], v[88:89], v[112:113] neg_lo:[0,0,1] neg_hi:[0,0,1]
    v_pk_fma_f32 v[100:101], v[92:93], v[88:89], v[116:117]
    v_pk_fma_f32 v[98:99], v[90:91], v[90:91], v[114:115] neg_lo:[0,0,1] neg_hi:[0,0,1]
    v_pk_fma_f32 v[102:103], v[94:95], v[90:91], v[118:119]
    s_mov_b32 s56, 0x43480000
    v_mul_f32 v116, s56, v76
    v_mul_f32 v117, s56, v77
    v_mul_f32 v118, s56, v78
    v_mul_f32 v119, s56, v79
    v_mul_f32 v112, s56, v72
    v_mul_f32 v113, s56, v73
    v_mul_f32 v114, s56, v74
    v_mul_f32 v115, s56, v75
    v_fract_f32 v116, v116
    v_fract_f32 v117, v117
    v_fract_f32 v118, v118
    v_fract_f32 v119, v119
    v_exp_f32 v112, v112
    v_exp_f32 v113, v113
    v_exp_f32 v114, v114
    v_exp_f32 v115, v115
    v_cos_f32 v104, v116
    v_cos_f32 v105, v117
    v_cos_f32 v106, v118
    v_cos_f32 v107, v119
    v_sin_f32 v108, v116
    v_sin_f32 v109, v117
    v_sin_f32 v110, v118
    v_sin_f32 v111, v119
    v_pk_mul_f32 v[104:105], v[104:105], v[112:113]
    v_pk_mul_f32 v[106:107], v[106:107], v[114:115]
    v_pk_mul_f32 v[108:109], v[108:109], v[112:113]
    v_pk_mul_f32 v[110:111], v[110:111], v[114:115]
    v_cvt_pk_f16_f32 v152, v104, v108
    v_cvt_pk_f16_f32 v153, v105, v109
    v_cvt_pk_f16_f32 v154, v106, v110
    v_cvt_pk_f16_f32 v155, v107, v111
    ds_write_b128 v137, v[152:155] offset:30096
    v_pk_mul_f32 v[112:113], v[108:109], v[100:101]
    v_pk_mul_f32 v[116:117], v[104:105], v[100:101]
    v_pk_mul_f32 v[114:115], v[110:111], v[102:103]
    v_pk_mul_f32 v[118:119], v[106:107], v[102:103]
    v_pk_fma_f32 v[104:105], v[104:105], v[96:97], v[112:113] neg_lo:[0,0,1] neg_hi:[0,0,1]
    v_pk_fma_f32 v[108:109], v[108:109], v[96:97], v[116:117]
    v_pk_fma_f32 v[106:107], v[106:107], v[98:99], v[114:115] neg_lo:[0,0,1] neg_hi:[0,0,1]
    v_pk_fma_f32 v[110:111], v[110:111], v[98:99], v[118:119]
    v_cvt_pk_f16_f32 v156, v104, v108
    v_cvt_pk_f16_f32 v157, v105, v109
    v_cvt_pk_f16_f32 v158, v106, v110
    v_cvt_pk_f16_f32 v159, v107, v111
    ds_write_b128 v137, v[156:159] offset:30624
    v_pk_mul_f32 v[112:113], v[108:109], v[100:101]
    v_pk_mul_f32 v[116:117], v[104:105], v[100:101]
    v_pk_mul_f32 v[114:115], v[110:111], v[102:103]
    v_pk_mul_f32 v[118:119], v[106:107], v[102:103]
    v_pk_fma_f32 v[104:105], v[104:105], v[96:97], v[112:113] neg_lo:[0,0,1] neg_hi:[0,0,1]
    v_pk_fma_f32 v[108:109], v[108:109], v[96:97], v[116:117]
    v_pk_fma_f32 v[106:107], v[106:107], v[98:99], v[114:115] neg_lo:[0,0,1] neg_hi:[0,0,1]
    v_pk_fma_f32 v[110:111], v[110:111], v[98:99], v[118:119]
    v_cvt_pk_f16_f32 v148, v104, v108
    v_cvt_pk_f16_f32 v149, v105, v109
    v_cvt_pk_f16_f32 v150, v106, v110
    v_cvt_pk_f16_f32 v151, v107, v111
    ds_write_b128 v137, v[148:151] offset:31152
    v_pk_mul_f32 v[112:113], v[108:109], v[100:101]
    v_pk_mul_f32 v[116:117], v[104:105], v[100:101]
    v_pk_mul_f32 v[114:115], v[110:111], v[102:103]
    v_pk_mul_f32 v[118:119], v[106:107], v[102:103]
    v_pk_fma_f32 v[104:105], v[104:105], v[96:97], v[112:113] neg_lo:[0,0,1] neg_hi:[0,0,1]
    v_pk_fma_f32 v[108:109], v[108:109], v[96:97], v[116:117]
    v_pk_fma_f32 v[106:107], v[106:107], v[98:99], v[114:115] neg_lo:[0,0,1] neg_hi:[0,0,1]
    v_pk_fma_f32 v[110:111], v[110:111], v[98:99], v[118:119]
    v_cvt_pk_f16_f32 v152, v104, v108
    v_cvt_pk_f16_f32 v153, v105, v109
    v_cvt_pk_f16_f32 v154, v106, v110
    v_cvt_pk_f16_f32 v155, v107, v111
    ds_write_b128 v137, v[152:155] offset:31680
    v_pk_mul_f32 v[112:113], v[108:109], v[100:101]
    v_pk_mul_f32 v[116:117], v[104:105], v[100:101]
    v_pk_mul_f32 v[114:115], v[110:111], v[102:103]
    v_pk_mul_f32 v[118:119], v[106:107], v[102:103]
    v_pk_fma_f32 v[104:105], v[104:105], v[96:97], v[112:113] neg_lo:[0,0,1] neg_hi:[0,0,1]
    v_pk_fma_f32 v[108:109], v[108:109], v[96:97], v[116:117]
    v_pk_fma_f32 v[106:107], v[106:107], v[98:99], v[114:115] neg_lo:[0,0,1] neg_hi:[0,0,1]
    v_pk_fma_f32 v[110:111], v[110:111], v[98:99], v[118:119]
    v_cvt_pk_f16_f32 v156, v104, v108
    v_cvt_pk_f16_f32 v157, v105, v109
    v_cvt_pk_f16_f32 v158, v106, v110
    v_cvt_pk_f16_f32 v159, v107, v111
    ds_write_b128 v137, v[156:159] offset:32208
    v_pk_mul_f32 v[112:113], v[108:109], v[100:101]
    v_pk_mul_f32 v[116:117], v[104:105], v[100:101]
    v_pk_mul_f32 v[114:115], v[110:111], v[102:103]
    v_pk_mul_f32 v[118:119], v[106:107], v[102:103]
    v_pk_fma_f32 v[104:105], v[104:105], v[96:97], v[112:113] neg_lo:[0,0,1] neg_hi:[0,0,1]
    v_pk_fma_f32 v[108:109], v[108:109], v[96:97], v[116:117]
    v_pk_fma_f32 v[106:107], v[106:107], v[98:99], v[114:115] neg_lo:[0,0,1] neg_hi:[0,0,1]
    v_pk_fma_f32 v[110:111], v[110:111], v[98:99], v[118:119]
    v_cvt_pk_f16_f32 v148, v104, v108
    v_cvt_pk_f16_f32 v149, v105, v109
    v_cvt_pk_f16_f32 v150, v106, v110
    v_cvt_pk_f16_f32 v151, v107, v111
    ds_write_b128 v137, v[148:151] offset:32736
    v_pk_mul_f32 v[112:113], v[108:109], v[100:101]
    v_pk_mul_f32 v[116:117], v[104:105], v[100:101]
    v_pk_mul_f32 v[114:115], v[110:111], v[102:103]
    v_pk_mul_f32 v[118:119], v[106:107], v[102:103]
    v_pk_fma_f32 v[104:105], v[104:105], v[96:97], v[112:113] neg_lo:[0,0,1] neg_hi:[0,0,1]
    v_pk_fma_f32 v[108:109], v[108:109], v[96:97], v[116:117]
    v_pk_fma_f32 v[106:107], v[106:107], v[98:99], v[114:115] neg_lo:[0,0,1] neg_hi:[0,0,1]
    v_pk_fma_f32 v[110:111], v[110:111], v[98:99], v[118:119]
    v_cvt_pk_f16_f32 v152, v104, v108
    v_cvt_pk_f16_f32 v153, v105, v109
    v_cvt_pk_f16_f32 v154, v106, v110
    v_cvt_pk_f16_f32 v155, v107, v111
    ds_write_b128 v137, v[152:155] offset:33264
L_m_j8:
    s_waitcnt lgkmcnt(0)
    v_and_b32 v113, 7, v1
    v_cmp_gt_u32 s[36:37], 3, v113
    v_cmp_eq_u32 s[40:41], 0, v113
    v_mov_b32 v146, s63
    v_cmp_eq_u32 s[70:71], 0, v0
    v_mov_b32 v113, 1
    s_lshl_b32 s62, s2, 7
    s_add_u32 s62, s62, 8716288
    v_and_b32 v115, 240, v2
    s_barrier
    ds_read_b32 v146, v146 offset:21248
    ds_read_b128 v[160:163], v138 offset:0
    ds_read_b128 v[164:167], v139 offset:0
    ds_read_b128 v[168:171], v138 offset:8448
    ds_read_b128 v[172:175], v138 offset:64
    ds_read_b128 v[176:179], v139 offset:64
    ds_read_b128 v[180:183], v138 offset:8512
    ds_read_b128 v[184:187], v138 offset:128
    ds_read_b128 v[188:191], v139 offset:128
    ds_read_b128 v[192:195], v138 offset:8576
    ds_read_b128 v[196:199], v138 offset:192
    ds_read_b128 v[200:203], v139 offset:192
    ds_read_b128 v[204:207], v138 offset:8640
    ds_read_b128 v[208:211], v138 offset:256
    ds_read_b128 v[212:215], v139 offset:256
    ds_read_b128 v[216:219], v138 offset:8704
    s_waitcnt lgkmcnt(12)
    v_mfma_f32_16x16x32_f16 v[48:51], v[160:163], v[164:167], 0
    v_mfma_f32_16x16x32_f16 v[52:55], v[168:171], v[164:167], 0
    ds_read_b128 v[220:223], v138 offset:320
    ds_read_b128 v[224:227], v139 offset:320
    ds_read_b128 v[228:231], v138 offset:8768
    s_waitcnt lgkmcnt(12)
    v_mfma_f32_16x16x32_f16 v[48:51], v[172:175], v[176:179], v[48:51]
    v_mfma_f32_16x16x32_f16 v[52:55], v[180:183], v[176:179], v[52:55]
    ds_read_b128 v[160:163], v138 offset:384
    ds_read_b128 v[164:167], v139 offset:384
    ds_read_b128 v[168:171], v138 offset:8832
    s_waitcnt lgkmcnt(12)
    v_mfma_f32_16x16x32_f16 v[48:51], v[184:187], v[188:191], v[48:51]
    v_mfma_f32_16x16x32_f16 v[52:55], v[192:195], v[188:191], v[52:55]
    ds_read_b128 v[172:175], v138 offset:448
    ds_read_b128 v[176:179], v139 offset:448
    ds_read_b128 v[180:183], v138 offset:8896
    s_waitcnt lgkmcnt(12)
    v_mfma_f32_16x16x32_f16 v[48:51], v[196:199], v[200:203], v[48:51]
    v_mfma_f32_16x16x32_f16 v[52:55], v[204:207], v[200:203], v[52:55]
    s_waitcnt vmcnt(1)
    s_mov_b64 exec, s[70:71]
    buffer_store_dword v113, v24, s[44:47], s62 offen sc1
    s_mov_b64 exec, -1
    s_waitcnt lgkmcnt(9)
    v_mfma_f32_16x16x32_f16 v[48:51], v[208:211], v[212:215], v[48:51]
    v_mfma_f32_16x16x32_f16 v[52:55], v[216:219], v[212:215], v[52:55]
    s_waitcnt lgkmcnt(6)
    v_mfma_f32_16x16x32_f16 v[48:51], v[220:223], v[224:227], v[48:51]
    v_mfma_f32_16x16x32_f16 v[52:55], v[228:231], v[224:227], v[52:55]
    global_load_dword v114, v115, s[96:97] sc1
    s_waitcnt lgkmcnt(3)
    v_mfma_f32_16x16x32_f16 v[48:51], v[160:163], v[164:167], v[48:51]
    v_mfma_f32_16x16x32_f16 v[52:55], v[168:171], v[164:167], v[52:55]
    s_waitcnt lgkmcnt(0)
    v_mfma_f32_16x16x32_f16 v[48:51], v[172:175], v[176:179], v[48:51]
    v_mfma_f32_16x16x32_f16 v[52:55], v[180:183], v[176:179], v[52:55]
    s_nop 6
    v_mul_f32 v48, v146, v48
    v_mul_f32 v49, v146, v49
    v_mul_f32 v50, v146, v50
    v_mul_f32 v51, v146, v51
    v_mul_f32 v52, v146, v52
    v_mul_f32 v53, v146, v53
    v_mul_f32 v54, v146, v54
    v_mul_f32 v55, v146, v55
    v_cvt_pk_bf16_f32 v56, v48, v49
    v_cvt_pk_bf16_f32 v57, v50, v51
    v_cvt_pk_bf16_f32 v58, v52, v53
    v_cvt_pk_bf16_f32 v59, v54, v55
    ds_write_b32 v140, v56
    ds_write_b32 v141, v57
    ds_write_b16 v142, v58
    ds_write_b16_d16_hi v142, v58 offset:64
    ds_write_b16 v142, v59 offset:128
    ds_write_b16_d16_hi v142, v59 offset:192
    s_mul_i32 s56, s5, 229376
    s_lshl_b32 s57, s3, 15
    s_add_u32 s72, s56, s57
    s_add_u32 s72, s72, 16777216
    s_lshl_b32 s74, s3, 11
    s_add_u32 s73, s56, s74
    s_add_u32 s73, s73, 16908288
    s_add_u32 s84, s74, 24576
    s_cmp_eq_u32 s3, 3
    s_cselect_b32 s84, 159744, s84
    s_cselect_b32 s85, 0, 31744
    s_mul_i32 s57, s3, 57344
    s_add_u32 s75, s56, s57
    s_add_u32 s75, s75, 18874368
    s_min_u32 s57, s3, 2
    s_lshl_b32 s57, s57, 15
    s_add_u32 s67, s56, s57
    s_add_u32 s67, s67, 16940032
    s_mul_i32 s68, s5, 3584
    s_add_u32 s68, s68, 8716288
    s_and_b32 s56, s4, 0
    s_xor_b32 s57, s56, 0
    s_lshl_b32 s57, s57, 10
    s_add_u32 s78, s11, s57
    s_xor_b32 s57, s56, 1
    s_lshl_b32 s57, s57, 10
    s_add_u32 s79, s11, s57
    s_xor_b32 s57, s56, 2
    s_lshl_b32 s57, s57, 10
    s_add_u32 s80, s11, s57
    s_xor_b32 s57, s56, 3
    s_lshl_b32 s57, s57, 10
    s_add_u32 s81, s11, s57
    v_min_u32 v249, 27, v1
    v_lshlrev_b32 v249, 7, v249
    s_waitcnt lgkmcnt(0)
    s_barrier
    ds_read_u16 v66, v128 offset:0
    ds_read_u16 v67, v129 offset:0
    ds_read_u16 v68, v130 offset:0
    ds_read_u16 v69, v131 offset:0
    ds_read_u16 v70, v132 offset:0
    ds_read_u16 v71, v133 offset:0
    ds_read_u16 v72, v134 offset:0
    ds_read_u16 v73, v135 offset:0
    ds_read_u16 v74, v136 offset:0
    ds_read_u16 v76, v128 offset:2048
    ds_read_u16 v77, v129 offset:2048
    ds_read_u16 v78, v130 offset:2048
    ds_read_u16 v79, v131 offset:2048
    ds_read_u16 v80, v132 offset:2048
    ds_read_u16 v81, v133 offset:2048
    ds_read_u16 v82, v134 offset:2048
    ds_read_u16 v83, v135 offset:2048
    ds_read_u16 v84, v136 offset:2048
    s_waitcnt vmcnt(0)
    v_cmp_ne_u32 vcc, 16, v114
    s_mov_b32 s63, 1
    s_cbranch_vccnz L_m_late12
    s_mov_b32 s64, 8650752
    s_add_u32 s65, s6, 0
    buffer_load_dwordx4 v[28:31], v6, s[44:47], s64 offen offset:0 sc1
    buffer_load_dwordx4 v[32:35], v6, s[44:47], s64 offen offset:16 sc1
    buffer_load_dwordx4 v[44:47], v5, s[44:47], s65 offen sc1
    s_mov_b32 s64, 8658944
    s_add_u32 s65, s6, 1081344
    buffer_load_dwordx4 v[92:95], v6, s[44:47], s64 offen offset:0 sc1
    buffer_load_dwordx4 v[96:99], v6, s[44:47], s64 offen offset:16 sc1
    buffer_load_dwordx4 v[108:111], v5, s[44:47], s65 offen sc1
    s_mov_b32 s63, 0
L_m_late12:
    v_add_u32 v64, 8320, v143
    v_add_u32 v65, 12480, v143
    s_waitcnt lgkmcnt(9)
    v_lshl_or_b32 v160, v68, 16, v67
    v_lshl_or_b32 v161, v70, 16, v69
    v_lshl_or_b32 v162, v72, 16, v71
    v_lshl_or_b32 v163, v74, 16, v73
    v_cndmask_b32 v66, v66, v24, s[70:71]
    ds_write_b128 v143, v[160:163] offset:0
    ds_write2_b32 v64, v160, v161 offset0:1 offset1:2
    ds_write2_b32 v64, v162, v163 offset0:3 offset1:4
    v_lshl_or_b32 v164, v67, 16, v66
    v_lshl_or_b32 v165, v69, 16, v68
    v_lshl_or_b32 v166, v71, 16, v70
    v_lshl_or_b32 v167, v73, 16, v72
    ds_write_b128 v143, v[164:167] offset:4160
    ds_write2_b32 v65, v164, v165 offset0:1 offset1:2
    ds_write2_b32 v65, v166, v167 offset0:3 offset1:4
    v_add_u32 v64, 24960, v143
    v_add_u32 v65, 29120, v143
    s_waitcnt lgkmcnt(6)
    v_lshl_or_b32 v168, v78, 16, v77
    v_lshl_or_b32 v169, v80, 16, v79
    v_lshl_or_b32 v170, v82, 16, v81
    v_lshl_or_b32 v171, v84, 16, v83
    v_cndmask_b32 v76, v76, v24, s[70:71]
    ds_write_b128 v143, v[168:171] offset:16640
    ds_write2_b32 v64, v168, v169 offset0:1 offset1:2
    ds_write2_b32 v64, v170, v171 offset0:3 offset1:4
    v_lshl_or_b32 v172, v77, 16, v76
    v_lshl_or_b32 v173, v79, 16, v78
    v_lshl_or_b32 v174, v81, 16, v80
    v_lshl_or_b32 v175, v83, 16, v82
    ds_write_b128 v143, v[172:175] offset:20800
    ds_write2_b32 v65, v172, v173 offset0:1 offset1:2
    ds_write2_b32 v65, v174, v175 offset0:3 offset1:4
    s_cmp_eq_u32 s63, 0
    s_cbranch_scc1 L_m_done13
    v_cmp_ne_u32 vcc, 16, v114
    s_cbranch_vccnz L_m_s14
L_m_r15:
    s_mov_b32 s64, 8650752
    s_add_u32 s65, s6, 0
    buffer_load_dwordx4 v[28:31], v6, s[44:47], s64 offen offset:0 sc1
    buffer_load_dwordx4 v[32:35], v6, s[44:47], s64 offen offset:16 sc1
    buffer_load_dwordx4 v[44:47], v5, s[44:47], s65 offen sc1
    s_mov_b32 s64, 8658944
    s_add_u32 s65, s6, 1081344
    buffer_load_dwordx4 v[92:95], v6, s[44:47], s64 offen offset:0 sc1
    buffer_load_dwordx4 v[96:99], v6, s[44:47], s64 offen offset:16 sc1
    buffer_load_dwordx4 v[108:111], v5, s[44:47], s65 offen sc1
L_m_done13:
    v_lshrrev_b32 v64, 5, v1
    v_bfe_u32 v65, v1, 2, 2
    v_lshl_add_u32 v64, v64, 2, v65
    v_mul_u32_u24 v64, 1088, v64
    v_bfe_u32 v65, v1, 4, 1
    v_lshl_add_u32 v64, v65, 5, v64
    v_and_b32 v65, 1, v1
    v_lshl_add_u32 v64, v65, 4, v64
    v_bfe_u32 v65, v1, 1, 1
    v_lshl_add_u32 v64, v65, 3, v64
    s_lshl_b32 s56, s3, 7
    v_add_u32 v64, s56, v64
    ds_read_b64_tr_b16 v[176:177], v64 offset:12288
    ds_read_b64_tr_b16 v[178:179], v64 offset:12800
    ds_read_b64_tr_b16 v[180:181], v64 offset:12352
    ds_read_b64_tr_b16 v[182:183], v64 offset:12864
    s_and_b32 s56, s2, 1
    s_lshl_b32 s56, s56, 2
    s_add_u32 s56, s56, s3
    s_mul_i32 s56, s56, 229376
    s_lshr_b32 s57, s2, 1
    s_lshl_b32 s57, s57, 11
    s_add_u32 s56, s56, s57
    s_add_u32 s56, s56, 18874368
    s_cmp_lt_u32 s2, 224
    s_cselect_b32 s83, s56, s46
L_m_conv0:
    s_waitcnt lgkmcnt(2)
    buffer_store_dwordx4 v[176:179], v2, s[44:47], s83 offen offset:0 sc1
    s_waitcnt lgkmcnt(0)
    buffer_store_dwordx4 v[180:183], v2, s[44:47], s83 offen offset:1024 sc1
    s_waitcnt vmcnt(5)
    v_min3_f32 v36, |v28|, |v30|, |v32|
    v_min3_f32 v36, v36, |v34|, |v44|
    v_cmp_gt_f32 vcc, s54, v36
    s_cbranch_vccnz L_m_s16
L_m_r17:
    v_lshlrev_b32 v60, 16, v44
    v_and_b32 v64, 0xffff0000, v44
    v_lshlrev_b32 v61, 16, v45
    v_and_b32 v65, 0xffff0000, v45
    v_lshlrev_b32 v62, 16, v46
    v_and_b32 v66, 0xffff0000, v46
    v_lshlrev_b32 v63, 16, v47
    v_and_b32 v67, 0xffff0000, v47
    v_fma_f32 v36, v60, v28, v29
    v_fma_f32 v37, v61, v30, v31
    v_fma_f32 v38, v62, v32, v33
    v_fma_f32 v39, v63, v34, v35
    v_cvt_pk_bf16_f32 v44, v36, v37
    v_cvt_pk_bf16_f32 v45, v38, v39
    ds_write_b64 v7, v[44:45] offset:0
    v_fma_f32 v40, v64, v28, v29
    v_fma_f32 v41, v65, v30, v31
    v_fma_f32 v42, v66, v32, v33
    v_fma_f32 v43, v67, v34, v35
    v_cvt_pk_bf16_f32 v46, v40, v41
    v_cvt_pk_bf16_f32 v47, v42, v43
    ds_write_b64 v7, v[46:47] offset:4608
    v_fma_f32 v60, v36, s24, v60
    v_fma_f32 v61, v37, s24, v61
    v_fma_f32 v62, v38, s24, v62
    v_fma_f32 v63, v39, s24, v63
    v_fma_f32 v64, v40, s26, v64
    v_fma_f32 v65, v41, s26, v65
    v_fma_f32 v66, v42, s26, v66
    v_fma_f32 v67, v43, s26, v67
    buffer_load_dword v248, v249, s[44:47], s68 offen sc1
    s_waitcnt lgkmcnt(0)
    s_barrier
    ds_read_b64_tr_b16 v[76:77], v3 offset:1544
    ds_read_b64_tr_b16 v[78:79], v3 offset:1536
    ds_read_b128 v[80:83], v4 offset:192
    ds_read_b64_tr_b16 v[84:85], v3 offset:1032
    ds_read_b64_tr_b16 v[86:87], v3 offset:1024
    ds_read_b128 v[88:91], v4 offset:704
    ds_read_b64_tr_b16 v[112:113], v3 offset:520
    ds_read_b64_tr_b16 v[114:115], v3 offset:512
    ds_read_b128 v[148:151], v4 offset:1216
    ds_read_b64_tr_b16 v[152:153], v3 offset:8
    ds_read_b64_tr_b16 v[154:155], v3 offset:0
    s_waitcnt lgkmcnt(8)
    v_mfma_f32_16x16x32_bf16 v[128:131], v[76:79], v[80:83], 0
    v_min_u32 v240, 223, v0
    s_add_u32 s66, s9, 0
    buffer_store_dwordx4 v[24:27], v2, s[44:47], s66 offen offset:0 sc1
    s_waitcnt lgkmcnt(6)
    v_mfma_f32_16x16x32_bf16 v[124:127], v[84:87], v[80:83], 0
    v_lshrrev_b32 v241, 5, v240
    s_waitcnt lgkmcnt(5)
    v_mfma_f32_16x16x32_bf16 v[128:131], v[84:87], v[88:91], v[128:131]
    v_mul_u32_u24 v241, 384, v241
    s_waitcnt lgkmcnt(3)
    v_mfma_f32_16x16x32_bf16 v[120:123], v[112:115], v[80:83], 0
    ds_read_b128 v[156:159], v4 offset:1728
    v_mfma_f32_16x16x32_bf16 v[124:127], v[112:115], v[88:91], v[124:127]
    ds_read_b64_tr_b16 v[48:49], v3 offset:1608
    ds_read_b64_tr_b16 v[50:51], v3 offset:1600
    s_waitcnt lgkmcnt(5)
    v_mfma_f32_16x16x32_bf16 v[128:131], v[112:115], v[148:151], v[128:131]
    ds_read_b128 v[52:55], v4 offset:128
    s_waitcnt lgkmcnt(4)
    v_mfma_f32_16x16x32_bf16 v[116:119], v[152:155], v[80:83], 0
    ds_read_b64_tr_b16 v[56:57], v3 offset:1096
    v_mfma_f32_16x16x32_bf16 v[120:123], v[152:155], v[88:91], v[120:123]
    ds_read_b64_tr_b16 v[58:59], v3 offset:1088
    ds_read_b128 v[76:79], v4 offset:640
    v_mfma_f32_16x16x32_bf16 v[124:127], v[152:155], v[148:151], v[124:127]
    ds_read_b64_tr_b16 v[84:85], v3 offset:584
    ds_read_b64_tr_b16 v[86:87], v3 offset:576
    s_add_u32 s66, s9, 0
    buffer_store_dwordx4 v[24:27], v2, s[44:47], s66 offen offset:1024 sc1
    s_waitcnt lgkmcnt(8)
    v_mfma_f32_16x16x32_bf16 v[128:131], v[152:155], v[156:159], v[128:131]
    ds_read_b128 v[112:115], v4 offset:1152
    s_waitcnt lgkmcnt(6)
    v_mfma_f32_16x16x32_bf16 v[128:131], v[48:51], v[52:55], v[128:131]
    ds_read_b64_tr_b16 v[80:81], v3 offset:72
    s_waitcnt lgkmcnt(5)
    v_mfma_f32_16x16x32_bf16 v[124:127], v[56:59], v[52:55], v[124:127]
    ds_read_b64_tr_b16 v[82:83], v3 offset:64
    s_waitcnt lgkmcnt(5)
    v_mfma_f32_16x16x32_bf16 v[128:131], v[56:59], v[76:79], v[128:131]
    v_lshl_add_u32 v241, v240, 2, v241
    s_waitcnt lgkmcnt(3)
    v_mfma_f32_16x16x32_bf16 v[120:123], v[84:87], v[52:55], v[120:123]
    ds_read_b128 v[88:91], v4 offset:1664
    v_mfma_f32_16x16x32_bf16 v[124:127], v[84:87], v[76:79], v[124:127]
    ds_read_b64_tr_b16 v[148:149], v3 offset:1672
    ds_read_b64_tr_b16 v[150:151], v3 offset:1664
    s_waitcnt lgkmcnt(5)
    v_mfma_f32_16x16x32_bf16 v[128:131], v[84:87], v[112:115], v[128:131]
    ds_read_b128 v[156:159], v4 offset:64
    s_waitcnt lgkmcnt(4)
    v_mfma_f32_16x16x32_bf16 v[116:119], v[80:83], v[52:55], v[116:119]
    ds_read_b64_tr_b16 v[152:153], v3 offset:1160
    s_add_u32 s66, s10, 0
    buffer_store_dwordx4 v[24:27], v2, s[44:47], s66 offen offset:0 sc1
    v_mfma_f32_16x16x32_bf16 v[120:123], v[80:83], v[76:79], v[120:123]
    ds_read_b64_tr_b16 v[154:155], v3 offset:1152
    ds_read_b128 v[48:51], v4 offset:576
    v_mfma_f32_16x16x32_bf16 v[124:127], v[80:83], v[112:115], v[124:127]
    ds_read_b64_tr_b16 v[56:57], v3 offset:648
    ds_read_b64_tr_b16 v[58:59], v3 offset:640
    s_waitcnt lgkmcnt(8)
    v_mfma_f32_16x16x32_bf16 v[128:131], v[80:83], v[88:91], v[128:131]
    ds_read_b128 v[84:87], v4 offset:1088
    s_waitcnt lgkmcnt(6)
    v_mfma_f32_16x16x32_bf16 v[128:131], v[148:151], v[156:159], v[128:131]
    ds_read_b64_tr_b16 v[52:53], v3 offset:136
    s_waitcnt lgkmcnt(5)
    v_mfma_f32_16x16x32_bf16 v[124:127], v[152:155], v[156:159], v[124:127]
    ds_read_b64_tr_b16 v[54:55], v3 offset:128
    s_waitcnt vmcnt(3)
    v_cmp_ne_u32 vcc, 1, v248
    s_cbranch_vccnz L_m_s18
L_m_r19:
    buffer_load_dwordx4 a[0:3], v2, s[44:47], s72 offen offset:0 sc1
    buffer_load_dwordx4 a[4:7], v2, s[44:47], s72 offen offset:1024 sc1
    buffer_load_dwordx4 a[8:11], v2, s[44:47], s72 offen offset:2048 sc1
    buffer_load_dwordx4 a[12:15], v2, s[44:47], s72 offen offset:3072 sc1
    s_add_u32 s72, s72, 4096
    buffer_load_dwordx4 a[16:19], v2, s[44:47], s72 offen offset:0 sc1
    buffer_load_dwordx4 a[20:23], v2, s[44:47], s72 offen offset:1024 sc1
    buffer_load_dwordx4 a[24:27], v2, s[44:47], s72 offen offset:2048 sc1
    buffer_load_dwordx4 a[28:31], v2, s[44:47], s72 offen offset:3072 sc1
    s_waitcnt lgkmcnt(5)
    v_mfma_f32_16x16x32_bf16 v[128:131], v[152:155], v[48:51], v[128:131]
    s_mul_i32 s69, s5, 3584
    s_waitcnt lgkmcnt(3)
    v_mfma_f32_16x16x32_bf16 v[120:123], v[56:59], v[156:159], v[120:123]
    ds_read_b128 v[76:79], v4 offset:1600
    v_mfma_f32_16x16x32_bf16 v[124:127], v[56:59], v[48:51], v[124:127]
    ds_read_b64_tr_b16 v[112:113], v3 offset:1736
    ds_read_b64_tr_b16 v[114:115], v3 offset:1728
    s_add_u32 m0, s74, 0
    s_add_u32 s87, s73, 0
    buffer_load_dwordx4 v2, s[44:47], s87 offen offset:0 sc1 lds
    s_add_u32 s66, s10, 0
    buffer_store_dwordx4 v[24:27], v2, s[44:47], s66 offen offset:1024 sc1
    s_waitcnt lgkmcnt(5)
    v_mfma_f32_16x16x32_bf16 v[128:131], v[56:59], v[84:87], v[128:131]
    ds_read_b128 v[88:91], v4 offset:0
    s_waitcnt lgkmcnt(4)
    v_mfma_f32_16x16x32_bf16 v[116:119], v[52:55], v[156:159], v[116:119]
    ds_read_b64_tr_b16 v[80:81], v3 offset:1224
    v_mfma_f32_16x16x32_bf16 v[120:123], v[52:55], v[48:51], v[120:123]
    ds_read_b64_tr_b16 v[82:83], v3 offset:1216
    ds_read_b128 v[148:151], v4 offset:512
    buffer_load_dwordx4 v2, s[44:47], s87 offen offset:1024 sc1 lds
    v_mfma_f32_16x16x32_bf16 v[124:127], v[52:55], v[84:87], v[124:127]
    ds_read_b64_tr_b16 v[152:153], v3 offset:712
    ds_read_b64_tr_b16 v[154:155], v3 offset:704
    s_waitcnt lgkmcnt(8)
    v_mfma_f32_16x16x32_bf16 v[128:131], v[52:55], v[76:79], v[128:131]
    ds_read_b128 v[56:59], v4 offset:1024
    s_waitcnt lgkmcnt(6)
    v_mfma_f32_16x16x32_bf16 v[128:131], v[112:115], v[88:91], v[128:131]
    ds_read_b64_tr_b16 v[156:157], v3 offset:200
    s_add_u32 m0, s74, 31744
    s_add_u32 s87, s73, 32768
    buffer_load_dwordx4 v2, s[44:47], s87 offen offset:0 sc1 lds
    s_waitcnt lgkmcnt(5)
    v_mfma_f32_16x16x32_bf16 v[124:127], v[80:83], v[88:91], v[124:127]
    ds_read_b64_tr_b16 v[158:159], v3 offset:192
    s_waitcnt lgkmcnt(5)
    v_mfma_f32_16x16x32_bf16 v[128:131], v[80:83], v[148:151], v[128:131]
    s_add_u32 s69, s69, 8749056
    s_add_u32 s66, s9, 3670016
    buffer_store_dwordx4 v[24:27], v2, s[44:47], s66 offen offset:0 sc1
    s_waitcnt lgkmcnt(3)
    v_mfma_f32_16x16x32_bf16 v[120:123], v[152:155], v[88:91], v[120:123]
    ds_read_b128 v[48:51], v4 offset:1536
    buffer_load_dwordx4 v2, s[44:47], s87 offen offset:1024 sc1 lds
    v_mfma_f32_16x16x32_bf16 v[124:127], v[152:155], v[148:151], v[124:127]
    buffer_load_dword v244, v241, s[44:47], s69 offen offset:0 sc1
    s_waitcnt lgkmcnt(3)
    v_mfma_f32_16x16x32_bf16 v[128:131], v[152:155], v[56:59], v[128:131]
    buffer_load_dword v245, v241, s[44:47], s69 offen offset:128 sc1
    s_waitcnt lgkmcnt(1)
    v_mfma_f32_16x16x32_bf16 v[116:119], v[156:159], v[88:91], v[116:119]
    buffer_load_dword v246, v241, s[44:47], s69 offen offset:256 sc1
    s_add_u32 m0, s74, 63488
    s_add_u32 s87, s73, 65536
    buffer_load_dwordx4 v2, s[44:47], s87 offen offset:0 sc1 lds
    v_mfma_f32_16x16x32_bf16 v[120:123], v[156:159], v[148:151], v[120:123]
    buffer_load_dword v247, v241, s[44:47], s69 offen offset:384 sc1
    v_mfma_f32_16x16x32_bf16 v[124:127], v[156:159], v[56:59], v[124:127]
    v_lshlrev_b32 v240, 2, v240
    v_add_u32 v240, 95232, v240
    s_waitcnt lgkmcnt(0)
    v_mfma_f32_16x16x32_bf16 v[128:131], v[156:159], v[48:51], v[128:131]
    buffer_load_dwordx4 v2, s[44:47], s87 offen offset:1024 sc1 lds
    ds_read_b64_tr_b16 v[84:85], v3 offset:520
    ds_read_b64_tr_b16 v[86:87], v3 offset:512
    ds_read_b128 v[52:55], v4 offset:1728
    ds_read_b64_tr_b16 v[76:77], v3 offset:1032
    ds_read_b64_tr_b16 v[78:79], v3 offset:1024
    ds_read_b128 v[112:115], v4 offset:1216
    ds_read_b64_tr_b16 v[80:81], v3 offset:1544
    ds_read_b64_tr_b16 v[82:83], v3 offset:1536
    ds_read_b128 v[152:155], v4 offset:704
    ds_read_b64_tr_b16 v[88:89], v3 offset:2056
    ds_read_b64_tr_b16 v[90:91], v3 offset:2048
    ds_read_b128 v[148:151], v4 offset:192
    s_waitcnt lgkmcnt(9)
    v_mfma_f32_16x16x32_bf16 v[132:135], v[84:87], v[52:55], 0
    s_add_u32 m0, s74, 8192
    s_add_u32 s87, s73, 8192
    buffer_load_dwordx4 v2, s[44:47], s87 offen offset:0 sc1 lds
    s_add_u32 s66, s9, 3670016
    buffer_store_dwordx4 v[24:27], v2, s[44:47], s66 offen offset:1024 sc1
    s_waitcnt lgkmcnt(6)
    v_mfma_f32_16x16x32_bf16 v[132:135], v[76:79], v[112:115], v[132:135]
    ds_write_b128 v8, v[116:119] offset:0
    ds_write_b128 v8, v[120:123] offset:1024
    ds_write_b128 v8, v[124:127] offset:2048
    ds_write_b128 v8, v[128:131] offset:3072
    v_mfma_f32_16x16x32_bf16 v[136:139], v[76:79], v[52:55], 0
    s_waitcnt lgkmcnt(7)
    v_mfma_f32_16x16x32_bf16 v[132:135], v[80:83], v[152:155], v[132:135]
    s_waitcnt lgkmcnt(0)
    s_barrier
    ds_read_b128 v[28:31], v9 offset:0
    ds_read_b128 v[32:35], v9 offset:4096
    ds_read_b128 v[36:39], v9 offset:8192
    ds_read_b128 v[40:43], v9 offset:12288
    buffer_load_dwordx4 v2, s[44:47], s87 offen offset:1024 sc1 lds
    v_mfma_f32_16x16x32_bf16 v[136:139], v[80:83], v[112:115], v[136:139]
    ds_read_b64_tr_b16 v[56:57], v3 offset:2568
    ds_read_b64_tr_b16 v[58:59], v3 offset:2560
    v_mfma_f32_16x16x32_bf16 v[140:143], v[80:83], v[52:55], 0
    v_mfma_f32_16x16x32_bf16 v[132:135], v[88:91], v[148:151], v[132:135]
    s_waitcnt lgkmcnt(4)
    v_add_f32 v60, v60, v28
    v_add_f32 v61, v61, v29
    v_add_f32 v62, v62, v30
    v_add_f32 v63, v63, v31
    v_add_f32 v60, v60, v32
    v_add_f32 v61, v61, v33
    v_add_f32 v62, v62, v34
    s_add_u32 m0, s74, 39936
    s_add_u32 s87, s73, 40960
    buffer_load_dwordx4 v2, s[44:47], s87 offen offset:0 sc1 lds
    v_mfma_f32_16x16x32_bf16 v[136:139], v[88:91], v[152:155], v[136:139]
    ds_read_b64_tr_b16 v[156:157], v3 offset:3080
    ds_read_b64_tr_b16 v[158:159], v3 offset:3072
    v_add_f32 v63, v63, v35
    v_max_u32 v61, s54, v61
    v_max_i32 v61, 0xa0000000, v61
    s_waitcnt lgkmcnt(4)
    v_add_f32 v64, v64, v36
    v_add_f32 v65, v65, v37
    v_add_f32 v66, v66, v38
    v_add_f32 v67, v67, v39
    v_mfma_f32_16x16x32_bf16 v[140:143], v[88:91], v[112:115], v[140:143]
    v_add_f32 v64, v64, v40
    v_add_f32 v65, v65, v41
    v_add_f32 v66, v66, v42
    v_add_f32 v67, v67, v43
    v_cvt_pk_bf16_f32 v28, v60, v61
    v_cvt_pk_bf16_f32 v29, v62, v63
    v_cvt_pk_bf16_f32 v30, v64, v65
    v_cvt_pk_bf16_f32 v31, v66, v67
    s_add_u32 s66, s10, 3670016
    buffer_store_dwordx4 v[24:27], v2, s[44:47], s66 offen offset:0 sc1
    v_mfma_f32_16x16x32_bf16 v[144:147], v[88:91], v[52:55], 0
    ds_read_b64_tr_b16 v[48:49], v3 offset:3592
    ds_read_b64_tr_b16 v[50:51], v3 offset:3584
    s_add_u32 s66, s7, 0
    buffer_store_dwordx4 v[28:31], v10, s[44:47], s66 offen sc1
    buffer_load_dwordx4 v2, s[44:47], s87 offen offset:1024 sc1 lds
    s_waitcnt lgkmcnt(4)
    v_mfma_f32_16x16x32_bf16 v[136:139], v[56:59], v[148:151], v[136:139]
    ds_read_b64_tr_b16 v[84:85], v3 offset:584
    v_mfma_f32_16x16x32_bf16 v[140:143], v[56:59], v[152:155], v[140:143]
    ds_read_b64_tr_b16 v[86:87], v3 offset:576
    ds_read_b128 v[76:79], v4 offset:1664
    v_mfma_f32_16x16x32_bf16 v[144:147], v[56:59], v[112:115], v[144:147]
    ds_read_b64_tr_b16 v[80:81], v3 offset:1096
    ds_read_b64_tr_b16 v[82:83], v3 offset:1088
    s_add_u32 m0, s74, 71680
    s_add_u32 s87, s73, 73728
    buffer_load_dwordx4 v2, s[44:47], s87 offen offset:0 sc1 lds
    s_waitcnt lgkmcnt(7)
    v_mfma_f32_16x16x32_bf16 v[140:143], v[156:159], v[148:151], v[140:143]
    ds_read_b128 v[88:91], v4 offset:1152
    v_mfma_f32_16x16x32_bf16 v[144:147], v[156:159], v[152:155], v[144:147]
    ds_read_b64_tr_b16 v[52:53], v3 offset:1608
    ds_read_b64_tr_b16 v[54:55], v3 offset:1600
    s_waitcnt lgkmcnt(8)
    v_mfma_f32_16x16x32_bf16 v[144:147], v[48:51], v[148:151], v[144:147]
    ds_read_b128 v[56:59], v4 offset:640
    buffer_load_dwordx4 v2, s[44:47], s87 offen offset:1024 sc1 lds
    s_waitcnt lgkmcnt(6)
    v_mfma_f32_16x16x32_bf16 v[132:135], v[84:87], v[76:79], v[132:135]
    ds_read_b64_tr_b16 v[112:113], v3 offset:2120
    s_add_u32 s66, s10, 3670016
    buffer_store_dwordx4 v[24:27], v2, s[44:47], s66 offen offset:1024 sc1
    s_waitcnt lgkmcnt(4)
    v_mfma_f32_16x16x32_bf16 v[132:135], v[80:83], v[88:91], v[132:135]
    ds_read_b64_tr_b16 v[114:115], v3 offset:2112
    v_mfma_f32_16x16x32_bf16 v[136:139], v[80:83], v[76:79], v[136:139]
    ds_read_b128 v[156:159], v4 offset:128
    s_add_u32 m0, s74, 16384
    s_add_u32 s87, s73, 16384
    buffer_load_dwordx4 v2, s[44:47], s87 offen offset:0 sc1 lds
    s_waitcnt lgkmcnt(3)
    v_mfma_f32_16x16x32_bf16 v[132:135], v[52:55], v[56:59], v[132:135]
    v_mfma_f32_16x16x32_bf16 v[136:139], v[52:55], v[88:91], v[136:139]
    ds_read_b64_tr_b16 v[152:153], v3 offset:2632
    ds_read_b64_tr_b16 v[154:155], v3 offset:2624
    v_mfma_f32_16x16x32_bf16 v[140:143], v[52:55], v[76:79], v[140:143]
    buffer_load_dwordx4 v2, s[44:47], s87 offen offset:1024 sc1 lds
    s_waitcnt lgkmcnt(2)
    v_mfma_f32_16x16x32_bf16 v[132:135], v[112:115], v[156:159], v[132:135]
    v_mfma_f32_16x16x32_bf16 v[136:139], v[112:115], v[56:59], v[136:139]
    ds_read_b64_tr_b16 v[48:49], v3 offset:3144
    ds_read_b64_tr_b16 v[50:51], v3 offset:3136
    v_mfma_f32_16x16x32_bf16 v[140:143], v[112:115], v[88:91], v[140:143]
    v_min3_f32 v100, |v92|, |v94|, |v96|
    v_min3_f32 v100, v100, |v98|, |v108|
    v_cmp_gt_f32 vcc, s54, v100
    s_cbranch_vccnz L_m_s20
L_m_r21:
    s_add_u32 m0, s74, 48128
    s_add_u32 s87, s73, 49152
    buffer_load_dwordx4 v2, s[44:47], s87 offen offset:0 sc1 lds
    v_mfma_f32_16x16x32_bf16 v[144:147], v[112:115], v[76:79], v[144:147]
    ds_read_b64_tr_b16 v[148:149], v3 offset:3656
    ds_read_b64_tr_b16 v[150:151], v3 offset:3648
    s_waitcnt lgkmcnt(4)
    v_mfma_f32_16x16x32_bf16 v[136:139], v[152:155], v[156:159], v[136:139]
    ds_read_b64_tr_b16 v[84:85], v3 offset:648
    v_mfma_f32_16x16x32_bf16 v[140:143], v[152:155], v[56:59], v[140:143]
    ds_read_b64_tr_b16 v[86:87], v3 offset:640
    ds_read_b128 v[80:83], v4 offset:1600
    buffer_load_dwordx4 v2, s[44:47], s87 offen offset:1024 sc1 lds
    v_mfma_f32_16x16x32_bf16 v[144:147], v[152:155], v[88:91], v[144:147]
    ds_read_b64_tr_b16 v[52:53], v3 offset:1160
    ds_read_b64_tr_b16 v[54:55], v3 offset:1152
    s_waitcnt lgkmcnt(7)
    v_mfma_f32_16x16x32_bf16 v[140:143], v[48:51], v[156:159], v[140:143]
    ds_read_b128 v[112:115], v4 offset:1088
    v_mfma_f32_16x16x32_bf16 v[144:147], v[48:51], v[56:59], v[144:147]
    ds_read_b64_tr_b16 v[76:77], v3 offset:1672
    ds_read_b64_tr_b16 v[78:79], v3 offset:1664
    s_add_u32 m0, s74, 79872
    s_add_u32 s87, s73, 81920
    buffer_load_dwordx4 v2, s[44:47], s87 offen offset:0 sc1 lds
    s_waitcnt lgkmcnt(8)
    v_mfma_f32_16x16x32_bf16 v[144:147], v[148:151], v[156:159], v[144:147]
    ds_read_b128 v[152:155], v4 offset:576
    s_waitcnt lgkmcnt(6)
    v_mfma_f32_16x16x32_bf16 v[132:135], v[84:87], v[80:83], v[132:135]
    ds_read_b64_tr_b16 v[88:89], v3 offset:2184
    s_waitcnt lgkmcnt(4)
    v_mfma_f32_16x16x32_bf16 v[132:135], v[52:55], v[112:115], v[132:135]
    ds_read_b64_tr_b16 v[90:91], v3 offset:2176
    buffer_load_dwordx4 v2, s[44:47], s87 offen offset:1024 sc1 lds
    v_mfma_f32_16x16x32_bf16 v[136:139], v[52:55], v[80:83], v[136:139]
    ds_read_b128 v[56:59], v4 offset:64
    v_lshlrev_b32 v68, 16, v108
    s_waitcnt lgkmcnt(3)
    v_mfma_f32_16x16x32_bf16 v[132:135], v[76:79], v[152:155], v[132:135]
    v_and_b32 v72, 0xffff0000, v108
    v_mfma_f32_16x16x32_bf16 v[136:139], v[76:79], v[112:115], v[136:139]
    ds_read_b64_tr_b16 v[48:49], v3 offset:2696
    ds_read_b64_tr_b16 v[50:51], v3 offset:2688
    s_add_u32 m0, s74, 24576
    s_add_u32 s87, s73, 24576
    buffer_load_dwordx4 v2, s[44:47], s87 offen offset:0 sc1 lds
    v_mfma_f32_16x16x32_bf16 v[140:143], v[76:79], v[80:83], v[140:143]
    v_lshlrev_b32 v69, 16, v109
    v_and_b32 v73, 0xffff0000, v109
    s_waitcnt lgkmcnt(2)
    v_mfma_f32_16x16x32_bf16 v[132:135], v[88:91], v[56:59], v[132:135]
    v_lshlrev_b32 v70, 16, v110
    v_mfma_f32_16x16x32_bf16 v[136:139], v[88:91], v[152:155], v[136:139]
    ds_read_b64_tr_b16 v[156:157], v3 offset:3208
    ds_read_b64_tr_b16 v[158:159], v3 offset:3200
    s_mov_b32 m0, s84
    s_add_u32 s84, s84, s85
    buffer_load_dwordx4 v2, s[44:47], s87 offen offset:1024 sc1 lds
    v_mfma_f32_16x16x32_bf16 v[140:143], v[88:91], v[112:115], v[140:143]
    v_and_b32 v74, 0xffff0000, v110
    v_lshlrev_b32 v71, 16, v111
    v_perm_b32 v0, v172, v164, s18
    buffer_store_dwordx4 v[160:163], v2, s[44:47], s15 offen
    v_mfma_f32_16x16x32_bf16 v[144:147], v[88:91], v[80:83], v[144:147]
    ds_read_b64_tr_b16 v[148:149], v3 offset:3720
    ds_read_b64_tr_b16 v[150:151], v3 offset:3712
    s_waitcnt lgkmcnt(4)
    v_mfma_f32_16x16x32_bf16 v[136:139], v[48:51], v[56:59], v[136:139]
    ds_read_b64_tr_b16 v[84:85], v3 offset:712
    s_add_u32 m0, s74, 56320
    s_add_u32 s87, s73, 57344
    buffer_load_dwordx4 v2, s[44:47], s87 offen offset:0 sc1 lds
    v_mfma_f32_16x16x32_bf16 v[140:143], v[48:51], v[152:155], v[140:143]
    ds_read_b64_tr_b16 v[86:87], v3 offset:704
    ds_read_b128 v[52:55], v4 offset:1536
    v_mfma_f32_16x16x32_bf16 v[144:147], v[48:51], v[112:115], v[144:147]
    ds_read_b64_tr_b16 v[76:77], v3 offset:1224
    ds_read_b64_tr_b16 v[78:79], v3 offset:1216
    s_waitcnt lgkmcnt(7)
    v_mfma_f32_16x16x32_bf16 v[140:143], v[156:159], v[56:59], v[140:143]
    ds_read_b128 v[88:91], v4 offset:1024
    s_mov_b32 m0, s84
    s_add_u32 s84, s84, s85
    buffer_load_dwordx4 v2, s[44:47], s87 offen offset:1024 sc1 lds
    v_mfma_f32_16x16x32_bf16 v[144:147], v[156:159], v[152:155], v[144:147]
    ds_read_b64_tr_b16 v[80:81], v3 offset:1736
    ds_read_b64_tr_b16 v[82:83], v3 offset:1728
    s_waitcnt lgkmcnt(8)
    v_mfma_f32_16x16x32_bf16 v[144:147], v[148:151], v[56:59], v[144:147]
    ds_read_b128 v[48:51], v4 offset:512
    s_waitcnt lgkmcnt(6)
    v_mfma_f32_16x16x32_bf16 v[132:135], v[84:87], v[52:55], v[132:135]
    ds_read_b64_tr_b16 v[112:113], v3 offset:2248
    buffer_store_dwordx4 v[168:171], v2, s[44:47], s16 offen
    s_add_u32 m0, s74, 88064
    s_add_u32 s87, s73, 90112
    buffer_load_dwordx4 v2, s[44:47], s87 offen offset:0 sc1 lds
    s_waitcnt lgkmcnt(4)
    v_mfma_f32_16x16x32_bf16 v[132:135], v[76:79], v[88:91], v[132:135]
    ds_read_b64_tr_b16 v[114:115], v3 offset:2240
    v_mfma_f32_16x16x32_bf16 v[136:139], v[76:79], v[52:55], v[136:139]
    ds_read_b128 v[152:155], v4 offset:0
    v_and_b32 v75, 0xffff0000, v111
    s_waitcnt lgkmcnt(3)
    v_mfma_f32_16x16x32_bf16 v[132:135], v[80:83], v[48:51], v[132:135]
    v_fma_f32 v100, v68, v92, v93
    s_mov_b32 m0, s84
    s_add_u32 s84, s84, s85
    buffer_load_dwordx4 v2, s[44:47], s87 offen offset:1024 sc1 lds
    v_mfma_f32_16x16x32_bf16 v[136:139], v[80:83], v[88:91], v[136:139]
    ds_read_b64_tr_b16 v[156:157], v3 offset:2760
    ds_read_b64_tr_b16 v[158:159], v3 offset:2752
    v_mfma_f32_16x16x32_bf16 v[140:143], v[80:83], v[52:55], v[140:143]
    v_fma_f32 v101, v69, v94, v95
    v_fma_f32 v102, v70, v96, v97
    s_waitcnt lgkmcnt(2)
    v_mfma_f32_16x16x32_bf16 v[132:135], v[112:115], v[152:155], v[132:135]
    v_fma_f32 v103, v71, v98, v99
    s_add_u32 s72, s72, 4096
    buffer_load_dwordx4 a[32:35], v2, s[44:47], s72 offen offset:0 sc1
    v_mfma_f32_16x16x32_bf16 v[136:139], v[112:115], v[48:51], v[136:139]
    ds_read_b64_tr_b16 v[148:149], v3 offset:3272
    ds_read_b64_tr_b16 v[150:151], v3 offset:3264
    v_mfma_f32_16x16x32_bf16 v[140:143], v[112:115], v[88:91], v[140:143]
    v_cvt_pk_bf16_f32 v108, v100, v101
    v_cvt_pk_bf16_f32 v109, v102, v103
    v_mfma_f32_16x16x32_bf16 v[144:147], v[112:115], v[52:55], v[144:147]
    ds_read_b64_tr_b16 v[56:57], v3 offset:3784
    ds_read_b64_tr_b16 v[58:59], v3 offset:3776
    buffer_load_dwordx4 a[36:39], v2, s[44:47], s72 offen offset:1024 sc1
    s_waitcnt lgkmcnt(4)
    v_mfma_f32_16x16x32_bf16 v[136:139], v[156:159], v[152:155], v[136:139]
    ds_write_b64 v7, v[108:109] offset:2048
    v_mfma_f32_16x16x32_bf16 v[140:143], v[156:159], v[48:51], v[140:143]
    v_fma_f32 v104, v72, v92, v93
    v_fma_f32 v105, v73, v94, v95
    v_mfma_f32_16x16x32_bf16 v[144:147], v[156:159], v[88:91], v[144:147]
    v_fma_f32 v106, v74, v96, v97
    v_fma_f32 v107, v75, v98, v99
    buffer_load_dwordx4 a[40:43], v2, s[44:47], s72 offen offset:2048 sc1
    s_waitcnt lgkmcnt(3)
    v_mfma_f32_16x16x32_bf16 v[140:143], v[148:151], v[152:155], v[140:143]
    v_cvt_pk_bf16_f32 v110, v104, v105
    v_mfma_f32_16x16x32_bf16 v[144:147], v[148:151], v[48:51], v[144:147]
    v_cvt_pk_bf16_f32 v111, v106, v107
    ds_write_b64 v7, v[110:111] offset:6656
    s_waitcnt lgkmcnt(2)
    v_mfma_f32_16x16x32_bf16 v[144:147], v[56:59], v[152:155], v[144:147]
    v_fma_f32 v68, v100, s24, v68
    buffer_load_dwordx4 a[44:47], v2, s[44:47], s72 offen offset:3072 sc1
    v_fma_f32 v69, v101, s24, v69
    v_fma_f32 v70, v102, s24, v70
    v_fma_f32 v71, v103, s24, v71
    v_fma_f32 v72, v104, s26, v72
    v_fma_f32 v73, v105, s26, v73
    v_fma_f32 v74, v106, s26, v74
    v_fma_f32 v75, v107, s26, v75
    s_lshl_b32 s56, s3, 12
    v_add_u32 v6, s56, v2
    s_waitcnt vmcnt(29)
    v_min3_f32 v242, |v244|, |v245|, |v246|
    v_min_f32 v242, v242, |v247|
    v_cmp_gt_f32 vcc, s54, v242
    s_cbranch_vccnz L_m_s22
L_m_r23:
    v_add_f32 v244, v244, v245
    v_add_f32 v246, v246, v247
    v_add_f32 v244, v244, v246
    v_mul_f32 v244, s23, v244
    ds_write_b32 v240, v244
    s_getpc_b64 s[56:57]
L_m_pc24:
    s_add_u32 s56, s56, L_m_g10-L_m_pc24
    s_addc_u32 s57, s57, 0
    s_bfe_u32 s58, s2, 0x50003
    s_mul_i32 s58, s58, 1024
    s_sub_u32 s58, s58, 65792
    v_lshrrev_b32 v240, 1, v7
    v_add_u32 v240, s58, v240
    v_min_u32 v240, L_code_end-L_m_g10-16, v240
    global_load_dword v241, v240, s[56:57]
    s_waitcnt lgkmcnt(1)
    s_barrier
    ds_read_b64_tr_b16 v[84:85], v3 offset:1544
    ds_read_b64_tr_b16 v[86:87], v3 offset:1536
    ds_read_b128 v[76:79], v4 offset:2240
    ds_read_b64_tr_b16 v[80:81], v3 offset:1032
    ds_read_b64_tr_b16 v[82:83], v3 offset:1024
    ds_read_b128 v[112:115], v4 offset:2752
    ds_read_b64_tr_b16 v[52:53], v3 offset:520
    ds_read_b64_tr_b16 v[54:55], v3 offset:512
    ds_read_b128 v[156:159], v4 offset:3264
    ds_read_b64_tr_b16 v[88:89], v3 offset:8
    ds_read_b64_tr_b16 v[90:91], v3 offset:0
    s_waitcnt lgkmcnt(8)
    v_mfma_f32_16x16x32_bf16 v[144:147], v[84:87], v[76:79], v[144:147]
    s_add_u32 s72, s72, 4096
    buffer_load_dwordx4 a[48:51], v2, s[44:47], s72 offen offset:0 sc1
    buffer_load_dwordx4 a[52:55], v2, s[44:47], s72 offen offset:1024 sc1
    s_waitcnt lgkmcnt(6)
    v_mfma_f32_16x16x32_bf16 v[140:143], v[80:83], v[76:79], v[140:143]
    buffer_load_dwordx4 a[56:59], v2, s[44:47], s72 offen offset:2048 sc1
    buffer_load_dwordx4 a[60:63], v2, s[44:47], s72 offen offset:3072 sc1
    s_waitcnt lgkmcnt(5)
    v_mfma_f32_16x16x32_bf16 v[144:147], v[80:83], v[112:115], v[144:147]
    s_add_u32 s72, s72, 4096
    buffer_load_dwordx4 a[64:67], v2, s[44:47], s72 offen offset:0 sc1
    buffer_load_dwordx4 a[68:71], v2, s[44:47], s72 offen offset:1024 sc1
    s_waitcnt lgkmcnt(3)
    v_mfma_f32_16x16x32_bf16 v[136:139], v[52:55], v[76:79], v[136:139]
    ds_read_b128 v[48:51], v4 offset:3776
    buffer_load_dwordx4 a[72:75], v2, s[44:47], s72 offen offset:2048 sc1
    buffer_load_dwordx4 a[76:79], v2, s[44:47], s72 offen offset:3072 sc1
    v_mfma_f32_16x16x32_bf16 v[140:143], v[52:55], v[112:115], v[140:143]
    ds_read_b64_tr_b16 v[148:149], v3 offset:1608
    ds_read_b64_tr_b16 v[150:151], v3 offset:1600
    buffer_load_dwordx4 v[24:27], v2, s[44:47], s67 offen sc1
    s_waitcnt lgkmcnt(5)
    v_mfma_f32_16x16x32_bf16 v[144:147], v[52:55], v[156:159], v[144:147]
    ds_read_b128 v[56:59], v4 offset:2176
    s_waitcnt lgkmcnt(4)
    v_mfma_f32_16x16x32_bf16 v[132:135], v[88:91], v[76:79], v[132:135]
    ds_read_b64_tr_b16 v[152:153], v3 offset:1096
    v_mfma_f32_16x16x32_bf16 v[136:139], v[88:91], v[112:115], v[136:139]
    ds_read_b64_tr_b16 v[154:155], v3 offset:1088
    ds_read_b128 v[84:87], v4 offset:2688
    v_mfma_f32_16x16x32_bf16 v[140:143], v[88:91], v[156:159], v[140:143]
    ds_read_b64_tr_b16 v[80:81], v3 offset:584
    ds_read_b64_tr_b16 v[82:83], v3 offset:576
    s_waitcnt lgkmcnt(8)
    v_mfma_f32_16x16x32_bf16 v[144:147], v[88:91], v[48:51], v[144:147]
    ds_read_b128 v[52:55], v4 offset:3200
    s_waitcnt lgkmcnt(6)
    v_mfma_f32_16x16x32_bf16 v[144:147], v[148:151], v[56:59], v[144:147]
    ds_read_b64_tr_b16 v[76:77], v3 offset:72
    s_waitcnt lgkmcnt(5)
    v_mfma_f32_16x16x32_bf16 v[140:143], v[152:155], v[56:59], v[140:143]
    ds_read_b64_tr_b16 v[78:79], v3 offset:64
    s_waitcnt lgkmcnt(5)
    v_mfma_f32_16x16x32_bf16 v[144:147], v[152:155], v[84:87], v[144:147]
    s_waitcnt lgkmcnt(3)
    v_mfma_f32_16x16x32_bf16 v[136:139], v[80:83], v[56:59], v[136:139]
    ds_read_b128 v[112:115], v4 offset:3712
    v_mfma_f32_16x16x32_bf16 v[140:143], v[80:83], v[84:87], v[140:143]
    ds_read_b64_tr_b16 v[156:157], v3 offset:1672
    ds_read_b64_tr_b16 v[158:159], v3 offset:1664
    s_waitcnt lgkmcnt(5)
    v_mfma_f32_16x16x32_bf16 v[144:147], v[80:83], v[52:55], v[144:147]
    ds_read_b128 v[88:91], v4 offset:2112
    s_waitcnt lgkmcnt(4)
    v_mfma_f32_16x16x32_bf16 v[132:135], v[76:79], v[56:59], v[132:135]
    ds_read_b64_tr_b16 v[48:49], v3 offset:1160
    v_mfma_f32_16x16x32_bf16 v[136:139], v[76:79], v[84:87], v[136:139]
    ds_read_b64_tr_b16 v[50:51], v3 offset:1152
    ds_read_b128 v[148:151], v4 offset:2624
    v_mfma_f32_16x16x32_bf16 v[140:143], v[76:79], v[52:55], v[140:143]
    ds_read_b64_tr_b16 v[152:153], v3 offset:648
    ds_read_b64_tr_b16 v[154:155], v3 offset:640
    s_waitcnt lgkmcnt(8)
    v_mfma_f32_16x16x32_bf16 v[144:147], v[76:79], v[112:115], v[144:147]
    ds_read_b128 v[80:83], v4 offset:3136
    s_waitcnt lgkmcnt(6)
    v_mfma_f32_16x16x32_bf16 v[144:147], v[156:159], v[88:91], v[144:147]
    ds_read_b64_tr_b16 v[56:57], v3 offset:136
    s_waitcnt lgkmcnt(5)
    v_mfma_f32_16x16x32_bf16 v[140:143], v[48:51], v[88:91], v[140:143]
    ds_read_b64_tr_b16 v[58:59], v3 offset:128
    s_waitcnt lgkmcnt(5)
    v_mfma_f32_16x16x32_bf16 v[144:147], v[48:51], v[148:151], v[144:147]
    s_waitcnt lgkmcnt(3)
    v_mfma_f32_16x16x32_bf16 v[136:139], v[152:155], v[88:91], v[136:139]
    ds_read_b128 v[84:87], v4 offset:3648
    v_mfma_f32_16x16x32_bf16 v[140:143], v[152:155], v[148:151], v[140:143]
    ds_read_b64_tr_b16 v[52:53], v3 offset:1736
    ds_read_b64_tr_b16 v[54:55], v3 offset:1728
    s_add_u32 s64, s8, 2162688
    buffer_load_dwordx4 v[28:31], v2, s[44:47], s64 offen sc1
    s_add_u32 s64, s8, 2166784
    buffer_load_dwordx4 v[32:35], v2, s[44:47], s64 offen sc1
    s_waitcnt lgkmcnt(5)
    v_mfma_f32_16x16x32_bf16 v[144:147], v[152:155], v[80:83], v[144:147]
    ds_read_b128 v[76:79], v4 offset:2048
    s_add_u32 s64, s8, 2170880
    buffer_load_dwordx4 v[60:63], v2, s[44:47], s64 offen sc1
    s_add_u32 s64, s8, 2174976
    buffer_load_dwordx4 v[64:67], v2, s[44:47], s64 offen sc1
    s_waitcnt lgkmcnt(4)
    v_mfma_f32_16x16x32_bf16 v[132:135], v[56:59], v[88:91], v[132:135]
    ds_read_b64_tr_b16 v[112:113], v3 offset:1224
    s_add_u32 s64, s8, 2179072
    buffer_load_dwordx4 v[116:119], v2, s[44:47], s64 offen sc1
    s_add_u32 s64, s8, 2183168
    buffer_load_dwordx4 v[120:123], v2, s[44:47], s64 offen sc1
    v_mfma_f32_16x16x32_bf16 v[136:139], v[56:59], v[148:151], v[136:139]
    ds_read_b64_tr_b16 v[114:115], v3 offset:1216
    ds_read_b128 v[156:159], v4 offset:2560
    s_add_u32 s64, s8, 2187264
    buffer_load_dwordx4 v[124:127], v2, s[44:47], s64 offen sc1
    s_add_u32 s64, s8, 2191360
    buffer_load_dwordx4 v[128:131], v2, s[44:47], s64 offen sc1
    v_mfma_f32_16x16x32_bf16 v[140:143], v[56:59], v[80:83], v[140:143]
    ds_read_b64_tr_b16 v[48:49], v3 offset:712
    ds_read_b64_tr_b16 v[50:51], v3 offset:704
    s_add_u32 s72, s72, 4096
    buffer_load_dwordx4 a[80:83], v2, s[44:47], s72 offen offset:0 sc1
    buffer_load_dwordx4 a[84:87], v2, s[44:47], s72 offen offset:1024 sc1
    s_waitcnt lgkmcnt(8)
    v_mfma_f32_16x16x32_bf16 v[144:147], v[56:59], v[84:87], v[144:147]
    ds_read_b128 v[152:155], v4 offset:3072
    buffer_load_dwordx4 a[88:91], v2, s[44:47], s72 offen offset:2048 sc1
    buffer_load_dwordx4 a[92:95], v2, s[44:47], s72 offen offset:3072 sc1
    s_waitcnt lgkmcnt(6)
    v_mfma_f32_16x16x32_bf16 v[144:147], v[52:55], v[76:79], v[144:147]
    ds_read_b64_tr_b16 v[88:89], v3 offset:200
    s_waitcnt lgkmcnt(5)
    v_mfma_f32_16x16x32_bf16 v[140:143], v[112:115], v[76:79], v[140:143]
    ds_read_b64_tr_b16 v[90:91], v3 offset:192
    s_waitcnt lgkmcnt(5)
    v_mfma_f32_16x16x32_bf16 v[144:147], v[112:115], v[156:159], v[144:147]
    s_waitcnt lgkmcnt(3)
    v_mfma_f32_16x16x32_bf16 v[136:139], v[48:51], v[76:79], v[136:139]
    ds_read_b128 v[148:151], v4 offset:3584
    v_mfma_f32_16x16x32_bf16 v[140:143], v[48:51], v[156:159], v[140:143]
    s_waitcnt lgkmcnt(3)
    v_mfma_f32_16x16x32_bf16 v[144:147], v[48:51], v[152:155], v[144:147]
    s_waitcnt lgkmcnt(1)
    v_mfma_f32_16x16x32_bf16 v[132:135], v[88:91], v[76:79], v[132:135]
    v_mfma_f32_16x16x32_bf16 v[136:139], v[88:91], v[156:159], v[136:139]
    v_mfma_f32_16x16x32_bf16 v[140:143], v[88:91], v[152:155], v[140:143]
    s_waitcnt lgkmcnt(0)
    v_mfma_f32_16x16x32_bf16 v[144:147], v[88:91], v[148:151], v[144:147]
    s_nop 3
    ds_write_b128 v8, v[132:135] offset:0
    ds_write_b128 v8, v[136:139] offset:1024
    ds_write_b128 v8, v[140:143] offset:2048
    s_nop 0
    ds_write_b128 v8, v[144:147] offset:3072
    s_waitcnt vmcnt(40) lgkmcnt(0)
    s_barrier
    ds_read_b128 v[92:95], v9 offset:0
    ds_read_b128 v[96:99], v9 offset:4096
    ds_read_b128 v[100:103], v9 offset:8192
    ds_read_b128 v[104:107], v9 offset:12288
    s_waitcnt lgkmcnt(2)
    v_add_f32 v68, v68, v92
    v_add_f32 v69, v69, v93
    v_add_f32 v70, v70, v94
    v_add_f32 v71, v71, v95
    v_add_f32 v68, v68, v96
    v_add_f32 v69, v69, v97
    v_add_f32 v70, v70, v98
    v_add_f32 v71, v71, v99
    v_max_u32 v69, s54, v69
    v_max_i32 v69, 0xa0000000, v69
    s_waitcnt lgkmcnt(0)
    v_add_f32 v72, v72, v100
    v_add_f32 v73, v73, v101
    v_add_f32 v74, v74, v102
    v_add_f32 v75, v75, v103
    v_add_f32 v72, v72, v104
    v_add_f32 v73, v73, v105
    v_add_f32 v74, v74, v106
    v_add_f32 v75, v75, v107
    v_cvt_pk_bf16_f32 v92, v68, v69
    v_cvt_pk_bf16_f32 v93, v70, v71
    v_cvt_pk_bf16_f32 v94, v72, v73
    v_cvt_pk_bf16_f32 v95, v74, v75
    s_add_u32 s66, s7, 1052672
    buffer_store_dwordx4 v[92:95], v10, s[44:47], s66 offen sc1
    s_add_u32 s72, s72, 4096
    buffer_load_dwordx4 a[96:99], v2, s[44:47], s72 offen offset:0 sc1
    buffer_load_dwordx4 a[100:103], v2, s[44:47], s72 offen offset:1024 sc1
    buffer_load_dwordx4 a[104:107], v2, s[44:47], s72 offen offset:2048 sc1
    buffer_load_dwordx4 a[108:111], v2, s[44:47], s72 offen offset:3072 sc1
    s_waitcnt vmcnt(9)
    v_min3_f32 v112, |v28|, |v32|, |v60|
    v_min3_f32 v112, v112, |v64|, |v116|
    v_min3_f32 v112, v112, |v120|, |v124|
    v_min_f32 v112, v112, |v128|
    v_cmp_gt_f32 vcc, s54, v112
    s_cbranch_vccnz L_m_s25
L_m_r26:
    ds_write_b128 v11, v[28:31] offset:0
    ds_write_b128 v11, v[32:35] offset:4096
    ds_write_b128 v11, v[60:63] offset:8192
    ds_write_b128 v11, v[64:67] offset:12288
    s_waitcnt lgkmcnt(0)
    s_barrier
L_m_g10:
    s_cmp_eq_u32 s3, 3
    s_cbranch_scc1 L_m_w327
    ds_read_b64_tr_b16 v[92:93], v12 offset:0
    ds_read_b64_tr_b16 v[94:95], v12 offset:256
    ds_read_b128 v[96:99], v13 offset:0
    ds_read_b64_tr_b16 v[100:101], v12 offset:1024
    ds_read_b64_tr_b16 v[102:103], v12 offset:1280
    ds_read_b128 v[104:107], v13 offset:1024
    ds_read_b64_tr_b16 v[108:109], v12 offset:2048
    ds_read_b64_tr_b16 v[110:111], v12 offset:2304
    s_waitcnt lgkmcnt(6)
    v_mfma_f32_32x32x16_bf16 v[28:43], a[0:3], v[92:95], 0
    ds_write_b128 v11, v[116:119] offset:16384
    s_add_u32 s72, s72, 4096
    buffer_load_dwordx4 a[112:115], v2, s[44:47], s72 offen offset:0 sc1
    s_waitcnt lgkmcnt(6)
    v_mfma_f32_32x32x16_bf16 v[44:59], v[96:99], v[92:95], 0
    ds_read_b128 v[112:115], v13 offset:2048
    ds_write_b128 v11, v[120:123] offset:20480
    s_waitcnt lgkmcnt(6)
    v_mfma_f32_32x32x16_bf16 v[28:43], a[4:7], v[100:103], v[28:43]
    ds_read_b64_tr_b16 v[92:93], v12 offset:3072
    ds_read_b64_tr_b16 v[94:95], v12 offset:3328
    ds_write_b128 v11, v[124:127] offset:24576
    buffer_load_dwordx4 a[116:119], v2, s[44:47], s72 offen offset:1024 sc1
    s_waitcnt lgkmcnt(8)
    v_mfma_f32_32x32x16_bf16 v[44:59], v[104:107], v[100:103], v[44:59]
    ds_read_b128 v[96:99], v13 offset:3072
    ds_write_b128 v11, v[128:131] offset:28672
    s_waitcnt lgkmcnt(8)
    v_mfma_f32_32x32x16_bf16 v[28:43], a[8:11], v[108:111], v[28:43]
    ds_read_b64_tr_b16 v[100:101], v12 offset:4096
    ds_read_b64_tr_b16 v[102:103], v12 offset:4352
    buffer_load_dwordx4 a[120:123], v2, s[44:47], s72 offen offset:2048 sc1
    s_waitcnt lgkmcnt(8)
    v_mfma_f32_32x32x16_bf16 v[44:59], v[112:115], v[108:111], v[44:59]
    ds_read_b128 v[104:107], v13 offset:4096
    s_waitcnt lgkmcnt(6)
    v_mfma_f32_32x32x16_bf16 v[28:43], a[12:15], v[92:95], v[28:43]
    ds_read_b64_tr_b16 v[108:109], v12 offset:5120
    ds_read_b64_tr_b16 v[110:111], v12 offset:5376
    buffer_load_dwordx4 a[124:127], v2, s[44:47], s72 offen offset:3072 sc1
    s_waitcnt lgkmcnt(6)
    v_mfma_f32_32x32x16_bf16 v[44:59], v[96:99], v[92:95], v[44:59]
    ds_read_b128 v[112:115], v13 offset:5120
    s_waitcnt lgkmcnt(4)
    v_mfma_f32_32x32x16_bf16 v[28:43], a[16:19], v[100:103], v[28:43]
    ds_read_b64_tr_b16 v[92:93], v12 offset:6144
    ds_read_b64_tr_b16 v[94:95], v12 offset:6400
    s_sub_u32 s94, s78, s11
    s_lshl_b32 s94, s94, 1
    s_add_u32 s94, s94, s75
    buffer_load_dwordx4 a[128:131], v2, s[44:47], s94 offen offset:0 sc1
    s_waitcnt lgkmcnt(5)
    v_mfma_f32_32x32x16_bf16 v[44:59], v[104:107], v[100:103], v[44:59]
    ds_read_b128 v[96:99], v13 offset:6144
    s_waitcnt lgkmcnt(4)
    v_mfma_f32_32x32x16_bf16 v[28:43], a[20:23], v[108:111], v[28:43]
    ds_read_b64_tr_b16 v[100:101], v12 offset:7168
    ds_read_b64_tr_b16 v[102:103], v12 offset:7424
    buffer_load_dwordx4 a[132:135], v2, s[44:47], s94 offen offset:1024 sc1
    s_waitcnt lgkmcnt(5)
    v_mfma_f32_32x32x16_bf16 v[44:59], v[112:115], v[108:111], v[44:59]
    ds_read_b128 v[104:107], v13 offset:7168
    s_barrier
    s_waitcnt lgkmcnt(4)
    v_mfma_f32_32x32x16_bf16 v[28:43], a[24:27], v[92:95], v[28:43]
    ds_read_b64_tr_b16 v[112:113], v12 offset:8192
    ds_read_b64_tr_b16 v[114:115], v12 offset:8448
    s_add_u32 s94, s94, 8192
    buffer_load_dwordx4 a[160:163], v2, s[44:47], s94 offen offset:0 sc1
    s_waitcnt lgkmcnt(5)
    v_mfma_f32_32x32x16_bf16 v[44:59], v[96:99], v[92:95], v[44:59]
    ds_read_b128 v[108:111], v13 offset:8192
    s_waitcnt lgkmcnt(4)
    v_mfma_f32_32x32x16_bf16 v[28:43], a[28:31], v[100:103], v[28:43]
    ds_read_b64_tr_b16 v[92:93], v12 offset:9216
    ds_read_b64_tr_b16 v[94:95], v12 offset:9472
    ds_read_b128 v[148:151], v19 offset:0
    buffer_load_dwordx4 a[164:167], v2, s[44:47], s94 offen offset:1024 sc1
    s_waitcnt lgkmcnt(6)
    v_mfma_f32_32x32x16_bf16 v[44:59], v[104:107], v[100:103], v[44:59]
    ds_read_b128 v[96:99], v13 offset:9216
    s_waitcnt lgkmcnt(5)
    v_mfma_f32_32x32x16_bf16 v[28:43], a[32:35], v[112:115], v[28:43]
    ds_read_b64_tr_b16 v[100:101], v12 offset:10240
    ds_read_b64_tr_b16 v[102:103], v12 offset:10496
    s_add_u32 s94, s94, 8192
    buffer_load_dwordx4 a[192:195], v2, s[44:47], s94 offen offset:0 sc1
    s_waitcnt lgkmcnt(6)
    v_mfma_f32_32x32x16_bf16 v[44:59], v[108:111], v[112:115], v[44:59]
    ds_read_b128 v[104:107], v13 offset:10240
    s_waitcnt lgkmcnt(5)
    v_mfma_f32_32x32x16_bf16 v[28:43], a[36:39], v[92:95], v[28:43]
    ds_read_b64_tr_b16 v[112:113], v12 offset:11264
    ds_read_b64_tr_b16 v[114:115], v12 offset:11520
    buffer_load_dwordx4 a[196:199], v2, s[44:47], s94 offen offset:1024 sc1
    s_waitcnt lgkmcnt(5)
    v_mfma_f32_32x32x16_bf16 v[44:59], v[96:99], v[92:95], v[44:59]
    ds_read_b128 v[108:111], v13 offset:11264
    s_waitcnt lgkmcnt(4)
    v_mfma_f32_32x32x16_bf16 v[28:43], a[40:43], v[100:103], v[28:43]
    ds_read_b64_tr_b16 v[92:93], v12 offset:12288
    ds_read_b64_tr_b16 v[94:95], v12 offset:12544
    v_perm_b32 v158, v150, v148, s18
    v_perm_b32 v159, v150, v148, s19
    v_perm_b32 v150, v151, v149, s18
    s_add_u32 s94, s94, 8192
    buffer_load_dwordx4 a[224:227], v2, s[44:47], s94 offen offset:0 sc1
    s_waitcnt lgkmcnt(5)
    v_mfma_f32_32x32x16_bf16 v[44:59], v[104:107], v[100:103], v[44:59]
    ds_read_b128 v[96:99], v13 offset:12288
    v_perm_b32 v151, v151, v149, s19
    v_mov_b32 v148, v158
    v_mov_b32 v149, v159
    v_permlane16_swap_b32 v150, v151
    s_waitcnt lgkmcnt(4)
    v_mfma_f32_32x32x16_bf16 v[28:43], a[44:47], v[112:115], v[28:43]
    ds_read_b64_tr_b16 v[104:105], v12 offset:13312
    ds_read_b64_tr_b16 v[106:107], v12 offset:13568
    v_permlane16_swap_b32 v148, v149
    s_nop 1
    v_permlane32_swap_b32 v148, v150
    v_permlane32_swap_b32 v149, v151
    buffer_load_dwordx4 a[228:231], v2, s[44:47], s94 offen offset:1024 sc1
    s_waitcnt lgkmcnt(5)
    v_mfma_f32_32x32x16_bf16 v[44:59], v[108:111], v[112:115], v[44:59]
    ds_read_b128 v[100:103], v13 offset:13312
    v_mov_b32 v124, 0
    v_mov_b32 v125, 0
    v_mov_b32 v126, 0
    v_mov_b32 v127, 0
    s_waitcnt lgkmcnt(4)
    v_mfma_f32_32x32x16_bf16 v[28:43], a[48:51], v[92:95], v[28:43]
    ds_read_b64_tr_b16 v[112:113], v12 offset:14336
    ds_read_b64_tr_b16 v[114:115], v12 offset:14592
    s_add_u32 s94, s94, 8192
    buffer_load_dwordx4 v[160:163], v2, s[44:47], s94 offen offset:0 sc1
    s_waitcnt lgkmcnt(5)
    v_mfma_f32_32x32x16_bf16 v[44:59], v[96:99], v[92:95], v[44:59]
    ds_read_b128 v[108:111], v13 offset:14336
    s_waitcnt lgkmcnt(4)
    v_mfma_f32_32x32x16_bf16 v[28:43], a[52:55], v[104:107], v[28:43]
    ds_read_b64_tr_b16 v[92:93], v12 offset:15360
    ds_read_b64_tr_b16 v[94:95], v12 offset:15616
    buffer_load_dwordx4 v[164:167], v2, s[44:47], s94 offen offset:1024 sc1
    s_waitcnt lgkmcnt(5)
    v_mfma_f32_32x32x16_bf16 v[44:59], v[100:103], v[104:107], v[44:59]
    ds_read_b128 v[96:99], v13 offset:15360
    s_waitcnt lgkmcnt(4)
    v_mfma_f32_32x32x16_bf16 v[28:43], a[56:59], v[112:115], v[28:43]
    ds_read_b64_tr_b16 v[104:105], v12 offset:16384
    ds_read_b64_tr_b16 v[106:107], v12 offset:16640
    s_add_u32 s94, s94, 8192
    buffer_load_dwordx4 v[192:195], v2, s[44:47], s94 offen offset:0 sc1
    s_waitcnt lgkmcnt(5)
    v_mfma_f32_32x32x16_bf16 v[44:59], v[108:111], v[112:115], v[44:59]
    ds_read_b128 v[100:103], v13 offset:16384
    s_waitcnt lgkmcnt(4)
    v_mfma_f32_32x32x16_bf16 v[28:43], a[60:63], v[92:95], v[28:43]
    ds_read_b64_tr_b16 v[112:113], v12 offset:17408
    ds_read_b64_tr_b16 v[114:115], v12 offset:17664
    buffer_load_dwordx4 v[196:199], v2, s[44:47], s94 offen offset:1024 sc1
    s_waitcnt lgkmcnt(5)
    v_mfma_f32_32x32x16_bf16 v[44:59], v[96:99], v[92:95], v[44:59]
    ds_read_b128 v[108:111], v13 offset:17408
    s_waitcnt lgkmcnt(4)
    v_mfma_f32_32x32x16_bf16 v[28:43], a[64:67], v[104:107], v[28:43]
    ds_read_b64_tr_b16 v[92:93], v12 offset:18432
    ds_read_b64_tr_b16 v[94:95], v12 offset:18688
    s_add_u32 s94, s94, 8192
    buffer_load_dwordx4 v[224:227], v2, s[44:47], s94 offen offset:0 sc1
    s_waitcnt lgkmcnt(5)
    v_mfma_f32_32x32x16_bf16 v[44:59], v[100:103], v[104:107], v[44:59]
    ds_read_b128 v[96:99], v13 offset:18432
    s_waitcnt lgkmcnt(4)
    v_mfma_f32_32x32x16_bf16 v[28:43], a[68:71], v[112:115], v[28:43]
    ds_read_b64_tr_b16 v[100:101], v12 offset:19456
    ds_read_b64_tr_b16 v[102:103], v12 offset:19712
    buffer_load_dwordx4 v[228:231], v2, s[44:47], s94 offen offset:1024 sc1
    s_waitcnt lgkmcnt(5)
    v_mfma_f32_32x32x16_bf16 v[44:59], v[108:111], v[112:115], v[44:59]
    ds_read_b128 v[104:107], v13 offset:19456
    s_waitcnt lgkmcnt(4)
    v_mfma_f32_32x32x16_bf16 v[28:43], a[72:75], v[92:95], v[28:43]
    ds_read_b64_tr_b16 v[112:113], v12 offset:20480
    ds_read_b64_tr_b16 v[114:115], v12 offset:20736
    s_add_u32 s64, s8, 3215360
    buffer_load_dwordx4 v[60:63], v2, s[44:47], s64 offen sc1
    s_sub_u32 s94, s79, s11
    s_lshl_b32 s94, s94, 1
    s_add_u32 s94, s94, s75
    buffer_load_dwordx4 a[136:139], v2, s[44:47], s94 offen offset:0 sc1
    s_waitcnt lgkmcnt(5)
    v_mfma_f32_32x32x16_bf16 v[44:59], v[96:99], v[92:95], v[44:59]
    ds_read_b128 v[108:111], v13 offset:20480
    s_add_u32 s64, s8, 3219456
    buffer_load_dwordx4 v[64:67], v2, s[44:47], s64 offen sc1
    s_add_u32 s64, s8, 3223552
    buffer_load_dwordx4 v[68:71], v2, s[44:47], s64 offen sc1
    s_waitcnt lgkmcnt(4)
    v_mfma_f32_32x32x16_bf16 v[28:43], a[76:79], v[100:103], v[28:43]
    ds_read_b64_tr_b16 v[92:93], v12 offset:21504
    ds_read_b64_tr_b16 v[94:95], v12 offset:21760
    s_add_u32 s64, s8, 3227648
    buffer_load_dwordx4 v[72:75], v2, s[44:47], s64 offen sc1
    buffer_load_dwordx4 a[140:143], v2, s[44:47], s94 offen offset:1024 sc1
    s_waitcnt lgkmcnt(5)
    v_mfma_f32_32x32x16_bf16 v[44:59], v[104:107], v[100:103], v[44:59]
    ds_read_b128 v[96:99], v13 offset:21504
    s_add_u32 s64, s8, 3231744
    buffer_load_dwordx4 v[76:79], v2, s[44:47], s64 offen sc1
    s_add_u32 s64, s8, 3235840
    buffer_load_dwordx4 v[80:83], v2, s[44:47], s64 offen sc1
    s_waitcnt vmcnt(31)
    s_waitcnt lgkmcnt(4)
    v_mfma_f32_32x32x16_bf16 v[28:43], a[80:83], v[112:115], v[28:43]
    ds_read_b64_tr_b16 v[100:101], v12 offset:22528
    ds_read_b64_tr_b16 v[102:103], v12 offset:22784
    s_add_u32 s64, s8, 3239936
    buffer_load_dwordx4 v[84:87], v2, s[44:47], s64 offen sc1
    s_add_u32 s94, s94, 8192
    buffer_load_dwordx4 a[168:171], v2, s[44:47], s94 offen offset:0 sc1
    s_waitcnt lgkmcnt(5)
    v_mfma_f32_32x32x16_bf16 v[44:59], v[108:111], v[112:115], v[44:59]
    ds_read_b128 v[104:107], v13 offset:22528
    s_add_u32 s64, s8, 3244032
    buffer_load_dwordx4 v[88:91], v2, s[44:47], s64 offen sc1
    s_waitcnt lgkmcnt(4)
    v_mfma_f32_32x32x16_bf16 v[28:43], a[84:87], v[92:95], v[28:43]
    ds_read_b64_tr_b16 v[112:113], v12 offset:23552
    ds_read_b64_tr_b16 v[114:115], v12 offset:23808
    buffer_load_dwordx4 a[172:175], v2, s[44:47], s94 offen offset:1024 sc1
    s_waitcnt lgkmcnt(5)
    v_mfma_f32_32x32x16_bf16 v[44:59], v[96:99], v[92:95], v[44:59]
    ds_read_b128 v[108:111], v13 offset:23552
    s_waitcnt lgkmcnt(4)
    v_mfma_f32_32x32x16_bf16 v[28:43], a[88:91], v[100:103], v[28:43]
    ds_read_b64_tr_b16 v[92:93], v12 offset:24576
    ds_read_b64_tr_b16 v[94:95], v12 offset:24832
    s_add_u32 s94, s94, 8192
    buffer_load_dwordx4 a[200:203], v2, s[44:47], s94 offen offset:0 sc1
    s_waitcnt lgkmcnt(5)
    v_mfma_f32_32x32x16_bf16 v[44:59], v[104:107], v[100:103], v[44:59]
    ds_read_b128 v[96:99], v13 offset:24576
    s_waitcnt lgkmcnt(4)
    v_mfma_f32_32x32x16_bf16 v[28:43], a[92:95], v[112:115], v[28:43]
    ds_read_b64_tr_b16 v[104:105], v12 offset:25600
    ds_read_b64_tr_b16 v[106:107], v12 offset:25856
    buffer_load_dwordx4 a[204:207], v2, s[44:47], s94 offen offset:1024 sc1
    s_waitcnt lgkmcnt(5)
    v_mfma_f32_32x32x16_bf16 v[44:59], v[108:111], v[112:115], v[44:59]
    ds_read_b128 v[100:103], v13 offset:25600
    s_waitcnt vmcnt(32)
    s_waitcnt lgkmcnt(4)
    v_mfma_f32_32x32x16_bf16 v[28:43], a[96:99], v[92:95], v[28:43]
    ds_read_b64_tr_b16 v[112:113], v12 offset:26624
    ds_read_b64_tr_b16 v[114:115], v12 offset:26880
    s_add_u32 s94, s94, 8192
    buffer_load_dwordx4 a[232:235], v2, s[44:47], s94 offen offset:0 sc1
    s_waitcnt lgkmcnt(5)
    v_mfma_f32_32x32x16_bf16 v[44:59], v[96:99], v[92:95], v[44:59]
    ds_read_b128 v[108:111], v13 offset:26624
    s_waitcnt lgkmcnt(4)
    v_mfma_f32_32x32x16_bf16 v[28:43], a[100:103], v[104:107], v[28:43]
    ds_read_b64_tr_b16 v[92:93], v12 offset:27648
    ds_read_b64_tr_b16 v[94:95], v12 offset:27904
    buffer_load_dwordx4 a[236:239], v2, s[44:47], s94 offen offset:1024 sc1
    s_waitcnt lgkmcnt(5)
    v_mfma_f32_32x32x16_bf16 v[44:59], v[100:103], v[104:107], v[44:59]
    ds_read_b128 v[96:99], v13 offset:27648
    s_waitcnt lgkmcnt(4)
    v_mfma_f32_32x32x16_bf16 v[28:43], a[104:107], v[112:115], v[28:43]
    ds_read_b64_tr_b16 v[104:105], v12 offset:28672
    ds_read_b64_tr_b16 v[106:107], v12 offset:28928
    s_add_u32 s94, s94, 8192
    buffer_load_dwordx4 v[168:171], v2, s[44:47], s94 offen offset:0 sc1
    s_waitcnt lgkmcnt(5)
    v_mfma_f32_32x32x16_bf16 v[44:59], v[108:111], v[112:115], v[44:59]
    ds_read_b128 v[100:103], v13 offset:28672
    s_waitcnt lgkmcnt(4)
    v_mfma_f32_32x32x16_bf16 v[28:43], a[108:111], v[92:95], v[28:43]
    ds_read_b64_tr_b16 v[112:113], v12 offset:29696
    ds_read_b64_tr_b16 v[114:115], v12 offset:29952
    buffer_load_dwordx4 v[172:175], v2, s[44:47], s94 offen offset:1024 sc1
    s_waitcnt lgkmcnt(5)
    v_mfma_f32_32x32x16_bf16 v[44:59], v[96:99], v[92:95], v[44:59]
    ds_read_b128 v[108:111], v13 offset:29696
    s_waitcnt vmcnt(32)
    s_waitcnt lgkmcnt(4)
    v_mfma_f32_32x32x16_bf16 v[28:43], a[112:115], v[104:107], v[28:43]
    ds_read_b64_tr_b16 v[96:97], v12 offset:30720
    ds_read_b64_tr_b16 v[98:99], v12 offset:30976
    s_add_u32 s94, s94, 8192
    buffer_load_dwordx4 v[200:203], v2, s[44:47], s94 offen offset:0 sc1
    s_waitcnt lgkmcnt(5)
    v_mfma_f32_32x32x16_bf16 v[44:59], v[100:103], v[104:107], v[44:59]
    ds_read_b128 v[92:95], v13 offset:30720
    s_waitcnt lgkmcnt(4)
    v_mfma_f32_32x32x16_bf16 v[28:43], a[116:119], v[112:115], v[28:43]
    ds_read_b64_tr_b16 v[104:105], v12 offset:31744
    ds_read_b64_tr_b16 v[106:107], v12 offset:32000
    s_waitcnt vmcnt(8)
    v_min3_f32 v136, |v60|, |v64|, |v68|
    v_min3_f32 v136, v136, |v72|, |v76|
    v_min3_f32 v136, v136, |v80|, |v84|
    v_min_f32 v136, v136, |v88|
    v_cmp_gt_f32 vcc, s54, v136
    s_cbranch_vccnz L_m_s29
L_m_r30:
    buffer_load_dwordx4 v[204:207], v2, s[44:47], s94 offen offset:1024 sc1
    s_waitcnt lgkmcnt(5)
    v_mfma_f32_32x32x16_bf16 v[44:59], v[108:111], v[112:115], v[44:59]
    ds_write_b128 v11, v[60:63] offset:32768
    ds_write_b128 v11, v[64:67] offset:36864
    s_waitcnt lgkmcnt(5)
    v_mfma_f32_32x32x16_bf16 v[28:43], a[120:123], v[96:99], v[28:43]
    ds_write_b128 v11, v[68:71] offset:40960
    ds_write_b128 v11, v[72:75] offset:45056
    s_add_u32 s94, s94, 8192
    buffer_load_dwordx4 v[232:235], v2, s[44:47], s94 offen offset:0 sc1
    s_waitcnt lgkmcnt(6)
    v_mfma_f32_32x32x16_bf16 v[44:59], v[92:95], v[96:99], v[44:59]
    ds_write_b128 v11, v[76:79] offset:49152
    ds_write_b128 v11, v[80:83] offset:53248
    s_waitcnt lgkmcnt(6)
    v_mfma_f32_32x32x16_bf16 v[28:43], a[124:127], v[104:107], v[28:43]
    ds_write_b128 v11, v[84:87] offset:57344
    ds_write_b128 v11, v[88:91] offset:61440
    buffer_load_dwordx4 v[236:239], v2, s[44:47], s94 offen offset:1024 sc1
    v_mfma_f32_32x32x16_bf16 v[44:59], v[24:27], v[104:107], v[44:59]
    s_waitcnt lgkmcnt(0)
    s_barrier
    ds_read_b64_tr_b16 v[92:93], v12 offset:32768
    ds_read_b64_tr_b16 v[94:95], v12 offset:33024
    ds_read_b128 v[96:99], v13 offset:0
    ds_read_b64_tr_b16 v[100:101], v12 offset:33792
    ds_read_b64_tr_b16 v[102:103], v12 offset:34048
    ds_read_b128 v[104:107], v13 offset:1024
    ds_read_b64_tr_b16 v[108:109], v12 offset:34816
    ds_read_b64_tr_b16 v[110:111], v12 offset:35072
    s_waitcnt lgkmcnt(6)
    v_mfma_f32_32x32x16_bf16 v[60:75], a[0:3], v[92:95], 0
    ds_read_b128 v[152:155], v19 offset:32768
    ds_read_b64 v[156:157], v15 offset:0
    ds_read_b128 v[116:119], v14 offset:0
    ds_read_b128 v[120:123], v14 offset:32
    ds_read_b128 v[124:127], v14 offset:896
    s_sub_u32 s94, s80, s11
    s_lshl_b32 s94, s94, 1
    s_add_u32 s94, s94, s75
    buffer_load_dwordx4 a[144:147], v2, s[44:47], s94 offen offset:0 sc1
    s_waitcnt lgkmcnt(10)
    v_mfma_f32_32x32x16_bf16 v[76:91], v[96:99], v[92:95], 0
    ds_read_b128 v[112:115], v13 offset:2048
    ds_read_b128 v[128:131], v14 offset:928
    ds_read_b128 v[132:135], v14 offset:64
    ds_read_b128 v[136:139], v14 offset:96
    ds_read_b128 v[140:143], v14 offset:960
    s_waitcnt lgkmcnt(13)
    v_mfma_f32_32x32x16_bf16 v[60:75], a[4:7], v[100:103], v[60:75]
    ds_read_b64_tr_b16 v[92:93], v12 offset:35840
    ds_read_b128 v[144:147], v14 offset:992
    s_waitcnt lgkmcnt(5)
    v_fmac_f32 v124, v116, v157
    v_fmac_f32 v125, v117, v157
    buffer_load_dwordx4 a[148:151], v2, s[44:47], s94 offen offset:1024 sc1
    v_mfma_f32_32x32x16_bf16 v[76:91], v[104:107], v[100:103], v[76:91]
    ds_read_b64_tr_b16 v[94:95], v12 offset:36096
    ds_read_b128 v[96:99], v13 offset:3072
    v_fmac_f32 v126, v118, v157
    v_fmac_f32 v127, v119, v157
    v_fmac_f32 v128, v120, v157
    v_fmac_f32 v129, v121, v157
    v_mfma_f32_32x32x16_bf16 v[60:75], a[8:11], v[108:111], v[60:75]
    ds_read_b64_tr_b16 v[100:101], v12 offset:36864
    ds_read_b64_tr_b16 v[102:103], v12 offset:37120
    v_fmac_f32 v130, v122, v157
    v_fmac_f32 v131, v123, v157
    v_fmac_f32 v124, v28, v156
    v_fmac_f32 v125, v29, v156
    s_add_u32 s94, s94, 8192
    buffer_load_dwordx4 a[176:179], v2, s[44:47], s94 offen offset:0 sc1
    v_mfma_f32_32x32x16_bf16 v[76:91], v[112:115], v[108:111], v[76:91]
    ds_read_b128 v[104:107], v13 offset:4096
    v_fmac_f32 v126, v30, v156
    v_fmac_f32 v127, v31, v156
    v_fmac_f32 v128, v32, v156
    v_fmac_f32 v129, v33, v156
    v_fmac_f32 v130, v34, v156
    s_waitcnt lgkmcnt(4)
    v_mfma_f32_32x32x16_bf16 v[60:75], a[12:15], v[92:95], v[60:75]
    ds_read_b64_tr_b16 v[112:113], v12 offset:37888
    ds_read_b64_tr_b16 v[114:115], v12 offset:38144
    v_fmac_f32 v131, v35, v156
    v_exp_f32 v28, v124
    buffer_load_dwordx4 a[180:183], v2, s[44:47], s94 offen offset:1024 sc1
    s_waitcnt lgkmcnt(5)
    v_mfma_f32_32x32x16_bf16 v[76:91], v[96:99], v[92:95], v[76:91]
    ds_read_b128 v[108:111], v13 offset:5120
    v_exp_f32 v29, v125
    v_exp_f32 v30, v126
    s_waitcnt lgkmcnt(4)
    v_mfma_f32_32x32x16_bf16 v[60:75], a[16:19], v[100:103], v[60:75]
    ds_read_b64_tr_b16 v[96:97], v12 offset:38912
    ds_read_b64_tr_b16 v[98:99], v12 offset:39168
    v_exp_f32 v31, v127
    v_exp_f32 v32, v128
    s_add_u32 s94, s94, 8192
    buffer_load_dwordx4 a[208:211], v2, s[44:47], s94 offen offset:0 sc1
    s_waitcnt lgkmcnt(5)
    v_mfma_f32_32x32x16_bf16 v[76:91], v[104:107], v[100:103], v[76:91]
    ds_read_b128 v[92:95], v13 offset:6144
    v_exp_f32 v33, v129
    v_exp_f32 v34, v130
    s_waitcnt lgkmcnt(4)
    v_mfma_f32_32x32x16_bf16 v[60:75], a[20:23], v[112:115], v[60:75]
    ds_read_b64_tr_b16 v[100:101], v12 offset:39936
    ds_read_b64_tr_b16 v[102:103], v12 offset:40192
    v_exp_f32 v35, v131
    v_fma_f32 v116, v28, 0.5, 1.0
    buffer_load_dwordx4 a[212:215], v2, s[44:47], s94 offen offset:1024 sc1
    s_waitcnt lgkmcnt(5)
    v_mfma_f32_32x32x16_bf16 v[76:91], v[108:111], v[112:115], v[76:91]
    ds_read_b128 v[104:107], v13 offset:7168
    v_fma_f32 v117, v29, 0.5, 1.0
    v_fma_f32 v118, v30, 0.5, 1.0
    v_fma_f32 v119, v31, 0.5, 1.0
    v_fma_f32 v120, v32, 0.5, 1.0
    s_waitcnt lgkmcnt(4)
    v_mfma_f32_32x32x16_bf16 v[60:75], a[24:27], v[96:99], v[60:75]
    ds_read_b64_tr_b16 v[112:113], v12 offset:40960
    ds_read_b64_tr_b16 v[114:115], v12 offset:41216
    v_fma_f32 v121, v33, 0.5, 1.0
    v_fma_f32 v122, v34, 0.5, 1.0
    v_fma_f32 v123, v35, 0.5, 1.0
    s_add_u32 s94, s94, 8192
    buffer_load_dwordx4 a[240:243], v2, s[44:47], s94 offen offset:0 sc1
    s_waitcnt lgkmcnt(5)
    v_mfma_f32_32x32x16_bf16 v[76:91], v[92:95], v[96:99], v[76:91]
    ds_read_b128 v[108:111], v13 offset:8192
    v_fma_f32 v28, -v28, v116, -1.0
    v_fma_f32 v29, -v29, v117, -1.0
    v_fma_f32 v30, -v30, v118, -1.0
    v_fma_f32 v31, -v31, v119, -1.0
    s_waitcnt lgkmcnt(4)
    v_mfma_f32_32x32x16_bf16 v[60:75], a[28:31], v[100:103], v[60:75]
    ds_read_b64_tr_b16 v[96:97], v12 offset:41984
    ds_read_b64_tr_b16 v[98:99], v12 offset:42240
    v_fma_f32 v32, -v32, v120, -1.0
    v_fma_f32 v33, -v33, v121, -1.0
    v_fma_f32 v34, -v34, v122, -1.0
    buffer_load_dwordx4 a[244:247], v2, s[44:47], s94 offen offset:1024 sc1
    s_waitcnt lgkmcnt(5)
    v_mfma_f32_32x32x16_bf16 v[76:91], v[104:107], v[100:103], v[76:91]
    ds_read_b128 v[92:95], v13 offset:9216
    v_fma_f32 v35, -v35, v123, -1.0
    v_rcp_f32 v28, v28
    v_rcp_f32 v29, v29
    s_waitcnt lgkmcnt(4)
    v_mfma_f32_32x32x16_bf16 v[60:75], a[32:35], v[112:115], v[60:75]
    ds_read_b64_tr_b16 v[100:101], v12 offset:43008
    ds_read_b64_tr_b16 v[102:103], v12 offset:43264
    v_rcp_f32 v30, v30
    v_rcp_f32 v31, v31
    s_add_u32 s94, s94, 8192
    buffer_load_dwordx4 v[176:179], v2, s[44:47], s94 offen offset:0 sc1
    s_waitcnt lgkmcnt(5)
    v_mfma_f32_32x32x16_bf16 v[76:91], v[108:111], v[112:115], v[76:91]
    ds_read_b128 v[104:107], v13 offset:10240
    v_rcp_f32 v32, v32
    v_rcp_f32 v33, v33
    s_waitcnt lgkmcnt(4)
    v_mfma_f32_32x32x16_bf16 v[60:75], a[36:39], v[96:99], v[60:75]
    ds_read_b64_tr_b16 v[108:109], v12 offset:44032
    ds_read_b64_tr_b16 v[110:111], v12 offset:44288
    v_rcp_f32 v34, v34
    v_rcp_f32 v35, v35
    buffer_load_dwordx4 v[180:183], v2, s[44:47], s94 offen offset:1024 sc1
    s_waitcnt lgkmcnt(5)
    v_mfma_f32_32x32x16_bf16 v[76:91], v[92:95], v[96:99], v[76:91]
    ds_read_b128 v[112:115], v13 offset:11264
    v_fmac_f32 v124, v28, v124
    v_fmac_f32 v125, v29, v125
    v_fmac_f32 v126, v30, v126
    v_fmac_f32 v127, v31, v127
    s_waitcnt lgkmcnt(4)
    v_mfma_f32_32x32x16_bf16 v[60:75], a[40:43], v[100:103], v[60:75]
    ds_read_b64_tr_b16 v[92:93], v12 offset:45056
    ds_read_b64_tr_b16 v[94:95], v12 offset:45312
    v_fmac_f32 v128, v32, v128
    v_fmac_f32 v129, v33, v129
    v_fmac_f32 v130, v34, v130
    s_add_u32 s94, s94, 8192
    buffer_load_dwordx4 v[208:211], v2, s[44:47], s94 offen offset:0 sc1
    s_waitcnt lgkmcnt(5)
    v_mfma_f32_32x32x16_bf16 v[76:91], v[104:107], v[100:103], v[76:91]
    ds_read_b128 v[96:99], v13 offset:12288
    v_fmac_f32 v131, v35, v131
    v_max_u32 v125, s54, v125
    v_max_i32 v125, 0xa0000000, v125
    v_cvt_pk_bf16_f32 v117, v126, v127
    s_waitcnt lgkmcnt(4)
    v_mfma_f32_32x32x16_bf16 v[60:75], a[44:47], v[108:111], v[60:75]
    ds_read_b64_tr_b16 v[100:101], v12 offset:46080
    ds_read_b64_tr_b16 v[102:103], v12 offset:46336
    v_cvt_pk_bf16_f32 v118, v128, v129
    v_cvt_pk_bf16_f32 v119, v130, v131
    v_cvt_pk_bf16_f32 v116, v124, v125
    buffer_load_dwordx4 v[212:215], v2, s[44:47], s94 offen offset:1024 sc1
    s_waitcnt lgkmcnt(5)
    v_mfma_f32_32x32x16_bf16 v[76:91], v[112:115], v[108:111], v[76:91]
    ds_read_b128 v[104:107], v13 offset:13312
    s_add_u32 s66, s9, 0
    buffer_store_dwordx4 v[116:119], v2, s[44:47], s66 offen offset:0 sc1
    s_nop 0
    ds_read_b128 v[116:119], v14 offset:512
    s_waitcnt lgkmcnt(5)
    v_mfma_f32_32x32x16_bf16 v[60:75], a[48:51], v[92:95], v[60:75]
    ds_read_b64_tr_b16 v[108:109], v12 offset:47104
    ds_read_b64_tr_b16 v[110:111], v12 offset:47360
    ds_read_b128 v[120:123], v14 offset:544
    ds_read_b128 v[124:127], v14 offset:1408
    ds_read_b128 v[128:131], v14 offset:1440
    s_add_u32 s94, s94, 8192
    buffer_load_dwordx4 v[240:243], v2, s[44:47], s94 offen offset:0 sc1
    s_waitcnt lgkmcnt(9)
    v_mfma_f32_32x32x16_bf16 v[76:91], v[96:99], v[92:95], v[76:91]
    ds_read_b128 v[112:115], v13 offset:14336
    v_fmac_f32 v140, v132, v157
    v_fmac_f32 v141, v133, v157
    v_fmac_f32 v142, v134, v157
    v_fmac_f32 v143, v135, v157
    s_waitcnt lgkmcnt(8)
    v_mfma_f32_32x32x16_bf16 v[60:75], a[52:55], v[100:103], v[60:75]
    ds_read_b64_tr_b16 v[92:93], v12 offset:48128
    ds_read_b64_tr_b16 v[94:95], v12 offset:48384
    v_fmac_f32 v144, v136, v157
    v_fmac_f32 v145, v137, v157
    v_fmac_f32 v146, v138, v157
    buffer_load_dwordx4 v[244:247], v2, s[44:47], s94 offen offset:1024 sc1
    s_waitcnt lgkmcnt(9)
    v_mfma_f32_32x32x16_bf16 v[76:91], v[104:107], v[100:103], v[76:91]
    ds_read_b128 v[96:99], v13 offset:15360
    v_fmac_f32 v147, v139, v157
    v_fmac_f32 v140, v36, v156
    v_fmac_f32 v141, v37, v156
    v_fmac_f32 v142, v38, v156
    s_waitcnt lgkmcnt(7)
    v_mfma_f32_32x32x16_bf16 v[60:75], a[56:59], v[108:111], v[60:75]
    ds_read_b64_tr_b16 v[100:101], v12 offset:49152
    ds_read_b64_tr_b16 v[102:103], v12 offset:49408
    v_fmac_f32 v143, v39, v156
    v_fmac_f32 v144, v40, v156
    v_fmac_f32 v145, v41, v156
    s_sub_u32 s94, s81, s11
    s_lshl_b32 s94, s94, 1
    s_add_u32 s94, s94, s75
    buffer_load_dwordx4 a[152:155], v2, s[44:47], s94 offen offset:0 sc1
    s_waitcnt lgkmcnt(5)
    v_mfma_f32_32x32x16_bf16 v[76:91], v[112:115], v[108:111], v[76:91]
    ds_read_b128 v[104:107], v13 offset:16384
    v_fmac_f32 v146, v42, v156
    v_fmac_f32 v147, v43, v156
    v_exp_f32 v36, v140
    s_waitcnt lgkmcnt(4)
    v_mfma_f32_32x32x16_bf16 v[60:75], a[60:63], v[92:95], v[60:75]
    ds_read_b64_tr_b16 v[112:113], v12 offset:50176
    ds_read_b64_tr_b16 v[114:115], v12 offset:50432
    v_exp_f32 v37, v141
    v_exp_f32 v38, v142
    buffer_load_dwordx4 a[156:159], v2, s[44:47], s94 offen offset:1024 sc1
    s_waitcnt lgkmcnt(5)
    v_mfma_f32_32x32x16_bf16 v[76:91], v[96:99], v[92:95], v[76:91]
    ds_read_b128 v[108:111], v13 offset:17408
    v_exp_f32 v39, v143
    v_exp_f32 v40, v144
    s_waitcnt lgkmcnt(4)
    v_mfma_f32_32x32x16_bf16 v[60:75], a[64:67], v[100:103], v[60:75]
    ds_read_b64_tr_b16 v[96:97], v12 offset:51200
    ds_read_b64_tr_b16 v[98:99], v12 offset:51456
    v_exp_f32 v41, v145
    v_exp_f32 v42, v146
    s_add_u32 s94, s94, 8192
    buffer_load_dwordx4 a[184:187], v2, s[44:47], s94 offen offset:0 sc1
    s_waitcnt lgkmcnt(5)
    v_mfma_f32_32x32x16_bf16 v[76:91], v[104:107], v[100:103], v[76:91]
    ds_read_b128 v[92:95], v13 offset:18432
    v_exp_f32 v43, v147
    v_fma_f32 v132, v36, 0.5, 1.0
    v_fma_f32 v133, v37, 0.5, 1.0
    s_waitcnt lgkmcnt(4)
    v_mfma_f32_32x32x16_bf16 v[60:75], a[68:71], v[112:115], v[60:75]
    ds_read_b64_tr_b16 v[100:101], v12 offset:52224
    ds_read_b64_tr_b16 v[102:103], v12 offset:52480
    v_fma_f32 v134, v38, 0.5, 1.0
    v_fma_f32 v135, v39, 0.5, 1.0
    v_fma_f32 v136, v40, 0.5, 1.0
    buffer_load_dwordx4 a[188:191], v2, s[44:47], s94 offen offset:1024 sc1
    s_waitcnt lgkmcnt(5)
    v_mfma_f32_32x32x16_bf16 v[76:91], v[108:111], v[112:115], v[76:91]
    ds_read_b128 v[104:107], v13 offset:19456
    v_fma_f32 v137, v41, 0.5, 1.0
    v_fma_f32 v138, v42, 0.5, 1.0
    v_fma_f32 v139, v43, 0.5, 1.0
    v_fma_f32 v36, -v36, v132, -1.0
    s_waitcnt lgkmcnt(4)
    v_mfma_f32_32x32x16_bf16 v[60:75], a[72:75], v[96:99], v[60:75]
    ds_read_b64_tr_b16 v[112:113], v12 offset:53248
    ds_read_b64_tr_b16 v[114:115], v12 offset:53504
    v_fma_f32 v37, -v37, v133, -1.0
    v_fma_f32 v38, -v38, v134, -1.0
    v_fma_f32 v39, -v39, v135, -1.0
    s_add_u32 s94, s94, 8192
    buffer_load_dwordx4 a[216:219], v2, s[44:47], s94 offen offset:0 sc1
    s_waitcnt lgkmcnt(5)
    v_mfma_f32_32x32x16_bf16 v[76:91], v[92:95], v[96:99], v[76:91]
    ds_read_b128 v[108:111], v13 offset:20480
    v_fma_f32 v40, -v40, v136, -1.0
    v_fma_f32 v41, -v41, v137, -1.0
    v_fma_f32 v42, -v42, v138, -1.0
    v_fma_f32 v43, -v43, v139, -1.0
    s_waitcnt lgkmcnt(4)
    v_mfma_f32_32x32x16_bf16 v[60:75], a[76:79], v[100:103], v[60:75]
    ds_read_b64_tr_b16 v[96:97], v12 offset:54272
    ds_read_b64_tr_b16 v[98:99], v12 offset:54528
    v_rcp_f32 v36, v36
    v_rcp_f32 v37, v37
    buffer_load_dwordx4 a[220:223], v2, s[44:47], s94 offen offset:1024 sc1
    s_waitcnt lgkmcnt(5)
    v_mfma_f32_32x32x16_bf16 v[76:91], v[104:107], v[100:103], v[76:91]
    ds_read_b128 v[92:95], v13 offset:21504
    v_rcp_f32 v38, v38
    v_rcp_f32 v39, v39
    s_waitcnt lgkmcnt(4)
    v_mfma_f32_32x32x16_bf16 v[60:75], a[80:83], v[112:115], v[60:75]
    ds_read_b64_tr_b16 v[104:105], v12 offset:55296
    ds_read_b64_tr_b16 v[106:107], v12 offset:55552
    v_rcp_f32 v40, v40
    v_rcp_f32 v41, v41
    s_add_u32 s94, s94, 8192
    buffer_load_dwordx4 a[248:251], v2, s[44:47], s94 offen offset:0 sc1
    s_waitcnt lgkmcnt(5)
    v_mfma_f32_32x32x16_bf16 v[76:91], v[108:111], v[112:115], v[76:91]
    ds_read_b128 v[100:103], v13 offset:22528
    v_rcp_f32 v42, v42
    v_rcp_f32 v43, v43
    s_waitcnt lgkmcnt(4)
    v_mfma_f32_32x32x16_bf16 v[60:75], a[84:87], v[96:99], v[60:75]
    ds_read_b64_tr_b16 v[108:109], v12 offset:56320
    ds_read_b64_tr_b16 v[110:111], v12 offset:56576
    v_fmac_f32 v140, v36, v140
    v_fmac_f32 v141, v37, v141
    v_fmac_f32 v142, v38, v142
    buffer_load_dwordx4 a[252:255], v2, s[44:47], s94 offen offset:1024 sc1
    s_waitcnt lgkmcnt(5)
    v_mfma_f32_32x32x16_bf16 v[76:91], v[92:95], v[96:99], v[76:91]
    ds_read_b128 v[112:115], v13 offset:23552
    v_fmac_f32 v143, v39, v143
    v_fmac_f32 v144, v40, v144
    v_fmac_f32 v145, v41, v145
    v_fmac_f32 v146, v42, v146
    s_waitcnt lgkmcnt(4)
    v_mfma_f32_32x32x16_bf16 v[60:75], a[88:91], v[104:107], v[60:75]
    ds_read_b64_tr_b16 v[96:97], v12 offset:57344
    ds_read_b64_tr_b16 v[98:99], v12 offset:57600
    v_fmac_f32 v147, v43, v147
    v_max_u32 v141, s54, v141
    v_max_i32 v141, 0xa0000000, v141
    s_add_u32 s94, s94, 8192
    buffer_load_dwordx4 v[184:187], v2, s[44:47], s94 offen offset:0 sc1
    s_waitcnt lgkmcnt(5)
    v_mfma_f32_32x32x16_bf16 v[76:91], v[100:103], v[104:107], v[76:91]
    ds_read_b128 v[92:95], v13 offset:24576
    v_cvt_pk_bf16_f32 v133, v142, v143
    v_cvt_pk_bf16_f32 v134, v144, v145
    v_cvt_pk_bf16_f32 v135, v146, v147
    v_cvt_pk_bf16_f32 v132, v140, v141
    s_waitcnt lgkmcnt(4)
    v_mfma_f32_32x32x16_bf16 v[60:75], a[92:95], v[108:111], v[60:75]
    ds_read_b64_tr_b16 v[104:105], v12 offset:58368
    ds_read_b64_tr_b16 v[106:107], v12 offset:58624
    s_add_u32 s66, s9, 0
    buffer_store_dwordx4 v[132:135], v2, s[44:47], s66 offen offset:1024 sc1
    buffer_load_dwordx4 v[188:191], v2, s[44:47], s94 offen offset:1024 sc1
    s_waitcnt lgkmcnt(5)
    v_mfma_f32_32x32x16_bf16 v[76:91], v[112:115], v[108:111], v[76:91]
    ds_read_b128 v[100:103], v13 offset:25600
    ds_read_b128 v[132:135], v14 offset:576
    ds_read_b128 v[136:139], v14 offset:608
    ds_read_b128 v[140:143], v14 offset:1472
    ds_read_b128 v[144:147], v14 offset:1504
    s_waitcnt lgkmcnt(8)
    v_mfma_f32_32x32x16_bf16 v[60:75], a[96:99], v[96:99], v[60:75]
    ds_read_b64_tr_b16 v[108:109], v12 offset:59392
    ds_read_b64_tr_b16 v[110:111], v12 offset:59648
    v_fmac_f32 v124, v116, v157
    v_fmac_f32 v125, v117, v157
    v_fmac_f32 v126, v118, v157
    s_add_u32 s94, s94, 8192
    buffer_load_dwordx4 v[216:219], v2, s[44:47], s94 offen offset:0 sc1
    s_waitcnt lgkmcnt(9)
    v_mfma_f32_32x32x16_bf16 v[76:91], v[92:95], v[96:99], v[76:91]
    ds_read_b128 v[112:115], v13 offset:26624
    v_fmac_f32 v127, v119, v157
    v_fmac_f32 v128, v120, v157
    v_fmac_f32 v129, v121, v157
    v_fmac_f32 v130, v122, v157
    s_waitcnt lgkmcnt(8)
    v_mfma_f32_32x32x16_bf16 v[60:75], a[100:103], v[104:107], v[60:75]
    ds_read_b64_tr_b16 v[96:97], v12 offset:60416
    ds_read_b64_tr_b16 v[98:99], v12 offset:60672
    v_fmac_f32 v131, v123, v157
    v_fmac_f32 v124, v44, v156
    v_fmac_f32 v125, v45, v156
    buffer_load_dwordx4 v[220:223], v2, s[44:47], s94 offen offset:1024 sc1
    s_waitcnt lgkmcnt(9)
    v_mfma_f32_32x32x16_bf16 v[76:91], v[100:103], v[104:107], v[76:91]
    ds_read_b128 v[92:95], v13 offset:27648
    v_fmac_f32 v126, v46, v156
    v_fmac_f32 v127, v47, v156
    v_fmac_f32 v128, v48, v156
    v_fmac_f32 v129, v49, v156
    s_waitcnt lgkmcnt(4)
    v_mfma_f32_32x32x16_bf16 v[60:75], a[104:107], v[108:111], v[60:75]
    ds_read_b64_tr_b16 v[100:101], v12 offset:61440
    ds_read_b64_tr_b16 v[102:103], v12 offset:61696
    v_fmac_f32 v130, v50, v156
    v_fmac_f32 v131, v51, v156
    v_exp_f32 v44, v124
    s_add_u32 s94, s94, 8192
    buffer_load_dwordx4 v[248:251], v2, s[44:47], s94 offen offset:0 sc1
    s_waitcnt lgkmcnt(5)
    v_mfma_f32_32x32x16_bf16 v[76:91], v[112:115], v[108:111], v[76:91]
    ds_read_b128 v[104:107], v13 offset:28672
    v_exp_f32 v45, v125
    v_exp_f32 v46, v126
    s_waitcnt lgkmcnt(4)
    v_mfma_f32_32x32x16_bf16 v[60:75], a[108:111], v[96:99], v[60:75]
    ds_read_b64_tr_b16 v[112:113], v12 offset:62464
    ds_read_b64_tr_b16 v[114:115], v12 offset:62720
    v_exp_f32 v47, v127
    v_exp_f32 v48, v128
    buffer_load_dwordx4 v[252:255], v2, s[44:47], s94 offen offset:1024 sc1
    s_waitcnt lgkmcnt(5)
    v_mfma_f32_32x32x16_bf16 v[76:91], v[92:95], v[96:99], v[76:91]
    ds_read_b128 v[108:111], v13 offset:29696
    v_exp_f32 v49, v129
    v_exp_f32 v50, v130
    s_waitcnt lgkmcnt(4)
    v_mfma_f32_32x32x16_bf16 v[60:75], a[112:115], v[100:103], v[60:75]
    ds_read_b64_tr_b16 v[96:97], v12 offset:63488
    ds_read_b64_tr_b16 v[98:99], v12 offset:63744
    v_exp_f32 v51, v131
    v_fma_f32 v116, v44, 0.5, 1.0
    s_waitcnt lgkmcnt(5)
    v_mfma_f32_32x32x16_bf16 v[76:91], v[104:107], v[100:103], v[76:91]
    ds_read_b128 v[92:95], v13 offset:30720
    v_fma_f32 v117, v45, 0.5, 1.0
    v_fma_f32 v118, v46, 0.5, 1.0
    v_fma_f32 v119, v47, 0.5, 1.0
    v_fma_f32 v120, v48, 0.5, 1.0
    s_waitcnt lgkmcnt(4)
    v_mfma_f32_32x32x16_bf16 v[60:75], a[116:119], v[112:115], v[60:75]
    ds_read_b64_tr_b16 v[100:101], v12 offset:64512
    ds_read_b64_tr_b16 v[102:103], v12 offset:64768
    v_fma_f32 v121, v49, 0.5, 1.0
    v_fma_f32 v122, v50, 0.5, 1.0
    v_fma_f32 v123, v51, 0.5, 1.0
    s_waitcnt lgkmcnt(5)
    v_mfma_f32_32x32x16_bf16 v[76:91], v[108:111], v[112:115], v[76:91]
    v_fma_f32 v44, -v44, v116, -1.0
    v_fma_f32 v45, -v45, v117, -1.0
    v_fma_f32 v46, -v46, v118, -1.0
    v_fma_f32 v47, -v47, v119, -1.0
    v_fma_f32 v48, -v48, v120, -1.0
    s_waitcnt lgkmcnt(3)
    v_mfma_f32_32x32x16_bf16 v[60:75], a[120:123], v[96:99], v[60:75]
    v_fma_f32 v49, -v49, v121, -1.0
    v_fma_f32 v50, -v50, v122, -1.0
    v_fma_f32 v51, -v51, v123, -1.0
    v_rcp_f32 v44, v44
    s_waitcnt lgkmcnt(2)
    v_mfma_f32_32x32x16_bf16 v[76:91], v[92:95], v[96:99], v[76:91]
    v_rcp_f32 v45, v45
    v_rcp_f32 v46, v46
    v_rcp_f32 v47, v47
    s_waitcnt lgkmcnt(0)
    v_mfma_f32_32x32x16_bf16 v[60:75], a[124:127], v[100:103], v[60:75]
    v_rcp_f32 v48, v48
    v_rcp_f32 v49, v49
    v_rcp_f32 v50, v50
    v_mfma_f32_32x32x16_bf16 v[76:91], v[24:27], v[100:103], v[76:91]
    v_rcp_f32 v51, v51
    v_fmac_f32 v124, v44, v124
    v_fmac_f32 v125, v45, v125
    v_fmac_f32 v126, v46, v126
    v_fmac_f32 v127, v47, v127
    s_add_u32 s69, s78, 0
    buffer_load_dwordx4 v[92:95], v2, s[44:47], s69 offen sc1
    v_fmac_f32 v128, v48, v128
    v_fmac_f32 v129, v49, v129
    v_fmac_f32 v130, v50, v130
    v_fmac_f32 v131, v51, v131
    v_max_u32 v125, s54, v125
    v_max_i32 v125, 0xa0000000, v125
    v_cvt_pk_bf16_f32 v117, v126, v127
    v_cvt_pk_bf16_f32 v118, v128, v129
    v_cvt_pk_bf16_f32 v119, v130, v131
    v_cvt_pk_bf16_f32 v116, v124, v125
    s_add_u32 s66, s10, 0
    buffer_store_dwordx4 v[116:119], v2, s[44:47], s66 offen offset:0 sc1
    v_fmac_f32 v140, v132, v157
    v_fmac_f32 v141, v133, v157
    s_add_u32 s69, s80, 0
    buffer_load_dwordx4 v[96:99], v2, s[44:47], s69 offen sc1
    v_fmac_f32 v142, v134, v157
    v_fmac_f32 v143, v135, v157
    v_fmac_f32 v144, v136, v157
    v_fmac_f32 v145, v137, v157
    v_fmac_f32 v146, v138, v157
    v_fmac_f32 v147, v139, v157
    v_fmac_f32 v140, v52, v156
    v_fmac_f32 v141, v53, v156
    v_fmac_f32 v142, v54, v156
    v_fmac_f32 v143, v55, v156
    v_fmac_f32 v144, v56, v156
    v_fmac_f32 v145, v57, v156
    v_fmac_f32 v146, v58, v156
    v_fmac_f32 v147, v59, v156
    s_add_u32 s69, s78, 4096
    buffer_load_dwordx4 v[100:103], v2, s[44:47], s69 offen sc1
    v_exp_f32 v52, v140
    v_exp_f32 v53, v141
    v_exp_f32 v54, v142
    v_exp_f32 v55, v143
    v_exp_f32 v56, v144
    v_exp_f32 v57, v145
    v_exp_f32 v58, v146
    v_exp_f32 v59, v147
    v_fma_f32 v132, v52, 0.5, 1.0
    v_fma_f32 v133, v53, 0.5, 1.0
    v_fma_f32 v134, v54, 0.5, 1.0
    v_fma_f32 v135, v55, 0.5, 1.0
    v_fma_f32 v136, v56, 0.5, 1.0
    v_fma_f32 v137, v57, 0.5, 1.0
    v_fma_f32 v138, v58, 0.5, 1.0
    s_add_u32 s69, s80, 12288
    buffer_load_dwordx4 v[104:107], v2, s[44:47], s69 offen sc1
    v_fma_f32 v139, v59, 0.5, 1.0
    v_fma_f32 v52, -v52, v132, -1.0
    v_fma_f32 v53, -v53, v133, -1.0
    v_fma_f32 v54, -v54, v134, -1.0
    v_fma_f32 v55, -v55, v135, -1.0
    v_fma_f32 v56, -v56, v136, -1.0
    v_fma_f32 v57, -v57, v137, -1.0
    v_fma_f32 v58, -v58, v138, -1.0
    v_fma_f32 v59, -v59, v139, -1.0
    v_rcp_f32 v52, v52
    v_rcp_f32 v53, v53
    v_rcp_f32 v54, v54
    v_rcp_f32 v55, v55
    v_rcp_f32 v56, v56
    s_add_u32 s69, s78, 16384
    buffer_load_dwordx4 v[108:111], v2, s[44:47], s69 offen sc1
    v_rcp_f32 v57, v57
    v_rcp_f32 v58, v58
    v_rcp_f32 v59, v59
    v_fmac_f32 v140, v52, v140
    v_fmac_f32 v141, v53, v141
    v_fmac_f32 v142, v54, v142
    v_fmac_f32 v143, v55, v143
    v_fmac_f32 v144, v56, v144
    v_fmac_f32 v145, v57, v145
    v_fmac_f32 v146, v58, v146
    v_fmac_f32 v147, v59, v147
    v_max_u32 v141, s54, v141
    v_max_i32 v141, 0xa0000000, v141
    v_cvt_pk_bf16_f32 v133, v142, v143
    s_add_u32 s69, s80, 16384
    buffer_load_dwordx4 v[112:115], v2, s[44:47], s69 offen sc1
    v_cvt_pk_bf16_f32 v134, v144, v145
    v_cvt_pk_bf16_f32 v135, v146, v147
    v_cvt_pk_bf16_f32 v132, v140, v141
    s_add_u32 s66, s10, 0
    buffer_store_dwordx4 v[132:135], v2, s[44:47], s66 offen offset:1024 sc1
    v_perm_b32 v158, v154, v152, s18
    v_perm_b32 v159, v154, v152, s19
    v_perm_b32 v154, v155, v153, s18
    v_perm_b32 v155, v155, v153, s19
    v_mov_b32 v152, v158
    v_mov_b32 v153, v159
    v_permlane16_swap_b32 v154, v155
    s_nop 0
    v_permlane16_swap_b32 v152, v153
    s_nop 1
    v_permlane32_swap_b32 v152, v154
    v_permlane32_swap_b32 v153, v155
    s_barrier
    s_add_u32 s69, s79, 0
    buffer_load_dwordx4 v[28:31], v2, s[44:47], s69 offen sc1
    ds_read_b64 v[158:159], v15 offset:256
    ds_read_b128 v[116:119], v14 offset:0
    ds_read_b128 v[120:123], v14 offset:32
    ds_read_b128 v[124:127], v14 offset:896
    ds_read_b128 v[128:131], v14 offset:928
    ds_read_b128 v[132:135], v14 offset:64
    ds_read_b128 v[136:139], v14 offset:96
    ds_read_b128 v[140:143], v14 offset:960
    ds_read_b128 v[144:147], v14 offset:992
    s_waitcnt lgkmcnt(4)
    v_pk_fma_f32 v[124:125], v[116:117], v[158:159], v[124:125] op_sel:[0,1,0] op_sel_hi:[1,1,1]
    v_pk_fma_f32 v[126:127], v[118:119], v[158:159], v[126:127] op_sel:[0,1,0] op_sel_hi:[1,1,1]
    v_pk_fma_f32 v[128:129], v[120:121], v[158:159], v[128:129] op_sel:[0,1,0] op_sel_hi:[1,1,1]
    v_pk_fma_f32 v[130:131], v[122:123], v[158:159], v[130:131] op_sel:[0,1,0] op_sel_hi:[1,1,1]
    v_pk_fma_f32 v[124:125], v[60:61], v[158:159], v[124:125] op_sel:[0,0,0] op_sel_hi:[1,0,1]
    v_pk_fma_f32 v[126:127], v[62:63], v[158:159], v[126:127] op_sel:[0,0,0] op_sel_hi:[1,0,1]
    v_pk_fma_f32 v[128:129], v[64:65], v[158:159], v[128:129] op_sel:[0,0,0] op_sel_hi:[1,0,1]
    v_pk_fma_f32 v[130:131], v[66:67], v[158:159], v[130:131] op_sel:[0,0,0] op_sel_hi:[1,0,1]
    v_exp_f32 v60, v124
    v_exp_f32 v61, v125
    v_exp_f32 v62, v126
    v_exp_f32 v63, v127
    v_exp_f32 v64, v128
    v_exp_f32 v65, v129
    s_add_u32 s69, s81, 0
    buffer_load_dwordx4 v[32:35], v2, s[44:47], s69 offen sc1
    v_exp_f32 v66, v130
    v_exp_f32 v67, v131
    v_pk_fma_f32 v[116:117], v[60:61], 0.5, 1.0 op_sel_hi:[1,0,0]
    v_pk_fma_f32 v[118:119], v[62:63], 0.5, 1.0 op_sel_hi:[1,0,0]
    v_pk_fma_f32 v[120:121], v[64:65], 0.5, 1.0 op_sel_hi:[1,0,0]
    v_pk_fma_f32 v[122:123], v[66:67], 0.5, 1.0 op_sel_hi:[1,0,0]
    v_pk_fma_f32 v[60:61], v[60:61], v[116:117], 1.0 op_sel_hi:[1,1,0]
    v_pk_fma_f32 v[62:63], v[62:63], v[118:119], 1.0 op_sel_hi:[1,1,0]
    v_pk_fma_f32 v[64:65], v[64:65], v[120:121], 1.0 op_sel_hi:[1,1,0]
    v_pk_fma_f32 v[66:67], v[66:67], v[122:123], 1.0 op_sel_hi:[1,1,0]
    v_rcp_f32 v60, v60
    v_rcp_f32 v61, v61
    v_rcp_f32 v62, v62
    v_rcp_f32 v63, v63
    v_rcp_f32 v64, v64
    v_rcp_f32 v65, v65
    v_rcp_f32 v66, v66
    v_rcp_f32 v67, v67
    v_pk_fma_f32 v[124:125], v[60:61], v[124:125], v[124:125] neg_lo:[1,0,0] neg_hi:[1,0,0]
    v_pk_fma_f32 v[126:127], v[62:63], v[126:127], v[126:127] neg_lo:[1,0,0] neg_hi:[1,0,0]
    v_pk_fma_f32 v[128:129], v[64:65], v[128:129], v[128:129] neg_lo:[1,0,0] neg_hi:[1,0,0]
    v_pk_fma_f32 v[130:131], v[66:67], v[130:131], v[130:131] neg_lo:[1,0,0] neg_hi:[1,0,0]
    v_max_u32 v125, s54, v125
    v_max_i32 v125, 0xa0000000, v125
    s_add_u32 s69, s79, 4096
    buffer_load_dwordx4 v[36:39], v2, s[44:47], s69 offen sc1
    v_cvt_pk_bf16_f32 v117, v126, v127
    v_cvt_pk_bf16_f32 v118, v128, v129
    v_cvt_pk_bf16_f32 v119, v130, v131
    v_cvt_pk_bf16_f32 v116, v124, v125
    s_add_u32 s66, s9, 3670016
    buffer_store_dwordx4 v[116:119], v2, s[44:47], s66 offen offset:0 sc1
    s_nop 0
    ds_read_b128 v[116:119], v14 offset:512
    ds_read_b128 v[120:123], v14 offset:544
    ds_read_b128 v[124:127], v14 offset:1408
    ds_read_b128 v[128:131], v14 offset:1440
    s_waitcnt lgkmcnt(4)
    v_pk_fma_f32 v[140:141], v[132:133], v[158:159], v[140:141] op_sel:[0,1,0] op_sel_hi:[1,1,1]
    v_pk_fma_f32 v[142:143], v[134:135], v[158:159], v[142:143] op_sel:[0,1,0] op_sel_hi:[1,1,1]
    v_pk_fma_f32 v[144:145], v[136:137], v[158:159], v[144:145] op_sel:[0,1,0] op_sel_hi:[1,1,1]
    v_pk_fma_f32 v[146:147], v[138:139], v[158:159], v[146:147] op_sel:[0,1,0] op_sel_hi:[1,1,1]
    v_pk_fma_f32 v[140:141], v[68:69], v[158:159], v[140:141] op_sel:[0,0,0] op_sel_hi:[1,0,1]
    v_pk_fma_f32 v[142:143], v[70:71], v[158:159], v[142:143] op_sel:[0,0,0] op_sel_hi:[1,0,1]
    v_pk_fma_f32 v[144:145], v[72:73], v[158:159], v[144:145] op_sel:[0,0,0] op_sel_hi:[1,0,1]
    v_pk_fma_f32 v[146:147], v[74:75], v[158:159], v[146:147] op_sel:[0,0,0] op_sel_hi:[1,0,1]
    v_exp_f32 v68, v140
    v_exp_f32 v69, v141
    v_exp_f32 v70, v142
    v_exp_f32 v71, v143
    v_exp_f32 v72, v144
    v_exp_f32 v73, v145
    s_add_u32 s69, s81, 12288
    buffer_load_dwordx4 v[40:43], v2, s[44:47], s69 offen sc1
    v_exp_f32 v74, v146
    v_exp_f32 v75, v147
    v_pk_fma_f32 v[132:133], v[68:69], 0.5, 1.0 op_sel_hi:[1,0,0]
    v_pk_fma_f32 v[134:135], v[70:71], 0.5, 1.0 op_sel_hi:[1,0,0]
    v_pk_fma_f32 v[136:137], v[72:73], 0.5, 1.0 op_sel_hi:[1,0,0]
    v_pk_fma_f32 v[138:139], v[74:75], 0.5, 1.0 op_sel_hi:[1,0,0]
    v_pk_fma_f32 v[68:69], v[68:69], v[132:133], 1.0 op_sel_hi:[1,1,0]
    v_pk_fma_f32 v[70:71], v[70:71], v[134:135], 1.0 op_sel_hi:[1,1,0]
    v_pk_fma_f32 v[72:73], v[72:73], v[136:137], 1.0 op_sel_hi:[1,1,0]
    v_pk_fma_f32 v[74:75], v[74:75], v[138:139], 1.0 op_sel_hi:[1,1,0]
    v_rcp_f32 v68, v68
    v_rcp_f32 v69, v69
    v_rcp_f32 v70, v70
    v_rcp_f32 v71, v71
    v_rcp_f32 v72, v72
    v_rcp_f32 v73, v73
    v_rcp_f32 v74, v74
    v_rcp_f32 v75, v75
    v_pk_fma_f32 v[140:141], v[68:69], v[140:141], v[140:141] neg_lo:[1,0,0] neg_hi:[1,0,0]
    v_pk_fma_f32 v[142:143], v[70:71], v[142:143], v[142:143] neg_lo:[1,0,0] neg_hi:[1,0,0]
    v_pk_fma_f32 v[144:145], v[72:73], v[144:145], v[144:145] neg_lo:[1,0,0] neg_hi:[1,0,0]
    v_pk_fma_f32 v[146:147], v[74:75], v[146:147], v[146:147] neg_lo:[1,0,0] neg_hi:[1,0,0]
    v_max_u32 v141, s54, v141
    v_max_i32 v141, 0xa0000000, v141
    s_add_u32 s69, s79, 16384
    buffer_load_dwordx4 v[44:47], v2, s[44:47], s69 offen sc1
    v_cvt_pk_bf16_f32 v133, v142, v143
    v_cvt_pk_bf16_f32 v134, v144, v145
    v_cvt_pk_bf16_f32 v135, v146, v147
    v_cvt_pk_bf16_f32 v132, v140, v141
    s_add_u32 s66, s9, 3670016
    buffer_store_dwordx4 v[132:135], v2, s[44:47], s66 offen offset:1024 sc1
    s_nop 0
    ds_read_b128 v[132:135], v14 offset:576
    ds_read_b128 v[136:139], v14 offset:608
    ds_read_b128 v[140:143], v14 offset:1472
    ds_read_b128 v[144:147], v14 offset:1504
    s_waitcnt lgkmcnt(4)
    v_pk_fma_f32 v[124:125], v[116:117], v[158:159], v[124:125] op_sel:[0,1,0] op_sel_hi:[1,1,1]
    v_pk_fma_f32 v[126:127], v[118:119], v[158:159], v[126:127] op_sel:[0,1,0] op_sel_hi:[1,1,1]
    v_pk_fma_f32 v[128:129], v[120:121], v[158:159], v[128:129] op_sel:[0,1,0] op_sel_hi:[1,1,1]
    v_pk_fma_f32 v[130:131], v[122:123], v[158:159], v[130:131] op_sel:[0,1,0] op_sel_hi:[1,1,1]
    v_pk_fma_f32 v[124:125], v[76:77], v[158:159], v[124:125] op_sel:[0,0,0] op_sel_hi:[1,0,1]
    v_pk_fma_f32 v[126:127], v[78:79], v[158:159], v[126:127] op_sel:[0,0,0] op_sel_hi:[1,0,1]
    v_pk_fma_f32 v[128:129], v[80:81], v[158:159], v[128:129] op_sel:[0,0,0] op_sel_hi:[1,0,1]
    v_pk_fma_f32 v[130:131], v[82:83], v[158:159], v[130:131] op_sel:[0,0,0] op_sel_hi:[1,0,1]
    v_exp_f32 v76, v124
    v_exp_f32 v77, v125
    v_exp_f32 v78, v126
    v_exp_f32 v79, v127
    v_exp_f32 v80, v128
    v_exp_f32 v81, v129
    v_exp_f32 v82, v130
    s_add_u32 s69, s81, 16384
    buffer_load_dwordx4 v[48:51], v2, s[44:47], s69 offen sc1
    v_exp_f32 v83, v131
    v_pk_fma_f32 v[116:117], v[76:77], 0.5, 1.0 op_sel_hi:[1,0,0]
    v_pk_fma_f32 v[118:119], v[78:79], 0.5, 1.0 op_sel_hi:[1,0,0]
    v_pk_fma_f32 v[120:121], v[80:81], 0.5, 1.0 op_sel_hi:[1,0,0]
    v_pk_fma_f32 v[122:123], v[82:83], 0.5, 1.0 op_sel_hi:[1,0,0]
    v_pk_fma_f32 v[76:77], v[76:77], v[116:117], 1.0 op_sel_hi:[1,1,0]
    v_pk_fma_f32 v[78:79], v[78:79], v[118:119], 1.0 op_sel_hi:[1,1,0]
    v_pk_fma_f32 v[80:81], v[80:81], v[120:121], 1.0 op_sel_hi:[1,1,0]
    v_pk_fma_f32 v[82:83], v[82:83], v[122:123], 1.0 op_sel_hi:[1,1,0]
    v_rcp_f32 v76, v76
    v_rcp_f32 v77, v77
    v_rcp_f32 v78, v78
    v_rcp_f32 v79, v79
    v_rcp_f32 v80, v80
    v_rcp_f32 v81, v81
    v_rcp_f32 v82, v82
    v_rcp_f32 v83, v83
    v_pk_fma_f32 v[124:125], v[76:77], v[124:125], v[124:125] neg_lo:[1,0,0] neg_hi:[1,0,0]
    v_pk_fma_f32 v[126:127], v[78:79], v[126:127], v[126:127] neg_lo:[1,0,0] neg_hi:[1,0,0]
    v_pk_fma_f32 v[128:129], v[80:81], v[128:129], v[128:129] neg_lo:[1,0,0] neg_hi:[1,0,0]
    v_pk_fma_f32 v[130:131], v[82:83], v[130:131], v[130:131] neg_lo:[1,0,0] neg_hi:[1,0,0]
    v_max_u32 v125, s54, v125
    v_max_i32 v125, 0xa0000000, v125
    s_add_u32 s69, s80, 4096
    buffer_load_dwordx4 v[52:55], v2, s[44:47], s69 offen sc1
    v_cvt_pk_bf16_f32 v117, v126, v127
    v_cvt_pk_bf16_f32 v118, v128, v129
    v_cvt_pk_bf16_f32 v119, v130, v131
    v_cvt_pk_bf16_f32 v116, v124, v125
    s_add_u32 s66, s10, 3670016
    buffer_store_dwordx4 v[116:119], v2, s[44:47], s66 offen offset:0 sc1
    s_waitcnt lgkmcnt(0)
    v_pk_fma_f32 v[140:141], v[132:133], v[158:159], v[140:141] op_sel:[0,1,0] op_sel_hi:[1,1,1]
    v_pk_fma_f32 v[142:143], v[134:135], v[158:159], v[142:143] op_sel:[0,1,0] op_sel_hi:[1,1,1]
    v_pk_fma_f32 v[144:145], v[136:137], v[158:159], v[144:145] op_sel:[0,1,0] op_sel_hi:[1,1,1]
    v_pk_fma_f32 v[146:147], v[138:139], v[158:159], v[146:147] op_sel:[0,1,0] op_sel_hi:[1,1,1]
    v_pk_fma_f32 v[140:141], v[84:85], v[158:159], v[140:141] op_sel:[0,0,0] op_sel_hi:[1,0,1]
    v_pk_fma_f32 v[142:143], v[86:87], v[158:159], v[142:143] op_sel:[0,0,0] op_sel_hi:[1,0,1]
    v_pk_fma_f32 v[144:145], v[88:89], v[158:159], v[144:145] op_sel:[0,0,0] op_sel_hi:[1,0,1]
    v_pk_fma_f32 v[146:147], v[90:91], v[158:159], v[146:147] op_sel:[0,0,0] op_sel_hi:[1,0,1]
    v_exp_f32 v84, v140
    v_exp_f32 v85, v141
    v_exp_f32 v86, v142
    v_exp_f32 v87, v143
    v_exp_f32 v88, v144
    v_exp_f32 v89, v145
    v_exp_f32 v90, v146
    v_exp_f32 v91, v147
    v_pk_fma_f32 v[132:133], v[84:85], 0.5, 1.0 op_sel_hi:[1,0,0]
    v_pk_fma_f32 v[134:135], v[86:87], 0.5, 1.0 op_sel_hi:[1,0,0]
    v_pk_fma_f32 v[136:137], v[88:89], 0.5, 1.0 op_sel_hi:[1,0,0]
    s_add_u32 s69, s78, 8192
    buffer_load_dwordx4 v[56:59], v2, s[44:47], s69 offen sc1
    v_pk_fma_f32 v[138:139], v[90:91], 0.5, 1.0 op_sel_hi:[1,0,0]
    v_pk_fma_f32 v[84:85], v[84:85], v[132:133], 1.0 op_sel_hi:[1,1,0]
    v_pk_fma_f32 v[86:87], v[86:87], v[134:135], 1.0 op_sel_hi:[1,1,0]
    v_pk_fma_f32 v[88:89], v[88:89], v[136:137], 1.0 op_sel_hi:[1,1,0]
    v_pk_fma_f32 v[90:91], v[90:91], v[138:139], 1.0 op_sel_hi:[1,1,0]
    v_rcp_f32 v84, v84
    v_rcp_f32 v85, v85
    v_rcp_f32 v86, v86
    v_rcp_f32 v87, v87
    v_rcp_f32 v88, v88
    v_rcp_f32 v89, v89
    v_rcp_f32 v90, v90
    v_rcp_f32 v91, v91
    v_pk_fma_f32 v[140:141], v[84:85], v[140:141], v[140:141] neg_lo:[1,0,0] neg_hi:[1,0,0]
    v_pk_fma_f32 v[142:143], v[86:87], v[142:143], v[142:143] neg_lo:[1,0,0] neg_hi:[1,0,0]
    v_pk_fma_f32 v[144:145], v[88:89], v[144:145], v[144:145] neg_lo:[1,0,0] neg_hi:[1,0,0]
    v_pk_fma_f32 v[146:147], v[90:91], v[146:147], v[146:147] neg_lo:[1,0,0] neg_hi:[1,0,0]
    v_max_u32 v141, s54, v141
    v_max_i32 v141, 0xa0000000, v141
    v_cvt_pk_bf16_f32 v133, v142, v143
    v_cvt_pk_bf16_f32 v134, v144, v145
    v_cvt_pk_bf16_f32 v135, v146, v147
    v_cvt_pk_bf16_f32 v132, v140, v141
    s_add_u32 s66, s10, 3670016
    buffer_store_dwordx4 v[132:135], v2, s[44:47], s66 offen offset:1024 sc1
    s_branch L_m_j28
L_m_w327:
    v_mov_b32 v24, s38
    v_mov_b32 v25, s38
    v_mov_b32 v26, s38
    v_mov_b32 v27, s38
    ds_read_b64_tr_b16 v[92:93], v13 offset:0
    ds_read_b64_tr_b16 v[94:95], v13 offset:256
    ds_read_b64_tr_b16 v[96:97], v13 offset:64
    ds_read_b64_tr_b16 v[98:99], v13 offset:320
    ds_read_b64_tr_b16 v[100:101], v13 offset:2048
    ds_read_b64_tr_b16 v[102:103], v13 offset:2304
    ds_read_b64_tr_b16 v[104:105], v13 offset:2112
    ds_read_b64_tr_b16 v[106:107], v13 offset:2368
    ds_read_b64_tr_b16 v[108:109], v13 offset:4096
    ds_read_b64_tr_b16 v[110:111], v13 offset:4352
    s_waitcnt lgkmcnt(8)
    v_mfma_f32_16x16x32_bf16 v[44:47], v[24:27], v[92:95], 0
    ds_write_b128 v11, v[116:119] offset:16384
    s_add_u32 s72, s72, 4096
    buffer_load_dwordx4 a[112:115], v2, s[44:47], s72 offen offset:0 sc1
    v_mfma_f32_16x16x32_bf16 v[52:55], v[92:95], v[92:95], 0
    s_waitcnt lgkmcnt(7)
    v_mfma_f32_16x16x32_bf16 v[48:51], v[24:27], v[96:99], 0
    ds_read_b64_tr_b16 v[112:113], v13 offset:4160
    ds_write_b128 v11, v[120:123] offset:20480
    v_mfma_f32_16x16x32_bf16 v[56:59], v[96:99], v[96:99], 0
    ds_read_b64_tr_b16 v[114:115], v13 offset:4416
    s_waitcnt lgkmcnt(8)
    v_mfma_f32_16x16x32_bf16 v[44:47], v[24:27], v[100:103], v[44:47]
    ds_read_b64_tr_b16 v[92:93], v13 offset:6144
    ds_write_b128 v11, v[124:127] offset:24576
    buffer_load_dwordx4 a[116:119], v2, s[44:47], s72 offen offset:1024 sc1
    v_mfma_f32_16x16x32_bf16 v[52:55], v[100:103], v[100:103], v[52:55]
    ds_read_b64_tr_b16 v[94:95], v13 offset:6400
    s_waitcnt lgkmcnt(9)
    v_mfma_f32_16x16x32_bf16 v[48:51], v[24:27], v[104:107], v[48:51]
    ds_read_b64_tr_b16 v[96:97], v13 offset:6208
    ds_write_b128 v11, v[128:131] offset:28672
    v_mfma_f32_16x16x32_bf16 v[56:59], v[104:107], v[104:107], v[56:59]
    ds_read_b64_tr_b16 v[98:99], v13 offset:6464
    s_waitcnt lgkmcnt(10)
    v_mfma_f32_16x16x32_bf16 v[44:47], v[24:27], v[108:111], v[44:47]
    ds_read_b64_tr_b16 v[100:101], v13 offset:8192
    buffer_load_dwordx4 a[120:123], v2, s[44:47], s72 offen offset:2048 sc1
    v_mfma_f32_16x16x32_bf16 v[52:55], v[108:111], v[108:111], v[52:55]
    ds_read_b64_tr_b16 v[102:103], v13 offset:8448
    s_waitcnt lgkmcnt(8)
    v_mfma_f32_16x16x32_bf16 v[48:51], v[24:27], v[112:115], v[48:51]
    ds_read_b64_tr_b16 v[104:105], v13 offset:8256
    v_mfma_f32_16x16x32_bf16 v[56:59], v[112:115], v[112:115], v[56:59]
    ds_read_b64_tr_b16 v[106:107], v13 offset:8512
    s_waitcnt lgkmcnt(7)
    v_mfma_f32_16x16x32_bf16 v[44:47], v[24:27], v[92:95], v[44:47]
    ds_read_b64_tr_b16 v[108:109], v13 offset:10240
    buffer_load_dwordx4 a[124:127], v2, s[44:47], s72 offen offset:3072 sc1
    v_mfma_f32_16x16x32_bf16 v[52:55], v[92:95], v[92:95], v[52:55]
    ds_read_b64_tr_b16 v[110:111], v13 offset:10496
    s_waitcnt lgkmcnt(6)
    v_mfma_f32_16x16x32_bf16 v[48:51], v[24:27], v[96:99], v[48:51]
    ds_read_b64_tr_b16 v[112:113], v13 offset:10304
    v_mfma_f32_16x16x32_bf16 v[56:59], v[96:99], v[96:99], v[56:59]
    ds_read_b64_tr_b16 v[114:115], v13 offset:10560
    s_waitcnt lgkmcnt(6)
    v_mfma_f32_16x16x32_bf16 v[44:47], v[24:27], v[100:103], v[44:47]
    ds_read_b64_tr_b16 v[92:93], v13 offset:12288
    s_sub_u32 s94, s78, s11
    s_lshl_b32 s94, s94, 1
    s_add_u32 s94, s94, s75
    buffer_load_dwordx4 a[128:131], v2, s[44:47], s94 offen offset:0 sc1
    v_mfma_f32_16x16x32_bf16 v[52:55], v[100:103], v[100:103], v[52:55]
    ds_read_b64_tr_b16 v[94:95], v13 offset:12544
    s_waitcnt lgkmcnt(6)
    v_mfma_f32_16x16x32_bf16 v[48:51], v[24:27], v[104:107], v[48:51]
    ds_read_b64_tr_b16 v[96:97], v13 offset:12352
    v_mfma_f32_16x16x32_bf16 v[56:59], v[104:107], v[104:107], v[56:59]
    ds_read_b64_tr_b16 v[98:99], v13 offset:12608
    s_waitcnt lgkmcnt(6)
    v_mfma_f32_16x16x32_bf16 v[44:47], v[24:27], v[108:111], v[44:47]
    ds_read_b64_tr_b16 v[100:101], v13 offset:14336
    buffer_load_dwordx4 a[132:135], v2, s[44:47], s94 offen offset:1024 sc1
    v_mfma_f32_16x16x32_bf16 v[52:55], v[108:111], v[108:111], v[52:55]
    ds_read_b64_tr_b16 v[102:103], v13 offset:14592
    s_waitcnt lgkmcnt(6)
    v_mfma_f32_16x16x32_bf16 v[48:51], v[24:27], v[112:115], v[48:51]
    ds_read_b64_tr_b16 v[104:105], v13 offset:14400
    s_barrier
    v_mfma_f32_16x16x32_bf16 v[56:59], v[112:115], v[112:115], v[56:59]
    ds_read_b64_tr_b16 v[106:107], v13 offset:14656
    s_waitcnt lgkmcnt(6)
    v_mfma_f32_16x16x32_bf16 v[44:47], v[24:27], v[92:95], v[44:47]
    ds_read_b64_tr_b16 v[108:109], v13 offset:16384
    s_add_u32 s94, s94, 8192
    buffer_load_dwordx4 a[160:163], v2, s[44:47], s94 offen offset:0 sc1
    v_mfma_f32_16x16x32_bf16 v[52:55], v[92:95], v[92:95], v[52:55]
    ds_read_b64_tr_b16 v[110:111], v13 offset:16640
    s_waitcnt lgkmcnt(6)
    v_mfma_f32_16x16x32_bf16 v[48:51], v[24:27], v[96:99], v[48:51]
    ds_read_b64_tr_b16 v[112:113], v13 offset:16448
    v_mfma_f32_16x16x32_bf16 v[56:59], v[96:99], v[96:99], v[56:59]
    ds_read_b64_tr_b16 v[114:115], v13 offset:16704
    s_waitcnt lgkmcnt(6)
    v_mfma_f32_16x16x32_bf16 v[44:47], v[24:27], v[100:103], v[44:47]
    ds_read_b64_tr_b16 v[92:93], v13 offset:18432
    buffer_load_dwordx4 a[164:167], v2, s[44:47], s94 offen offset:1024 sc1
    v_mfma_f32_16x16x32_bf16 v[52:55], v[100:103], v[100:103], v[52:55]
    ds_read_b64_tr_b16 v[94:95], v13 offset:18688
    ds_read_b128 v[148:151], v19 offset:0
    s_waitcnt lgkmcnt(7)
    v_mfma_f32_16x16x32_bf16 v[48:51], v[24:27], v[104:107], v[48:51]
    ds_read_b64_tr_b16 v[96:97], v13 offset:18496
    v_mfma_f32_16x16x32_bf16 v[56:59], v[104:107], v[104:107], v[56:59]
    ds_read_b64_tr_b16 v[98:99], v13 offset:18752
    s_waitcnt lgkmcnt(7)
    v_mfma_f32_16x16x32_bf16 v[44:47], v[24:27], v[108:111], v[44:47]
    ds_read_b64_tr_b16 v[100:101], v13 offset:20480
    s_add_u32 s94, s94, 8192
    buffer_load_dwordx4 a[192:195], v2, s[44:47], s94 offen offset:0 sc1
    v_mfma_f32_16x16x32_bf16 v[52:55], v[108:111], v[108:111], v[52:55]
    ds_read_b64_tr_b16 v[102:103], v13 offset:20736
    s_waitcnt lgkmcnt(7)
    v_mfma_f32_16x16x32_bf16 v[48:51], v[24:27], v[112:115], v[48:51]
    ds_read_b64_tr_b16 v[104:105], v13 offset:20544
    v_mfma_f32_16x16x32_bf16 v[56:59], v[112:115], v[112:115], v[56:59]
    ds_read_b64_tr_b16 v[106:107], v13 offset:20800
    s_waitcnt lgkmcnt(7)
    v_mfma_f32_16x16x32_bf16 v[44:47], v[24:27], v[92:95], v[44:47]
    ds_read_b64_tr_b16 v[108:109], v13 offset:22528
    buffer_load_dwordx4 a[196:199], v2, s[44:47], s94 offen offset:1024 sc1
    v_mfma_f32_16x16x32_bf16 v[52:55], v[92:95], v[92:95], v[52:55]
    ds_read_b64_tr_b16 v[110:111], v13 offset:22784
    s_waitcnt lgkmcnt(6)
    v_mfma_f32_16x16x32_bf16 v[48:51], v[24:27], v[96:99], v[48:51]
    ds_read_b64_tr_b16 v[112:113], v13 offset:22592
    v_mfma_f32_16x16x32_bf16 v[56:59], v[96:99], v[96:99], v[56:59]
    ds_read_b64_tr_b16 v[114:115], v13 offset:22848
    s_waitcnt lgkmcnt(6)
    v_mfma_f32_16x16x32_bf16 v[44:47], v[24:27], v[100:103], v[44:47]
    ds_read_b64_tr_b16 v[92:93], v13 offset:24576
    s_add_u32 s94, s94, 8192
    buffer_load_dwordx4 a[224:227], v2, s[44:47], s94 offen offset:0 sc1
    v_mfma_f32_16x16x32_bf16 v[52:55], v[100:103], v[100:103], v[52:55]
    ds_read_b64_tr_b16 v[94:95], v13 offset:24832
    v_perm_b32 v158, v150, v148, s18
    s_waitcnt lgkmcnt(6)
    v_mfma_f32_16x16x32_bf16 v[48:51], v[24:27], v[104:107], v[48:51]
    ds_read_b64_tr_b16 v[96:97], v13 offset:24640
    v_mfma_f32_16x16x32_bf16 v[56:59], v[104:107], v[104:107], v[56:59]
    ds_read_b64_tr_b16 v[98:99], v13 offset:24896
    v_perm_b32 v159, v150, v148, s19
    s_waitcnt lgkmcnt(6)
    v_mfma_f32_16x16x32_bf16 v[44:47], v[24:27], v[108:111], v[44:47]
    ds_read_b64_tr_b16 v[100:101], v13 offset:26624
    buffer_load_dwordx4 a[228:231], v2, s[44:47], s94 offen offset:1024 sc1
    v_mfma_f32_16x16x32_bf16 v[52:55], v[108:111], v[108:111], v[52:55]
    ds_read_b64_tr_b16 v[102:103], v13 offset:26880
    v_perm_b32 v150, v151, v149, s18
    s_waitcnt lgkmcnt(6)
    v_mfma_f32_16x16x32_bf16 v[48:51], v[24:27], v[112:115], v[48:51]
    ds_read_b64_tr_b16 v[104:105], v13 offset:26688
    v_mfma_f32_16x16x32_bf16 v[56:59], v[112:115], v[112:115], v[56:59]
    ds_read_b64_tr_b16 v[106:107], v13 offset:26944
    v_perm_b32 v151, v151, v149, s19
    s_waitcnt lgkmcnt(6)
    v_mfma_f32_16x16x32_bf16 v[44:47], v[24:27], v[92:95], v[44:47]
    ds_read_b64_tr_b16 v[108:109], v13 offset:28672
    s_add_u32 s94, s94, 8192
    buffer_load_dwordx4 v[160:163], v2, s[44:47], s94 offen offset:0 sc1
    v_mfma_f32_16x16x32_bf16 v[52:55], v[92:95], v[92:95], v[52:55]
    ds_read_b64_tr_b16 v[110:111], v13 offset:28928
    v_mov_b32 v148, v158
    s_waitcnt lgkmcnt(6)
    v_mfma_f32_16x16x32_bf16 v[48:51], v[24:27], v[96:99], v[48:51]
    ds_read_b64_tr_b16 v[112:113], v13 offset:28736
    v_mfma_f32_16x16x32_bf16 v[56:59], v[96:99], v[96:99], v[56:59]
    ds_read_b64_tr_b16 v[114:115], v13 offset:28992
    v_mov_b32 v149, v159
    s_waitcnt lgkmcnt(6)
    v_mfma_f32_16x16x32_bf16 v[44:47], v[24:27], v[100:103], v[44:47]
    ds_read_b64_tr_b16 v[92:93], v13 offset:30720
    buffer_load_dwordx4 v[164:167], v2, s[44:47], s94 offen offset:1024 sc1
    v_mfma_f32_16x16x32_bf16 v[52:55], v[100:103], v[100:103], v[52:55]
    ds_read_b64_tr_b16 v[94:95], v13 offset:30976
    v_permlane16_swap_b32 v150, v151
    s_waitcnt lgkmcnt(6)
    v_mfma_f32_16x16x32_bf16 v[48:51], v[24:27], v[104:107], v[48:51]
    ds_read_b64_tr_b16 v[96:97], v13 offset:30784
    v_mfma_f32_16x16x32_bf16 v[56:59], v[104:107], v[104:107], v[56:59]
    ds_read_b64_tr_b16 v[98:99], v13 offset:31040
    v_permlane16_swap_b32 v148, v149
    s_waitcnt lgkmcnt(6)
    v_mfma_f32_16x16x32_bf16 v[44:47], v[24:27], v[108:111], v[44:47]
    v_permlane32_swap_b32 v148, v150
    s_add_u32 s94, s94, 8192
    buffer_load_dwordx4 v[192:195], v2, s[44:47], s94 offen offset:0 sc1
    v_mfma_f32_16x16x32_bf16 v[52:55], v[108:111], v[108:111], v[52:55]
    v_permlane32_swap_b32 v149, v151
    v_mov_b32 v124, 0
    s_waitcnt lgkmcnt(4)
    v_mfma_f32_16x16x32_bf16 v[48:51], v[24:27], v[112:115], v[48:51]
    v_mov_b32 v125, 0
    v_mfma_f32_16x16x32_bf16 v[56:59], v[112:115], v[112:115], v[56:59]
    v_mov_b32 v126, 0
    v_mov_b32 v127, 0
    s_waitcnt lgkmcnt(2)
    v_mfma_f32_16x16x32_bf16 v[44:47], v[24:27], v[92:95], v[44:47]
    buffer_load_dwordx4 v[196:199], v2, s[44:47], s94 offen offset:1024 sc1
    v_mfma_f32_16x16x32_bf16 v[52:55], v[92:95], v[92:95], v[52:55]
    s_waitcnt lgkmcnt(0)
    v_mfma_f32_16x16x32_bf16 v[48:51], v[24:27], v[96:99], v[48:51]
    v_mfma_f32_16x16x32_bf16 v[56:59], v[96:99], v[96:99], v[56:59]
    ds_read_b64_tr_b16 v[100:101], v12 offset:0
    ds_read_b64_tr_b16 v[102:103], v12 offset:256
    ds_read_b64_tr_b16 v[104:105], v12 offset:1024
    ds_read_b64_tr_b16 v[106:107], v12 offset:1280
    ds_read_b64_tr_b16 v[108:109], v12 offset:2048
    ds_read_b64_tr_b16 v[110:111], v12 offset:2304
    ds_read_b64_tr_b16 v[112:113], v12 offset:3072
    ds_read_b64_tr_b16 v[114:115], v12 offset:3328
    s_waitcnt lgkmcnt(6)
    v_mfma_f32_32x32x16_bf16 v[28:43], a[0:3], v[100:103], 0
    s_add_u32 s94, s94, 8192
    buffer_load_dwordx4 v[224:227], v2, s[44:47], s94 offen offset:0 sc1
    s_waitcnt lgkmcnt(4)
    v_mfma_f32_32x32x16_bf16 v[28:43], a[4:7], v[104:107], v[28:43]
    ds_read_b64_tr_b16 v[92:93], v12 offset:4096
    ds_read_b64_tr_b16 v[94:95], v12 offset:4352
    v_cndmask_b32 v52, v52, v53, s[30:31]
    v_cndmask_b32 v54, v54, v55, s[30:31]
    v_cndmask_b32 v56, v56, v57, s[30:31]
    s_waitcnt lgkmcnt(4)
    v_mfma_f32_32x32x16_bf16 v[28:43], a[8:11], v[108:111], v[28:43]
    ds_read_b64_tr_b16 v[96:97], v12 offset:5120
    ds_read_b64_tr_b16 v[98:99], v12 offset:5376
    v_cndmask_b32 v58, v58, v59, s[30:31]
    v_mov_b32 v45, s22
    v_cndmask_b32 v52, v52, v54, s[32:33]
    buffer_load_dwordx4 v[228:231], v2, s[44:47], s94 offen offset:1024 sc1
    s_waitcnt lgkmcnt(4)
    v_mfma_f32_32x32x16_bf16 v[28:43], a[12:15], v[112:115], v[28:43]
    ds_read_b64_tr_b16 v[100:101], v12 offset:6144
    ds_read_b64_tr_b16 v[102:103], v12 offset:6400
    v_cndmask_b32 v56, v56, v58, s[32:33]
    v_mul_f32 v44, s20, v44
    v_fma_f32 v52, v52, s20, v45
    s_waitcnt lgkmcnt(4)
    v_mfma_f32_32x32x16_bf16 v[28:43], a[16:19], v[92:95], v[28:43]
    ds_read_b64_tr_b16 v[104:105], v12 offset:7168
    ds_read_b64_tr_b16 v[106:107], v12 offset:7424
    v_mul_f32 v48, s20, v48
    v_fma_f32 v56, v56, s20, v45
    v_fma_f32 v52, -v44, v44, v52
    s_sub_u32 s94, s79, s11
    s_lshl_b32 s94, s94, 1
    s_add_u32 s94, s94, s75
    buffer_load_dwordx4 a[136:139], v2, s[44:47], s94 offen offset:0 sc1
    s_waitcnt lgkmcnt(4)
    v_mfma_f32_32x32x16_bf16 v[28:43], a[20:23], v[96:99], v[28:43]
    ds_read_b64_tr_b16 v[108:109], v12 offset:8192
    ds_read_b64_tr_b16 v[110:111], v12 offset:8448
    v_fma_f32 v56, -v48, v48, v56
    v_max_f32 v52, s22, v52
    v_max_f32 v56, s22, v56
    s_waitcnt lgkmcnt(4)
    v_mfma_f32_32x32x16_bf16 v[28:43], a[24:27], v[100:103], v[28:43]
    ds_read_b64_tr_b16 v[112:113], v12 offset:9216
    ds_read_b64_tr_b16 v[114:115], v12 offset:9472
    v_rsq_f32 v52, v52
    v_rsq_f32 v56, v56
    buffer_load_dwordx4 a[140:143], v2, s[44:47], s94 offen offset:1024 sc1
    s_waitcnt lgkmcnt(4)
    v_mfma_f32_32x32x16_bf16 v[28:43], a[28:31], v[104:107], v[28:43]
    ds_read_b64_tr_b16 v[92:93], v12 offset:10240
    ds_read_b64_tr_b16 v[94:95], v12 offset:10496
    v_and_b32 v46, 15, v1
    v_lshlrev_b32 v46, 3, v46
    v_add_u32 v46, 97024, v46
    s_waitcnt lgkmcnt(4)
    v_mfma_f32_32x32x16_bf16 v[28:43], a[32:35], v[108:111], v[28:43]
    ds_read_b64_tr_b16 v[96:97], v12 offset:11264
    ds_read_b64_tr_b16 v[98:99], v12 offset:11520
    v_mul_f32 v45, -v44, v52
    v_mul_f32 v44, s23, v52
    v_mul_f32 v49, -v48, v56
    s_add_u32 s94, s94, 8192
    buffer_load_dwordx4 a[168:171], v2, s[44:47], s94 offen offset:0 sc1
    s_waitcnt lgkmcnt(4)
    v_mfma_f32_32x32x16_bf16 v[28:43], a[36:39], v[112:115], v[28:43]
    ds_read_b64_tr_b16 v[100:101], v12 offset:12288
    ds_read_b64_tr_b16 v[102:103], v12 offset:12544
    v_mul_f32 v48, s23, v56
    s_mov_b64 exec, s[34:35]
    ds_write_b64 v46, v[44:45] offset:0
    ds_write_b64 v46, v[48:49] offset:128
    s_mov_b64 exec, -1
    s_waitcnt lgkmcnt(6)
    v_mfma_f32_32x32x16_bf16 v[28:43], a[40:43], v[92:95], v[28:43]
    ds_read_b64_tr_b16 v[104:105], v12 offset:13312
    ds_read_b64_tr_b16 v[106:107], v12 offset:13568
    s_add_u32 s64, s8, 3215360
    buffer_load_dwordx4 v[60:63], v2, s[44:47], s64 offen sc1
    buffer_load_dwordx4 a[172:175], v2, s[44:47], s94 offen offset:1024 sc1
    s_waitcnt lgkmcnt(6)
    v_mfma_f32_32x32x16_bf16 v[28:43], a[44:47], v[96:99], v[28:43]
    ds_read_b64_tr_b16 v[108:109], v12 offset:14336
    ds_read_b64_tr_b16 v[110:111], v12 offset:14592
    s_add_u32 s64, s8, 3219456
    buffer_load_dwordx4 v[64:67], v2, s[44:47], s64 offen sc1
    s_waitcnt lgkmcnt(6)
    v_mfma_f32_32x32x16_bf16 v[28:43], a[48:51], v[100:103], v[28:43]
    ds_read_b64_tr_b16 v[112:113], v12 offset:15360
    ds_read_b64_tr_b16 v[114:115], v12 offset:15616
    s_add_u32 s64, s8, 3223552
    buffer_load_dwordx4 v[68:71], v2, s[44:47], s64 offen sc1
    s_add_u32 s94, s94, 8192
    buffer_load_dwordx4 a[200:203], v2, s[44:47], s94 offen offset:0 sc1
    s_waitcnt lgkmcnt(4)
    v_mfma_f32_32x32x16_bf16 v[28:43], a[52:55], v[104:107], v[28:43]
    ds_read_b64_tr_b16 v[92:93], v12 offset:16384
    ds_read_b64_tr_b16 v[94:95], v12 offset:16640
    s_add_u32 s64, s8, 3227648
    buffer_load_dwordx4 v[72:75], v2, s[44:47], s64 offen sc1
    s_waitcnt lgkmcnt(4)
    v_mfma_f32_32x32x16_bf16 v[28:43], a[56:59], v[108:111], v[28:43]
    ds_read_b64_tr_b16 v[96:97], v12 offset:17408
    ds_read_b64_tr_b16 v[98:99], v12 offset:17664
    s_add_u32 s64, s8, 3231744
    buffer_load_dwordx4 v[76:79], v2, s[44:47], s64 offen sc1
    buffer_load_dwordx4 a[204:207], v2, s[44:47], s94 offen offset:1024 sc1
    s_waitcnt lgkmcnt(4)
    v_mfma_f32_32x32x16_bf16 v[28:43], a[60:63], v[112:115], v[28:43]
    ds_read_b64_tr_b16 v[100:101], v12 offset:18432
    ds_read_b64_tr_b16 v[102:103], v12 offset:18688
    s_add_u32 s64, s8, 3235840
    buffer_load_dwordx4 v[80:83], v2, s[44:47], s64 offen sc1
    s_waitcnt lgkmcnt(4)
    v_mfma_f32_32x32x16_bf16 v[28:43], a[64:67], v[92:95], v[28:43]
    ds_read_b64_tr_b16 v[104:105], v12 offset:19456
    ds_read_b64_tr_b16 v[106:107], v12 offset:19712
    s_add_u32 s64, s8, 3239936
    buffer_load_dwordx4 v[84:87], v2, s[44:47], s64 offen sc1
    s_add_u32 s94, s94, 8192
    buffer_load_dwordx4 a[232:235], v2, s[44:47], s94 offen offset:0 sc1
    s_waitcnt lgkmcnt(4)
    v_mfma_f32_32x32x16_bf16 v[28:43], a[68:71], v[96:99], v[28:43]
    ds_read_b64_tr_b16 v[108:109], v12 offset:20480
    ds_read_b64_tr_b16 v[110:111], v12 offset:20736
    s_add_u32 s64, s8, 3244032
    buffer_load_dwordx4 v[88:91], v2, s[44:47], s64 offen sc1
    s_waitcnt lgkmcnt(4)
    v_mfma_f32_32x32x16_bf16 v[28:43], a[72:75], v[100:103], v[28:43]
    ds_read_b64_tr_b16 v[112:113], v12 offset:21504
    ds_read_b64_tr_b16 v[114:115], v12 offset:21760
    buffer_load_dwordx4 a[236:239], v2, s[44:47], s94 offen offset:1024 sc1
    s_waitcnt lgkmcnt(4)
    v_mfma_f32_32x32x16_bf16 v[28:43], a[76:79], v[104:107], v[28:43]
    ds_read_b64_tr_b16 v[92:93], v12 offset:22528
    ds_read_b64_tr_b16 v[94:95], v12 offset:22784
    s_waitcnt vmcnt(39)
    s_waitcnt lgkmcnt(4)
    v_mfma_f32_32x32x16_bf16 v[28:43], a[80:83], v[108:111], v[28:43]
    ds_read_b64_tr_b16 v[96:97], v12 offset:23552
    ds_read_b64_tr_b16 v[98:99], v12 offset:23808
    s_add_u32 s94, s94, 8192
    buffer_load_dwordx4 v[168:171], v2, s[44:47], s94 offen offset:0 sc1
    s_waitcnt lgkmcnt(4)
    v_mfma_f32_32x32x16_bf16 v[28:43], a[84:87], v[112:115], v[28:43]
    ds_read_b64_tr_b16 v[100:101], v12 offset:24576
    ds_read_b64_tr_b16 v[102:103], v12 offset:24832
    s_waitcnt lgkmcnt(4)
    v_mfma_f32_32x32x16_bf16 v[28:43], a[88:91], v[92:95], v[28:43]
    ds_read_b64_tr_b16 v[104:105], v12 offset:25600
    ds_read_b64_tr_b16 v[106:107], v12 offset:25856
    buffer_load_dwordx4 v[172:175], v2, s[44:47], s94 offen offset:1024 sc1
    s_waitcnt lgkmcnt(4)
    v_mfma_f32_32x32x16_bf16 v[28:43], a[92:95], v[96:99], v[28:43]
    ds_read_b64_tr_b16 v[108:109], v12 offset:26624
    ds_read_b64_tr_b16 v[110:111], v12 offset:26880
    s_waitcnt vmcnt(36)
    s_waitcnt lgkmcnt(4)
    v_mfma_f32_32x32x16_bf16 v[28:43], a[96:99], v[100:103], v[28:43]
    ds_read_b64_tr_b16 v[112:113], v12 offset:27648
    ds_read_b64_tr_b16 v[114:115], v12 offset:27904
    s_add_u32 s94, s94, 8192
    buffer_load_dwordx4 v[200:203], v2, s[44:47], s94 offen offset:0 sc1
    s_waitcnt lgkmcnt(4)
    v_mfma_f32_32x32x16_bf16 v[28:43], a[100:103], v[104:107], v[28:43]
    ds_read_b64_tr_b16 v[92:93], v12 offset:28672
    ds_read_b64_tr_b16 v[94:95], v12 offset:28928
    s_waitcnt lgkmcnt(4)
    v_mfma_f32_32x32x16_bf16 v[28:43], a[104:107], v[108:111], v[28:43]
    ds_read_b64_tr_b16 v[96:97], v12 offset:29696
    ds_read_b64_tr_b16 v[98:99], v12 offset:29952
    s_waitcnt vmcnt(4)
    v_min3_f32 v136, |v60|, |v64|, |v68|
    v_min3_f32 v136, v136, |v72|, |v76|
    v_min3_f32 v136, v136, |v80|, |v84|
    v_min_f32 v136, v136, |v88|
    v_cmp_gt_f32 vcc, s54, v136
    s_cbranch_vccnz L_m_s31
L_m_r32:
    buffer_load_dwordx4 v[204:207], v2, s[44:47], s94 offen offset:1024 sc1
    s_waitcnt lgkmcnt(4)
    v_mfma_f32_32x32x16_bf16 v[28:43], a[108:111], v[112:115], v[28:43]
    ds_read_b64_tr_b16 v[100:101], v12 offset:30720
    ds_read_b64_tr_b16 v[102:103], v12 offset:30976
    ds_write_b128 v11, v[60:63] offset:32768
    s_waitcnt lgkmcnt(5)
    v_mfma_f32_32x32x16_bf16 v[28:43], a[112:115], v[92:95], v[28:43]
    ds_read_b64_tr_b16 v[104:105], v12 offset:31744
    ds_read_b64_tr_b16 v[106:107], v12 offset:32000
    ds_write_b128 v11, v[64:67] offset:36864
    s_add_u32 s94, s94, 8192
    buffer_load_dwordx4 v[232:235], v2, s[44:47], s94 offen offset:0 sc1
    s_waitcnt lgkmcnt(6)
    v_mfma_f32_32x32x16_bf16 v[28:43], a[116:119], v[96:99], v[28:43]
    ds_write_b128 v11, v[68:71] offset:40960
    ds_write_b128 v11, v[72:75] offset:45056
    s_waitcnt lgkmcnt(6)
    v_mfma_f32_32x32x16_bf16 v[28:43], a[120:123], v[100:103], v[28:43]
    ds_write_b128 v11, v[76:79] offset:49152
    ds_write_b128 v11, v[80:83] offset:53248
    buffer_load_dwordx4 v[236:239], v2, s[44:47], s94 offen offset:1024 sc1
    s_waitcnt lgkmcnt(5)
    v_mfma_f32_32x32x16_bf16 v[28:43], a[124:127], v[104:107], v[28:43]
    ds_write_b128 v11, v[84:87] offset:57344
    ds_write_b128 v11, v[88:91] offset:61440
    s_waitcnt lgkmcnt(0)
    s_barrier
    ds_read_b64_tr_b16 v[92:93], v13 offset:32768
    ds_read_b64_tr_b16 v[94:95], v13 offset:33024
    ds_read_b64_tr_b16 v[96:97], v13 offset:32832
    ds_read_b64_tr_b16 v[98:99], v13 offset:33088
    ds_read_b64_tr_b16 v[100:101], v13 offset:34816
    ds_read_b64_tr_b16 v[102:103], v13 offset:35072
    ds_read_b64_tr_b16 v[104:105], v13 offset:34880
    ds_read_b64_tr_b16 v[106:107], v13 offset:35136
    ds_read_b64_tr_b16 v[108:109], v13 offset:36864
    ds_read_b64_tr_b16 v[110:111], v13 offset:37120
    s_waitcnt lgkmcnt(8)
    v_mfma_f32_16x16x32_bf16 v[76:79], v[24:27], v[92:95], 0
    ds_read_b128 v[152:155], v19 offset:32768
    s_sub_u32 s94, s80, s11
    s_lshl_b32 s94, s94, 1
    s_add_u32 s94, s94, s75
    buffer_load_dwordx4 a[144:147], v2, s[44:47], s94 offen offset:0 sc1
    v_mfma_f32_16x16x32_bf16 v[84:87], v[92:95], v[92:95], 0
    ds_read_b64 v[156:157], v15 offset:0
    ds_read_b128 v[116:119], v14 offset:0
    s_waitcnt lgkmcnt(9)
    v_mfma_f32_16x16x32_bf16 v[80:83], v[24:27], v[96:99], 0
    ds_read_b64_tr_b16 v[112:113], v13 offset:36928
    v_mfma_f32_16x16x32_bf16 v[88:91], v[96:99], v[96:99], 0
    ds_read_b64_tr_b16 v[114:115], v13 offset:37184
    ds_read_b128 v[120:123], v14 offset:32
    s_waitcnt lgkmcnt(10)
    v_mfma_f32_16x16x32_bf16 v[76:79], v[24:27], v[100:103], v[76:79]
    ds_read_b64_tr_b16 v[92:93], v13 offset:38912
    buffer_load_dwordx4 a[148:151], v2, s[44:47], s94 offen offset:1024 sc1
    v_mfma_f32_16x16x32_bf16 v[84:87], v[100:103], v[100:103], v[84:87]
    ds_read_b64_tr_b16 v[94:95], v13 offset:39168
    ds_read_b128 v[124:127], v14 offset:896
    s_waitcnt lgkmcnt(11)
    v_mfma_f32_16x16x32_bf16 v[80:83], v[24:27], v[104:107], v[80:83]
    ds_read_b64_tr_b16 v[96:97], v13 offset:38976
    v_mfma_f32_16x16x32_bf16 v[88:91], v[104:107], v[104:107], v[88:91]
    ds_read_b64_tr_b16 v[98:99], v13 offset:39232
    ds_read_b128 v[128:131], v14 offset:928
    s_waitcnt lgkmcnt(12)
    v_mfma_f32_16x16x32_bf16 v[76:79], v[24:27], v[108:111], v[76:79]
    ds_read_b64_tr_b16 v[100:101], v13 offset:40960
    s_add_u32 s94, s94, 8192
    buffer_load_dwordx4 a[176:179], v2, s[44:47], s94 offen offset:0 sc1
    v_mfma_f32_16x16x32_bf16 v[84:87], v[108:111], v[108:111], v[84:87]
    ds_read_b64_tr_b16 v[102:103], v13 offset:41216
    ds_read_b128 v[132:135], v14 offset:64
    s_waitcnt lgkmcnt(10)
    v_mfma_f32_16x16x32_bf16 v[80:83], v[24:27], v[112:115], v[80:83]
    ds_read_b64_tr_b16 v[104:105], v13 offset:41024
    v_mfma_f32_16x16x32_bf16 v[88:91], v[112:115], v[112:115], v[88:91]
    ds_read_b64_tr_b16 v[106:107], v13 offset:41280
    ds_read_b128 v[136:139], v14 offset:96
    s_waitcnt lgkmcnt(10)
    v_mfma_f32_16x16x32_bf16 v[76:79], v[24:27], v[92:95], v[76:79]
    ds_read_b64_tr_b16 v[108:109], v13 offset:43008
    buffer_load_dwordx4 a[180:183], v2, s[44:47], s94 offen offset:1024 sc1
    v_mfma_f32_16x16x32_bf16 v[84:87], v[92:95], v[92:95], v[84:87]
    ds_read_b64_tr_b16 v[110:111], v13 offset:43264
    ds_read_b128 v[140:143], v14 offset:960
    s_waitcnt lgkmcnt(10)
    v_mfma_f32_16x16x32_bf16 v[80:83], v[24:27], v[96:99], v[80:83]
    ds_read_b64_tr_b16 v[112:113], v13 offset:43072
    v_mfma_f32_16x16x32_bf16 v[88:91], v[96:99], v[96:99], v[88:91]
    ds_read_b64_tr_b16 v[114:115], v13 offset:43328
    ds_read_b128 v[144:147], v14 offset:992
    s_waitcnt lgkmcnt(10)
    v_mfma_f32_16x16x32_bf16 v[76:79], v[24:27], v[100:103], v[76:79]
    ds_read_b64_tr_b16 v[92:93], v13 offset:45056
    s_add_u32 s94, s94, 8192
    buffer_load_dwordx4 a[208:211], v2, s[44:47], s94 offen offset:0 sc1
    v_mfma_f32_16x16x32_bf16 v[84:87], v[100:103], v[100:103], v[84:87]
    ds_read_b64_tr_b16 v[94:95], v13 offset:45312
    v_fmac_f32 v124, v116, v157
    s_waitcnt lgkmcnt(9)
    v_mfma_f32_16x16x32_bf16 v[80:83], v[24:27], v[104:107], v[80:83]
    ds_read_b64_tr_b16 v[96:97], v13 offset:45120
    v_mfma_f32_16x16x32_bf16 v[88:91], v[104:107], v[104:107], v[88:91]
    ds_read_b64_tr_b16 v[98:99], v13 offset:45376
    v_fmac_f32 v125, v117, v157
    s_waitcnt lgkmcnt(8)
    v_mfma_f32_16x16x32_bf16 v[76:79], v[24:27], v[108:111], v[76:79]
    ds_read_b64_tr_b16 v[100:101], v13 offset:47104
    buffer_load_dwordx4 a[212:215], v2, s[44:47], s94 offen offset:1024 sc1
    v_mfma_f32_16x16x32_bf16 v[84:87], v[108:111], v[108:111], v[84:87]
    ds_read_b64_tr_b16 v[102:103], v13 offset:47360
    v_fmac_f32 v126, v118, v157
    s_waitcnt lgkmcnt(7)
    v_mfma_f32_16x16x32_bf16 v[80:83], v[24:27], v[112:115], v[80:83]
    ds_read_b64_tr_b16 v[104:105], v13 offset:47168
    v_mfma_f32_16x16x32_bf16 v[88:91], v[112:115], v[112:115], v[88:91]
    ds_read_b64_tr_b16 v[106:107], v13 offset:47424
    v_fmac_f32 v127, v119, v157
    s_waitcnt lgkmcnt(6)
    v_mfma_f32_16x16x32_bf16 v[76:79], v[24:27], v[92:95], v[76:79]
    ds_read_b64_tr_b16 v[108:109], v13 offset:49152
    s_add_u32 s94, s94, 8192
    buffer_load_dwordx4 a[240:243], v2, s[44:47], s94 offen offset:0 sc1
    v_mfma_f32_16x16x32_bf16 v[84:87], v[92:95], v[92:95], v[84:87]
    ds_read_b64_tr_b16 v[110:111], v13 offset:49408
    v_fmac_f32 v128, v120, v157
    s_waitcnt lgkmcnt(6)
    v_mfma_f32_16x16x32_bf16 v[80:83], v[24:27], v[96:99], v[80:83]
    ds_read_b64_tr_b16 v[112:113], v13 offset:49216
    v_mfma_f32_16x16x32_bf16 v[88:91], v[96:99], v[96:99], v[88:91]
    ds_read_b64_tr_b16 v[114:115], v13 offset:49472
    v_fmac_f32 v129, v121, v157
    s_waitcnt lgkmcnt(6)
    v_mfma_f32_16x16x32_bf16 v[76:79], v[24:27], v[100:103], v[76:79]
    ds_read_b64_tr_b16 v[92:93], v13 offset:51200
    buffer_load_dwordx4 a[244:247], v2, s[44:47], s94 offen offset:1024 sc1
    v_mfma_f32_16x16x32_bf16 v[84:87], v[100:103], v[100:103], v[84:87]
    ds_read_b64_tr_b16 v[94:95], v13 offset:51456
    v_fmac_f32 v130, v122, v157
    s_waitcnt lgkmcnt(6)
    v_mfma_f32_16x16x32_bf16 v[80:83], v[24:27], v[104:107], v[80:83]
    ds_read_b64_tr_b16 v[96:97], v13 offset:51264
    v_mfma_f32_16x16x32_bf16 v[88:91], v[104:107], v[104:107], v[88:91]
    ds_read_b64_tr_b16 v[98:99], v13 offset:51520
    v_fmac_f32 v131, v123, v157
    s_waitcnt lgkmcnt(6)
    v_mfma_f32_16x16x32_bf16 v[76:79], v[24:27], v[108:111], v[76:79]
    ds_read_b64_tr_b16 v[100:101], v13 offset:53248
    s_add_u32 s94, s94, 8192
    buffer_load_dwordx4 v[176:179], v2, s[44:47], s94 offen offset:0 sc1
    v_mfma_f32_16x16x32_bf16 v[84:87], v[108:111], v[108:111], v[84:87]
    ds_read_b64_tr_b16 v[102:103], v13 offset:53504
    v_fmac_f32 v124, v28, v156
    s_waitcnt lgkmcnt(6)
    v_mfma_f32_16x16x32_bf16 v[80:83], v[24:27], v[112:115], v[80:83]
    ds_read_b64_tr_b16 v[104:105], v13 offset:53312
    v_mfma_f32_16x16x32_bf16 v[88:91], v[112:115], v[112:115], v[88:91]
    ds_read_b64_tr_b16 v[106:107], v13 offset:53568
    v_fmac_f32 v125, v29, v156
    s_waitcnt lgkmcnt(6)
    v_mfma_f32_16x16x32_bf16 v[76:79], v[24:27], v[92:95], v[76:79]
    ds_read_b64_tr_b16 v[108:109], v13 offset:55296
    buffer_load_dwordx4 v[180:183], v2, s[44:47], s94 offen offset:1024 sc1
    v_mfma_f32_16x16x32_bf16 v[84:87], v[92:95], v[92:95], v[84:87]
    ds_read_b64_tr_b16 v[110:111], v13 offset:55552
    v_fmac_f32 v126, v30, v156
    s_waitcnt lgkmcnt(6)
    v_mfma_f32_16x16x32_bf16 v[80:83], v[24:27], v[96:99], v[80:83]
    ds_read_b64_tr_b16 v[112:113], v13 offset:55360
    v_mfma_f32_16x16x32_bf16 v[88:91], v[96:99], v[96:99], v[88:91]
    ds_read_b64_tr_b16 v[114:115], v13 offset:55616
    v_fmac_f32 v127, v31, v156
    s_waitcnt lgkmcnt(6)
    v_mfma_f32_16x16x32_bf16 v[76:79], v[24:27], v[100:103], v[76:79]
    ds_read_b64_tr_b16 v[92:93], v13 offset:57344
    s_add_u32 s94, s94, 8192
    buffer_load_dwordx4 v[208:211], v2, s[44:47], s94 offen offset:0 sc1
    v_mfma_f32_16x16x32_bf16 v[84:87], v[100:103], v[100:103], v[84:87]
    ds_read_b64_tr_b16 v[94:95], v13 offset:57600
    v_fmac_f32 v128, v32, v156
    s_waitcnt lgkmcnt(6)
    v_mfma_f32_16x16x32_bf16 v[80:83], v[24:27], v[104:107], v[80:83]
    ds_read_b64_tr_b16 v[96:97], v13 offset:57408
    v_mfma_f32_16x16x32_bf16 v[88:91], v[104:107], v[104:107], v[88:91]
    ds_read_b64_tr_b16 v[98:99], v13 offset:57664
    v_fmac_f32 v129, v33, v156
    s_waitcnt lgkmcnt(6)
    v_mfma_f32_16x16x32_bf16 v[76:79], v[24:27], v[108:111], v[76:79]
    ds_read_b64_tr_b16 v[100:101], v13 offset:59392
    buffer_load_dwordx4 v[212:215], v2, s[44:47], s94 offen offset:1024 sc1
    v_mfma_f32_16x16x32_bf16 v[84:87], v[108:111], v[108:111], v[84:87]
    ds_read_b64_tr_b16 v[102:103], v13 offset:59648
    v_fmac_f32 v130, v34, v156
    s_waitcnt lgkmcnt(6)
    v_mfma_f32_16x16x32_bf16 v[80:83], v[24:27], v[112:115], v[80:83]
    ds_read_b64_tr_b16 v[104:105], v13 offset:59456
    v_mfma_f32_16x16x32_bf16 v[88:91], v[112:115], v[112:115], v[88:91]
    ds_read_b64_tr_b16 v[106:107], v13 offset:59712
    v_fmac_f32 v131, v35, v156
    s_waitcnt lgkmcnt(6)
    v_mfma_f32_16x16x32_bf16 v[76:79], v[24:27], v[92:95], v[76:79]
    ds_read_b64_tr_b16 v[108:109], v13 offset:61440
    s_add_u32 s94, s94, 8192
    buffer_load_dwordx4 v[240:243], v2, s[44:47], s94 offen offset:0 sc1
    v_mfma_f32_16x16x32_bf16 v[84:87], v[92:95], v[92:95], v[84:87]
    ds_read_b64_tr_b16 v[110:111], v13 offset:61696
    v_exp_f32 v28, v124
    s_waitcnt lgkmcnt(6)
    v_mfma_f32_16x16x32_bf16 v[80:83], v[24:27], v[96:99], v[80:83]
    ds_read_b64_tr_b16 v[112:113], v13 offset:61504
    v_mfma_f32_16x16x32_bf16 v[88:91], v[96:99], v[96:99], v[88:91]
    ds_read_b64_tr_b16 v[114:115], v13 offset:61760
    v_exp_f32 v29, v125
    s_waitcnt lgkmcnt(6)
    v_mfma_f32_16x16x32_bf16 v[76:79], v[24:27], v[100:103], v[76:79]
    ds_read_b64_tr_b16 v[92:93], v13 offset:63488
    buffer_load_dwordx4 v[244:247], v2, s[44:47], s94 offen offset:1024 sc1
    v_mfma_f32_16x16x32_bf16 v[84:87], v[100:103], v[100:103], v[84:87]
    ds_read_b64_tr_b16 v[94:95], v13 offset:63744
    v_exp_f32 v30, v126
    s_waitcnt lgkmcnt(6)
    v_mfma_f32_16x16x32_bf16 v[80:83], v[24:27], v[104:107], v[80:83]
    ds_read_b64_tr_b16 v[96:97], v13 offset:63552
    v_mfma_f32_16x16x32_bf16 v[88:91], v[104:107], v[104:107], v[88:91]
    ds_read_b64_tr_b16 v[98:99], v13 offset:63808
    v_exp_f32 v31, v127
    s_waitcnt lgkmcnt(6)
    v_mfma_f32_16x16x32_bf16 v[76:79], v[24:27], v[108:111], v[76:79]
    v_exp_f32 v32, v128
    s_sub_u32 s94, s81, s11
    s_lshl_b32 s94, s94, 1
    s_add_u32 s94, s94, s75
    buffer_load_dwordx4 a[152:155], v2, s[44:47], s94 offen offset:0 sc1
    v_mfma_f32_16x16x32_bf16 v[84:87], v[108:111], v[108:111], v[84:87]
    v_exp_f32 v33, v129
    s_waitcnt lgkmcnt(4)
    v_mfma_f32_16x16x32_bf16 v[80:83], v[24:27], v[112:115], v[80:83]
    v_exp_f32 v34, v130
    v_mfma_f32_16x16x32_bf16 v[88:91], v[112:115], v[112:115], v[88:91]
    v_exp_f32 v35, v131
    s_waitcnt lgkmcnt(2)
    v_mfma_f32_16x16x32_bf16 v[76:79], v[24:27], v[92:95], v[76:79]
    v_fma_f32 v116, v28, 0.5, 1.0
    buffer_load_dwordx4 a[156:159], v2, s[44:47], s94 offen offset:1024 sc1
    v_mfma_f32_16x16x32_bf16 v[84:87], v[92:95], v[92:95], v[84:87]
    v_fma_f32 v117, v29, 0.5, 1.0
    v_fma_f32 v118, v30, 0.5, 1.0
    s_waitcnt lgkmcnt(0)
    v_mfma_f32_16x16x32_bf16 v[80:83], v[24:27], v[96:99], v[80:83]
    v_fma_f32 v119, v31, 0.5, 1.0
    v_mfma_f32_16x16x32_bf16 v[88:91], v[96:99], v[96:99], v[88:91]
    v_fma_f32 v120, v32, 0.5, 1.0
    v_fma_f32 v121, v33, 0.5, 1.0
    ds_read_b64_tr_b16 v[100:101], v12 offset:32768
    ds_read_b64_tr_b16 v[102:103], v12 offset:33024
    ds_read_b64_tr_b16 v[104:105], v12 offset:33792
    ds_read_b64_tr_b16 v[106:107], v12 offset:34048
    ds_read_b64_tr_b16 v[108:109], v12 offset:34816
    ds_read_b64_tr_b16 v[110:111], v12 offset:35072
    ds_read_b64_tr_b16 v[112:113], v12 offset:35840
    ds_read_b64_tr_b16 v[114:115], v12 offset:36096
    s_waitcnt lgkmcnt(6)
    v_mfma_f32_32x32x16_bf16 v[60:75], a[0:3], v[100:103], 0
    v_fma_f32 v122, v34, 0.5, 1.0
    v_fma_f32 v123, v35, 0.5, 1.0
    v_fma_f32 v28, -v28, v116, -1.0
    v_fma_f32 v29, -v29, v117, -1.0
    v_fma_f32 v30, -v30, v118, -1.0
    s_add_u32 s94, s94, 8192
    buffer_load_dwordx4 a[184:187], v2, s[44:47], s94 offen offset:0 sc1
    s_waitcnt lgkmcnt(4)
    v_mfma_f32_32x32x16_bf16 v[60:75], a[4:7], v[104:107], v[60:75]
    ds_read_b64_tr_b16 v[92:93], v12 offset:36864
    ds_read_b64_tr_b16 v[94:95], v12 offset:37120
    v_cndmask_b32 v84, v84, v85, s[30:31]
    v_cndmask_b32 v86, v86, v87, s[30:31]
    v_cndmask_b32 v88, v88, v89, s[30:31]
    s_waitcnt lgkmcnt(4)
    v_mfma_f32_32x32x16_bf16 v[60:75], a[8:11], v[108:111], v[60:75]
    ds_read_b64_tr_b16 v[96:97], v12 offset:37888
    ds_read_b64_tr_b16 v[98:99], v12 offset:38144
    v_cndmask_b32 v90, v90, v91, s[30:31]
    v_mov_b32 v77, s22
    v_cndmask_b32 v84, v84, v86, s[32:33]
    buffer_load_dwordx4 a[188:191], v2, s[44:47], s94 offen offset:1024 sc1
    s_waitcnt lgkmcnt(4)
    v_mfma_f32_32x32x16_bf16 v[60:75], a[12:15], v[112:115], v[60:75]
    ds_read_b64_tr_b16 v[100:101], v12 offset:38912
    ds_read_b64_tr_b16 v[102:103], v12 offset:39168
    v_cndmask_b32 v88, v88, v90, s[32:33]
    v_mul_f32 v76, s20, v76
    v_fma_f32 v84, v84, s20, v77
    s_waitcnt lgkmcnt(4)
    v_mfma_f32_32x32x16_bf16 v[60:75], a[16:19], v[92:95], v[60:75]
    ds_read_b64_tr_b16 v[104:105], v12 offset:39936
    ds_read_b64_tr_b16 v[106:107], v12 offset:40192
    v_mul_f32 v80, s20, v80
    v_fma_f32 v88, v88, s20, v77
    v_fma_f32 v84, -v76, v76, v84
    s_add_u32 s94, s94, 8192
    buffer_load_dwordx4 a[216:219], v2, s[44:47], s94 offen offset:0 sc1
    s_waitcnt lgkmcnt(4)
    v_mfma_f32_32x32x16_bf16 v[60:75], a[20:23], v[96:99], v[60:75]
    ds_read_b64_tr_b16 v[108:109], v12 offset:40960
    ds_read_b64_tr_b16 v[110:111], v12 offset:41216
    v_fma_f32 v88, -v80, v80, v88
    v_max_f32 v84, s22, v84
    v_max_f32 v88, s22, v88
    s_waitcnt lgkmcnt(4)
    v_mfma_f32_32x32x16_bf16 v[60:75], a[24:27], v[100:103], v[60:75]
    ds_read_b64_tr_b16 v[112:113], v12 offset:41984
    ds_read_b64_tr_b16 v[114:115], v12 offset:42240
    v_rsq_f32 v84, v84
    v_rsq_f32 v88, v88
    buffer_load_dwordx4 a[220:223], v2, s[44:47], s94 offen offset:1024 sc1
    s_waitcnt lgkmcnt(4)
    v_mfma_f32_32x32x16_bf16 v[60:75], a[28:31], v[104:107], v[60:75]
    ds_read_b64_tr_b16 v[92:93], v12 offset:43008
    ds_read_b64_tr_b16 v[94:95], v12 offset:43264
    v_and_b32 v78, 15, v1
    v_lshlrev_b32 v78, 3, v78
    v_add_u32 v78, 97024, v78
    s_waitcnt lgkmcnt(4)
    v_mfma_f32_32x32x16_bf16 v[60:75], a[32:35], v[108:111], v[60:75]
    ds_read_b64_tr_b16 v[96:97], v12 offset:44032
    ds_read_b64_tr_b16 v[98:99], v12 offset:44288
    v_mul_f32 v77, -v76, v84
    v_mul_f32 v76, s23, v84
    v_mul_f32 v81, -v80, v88
    s_add_u32 s94, s94, 8192
    buffer_load_dwordx4 a[248:251], v2, s[44:47], s94 offen offset:0 sc1
    s_waitcnt lgkmcnt(4)
    v_mfma_f32_32x32x16_bf16 v[60:75], a[36:39], v[112:115], v[60:75]
    ds_read_b64_tr_b16 v[100:101], v12 offset:45056
    ds_read_b64_tr_b16 v[102:103], v12 offset:45312
    v_mul_f32 v80, s23, v88
    s_mov_b64 exec, s[34:35]
    ds_write_b64 v78, v[76:77] offset:256
    ds_write_b64 v78, v[80:81] offset:384
    s_mov_b64 exec, -1
    s_waitcnt lgkmcnt(6)
    v_mfma_f32_32x32x16_bf16 v[60:75], a[40:43], v[92:95], v[60:75]
    ds_read_b64_tr_b16 v[104:105], v12 offset:46080
    ds_read_b64_tr_b16 v[106:107], v12 offset:46336
    v_fma_f32 v31, -v31, v119, -1.0
    v_fma_f32 v32, -v32, v120, -1.0
    v_fma_f32 v33, -v33, v121, -1.0
    buffer_load_dwordx4 a[252:255], v2, s[44:47], s94 offen offset:1024 sc1
    s_waitcnt lgkmcnt(6)
    v_mfma_f32_32x32x16_bf16 v[60:75], a[44:47], v[96:99], v[60:75]
    ds_read_b64_tr_b16 v[108:109], v12 offset:47104
    ds_read_b64_tr_b16 v[110:111], v12 offset:47360
    v_fma_f32 v34, -v34, v122, -1.0
    v_fma_f32 v35, -v35, v123, -1.0
    v_rcp_f32 v28, v28
    s_waitcnt lgkmcnt(6)
    v_mfma_f32_32x32x16_bf16 v[60:75], a[48:51], v[100:103], v[60:75]
    ds_read_b64_tr_b16 v[112:113], v12 offset:48128
    ds_read_b64_tr_b16 v[114:115], v12 offset:48384
    v_rcp_f32 v29, v29
    v_rcp_f32 v30, v30
    s_add_u32 s94, s94, 8192
    buffer_load_dwordx4 v[184:187], v2, s[44:47], s94 offen offset:0 sc1
    s_waitcnt lgkmcnt(4)
    v_mfma_f32_32x32x16_bf16 v[60:75], a[52:55], v[104:107], v[60:75]
    ds_read_b64_tr_b16 v[92:93], v12 offset:49152
    ds_read_b64_tr_b16 v[94:95], v12 offset:49408
    v_rcp_f32 v31, v31
    v_rcp_f32 v32, v32
    s_waitcnt lgkmcnt(4)
    v_mfma_f32_32x32x16_bf16 v[60:75], a[56:59], v[108:111], v[60:75]
    ds_read_b64_tr_b16 v[96:97], v12 offset:50176
    ds_read_b64_tr_b16 v[98:99], v12 offset:50432
    v_rcp_f32 v33, v33
    v_rcp_f32 v34, v34
    buffer_load_dwordx4 v[188:191], v2, s[44:47], s94 offen offset:1024 sc1
    s_waitcnt lgkmcnt(4)
    v_mfma_f32_32x32x16_bf16 v[60:75], a[60:63], v[112:115], v[60:75]
    ds_read_b64_tr_b16 v[100:101], v12 offset:51200
    ds_read_b64_tr_b16 v[102:103], v12 offset:51456
    v_rcp_f32 v35, v35
    v_fmac_f32 v124, v28, v124
    s_waitcnt lgkmcnt(4)
    v_mfma_f32_32x32x16_bf16 v[60:75], a[64:67], v[92:95], v[60:75]
    ds_read_b64_tr_b16 v[104:105], v12 offset:52224
    ds_read_b64_tr_b16 v[106:107], v12 offset:52480
    v_fmac_f32 v125, v29, v125
    v_fmac_f32 v126, v30, v126
    v_fmac_f32 v127, v31, v127
    s_add_u32 s94, s94, 8192
    buffer_load_dwordx4 v[216:219], v2, s[44:47], s94 offen offset:0 sc1
    s_waitcnt lgkmcnt(4)
    v_mfma_f32_32x32x16_bf16 v[60:75], a[68:71], v[96:99], v[60:75]
    ds_read_b64_tr_b16 v[108:109], v12 offset:53248
    ds_read_b64_tr_b16 v[110:111], v12 offset:53504
    v_fmac_f32 v128, v32, v128
    v_fmac_f32 v129, v33, v129
    v_fmac_f32 v130, v34, v130
    s_waitcnt lgkmcnt(4)
    v_mfma_f32_32x32x16_bf16 v[60:75], a[72:75], v[100:103], v[60:75]
    ds_read_b64_tr_b16 v[112:113], v12 offset:54272
    ds_read_b64_tr_b16 v[114:115], v12 offset:54528
    v_fmac_f32 v131, v35, v131
    v_max_u32 v125, s54, v125
    v_max_i32 v125, 0xa0000000, v125
    buffer_load_dwordx4 v[220:223], v2, s[44:47], s94 offen offset:1024 sc1
    s_waitcnt lgkmcnt(4)
    v_mfma_f32_32x32x16_bf16 v[60:75], a[76:79], v[104:107], v[60:75]
    ds_read_b64_tr_b16 v[92:93], v12 offset:55296
    ds_read_b64_tr_b16 v[94:95], v12 offset:55552
    v_cvt_pk_bf16_f32 v117, v126, v127
    v_cvt_pk_bf16_f32 v118, v128, v129
    v_cvt_pk_bf16_f32 v119, v130, v131
    s_waitcnt lgkmcnt(4)
    v_mfma_f32_32x32x16_bf16 v[60:75], a[80:83], v[108:111], v[60:75]
    ds_read_b64_tr_b16 v[96:97], v12 offset:56320
    ds_read_b64_tr_b16 v[98:99], v12 offset:56576
    v_cvt_pk_bf16_f32 v116, v124, v125
    s_add_u32 s66, s9, 0
    buffer_store_dwordx4 v[116:119], v2, s[44:47], s66 offen offset:0 sc1
    s_add_u32 s94, s94, 8192
    buffer_load_dwordx4 v[248:251], v2, s[44:47], s94 offen offset:0 sc1
    s_waitcnt lgkmcnt(4)
    v_mfma_f32_32x32x16_bf16 v[60:75], a[84:87], v[112:115], v[60:75]
    ds_read_b64_tr_b16 v[100:101], v12 offset:57344
    ds_read_b64_tr_b16 v[102:103], v12 offset:57600
    v_fmac_f32 v140, v132, v157
    v_fmac_f32 v141, v133, v157
    v_fmac_f32 v142, v134, v157
    s_waitcnt lgkmcnt(4)
    v_mfma_f32_32x32x16_bf16 v[60:75], a[88:91], v[92:95], v[60:75]
    ds_read_b64_tr_b16 v[104:105], v12 offset:58368
    ds_read_b64_tr_b16 v[106:107], v12 offset:58624
    v_fmac_f32 v143, v135, v157
    v_fmac_f32 v144, v136, v157
    v_fmac_f32 v145, v137, v157
    buffer_load_dwordx4 v[252:255], v2, s[44:47], s94 offen offset:1024 sc1
    s_waitcnt lgkmcnt(4)
    v_mfma_f32_32x32x16_bf16 v[60:75], a[92:95], v[96:99], v[60:75]
    ds_read_b64_tr_b16 v[108:109], v12 offset:59392
    ds_read_b64_tr_b16 v[110:111], v12 offset:59648
    v_fmac_f32 v146, v138, v157
    v_fmac_f32 v147, v139, v157
    v_fmac_f32 v140, v36, v156
    s_waitcnt lgkmcnt(4)
    v_mfma_f32_32x32x16_bf16 v[60:75], a[96:99], v[100:103], v[60:75]
    ds_read_b64_tr_b16 v[112:113], v12 offset:60416
    ds_read_b64_tr_b16 v[114:115], v12 offset:60672
    v_fmac_f32 v141, v37, v156
    v_fmac_f32 v142, v38, v156
    v_fmac_f32 v143, v39, v156
    s_waitcnt lgkmcnt(4)
    v_mfma_f32_32x32x16_bf16 v[60:75], a[100:103], v[104:107], v[60:75]
    ds_read_b64_tr_b16 v[92:93], v12 offset:61440
    ds_read_b64_tr_b16 v[94:95], v12 offset:61696
    v_fmac_f32 v144, v40, v156
    v_fmac_f32 v145, v41, v156
    v_fmac_f32 v146, v42, v156
    s_waitcnt lgkmcnt(4)
    v_mfma_f32_32x32x16_bf16 v[60:75], a[104:107], v[108:111], v[60:75]
    ds_read_b64_tr_b16 v[96:97], v12 offset:62464
    ds_read_b64_tr_b16 v[98:99], v12 offset:62720
    v_fmac_f32 v147, v43, v156
    v_exp_f32 v36, v140
    s_waitcnt lgkmcnt(4)
    v_mfma_f32_32x32x16_bf16 v[60:75], a[108:111], v[112:115], v[60:75]
    ds_read_b64_tr_b16 v[100:101], v12 offset:63488
    ds_read_b64_tr_b16 v[102:103], v12 offset:63744
    v_exp_f32 v37, v141
    v_exp_f32 v38, v142
    s_waitcnt lgkmcnt(4)
    v_mfma_f32_32x32x16_bf16 v[60:75], a[112:115], v[92:95], v[60:75]
    ds_read_b64_tr_b16 v[104:105], v12 offset:64512
    ds_read_b64_tr_b16 v[106:107], v12 offset:64768
    v_exp_f32 v39, v143
    v_exp_f32 v40, v144
    s_waitcnt lgkmcnt(4)
    v_mfma_f32_32x32x16_bf16 v[60:75], a[116:119], v[96:99], v[60:75]
    v_exp_f32 v41, v145
    v_exp_f32 v42, v146
    v_exp_f32 v43, v147
    s_waitcnt lgkmcnt(2)
    v_mfma_f32_32x32x16_bf16 v[60:75], a[120:123], v[100:103], v[60:75]
    v_fma_f32 v132, v36, 0.5, 1.0
    v_fma_f32 v133, v37, 0.5, 1.0
    v_fma_f32 v134, v38, 0.5, 1.0
    v_fma_f32 v135, v39, 0.5, 1.0
    v_fma_f32 v136, v40, 0.5, 1.0
    s_waitcnt lgkmcnt(0)
    v_mfma_f32_32x32x16_bf16 v[60:75], a[124:127], v[104:107], v[60:75]
    v_fma_f32 v137, v41, 0.5, 1.0
    v_fma_f32 v138, v42, 0.5, 1.0
    v_fma_f32 v139, v43, 0.5, 1.0
    v_fma_f32 v36, -v36, v132, -1.0
    v_fma_f32 v37, -v37, v133, -1.0
    s_add_u32 s69, s78, 0
    buffer_load_dwordx4 v[92:95], v2, s[44:47], s69 offen sc1
    v_fma_f32 v38, -v38, v134, -1.0
    v_fma_f32 v39, -v39, v135, -1.0
    v_fma_f32 v40, -v40, v136, -1.0
    v_fma_f32 v41, -v41, v137, -1.0
    v_fma_f32 v42, -v42, v138, -1.0
    v_fma_f32 v43, -v43, v139, -1.0
    s_add_u32 s69, s80, 0
    buffer_load_dwordx4 v[96:99], v2, s[44:47], s69 offen sc1
    v_rcp_f32 v36, v36
    v_rcp_f32 v37, v37
    v_rcp_f32 v38, v38
    v_rcp_f32 v39, v39
    v_rcp_f32 v40, v40
    v_rcp_f32 v41, v41
    v_rcp_f32 v42, v42
    s_add_u32 s69, s78, 4096
    buffer_load_dwordx4 v[100:103], v2, s[44:47], s69 offen sc1
    v_rcp_f32 v43, v43
    v_fmac_f32 v140, v36, v140
    v_fmac_f32 v141, v37, v141
    v_fmac_f32 v142, v38, v142
    v_fmac_f32 v143, v39, v143
    v_fmac_f32 v144, v40, v144
    v_fmac_f32 v145, v41, v145
    s_add_u32 s69, s80, 12288
    buffer_load_dwordx4 v[104:107], v2, s[44:47], s69 offen sc1
    v_fmac_f32 v146, v42, v146
    v_fmac_f32 v147, v43, v147
    v_max_u32 v141, s54, v141
    v_max_i32 v141, 0xa0000000, v141
    v_cvt_pk_bf16_f32 v133, v142, v143
    v_cvt_pk_bf16_f32 v134, v144, v145
    s_add_u32 s69, s78, 16384
    buffer_load_dwordx4 v[108:111], v2, s[44:47], s69 offen sc1
    v_cvt_pk_bf16_f32 v135, v146, v147
    v_cvt_pk_bf16_f32 v132, v140, v141
    s_add_u32 s66, s9, 0
    buffer_store_dwordx4 v[132:135], v2, s[44:47], s66 offen offset:1024 sc1
    v_perm_b32 v158, v154, v152, s18
    v_perm_b32 v159, v154, v152, s19
    v_perm_b32 v154, v155, v153, s18
    s_add_u32 s69, s80, 16384
    buffer_load_dwordx4 v[112:115], v2, s[44:47], s69 offen sc1
    v_perm_b32 v155, v155, v153, s19
    v_mov_b32 v152, v158
    v_mov_b32 v153, v159
    v_permlane16_swap_b32 v154, v155
    s_nop 0
    v_permlane16_swap_b32 v152, v153
    s_nop 1
    v_permlane32_swap_b32 v152, v154
    v_permlane32_swap_b32 v153, v155
    s_barrier
    s_add_u32 s69, s79, 0
    buffer_load_dwordx4 v[28:31], v2, s[44:47], s69 offen sc1
    ds_read_b64 v[158:159], v15 offset:256
    ds_read_b128 v[116:119], v14 offset:0
    ds_read_b128 v[120:123], v14 offset:32
    ds_read_b128 v[124:127], v14 offset:896
    ds_read_b128 v[128:131], v14 offset:928
    ds_read_b128 v[132:135], v14 offset:64
    ds_read_b128 v[136:139], v14 offset:96
    ds_read_b128 v[140:143], v14 offset:960
    ds_read_b128 v[144:147], v14 offset:992
    s_waitcnt lgkmcnt(4)
    v_pk_fma_f32 v[124:125], v[116:117], v[158:159], v[124:125] op_sel:[0,1,0] op_sel_hi:[1,1,1]
    v_pk_fma_f32 v[126:127], v[118:119], v[158:159], v[126:127] op_sel:[0,1,0] op_sel_hi:[1,1,1]
    s_add_u32 s69, s81, 0
    buffer_load_dwordx4 v[32:35], v2, s[44:47], s69 offen sc1
    v_pk_fma_f32 v[128:129], v[120:121], v[158:159], v[128:129] op_sel:[0,1,0] op_sel_hi:[1,1,1]
    v_pk_fma_f32 v[130:131], v[122:123], v[158:159], v[130:131] op_sel:[0,1,0] op_sel_hi:[1,1,1]
    v_pk_fma_f32 v[124:125], v[60:61], v[158:159], v[124:125] op_sel:[0,0,0] op_sel_hi:[1,0,1]
    v_pk_fma_f32 v[126:127], v[62:63], v[158:159], v[126:127] op_sel:[0,0,0] op_sel_hi:[1,0,1]
    v_pk_fma_f32 v[128:129], v[64:65], v[158:159], v[128:129] op_sel:[0,0,0] op_sel_hi:[1,0,1]
    v_pk_fma_f32 v[130:131], v[66:67], v[158:159], v[130:131] op_sel:[0,0,0] op_sel_hi:[1,0,1]
    v_exp_f32 v60, v124
    v_exp_f32 v61, v125
    v_exp_f32 v62, v126
    v_exp_f32 v63, v127
    v_exp_f32 v64, v128
    v_exp_f32 v65, v129
    s_add_u32 s69, s79, 4096
    buffer_load_dwordx4 v[36:39], v2, s[44:47], s69 offen sc1
    v_exp_f32 v66, v130
    v_exp_f32 v67, v131
    v_pk_fma_f32 v[116:117], v[60:61], 0.5, 1.0 op_sel_hi:[1,0,0]
    v_pk_fma_f32 v[118:119], v[62:63], 0.5, 1.0 op_sel_hi:[1,0,0]
    v_pk_fma_f32 v[120:121], v[64:65], 0.5, 1.0 op_sel_hi:[1,0,0]
    v_pk_fma_f32 v[122:123], v[66:67], 0.5, 1.0 op_sel_hi:[1,0,0]
    v_pk_fma_f32 v[60:61], v[60:61], v[116:117], 1.0 op_sel_hi:[1,1,0]
    v_pk_fma_f32 v[62:63], v[62:63], v[118:119], 1.0 op_sel_hi:[1,1,0]
    v_pk_fma_f32 v[64:65], v[64:65], v[120:121], 1.0 op_sel_hi:[1,1,0]
    v_pk_fma_f32 v[66:67], v[66:67], v[122:123], 1.0 op_sel_hi:[1,1,0]
    v_rcp_f32 v60, v60
    v_rcp_f32 v61, v61
    v_rcp_f32 v62, v62
    s_add_u32 s69, s81, 12288
    buffer_load_dwordx4 v[40:43], v2, s[44:47], s69 offen sc1
    v_rcp_f32 v63, v63
    v_rcp_f32 v64, v64
    v_rcp_f32 v65, v65
    v_rcp_f32 v66, v66
    v_rcp_f32 v67, v67
    v_pk_fma_f32 v[124:125], v[60:61], v[124:125], v[124:125] neg_lo:[1,0,0] neg_hi:[1,0,0]
    v_pk_fma_f32 v[126:127], v[62:63], v[126:127], v[126:127] neg_lo:[1,0,0] neg_hi:[1,0,0]
    v_pk_fma_f32 v[128:129], v[64:65], v[128:129], v[128:129] neg_lo:[1,0,0] neg_hi:[1,0,0]
    v_pk_fma_f32 v[130:131], v[66:67], v[130:131], v[130:131] neg_lo:[1,0,0] neg_hi:[1,0,0]
    v_max_u32 v125, s54, v125
    v_max_i32 v125, 0xa0000000, v125
    s_add_u32 s69, s79, 16384
    buffer_load_dwordx4 v[44:47], v2, s[44:47], s69 offen sc1
    v_cvt_pk_bf16_f32 v117, v126, v127
    v_cvt_pk_bf16_f32 v118, v128, v129
    v_cvt_pk_bf16_f32 v119, v130, v131
    v_cvt_pk_bf16_f32 v116, v124, v125
    s_add_u32 s66, s9, 3670016
    buffer_store_dwordx4 v[116:119], v2, s[44:47], s66 offen offset:0 sc1
    s_waitcnt lgkmcnt(0)
    v_pk_fma_f32 v[140:141], v[132:133], v[158:159], v[140:141] op_sel:[0,1,0] op_sel_hi:[1,1,1]
    v_pk_fma_f32 v[142:143], v[134:135], v[158:159], v[142:143] op_sel:[0,1,0] op_sel_hi:[1,1,1]
    v_pk_fma_f32 v[144:145], v[136:137], v[158:159], v[144:145] op_sel:[0,1,0] op_sel_hi:[1,1,1]
    v_pk_fma_f32 v[146:147], v[138:139], v[158:159], v[146:147] op_sel:[0,1,0] op_sel_hi:[1,1,1]
    v_pk_fma_f32 v[140:141], v[68:69], v[158:159], v[140:141] op_sel:[0,0,0] op_sel_hi:[1,0,1]
    v_pk_fma_f32 v[142:143], v[70:71], v[158:159], v[142:143] op_sel:[0,0,0] op_sel_hi:[1,0,1]
    s_add_u32 s69, s81, 16384
    buffer_load_dwordx4 v[48:51], v2, s[44:47], s69 offen sc1
    v_pk_fma_f32 v[144:145], v[72:73], v[158:159], v[144:145] op_sel:[0,0,0] op_sel_hi:[1,0,1]
    v_pk_fma_f32 v[146:147], v[74:75], v[158:159], v[146:147] op_sel:[0,0,0] op_sel_hi:[1,0,1]
    v_exp_f32 v68, v140
    v_exp_f32 v69, v141
    v_exp_f32 v70, v142
    v_exp_f32 v71, v143
    v_exp_f32 v72, v144
    v_exp_f32 v73, v145
    v_exp_f32 v74, v146
    v_exp_f32 v75, v147
    v_pk_fma_f32 v[132:133], v[68:69], 0.5, 1.0 op_sel_hi:[1,0,0]
    v_pk_fma_f32 v[134:135], v[70:71], 0.5, 1.0 op_sel_hi:[1,0,0]
    v_pk_fma_f32 v[136:137], v[72:73], 0.5, 1.0 op_sel_hi:[1,0,0]
    s_add_u32 s69, s80, 4096
    buffer_load_dwordx4 v[52:55], v2, s[44:47], s69 offen sc1
    v_pk_fma_f32 v[138:139], v[74:75], 0.5, 1.0 op_sel_hi:[1,0,0]
    v_pk_fma_f32 v[68:69], v[68:69], v[132:133], 1.0 op_sel_hi:[1,1,0]
    v_pk_fma_f32 v[70:71], v[70:71], v[134:135], 1.0 op_sel_hi:[1,1,0]
    v_pk_fma_f32 v[72:73], v[72:73], v[136:137], 1.0 op_sel_hi:[1,1,0]
    v_pk_fma_f32 v[74:75], v[74:75], v[138:139], 1.0 op_sel_hi:[1,1,0]
    v_rcp_f32 v68, v68
    v_rcp_f32 v69, v69
    v_rcp_f32 v70, v70
    v_rcp_f32 v71, v71
    v_rcp_f32 v72, v72
    v_rcp_f32 v73, v73
    v_rcp_f32 v74, v74
    s_add_u32 s69, s78, 8192
    buffer_load_dwordx4 v[56:59], v2, s[44:47], s69 offen sc1
    v_rcp_f32 v75, v75
    v_pk_fma_f32 v[140:141], v[68:69], v[140:141], v[140:141] neg_lo:[1,0,0] neg_hi:[1,0,0]
    v_pk_fma_f32 v[142:143], v[70:71], v[142:143], v[142:143] neg_lo:[1,0,0] neg_hi:[1,0,0]
    v_pk_fma_f32 v[144:145], v[72:73], v[144:145], v[144:145] neg_lo:[1,0,0] neg_hi:[1,0,0]
    v_pk_fma_f32 v[146:147], v[74:75], v[146:147], v[146:147] neg_lo:[1,0,0] neg_hi:[1,0,0]
    v_max_u32 v141, s54, v141
    v_max_i32 v141, 0xa0000000, v141
    v_cvt_pk_bf16_f32 v133, v142, v143
    v_cvt_pk_bf16_f32 v134, v144, v145
    v_cvt_pk_bf16_f32 v135, v146, v147
    v_cvt_pk_bf16_f32 v132, v140, v141
    s_add_u32 s66, s9, 3670016
    buffer_store_dwordx4 v[132:135], v2, s[44:47], s66 offen offset:1024 sc1
L_m_j28:
L_m_g20:
    s_waitcnt vmcnt(13)
    v_min3_f32 v156, |v92|, |v96|, |v100|
    v_min_f32 v156, v156, |v104|
    v_cmp_gt_f32 s[60:61], s54, v156
    s_nop 0
    s_cmp_lg_u64 s[60:61], 0
    s_cbranch_scc1 L_m_s33
L_m_r34:
    v_mfma_f32_32x32x16_bf16 v[116:131], a[128:131], v[92:95], 0
    v_mfma_f32_32x32x16_bf16 v[132:147], a[132:135], v[92:95], 0
    s_add_u32 s69, s80, 8192
    buffer_load_dwordx4 v[92:95], v2, s[44:47], s69 offen sc1
    v_mfma_f32_32x32x16_bf16 v[116:131], a[144:147], v[96:99], v[116:131]
    v_mfma_f32_32x32x16_bf16 v[132:147], a[148:151], v[96:99], v[132:147]
    s_add_u32 s69, s78, 12288
    buffer_load_dwordx4 v[96:99], v2, s[44:47], s69 offen sc1
    s_waitcnt vmcnt(10)
    v_min3_f32 v156, |v108|, |v112|, |v28|
    v_mfma_f32_32x32x16_bf16 v[116:131], a[160:163], v[100:103], v[116:131]
    v_min_f32 v156, v156, |v32|
    v_cmp_gt_f32 s[60:61], s54, v156
    s_nop 0
    s_cmp_lg_u64 s[60:61], 0
    s_cbranch_scc1 L_m_s35
L_m_r36:
    v_mfma_f32_32x32x16_bf16 v[132:147], a[164:167], v[100:103], v[132:147]
    s_add_u32 s69, s78, 20480
    buffer_load_dwordx4 v[100:103], v2, s[44:47], s69 offen sc1
    v_mfma_f32_32x32x16_bf16 v[116:131], a[240:243], v[104:107], v[116:131]
    v_mfma_f32_32x32x16_bf16 v[132:147], a[244:247], v[104:107], v[132:147]
    s_add_u32 s69, s80, 20480
    buffer_load_dwordx4 v[104:107], v2, s[44:47], s69 offen sc1
    v_mfma_f32_32x32x16_bf16 v[116:131], v[160:163], v[108:111], v[116:131]
    v_mfma_f32_32x32x16_bf16 v[132:147], v[164:167], v[108:111], v[132:147]
    s_add_u32 s69, s78, 24576
    buffer_load_dwordx4 v[108:111], v2, s[44:47], s69 offen sc1
    v_mfma_f32_32x32x16_bf16 v[116:131], v[176:179], v[112:115], v[116:131]
    v_mfma_f32_32x32x16_bf16 v[132:147], v[180:183], v[112:115], v[132:147]
    s_add_u32 s69, s80, 24576
    buffer_load_dwordx4 v[112:115], v2, s[44:47], s69 offen sc1
    s_waitcnt vmcnt(9)
    v_min3_f32 v156, |v36|, |v40|, |v44|
    v_mfma_f32_32x32x16_bf16 v[116:131], a[136:139], v[28:31], v[116:131]
    v_min_f32 v156, v156, |v48|
    v_cmp_gt_f32 s[60:61], s54, v156
    s_nop 0
    s_cmp_lg_u64 s[60:61], 0
    s_cbranch_scc1 L_m_s37
L_m_r38:
    v_mfma_f32_32x32x16_bf16 v[132:147], a[140:143], v[28:31], v[132:147]
    s_add_u32 s69, s81, 4096
    buffer_load_dwordx4 v[28:31], v2, s[44:47], s69 offen sc1
    v_mfma_f32_32x32x16_bf16 v[116:131], a[152:155], v[32:35], v[116:131]
    v_mfma_f32_32x32x16_bf16 v[132:147], a[156:159], v[32:35], v[132:147]
    s_add_u32 s69, s79, 8192
    buffer_load_dwordx4 v[32:35], v2, s[44:47], s69 offen sc1
    v_mfma_f32_32x32x16_bf16 v[116:131], a[168:171], v[36:39], v[116:131]
    v_mfma_f32_32x32x16_bf16 v[132:147], a[172:175], v[36:39], v[132:147]
    s_add_u32 s69, s81, 8192
    buffer_load_dwordx4 v[36:39], v2, s[44:47], s69 offen sc1
    v_mfma_f32_32x32x16_bf16 v[116:131], a[248:251], v[40:43], v[116:131]
    v_mfma_f32_32x32x16_bf16 v[132:147], a[252:255], v[40:43], v[132:147]
    s_add_u32 s69, s79, 12288
    buffer_load_dwordx4 v[40:43], v2, s[44:47], s69 offen sc1
    s_waitcnt vmcnt(8)
    v_min3_f32 v156, |v52|, |v56|, |v92|
    v_mfma_f32_32x32x16_bf16 v[116:131], v[168:171], v[44:47], v[116:131]
    v_min_f32 v156, v156, |v96|
    v_cmp_gt_f32 s[60:61], s54, v156
    s_nop 0
    s_cmp_lg_u64 s[60:61], 0
    s_cbranch_scc1 L_m_s39
L_m_r40:
    v_mfma_f32_32x32x16_bf16 v[132:147], v[172:175], v[44:47], v[132:147]
    s_add_u32 s69, s79, 20480
    buffer_load_dwordx4 v[44:47], v2, s[44:47], s69 offen sc1
    v_mfma_f32_32x32x16_bf16 v[116:131], v[184:187], v[48:51], v[116:131]
    v_mfma_f32_32x32x16_bf16 v[132:147], v[188:191], v[48:51], v[132:147]
    s_add_u32 s69, s81, 20480
    buffer_load_dwordx4 v[48:51], v2, s[44:47], s69 offen sc1
    v_mfma_f32_32x32x16_bf16 v[116:131], a[176:179], v[52:55], v[116:131]
    v_mfma_f32_32x32x16_bf16 v[132:147], a[180:183], v[52:55], v[132:147]
    s_add_u32 s69, s79, 24576
    buffer_load_dwordx4 v[52:55], v2, s[44:47], s69 offen sc1
    v_mfma_f32_32x32x16_bf16 v[116:131], a[192:195], v[56:59], v[116:131]
    v_mfma_f32_32x32x16_bf16 v[132:147], a[196:199], v[56:59], v[132:147]
    s_add_u32 s69, s81, 24576
    buffer_load_dwordx4 v[56:59], v2, s[44:47], s69 offen sc1
    s_waitcnt vmcnt(8)
    v_min3_f32 v156, |v100|, |v104|, |v108|
    v_mfma_f32_32x32x16_bf16 v[116:131], a[208:211], v[92:95], v[116:131]
    v_min_f32 v156, v156, |v112|
    v_cmp_gt_f32 s[60:61], s54, v156
    s_nop 0
    s_cmp_lg_u64 s[60:61], 0
    s_cbranch_scc1 L_m_s41
L_m_r42:
    v_mfma_f32_32x32x16_bf16 v[132:147], a[212:215], v[92:95], v[132:147]
    s_add_u32 s69, s78, 3670016
    buffer_load_dwordx4 v[92:95], v2, s[44:47], s69 offen sc1
    v_mfma_f32_32x32x16_bf16 v[116:131], a[224:227], v[96:99], v[116:131]
    v_mfma_f32_32x32x16_bf16 v[132:147], a[228:231], v[96:99], v[132:147]
    s_add_u32 s69, s80, 3670016
    buffer_load_dwordx4 v[96:99], v2, s[44:47], s69 offen sc1
    v_mfma_f32_32x32x16_bf16 v[116:131], v[192:195], v[100:103], v[116:131]
    v_mfma_f32_32x32x16_bf16 v[132:147], v[196:199], v[100:103], v[132:147]
    s_add_u32 s69, s78, 3674112
    buffer_load_dwordx4 v[100:103], v2, s[44:47], s69 offen sc1
    v_mfma_f32_32x32x16_bf16 v[116:131], v[208:211], v[104:107], v[116:131]
    v_mfma_f32_32x32x16_bf16 v[132:147], v[212:215], v[104:107], v[132:147]
    s_add_u32 s69, s80, 3682304
    buffer_load_dwordx4 v[104:107], v2, s[44:47], s69 offen sc1
    s_waitcnt vmcnt(8)
    v_min3_f32 v156, |v28|, |v32|, |v36|
    v_mfma_f32_32x32x16_bf16 v[116:131], v[224:227], v[108:111], v[116:131]
    v_min_f32 v156, v156, |v40|
    v_cmp_gt_f32 s[60:61], s54, v156
    s_nop 0
    s_cmp_lg_u64 s[60:61], 0
    s_cbranch_scc1 L_m_s43
L_m_r44:
    v_mfma_f32_32x32x16_bf16 v[132:147], v[228:231], v[108:111], v[132:147]
    s_add_u32 s69, s78, 3686400
    buffer_load_dwordx4 v[108:111], v2, s[44:47], s69 offen sc1
    v_mfma_f32_32x32x16_bf16 v[116:131], v[240:243], v[112:115], v[116:131]
    v_mfma_f32_32x32x16_bf16 v[132:147], v[244:247], v[112:115], v[132:147]
    s_add_u32 s69, s80, 3686400
    buffer_load_dwordx4 v[112:115], v2, s[44:47], s69 offen sc1
    v_mfma_f32_32x32x16_bf16 v[116:131], a[184:187], v[28:31], v[116:131]
    v_mfma_f32_32x32x16_bf16 v[132:147], a[188:191], v[28:31], v[132:147]
    s_add_u32 s69, s79, 3670016
    buffer_load_dwordx4 v[28:31], v2, s[44:47], s69 offen sc1
    v_mfma_f32_32x32x16_bf16 v[116:131], a[200:203], v[32:35], v[116:131]
    v_mfma_f32_32x32x16_bf16 v[132:147], a[204:207], v[32:35], v[132:147]
    s_add_u32 s69, s81, 3670016
    buffer_load_dwordx4 v[32:35], v2, s[44:47], s69 offen sc1
    s_waitcnt vmcnt(8)
    v_min3_f32 v156, |v44|, |v48|, |v52|
    v_mfma_f32_32x32x16_bf16 v[116:131], a[216:219], v[36:39], v[116:131]
    v_min_f32 v156, v156, |v56|
    v_cmp_gt_f32 s[60:61], s54, v156
    s_nop 0
    s_cmp_lg_u64 s[60:61], 0
    s_cbranch_scc1 L_m_s45
L_m_r46:
    v_mfma_f32_32x32x16_bf16 v[132:147], a[220:223], v[36:39], v[132:147]
    s_add_u32 s69, s79, 3674112
    buffer_load_dwordx4 v[36:39], v2, s[44:47], s69 offen sc1
    v_mfma_f32_32x32x16_bf16 v[116:131], a[232:235], v[40:43], v[116:131]
    v_mfma_f32_32x32x16_bf16 v[132:147], a[236:239], v[40:43], v[132:147]
    s_add_u32 s69, s81, 3682304
    buffer_load_dwordx4 v[40:43], v2, s[44:47], s69 offen sc1
    v_mfma_f32_32x32x16_bf16 v[116:131], v[200:203], v[44:47], v[116:131]
    v_mfma_f32_32x32x16_bf16 v[132:147], v[204:207], v[44:47], v[132:147]
    s_add_u32 s69, s79, 3686400
    buffer_load_dwordx4 v[44:47], v2, s[44:47], s69 offen sc1
    v_mfma_f32_32x32x16_bf16 v[116:131], v[216:219], v[48:51], v[116:131]
    v_mfma_f32_32x32x16_bf16 v[132:147], v[220:223], v[48:51], v[132:147]
    s_add_u32 s69, s81, 3686400
    buffer_load_dwordx4 v[48:51], v2, s[44:47], s69 offen sc1
    s_waitcnt vmcnt(8)
    v_min3_f32 v156, |v92|, |v96|, |v100|
    v_mfma_f32_32x32x16_bf16 v[116:131], v[232:235], v[52:55], v[116:131]
    v_min_f32 v156, v156, |v104|
    v_cmp_gt_f32 s[60:61], s54, v156
    s_nop 0
    s_cmp_lg_u64 s[60:61], 0
    s_cbranch_scc1 L_m_s47
L_m_r48:
    v_mfma_f32_32x32x16_bf16 v[132:147], v[236:239], v[52:55], v[132:147]
    s_add_u32 s69, s80, 3674112
    buffer_load_dwordx4 v[52:55], v2, s[44:47], s69 offen sc1
    v_mfma_f32_32x32x16_bf16 v[116:131], v[248:251], v[56:59], v[116:131]
    v_mfma_f32_32x32x16_bf16 v[132:147], v[252:255], v[56:59], v[132:147]
    s_add_u32 s69, s78, 3678208
    buffer_load_dwordx4 v[56:59], v2, s[44:47], s69 offen sc1
    s_add_u32 s69, s80, 3678208
    buffer_load_dwordx4 v[60:63], v2, s[44:47], s69 offen sc1
    s_nop 6
    ds_write_b128 v16, v[116:119] offset:0
    s_add_u32 s69, s78, 3682304
    buffer_load_dwordx4 v[64:67], v2, s[44:47], s69 offen sc1
    ds_write_b128 v16, v[120:123] offset:1024
    s_add_u32 s69, s78, 3690496
    buffer_load_dwordx4 v[68:71], v2, s[44:47], s69 offen sc1
    ds_write_b128 v17, v[124:127] offset:2048
    s_add_u32 s69, s80, 3690496
    buffer_load_dwordx4 v[72:75], v2, s[44:47], s69 offen sc1
    ds_write_b128 v17, v[128:131] offset:3072
    s_add_u32 s69, s78, 3694592
    buffer_load_dwordx4 v[76:79], v2, s[44:47], s69 offen sc1
    ds_write_b128 v16, v[132:135] offset:4096
    s_add_u32 s69, s80, 3694592
    buffer_load_dwordx4 v[80:83], v2, s[44:47], s69 offen sc1
    ds_write_b128 v16, v[136:139] offset:5120
    s_add_u32 s69, s81, 3674112
    buffer_load_dwordx4 v[84:87], v2, s[44:47], s69 offen sc1
    ds_write_b128 v17, v[140:143] offset:6144
    s_add_u32 s69, s79, 3678208
    buffer_load_dwordx4 v[88:91], v2, s[44:47], s69 offen sc1
    ds_write_b128 v17, v[144:147] offset:7168
    s_waitcnt lgkmcnt(0)
    s_barrier
    ds_read_b128 v[116:119], v18 offset:0
    ds_read_b128 v[120:123], v18 offset:1024
    ds_read_b128 v[124:127], v18 offset:8192
    ds_read_b128 v[128:131], v18 offset:9216
    ds_read_b128 v[132:135], v18 offset:16384
    ds_read_b128 v[136:139], v18 offset:17408
    ds_read_b128 v[140:143], v18 offset:24576
    ds_read_b128 v[144:147], v18 offset:25600
    s_waitcnt lgkmcnt(4)
    v_pk_add_f32 v[116:117], v[116:117], v[124:125]
    v_pk_add_f32 v[118:119], v[118:119], v[126:127]
    v_pk_add_f32 v[120:121], v[120:121], v[128:129]
    v_pk_add_f32 v[122:123], v[122:123], v[130:131]
    v_lshlrev_b32 v124, 16, v148
    v_and_b32 v125, 0xffff0000, v148
    v_lshlrev_b32 v126, 16, v149
    v_and_b32 v127, 0xffff0000, v149
    v_lshlrev_b32 v128, 16, v150
    v_and_b32 v129, 0xffff0000, v150
    v_lshlrev_b32 v130, 16, v151
    v_and_b32 v131, 0xffff0000, v151
    s_waitcnt lgkmcnt(0)
    v_pk_add_f32 v[132:133], v[132:133], v[140:141]
    v_pk_add_f32 v[134:135], v[134:135], v[142:143]
    v_pk_add_f32 v[136:137], v[136:137], v[144:145]
    v_pk_add_f32 v[138:139], v[138:139], v[146:147]
    v_pk_add_f32 v[116:117], v[116:117], v[132:133]
    v_pk_add_f32 v[118:119], v[118:119], v[134:135]
    v_pk_add_f32 v[120:121], v[120:121], v[136:137]
    v_pk_add_f32 v[122:123], v[122:123], v[138:139]
    v_fma_f32 v124, v116, s29, v124
    v_fma_f32 v125, v117, s29, v125
    v_fma_f32 v126, v118, s29, v126
    v_fma_f32 v127, v119, s29, v127
    v_fma_f32 v128, v120, s29, v128
    v_fma_f32 v129, v121, s29, v129
    v_fma_f32 v130, v122, s29, v130
    v_fma_f32 v131, v123, s29, v131
    v_cvt_pk_bf16_f32 v132, v124, v125
    v_cvt_pk_bf16_f32 v133, v126, v127
    v_cvt_pk_bf16_f32 v134, v128, v129
    v_cvt_pk_bf16_f32 v135, v130, v131
    v_dot2_f32_bf16 v136, v132, s38, 0
    v_dot2_f32_bf16 v137, v132, v132, 0
    v_dot2_f32_bf16 v136, v133, s38, v136
    v_dot2_f32_bf16 v137, v133, v133, v137
    v_dot2_f32_bf16 v136, v134, s38, v136
    v_dot2_f32_bf16 v137, v134, v134, v137
    v_dot2_f32_bf16 v136, v135, s38, v136
    v_dot2_f32_bf16 v137, v135, v135, v137
    v_permlane16_swap_b32 v132, v133
    v_permlane16_swap_b32 v134, v135
    v_add_f32_dpp v136, v136, v136 quad_perm:[1,0,3,2] row_mask:0xf bank_mask:0xf
    v_add_f32_dpp v137, v137, v137 quad_perm:[1,0,3,2] row_mask:0xf bank_mask:0xf
    v_permlane32_swap_b32 v132, v134
    v_permlane32_swap_b32 v133, v135
    v_add_f32_dpp v136, v136, v136 quad_perm:[2,3,0,1] row_mask:0xf bank_mask:0xf
    v_add_f32_dpp v137, v137, v137 quad_perm:[2,3,0,1] row_mask:0xf bank_mask:0xf
    s_nop 0
    v_add_f32_dpp v136, v136, v136 row_half_mirror row_mask:0xf bank_mask:0xf
    v_add_f32_dpp v137, v137, v137 row_half_mirror row_mask:0xf bank_mask:0xf
    v_cndmask_b32 v137, 1.0, v137, s[52:53]
    v_cmp_gt_f32 vcc, s54, |v132|
    v_and_b32 v138, 0xffff, v132
    v_or_b32 v138, s54, v138
    v_cndmask_b32 v132, v132, v138, vcc
    v_xor_b32 v132, s54, v132
    v_cndmask_b32 v137, v137, v136, s[40:41]
    s_add_u32 s66, s13, 8683520
    s_add_u32 s67, s12, 0
    s_mov_b64 exec, s[36:37]
    buffer_atomic_add_f32 v137, v21, s[44:47], s66 offen sc1
    s_mov_b64 exec, -1
    buffer_store_dwordx4 v[132:135], v20, s[44:47], s67 offen sc1
    v_mfma_f32_32x32x16_bf16 v[116:131], a[128:131], v[92:95], 0
    v_mfma_f32_32x32x16_bf16 v[132:147], a[132:135], v[92:95], 0
    s_add_u32 s69, s81, 3678208
    buffer_load_dwordx4 v[92:95], v2, s[44:47], s69 offen sc1
    v_mfma_f32_32x32x16_bf16 v[116:131], a[144:147], v[96:99], v[116:131]
    v_mfma_f32_32x32x16_bf16 v[132:147], a[148:151], v[96:99], v[132:147]
    s_add_u32 s69, s79, 3682304
    buffer_load_dwordx4 v[96:99], v2, s[44:47], s69 offen sc1
    s_waitcnt vmcnt(18)
    v_min3_f32 v156, |v108|, |v112|, |v28|
    v_mfma_f32_32x32x16_bf16 v[116:131], a[160:163], v[100:103], v[116:131]
    v_min_f32 v156, v156, |v32|
    v_cmp_gt_f32 s[60:61], s54, v156
    s_nop 0
    s_cmp_lg_u64 s[60:61], 0
    s_cbranch_scc1 L_m_s49
L_m_r50:
    v_mfma_f32_32x32x16_bf16 v[132:147], a[164:167], v[100:103], v[132:147]
    s_add_u32 s69, s79, 3690496
    buffer_load_dwordx4 v[100:103], v2, s[44:47], s69 offen sc1
    v_mfma_f32_32x32x16_bf16 v[116:131], a[240:243], v[104:107], v[116:131]
    v_mfma_f32_32x32x16_bf16 v[132:147], a[244:247], v[104:107], v[132:147]
    s_add_u32 s69, s81, 3690496
    buffer_load_dwordx4 v[104:107], v2, s[44:47], s69 offen sc1
    v_mfma_f32_32x32x16_bf16 v[116:131], v[160:163], v[108:111], v[116:131]
    v_mfma_f32_32x32x16_bf16 v[132:147], v[164:167], v[108:111], v[132:147]
    s_add_u32 s69, s79, 3694592
    buffer_load_dwordx4 v[108:111], v2, s[44:47], s69 offen sc1
    v_mfma_f32_32x32x16_bf16 v[116:131], v[176:179], v[112:115], v[116:131]
    s_getpc_b64 s[56:57]
L_m_pc51:
    s_add_u32 s56, s56, L_m_conv1-L_m_pc51
    s_addc_u32 s57, s57, 0
    s_bfe_u32 s58, s2, 0x50003
    s_mul_i32 s58, s58, 1024
    s_sub_u32 s58, s58, 65792
    v_lshrrev_b32 v158, 1, v7
    v_add_u32 v158, s58, v158
    v_min_u32 v158, L_code_end-L_m_conv1-16, v158
    global_load_dword v159, v158, s[56:57]
    v_mfma_f32_32x32x16_bf16 v[132:147], v[180:183], v[112:115], v[132:147]
    s_add_u32 s69, s81, 3694592
    buffer_load_dwordx4 v[112:115], v2, s[44:47], s69 offen sc1
    s_waitcnt vmcnt(19)
    v_min3_f32 v156, |v36|, |v40|, |v44|
    v_mfma_f32_32x32x16_bf16 v[116:131], a[136:139], v[28:31], v[116:131]
    v_min_f32 v156, v156, |v48|
    v_cmp_gt_f32 s[60:61], s54, v156
    s_nop 0
    s_cmp_lg_u64 s[60:61], 0
    s_cbranch_scc1 L_m_s52
L_m_r53:
    v_mfma_f32_32x32x16_bf16 v[132:147], a[140:143], v[28:31], v[132:147]
    v_mfma_f32_32x32x16_bf16 v[116:131], a[152:155], v[32:35], v[116:131]
    v_mfma_f32_32x32x16_bf16 v[132:147], a[156:159], v[32:35], v[132:147]
    buffer_load_dwordx4 v[28:31], v2, s[44:47], s15 offen
    buffer_load_dwordx4 v[32:35], v2, s[44:47], s16 offen
    v_mfma_f32_32x32x16_bf16 v[116:131], a[168:171], v[36:39], v[116:131]
    v_mfma_f32_32x32x16_bf16 v[132:147], a[172:175], v[36:39], v[132:147]
    v_mfma_f32_32x32x16_bf16 v[116:131], a[248:251], v[40:43], v[116:131]
    v_mfma_f32_32x32x16_bf16 v[132:147], a[252:255], v[40:43], v[132:147]
    s_waitcnt vmcnt(17)
    v_min3_f32 v156, |v52|, |v56|, |v60|
    v_min_f32 v156, v156, |v64|
    v_cmp_gt_f32 s[60:61], s54, v156
    s_nop 0
    s_cmp_lg_u64 s[60:61], 0
    s_cbranch_scc1 L_m_s54
L_m_r55:
    v_mfma_f32_32x32x16_bf16 v[116:131], v[168:171], v[44:47], v[116:131]
    v_mfma_f32_32x32x16_bf16 v[132:147], v[172:175], v[44:47], v[132:147]
    v_mfma_f32_32x32x16_bf16 v[116:131], v[184:187], v[48:51], v[116:131]
    v_mfma_f32_32x32x16_bf16 v[132:147], v[188:191], v[48:51], v[132:147]
    v_mfma_f32_32x32x16_bf16 v[116:131], a[176:179], v[52:55], v[116:131]
    v_mfma_f32_32x32x16_bf16 v[132:147], a[180:183], v[52:55], v[132:147]
    v_mfma_f32_32x32x16_bf16 v[116:131], a[192:195], v[56:59], v[116:131]
    v_mfma_f32_32x32x16_bf16 v[132:147], a[196:199], v[56:59], v[132:147]
    s_waitcnt vmcnt(13)
    v_min3_f32 v156, |v68|, |v72|, |v76|
    v_min_f32 v156, v156, |v80|
    v_cmp_gt_f32 s[60:61], s54, v156
    s_nop 0
    s_cmp_lg_u64 s[60:61], 0
    s_cbranch_scc1 L_m_s56
L_m_r57:
    v_mfma_f32_32x32x16_bf16 v[116:131], a[208:211], v[60:63], v[116:131]
    v_mfma_f32_32x32x16_bf16 v[132:147], a[212:215], v[60:63], v[132:147]
    v_mfma_f32_32x32x16_bf16 v[116:131], a[224:227], v[64:67], v[116:131]
    v_mfma_f32_32x32x16_bf16 v[132:147], a[228:231], v[64:67], v[132:147]
    v_mfma_f32_32x32x16_bf16 v[116:131], v[192:195], v[68:71], v[116:131]
    v_mfma_f32_32x32x16_bf16 v[132:147], v[196:199], v[68:71], v[132:147]
    v_mfma_f32_32x32x16_bf16 v[116:131], v[208:211], v[72:75], v[116:131]
    v_lshlrev_b32 v44, 1, v7
    v_subrev_u32 v44, 165344, v44
    v_mfma_f32_32x32x16_bf16 v[132:147], v[212:215], v[72:75], v[132:147]
    s_waitcnt vmcnt(7)
    v_min3_f32 v156, |v84|, |v88|, |v92|
    v_min_f32 v156, v156, |v96|
    v_cmp_gt_f32 s[60:61], s54, v156
    s_nop 0
    s_cmp_lg_u64 s[60:61], 0
    s_cbranch_scc1 L_m_s58
L_m_r59:
    v_mfma_f32_32x32x16_bf16 v[116:131], v[224:227], v[76:79], v[116:131]
    s_waitcnt vmcnt(0)
    v_add_u32 v45, 8320, v44
    v_mfma_f32_32x32x16_bf16 v[132:147], v[228:231], v[76:79], v[132:147]
    v_add_u32 v46, 12480, v44
    ds_write_b128 v44, v[28:31] offset:0
    v_mfma_f32_32x32x16_bf16 v[116:131], v[240:243], v[80:83], v[116:131]
    v_perm_b32 v36, v28, v0, s18
    v_alignbit_b32 v37, v29, v28, 16
    v_mfma_f32_32x32x16_bf16 v[132:147], v[244:247], v[80:83], v[132:147]
    v_alignbit_b32 v38, v30, v29, 16
    v_alignbit_b32 v39, v31, v30, 16
    v_mfma_f32_32x32x16_bf16 v[116:131], a[184:187], v[84:87], v[116:131]
    ds_write2_b32 v45, v28, v29 offset0:1 offset1:2
    ds_write2_b32 v45, v30, v31 offset0:3 offset1:4
    v_mfma_f32_32x32x16_bf16 v[132:147], a[188:191], v[84:87], v[132:147]
    ds_write_b128 v44, v[36:39] offset:4160
    ds_write2_b32 v46, v36, v37 offset0:1 offset1:2
    v_mfma_f32_32x32x16_bf16 v[116:131], a[200:203], v[88:91], v[116:131]
    ds_write2_b32 v46, v38, v39 offset0:3 offset1:4
    v_add_u32 v45, 24960, v44
    v_mfma_f32_32x32x16_bf16 v[132:147], a[204:207], v[88:91], v[132:147]
    v_min3_f32 v156, |v100|, |v104|, |v108|
    v_min_f32 v156, v156, |v112|
    v_cmp_gt_f32 s[60:61], s54, v156
    s_nop 0
    s_cmp_lg_u64 s[60:61], 0
    s_cbranch_scc1 L_m_s60
L_m_r61:
    v_mfma_f32_32x32x16_bf16 v[116:131], a[216:219], v[92:95], v[116:131]
    v_add_u32 v46, 29120, v44
    ds_write_b128 v44, v[32:35] offset:16640
    v_mfma_f32_32x32x16_bf16 v[132:147], a[220:223], v[92:95], v[132:147]
    v_alignbit_b32 v40, v32, v0, 16
    v_alignbit_b32 v41, v33, v32, 16
    v_mfma_f32_32x32x16_bf16 v[116:131], a[232:235], v[96:99], v[116:131]
    v_alignbit_b32 v42, v34, v33, 16
    v_alignbit_b32 v43, v35, v34, 16
    v_mfma_f32_32x32x16_bf16 v[132:147], a[236:239], v[96:99], v[132:147]
    ds_write2_b32 v45, v32, v33 offset0:1 offset1:2
    ds_write2_b32 v45, v34, v35 offset0:3 offset1:4
    v_mfma_f32_32x32x16_bf16 v[116:131], v[200:203], v[100:103], v[116:131]
    ds_write_b128 v44, v[40:43] offset:20800
    ds_write2_b32 v46, v40, v41 offset0:1 offset1:2
    v_mfma_f32_32x32x16_bf16 v[132:147], v[204:207], v[100:103], v[132:147]
    ds_write2_b32 v46, v42, v43 offset0:3 offset1:4
    v_mfma_f32_32x32x16_bf16 v[116:131], v[216:219], v[104:107], v[116:131]
    v_mfma_f32_32x32x16_bf16 v[132:147], v[220:223], v[104:107], v[132:147]
    v_mfma_f32_32x32x16_bf16 v[116:131], v[232:235], v[108:111], v[116:131]
    v_mfma_f32_32x32x16_bf16 v[132:147], v[236:239], v[108:111], v[132:147]
    s_mov_b32 s64, 8683520
    s_add_u32 s65, s6, 0
    buffer_load_dwordx4 v[28:31], v6, s[44:47], s64 offen offset:0 sc1
    buffer_load_dwordx4 v[32:35], v6, s[44:47], s64 offen offset:1024 sc1
    buffer_load_dwordx4 v[36:39], v6, s[44:47], s64 offen offset:2048 sc1
    buffer_load_dwordx4 v[40:43], v6, s[44:47], s64 offen offset:3072 sc1
    buffer_load_dwordx4 v[44:47], v5, s[44:47], s65 offen sc1
    v_mfma_f32_32x32x16_bf16 v[116:131], v[248:251], v[112:115], v[116:131]
    v_mfma_f32_32x32x16_bf16 v[132:147], v[252:255], v[112:115], v[132:147]
    s_barrier
    s_nop 9
    ds_write_b128 v16, v[116:119] offset:0
    ds_write_b128 v16, v[120:123] offset:1024
    ds_write_b128 v17, v[124:127] offset:2048
    ds_write_b128 v17, v[128:131] offset:3072
    ds_write_b128 v16, v[132:135] offset:4096
    ds_write_b128 v16, v[136:139] offset:5120
    ds_write_b128 v17, v[140:143] offset:6144
    ds_write_b128 v17, v[144:147] offset:7168
    s_waitcnt lgkmcnt(0)
    s_barrier
    ds_read_b128 v[116:119], v18 offset:0
    ds_read_b128 v[120:123], v18 offset:1024
    ds_read_b128 v[124:127], v18 offset:8192
    ds_read_b128 v[128:131], v18 offset:9216
    ds_read_b128 v[132:135], v18 offset:16384
    ds_read_b128 v[136:139], v18 offset:17408
    ds_read_b128 v[140:143], v18 offset:24576
    ds_read_b128 v[144:147], v18 offset:25600
    s_waitcnt lgkmcnt(4)
    v_pk_add_f32 v[116:117], v[116:117], v[124:125]
    v_pk_add_f32 v[118:119], v[118:119], v[126:127]
    v_pk_add_f32 v[120:121], v[120:121], v[128:129]
    v_pk_add_f32 v[122:123], v[122:123], v[130:131]
    v_lshlrev_b32 v124, 16, v152
    v_and_b32 v125, 0xffff0000, v152
    v_lshlrev_b32 v126, 16, v153
    v_and_b32 v127, 0xffff0000, v153
    v_lshlrev_b32 v128, 16, v154
    v_and_b32 v129, 0xffff0000, v154
    v_lshlrev_b32 v130, 16, v155
    v_and_b32 v131, 0xffff0000, v155
    s_waitcnt lgkmcnt(0)
    v_pk_add_f32 v[132:133], v[132:133], v[140:141]
    v_pk_add_f32 v[134:135], v[134:135], v[142:143]
    v_pk_add_f32 v[136:137], v[136:137], v[144:145]
    v_pk_add_f32 v[138:139], v[138:139], v[146:147]
    v_pk_add_f32 v[116:117], v[116:117], v[132:133]
    v_pk_add_f32 v[118:119], v[118:119], v[134:135]
    v_pk_add_f32 v[120:121], v[120:121], v[136:137]
    v_pk_add_f32 v[122:123], v[122:123], v[138:139]
    v_fma_f32 v124, v116, s29, v124
    v_fma_f32 v125, v117, s29, v125
    v_fma_f32 v126, v118, s29, v126
    v_fma_f32 v127, v119, s29, v127
    v_fma_f32 v128, v120, s29, v128
    v_fma_f32 v129, v121, s29, v129
    v_fma_f32 v130, v122, s29, v130
    v_fma_f32 v131, v123, s29, v131
    v_cvt_pk_bf16_f32 v132, v124, v125
    v_cvt_pk_bf16_f32 v133, v126, v127
    v_cvt_pk_bf16_f32 v134, v128, v129
    v_cvt_pk_bf16_f32 v135, v130, v131
    v_dot2_f32_bf16 v136, v132, s38, 0
    v_dot2_f32_bf16 v137, v132, v132, 0
    v_dot2_f32_bf16 v136, v133, s38, v136
    v_dot2_f32_bf16 v137, v133, v133, v137
    v_dot2_f32_bf16 v136, v134, s38, v136
    v_dot2_f32_bf16 v137, v134, v134, v137
    v_dot2_f32_bf16 v136, v135, s38, v136
    v_dot2_f32_bf16 v137, v135, v135, v137
    v_permlane16_swap_b32 v132, v133
    v_permlane16_swap_b32 v134, v135
    v_add_f32_dpp v136, v136, v136 quad_perm:[1,0,3,2] row_mask:0xf bank_mask:0xf
    v_add_f32_dpp v137, v137, v137 quad_perm:[1,0,3,2] row_mask:0xf bank_mask:0xf
    v_permlane32_swap_b32 v132, v134
    v_permlane32_swap_b32 v133, v135
    v_add_f32_dpp v136, v136, v136 quad_perm:[2,3,0,1] row_mask:0xf bank_mask:0xf
    v_add_f32_dpp v137, v137, v137 quad_perm:[2,3,0,1] row_mask:0xf bank_mask:0xf
    s_nop 0
    v_add_f32_dpp v136, v136, v136 row_half_mirror row_mask:0xf bank_mask:0xf
    v_add_f32_dpp v137, v137, v137 row_half_mirror row_mask:0xf bank_mask:0xf
    v_cndmask_b32 v137, 1.0, v137, s[52:53]
    v_cmp_gt_f32 vcc, s54, |v132|
    v_and_b32 v138, 0xffff, v132
    v_or_b32 v138, s54, v138
    v_cndmask_b32 v132, v132, v138, vcc
    v_xor_b32 v132, s54, v132
    v_cndmask_b32 v137, v137, v136, s[40:41]
    s_add_u32 s66, s13, 8699904
    s_add_u32 s67, s12, 1081344
    s_mov_b64 exec, s[36:37]
    buffer_atomic_add_f32 v137, v21, s[44:47], s66 offen sc1
    s_mov_b64 exec, -1
    buffer_store_dwordx4 v[132:135], v20, s[44:47], s67 offen sc1
    s_barrier
    v_mov_b32 v120, 0
    v_mov_b32 v121, 0
    v_mov_b32 v122, 0
    v_mov_b32 v123, 0
    v_lshrrev_b32 v124, 5, v1
    v_mul_u32_u24 v124, 4608, v124
    v_and_b32 v125, 31, v1
    v_lshl_add_u32 v124, v125, 4, v124
    v_add_u32 v124, 131072, v124
    ds_write_b128 v124, v[120:123]
    v_bfe_u32 v124, v1, 1, 3
    v_mul_u32_u24 v124, 4160, v124
    v_and_b32 v125, 1, v1
    v_lshl_add_u32 v124, v125, 4, v124
    v_add_u32 v124, 97792, v124
    ds_write_b128 v124, v[120:123]
    v_and_b32 v124, 5, v1
    v_mul_u32_u24 v124, 4160, v124
    v_add_u32 v124, 106144, v124
    ds_write_b32 v124, v120
L_m_conv1:
    s_waitcnt vmcnt(2)
    v_min3_f32 v31, v30, v34, v38
    v_min_f32 v31, v31, v42
    v_cmp_gt_f32 s[62:63], s39, v31
    v_xor_b32 v44, s54, v44
    v_cmp_le_f32 s[70:71], s55, |v44|
    v_cmp_gt_f32 vcc, s54, |v44|
    s_nop 0
    s_or_b64 vcc, vcc, s[70:71]
    s_or_b64 vcc, vcc, s[62:63]
    s_cbranch_vccnz L_m_s62
L_m_r63:
    v_mul_f32 v30, s20, v28
    v_mul_f32 v31, s20, v32
    v_mul_f32 v34, s20, v36
    v_mul_f32 v35, s20, v40
    v_mov_b32 v60, s22
    v_fma_f32 v38, v29, s20, v60
    v_fma_f32 v39, v33, s20, v60
    v_fma_f32 v42, v37, s20, v60
    v_fma_f32 v43, v41, s20, v60
    v_fma_f32 v38, -v30, v30, v38
    v_fma_f32 v39, -v31, v31, v39
    v_fma_f32 v42, -v34, v34, v42
    v_fma_f32 v43, -v35, v35, v43
    v_max_f32 v38, s22, v38
    v_max_f32 v39, s22, v39
    v_max_f32 v42, s22, v42
    v_max_f32 v43, s22, v43
    v_rsq_f32 v38, v38
    v_rsq_f32 v39, v39
    v_rsq_f32 v42, v42
    v_rsq_f32 v43, v43
    v_lshlrev_b32 v60, 16, v44
    v_and_b32 v64, 0xffff0000, v44
    v_lshlrev_b32 v61, 16, v45
    v_and_b32 v65, 0xffff0000, v45
    v_lshlrev_b32 v62, 16, v46
    v_and_b32 v66, 0xffff0000, v46
    v_lshlrev_b32 v63, 16, v47
    v_and_b32 v67, 0xffff0000, v47
    v_mul_f32 v30, -v30, v38
    v_mul_f32 v31, -v31, v39
    v_mul_f32 v34, -v34, v42
    v_mul_f32 v35, -v35, v43
    v_pk_fma_f32 v[28:29], v[60:61], v[38:39], v[30:31]
    v_pk_fma_f32 v[32:33], v[62:63], v[42:43], v[34:35]
    v_pk_fma_f32 v[36:37], v[64:65], v[38:39], v[30:31]
    v_pk_fma_f32 v[40:41], v[66:67], v[42:43], v[34:35]
    v_cvt_pk_bf16_f32 v44, v28, v29
    v_cvt_pk_bf16_f32 v45, v32, v33
    ds_write_b64 v7, v[44:45] offset:0
    v_cvt_pk_bf16_f32 v46, v36, v37
    v_cvt_pk_bf16_f32 v47, v40, v41
    ds_write_b64 v7, v[46:47] offset:4608
    v_pk_fma_f32 v[60:61], v[28:29], s[24:25], v[60:61]
    v_pk_fma_f32 v[62:63], v[32:33], s[24:25], v[62:63]
    v_pk_fma_f32 v[64:65], v[36:37], s[26:27], v[64:65]
    v_pk_fma_f32 v[66:67], v[40:41], s[26:27], v[66:67]
    s_waitcnt lgkmcnt(0)
    s_barrier
    ds_read_b64_tr_b16 v[76:77], v3 offset:1544
    ds_read_b64_tr_b16 v[78:79], v3 offset:1536
    ds_read_b128 v[80:83], v4 offset:192
    ds_read_b64_tr_b16 v[84:85], v3 offset:1032
    ds_read_b64_tr_b16 v[86:87], v3 offset:1024
    ds_read_b128 v[88:91], v4 offset:704
    ds_read_b64_tr_b16 v[112:113], v3 offset:520
    ds_read_b64_tr_b16 v[114:115], v3 offset:512
    ds_read_b128 v[148:151], v4 offset:1216
    ds_read_b64_tr_b16 v[152:153], v3 offset:8
    ds_read_b64_tr_b16 v[154:155], v3 offset:0
    s_waitcnt lgkmcnt(8)
    v_mfma_f32_16x16x32_bf16 v[128:131], v[76:79], v[80:83], 0
    s_waitcnt lgkmcnt(6)
    v_mfma_f32_16x16x32_bf16 v[124:127], v[84:87], v[80:83], 0
    s_waitcnt lgkmcnt(5)
    v_mfma_f32_16x16x32_bf16 v[128:131], v[84:87], v[88:91], v[128:131]
    s_waitcnt lgkmcnt(3)
    v_mfma_f32_16x16x32_bf16 v[120:123], v[112:115], v[80:83], 0
    ds_read_b128 v[156:159], v4 offset:1728
    v_mfma_f32_16x16x32_bf16 v[124:127], v[112:115], v[88:91], v[124:127]
    ds_read_b64_tr_b16 v[48:49], v3 offset:1608
    ds_read_b64_tr_b16 v[50:51], v3 offset:1600
    s_waitcnt lgkmcnt(5)
    v_mfma_f32_16x16x32_bf16 v[128:131], v[112:115], v[148:151], v[128:131]
    ds_read_b128 v[52:55], v4 offset:128
    s_waitcnt lgkmcnt(4)
    v_mfma_f32_16x16x32_bf16 v[116:119], v[152:155], v[80:83], 0
    ds_read_b64_tr_b16 v[56:57], v3 offset:1096
    v_mfma_f32_16x16x32_bf16 v[120:123], v[152:155], v[88:91], v[120:123]
    ds_read_b64_tr_b16 v[58:59], v3 offset:1088
    ds_read_b128 v[76:79], v4 offset:640
    v_mfma_f32_16x16x32_bf16 v[124:127], v[152:155], v[148:151], v[124:127]
    ds_read_b64_tr_b16 v[84:85], v3 offset:584
    ds_read_b64_tr_b16 v[86:87], v3 offset:576
    s_waitcnt lgkmcnt(8)
    v_mfma_f32_16x16x32_bf16 v[128:131], v[152:155], v[156:159], v[128:131]
    ds_read_b128 v[112:115], v4 offset:1152
    s_waitcnt lgkmcnt(6)
    v_mfma_f32_16x16x32_bf16 v[128:131], v[48:51], v[52:55], v[128:131]
    ds_read_b64_tr_b16 v[80:81], v3 offset:72
    s_waitcnt lgkmcnt(5)
    v_mfma_f32_16x16x32_bf16 v[124:127], v[56:59], v[52:55], v[124:127]
    ds_read_b64_tr_b16 v[82:83], v3 offset:64
    s_waitcnt lgkmcnt(5)
    v_mfma_f32_16x16x32_bf16 v[128:131], v[56:59], v[76:79], v[128:131]
    s_waitcnt lgkmcnt(3)
    v_mfma_f32_16x16x32_bf16 v[120:123], v[84:87], v[52:55], v[120:123]
    ds_read_b128 v[88:91], v4 offset:1664
    v_mfma_f32_16x16x32_bf16 v[124:127], v[84:87], v[76:79], v[124:127]
    ds_read_b64_tr_b16 v[148:149], v3 offset:1672
    ds_read_b64_tr_b16 v[150:151], v3 offset:1664
    s_waitcnt lgkmcnt(5)
    v_mfma_f32_16x16x32_bf16 v[128:131], v[84:87], v[112:115], v[128:131]
    ds_read_b128 v[152:155], v4 offset:64
    s_waitcnt lgkmcnt(4)
    v_mfma_f32_16x16x32_bf16 v[116:119], v[80:83], v[52:55], v[116:119]
    ds_read_b64_tr_b16 v[156:157], v3 offset:1160
    v_mfma_f32_16x16x32_bf16 v[120:123], v[80:83], v[76:79], v[120:123]
    ds_read_b64_tr_b16 v[158:159], v3 offset:1152
    ds_read_b128 v[48:51], v4 offset:576
    v_mfma_f32_16x16x32_bf16 v[124:127], v[80:83], v[112:115], v[124:127]
    ds_read_b64_tr_b16 v[56:57], v3 offset:648
    ds_read_b64_tr_b16 v[58:59], v3 offset:640
    s_waitcnt lgkmcnt(8)
    v_mfma_f32_16x16x32_bf16 v[128:131], v[80:83], v[88:91], v[128:131]
    ds_read_b128 v[84:87], v4 offset:1088
    s_waitcnt lgkmcnt(6)
    v_mfma_f32_16x16x32_bf16 v[128:131], v[148:151], v[152:155], v[128:131]
    ds_read_b64_tr_b16 v[52:53], v3 offset:136
    s_waitcnt lgkmcnt(5)
    v_mfma_f32_16x16x32_bf16 v[124:127], v[156:159], v[152:155], v[124:127]
    ds_read_b64_tr_b16 v[54:55], v3 offset:128
    s_waitcnt lgkmcnt(5)
    v_mfma_f32_16x16x32_bf16 v[128:131], v[156:159], v[48:51], v[128:131]
    s_waitcnt lgkmcnt(3)
    v_mfma_f32_16x16x32_bf16 v[120:123], v[56:59], v[152:155], v[120:123]
    ds_read_b128 v[76:79], v4 offset:1600
    v_mfma_f32_16x16x32_bf16 v[124:127], v[56:59], v[48:51], v[124:127]
    ds_read_b64_tr_b16 v[112:113], v3 offset:1736
    ds_read_b64_tr_b16 v[114:115], v3 offset:1728
    s_waitcnt lgkmcnt(5)
    v_mfma_f32_16x16x32_bf16 v[128:131], v[56:59], v[84:87], v[128:131]
    ds_read_b128 v[80:83], v4 offset:0
    s_waitcnt lgkmcnt(4)
    v_mfma_f32_16x16x32_bf16 v[116:119], v[52:55], v[152:155], v[116:119]
    ds_read_b64_tr_b16 v[88:89], v3 offset:1224
    v_mfma_f32_16x16x32_bf16 v[120:123], v[52:55], v[48:51], v[120:123]
    ds_read_b64_tr_b16 v[90:91], v3 offset:1216
    ds_read_b128 v[148:151], v4 offset:512
    v_mfma_f32_16x16x32_bf16 v[124:127], v[52:55], v[84:87], v[124:127]
    ds_read_b64_tr_b16 v[156:157], v3 offset:712
    ds_read_b64_tr_b16 v[158:159], v3 offset:704
    s_waitcnt lgkmcnt(8)
    v_mfma_f32_16x16x32_bf16 v[128:131], v[52:55], v[76:79], v[128:131]
    ds_read_b128 v[56:59], v4 offset:1024
    s_waitcnt lgkmcnt(6)
    v_mfma_f32_16x16x32_bf16 v[128:131], v[112:115], v[80:83], v[128:131]
    ds_read_b64_tr_b16 v[152:153], v3 offset:200
    s_waitcnt lgkmcnt(5)
    v_mfma_f32_16x16x32_bf16 v[124:127], v[88:91], v[80:83], v[124:127]
    ds_read_b64_tr_b16 v[154:155], v3 offset:192
    s_waitcnt lgkmcnt(5)
    v_mfma_f32_16x16x32_bf16 v[128:131], v[88:91], v[148:151], v[128:131]
    s_waitcnt lgkmcnt(3)
    v_mfma_f32_16x16x32_bf16 v[120:123], v[156:159], v[80:83], v[120:123]
    ds_read_b128 v[48:51], v4 offset:1536
    v_mfma_f32_16x16x32_bf16 v[124:127], v[156:159], v[148:151], v[124:127]
    s_waitcnt lgkmcnt(3)
    v_mfma_f32_16x16x32_bf16 v[128:131], v[156:159], v[56:59], v[128:131]
    s_waitcnt lgkmcnt(1)
    v_mfma_f32_16x16x32_bf16 v[116:119], v[152:155], v[80:83], v[116:119]
    v_mfma_f32_16x16x32_bf16 v[120:123], v[152:155], v[148:151], v[120:123]
    v_mfma_f32_16x16x32_bf16 v[124:127], v[152:155], v[56:59], v[124:127]
    s_waitcnt lgkmcnt(0)
    v_mfma_f32_16x16x32_bf16 v[128:131], v[152:155], v[48:51], v[128:131]
    ds_read_b64_tr_b16 v[84:85], v3 offset:520
    ds_read_b64_tr_b16 v[86:87], v3 offset:512
    ds_read_b128 v[52:55], v4 offset:1728
    ds_read_b64_tr_b16 v[76:77], v3 offset:1032
    ds_read_b64_tr_b16 v[78:79], v3 offset:1024
    ds_read_b128 v[112:115], v4 offset:1216
    ds_read_b64_tr_b16 v[88:89], v3 offset:1544
    ds_read_b64_tr_b16 v[90:91], v3 offset:1536
    ds_read_b128 v[156:159], v4 offset:704
    ds_read_b64_tr_b16 v[80:81], v3 offset:2056
    ds_read_b64_tr_b16 v[82:83], v3 offset:2048
    ds_read_b128 v[148:151], v4 offset:192
    s_waitcnt lgkmcnt(9)
    v_mfma_f32_16x16x32_bf16 v[132:135], v[84:87], v[52:55], 0
    s_waitcnt lgkmcnt(6)
    v_mfma_f32_16x16x32_bf16 v[132:135], v[76:79], v[112:115], v[132:135]
    ds_write_b128 v8, v[116:119] offset:0
    ds_write_b128 v8, v[120:123] offset:1024
    ds_write_b128 v8, v[124:127] offset:2048
    ds_write_b128 v8, v[128:131] offset:3072
    v_mfma_f32_16x16x32_bf16 v[136:139], v[76:79], v[52:55], 0
    s_waitcnt lgkmcnt(7)
    v_mfma_f32_16x16x32_bf16 v[132:135], v[88:91], v[156:159], v[132:135]
    s_waitcnt lgkmcnt(0)
    s_barrier
    ds_read_b128 v[28:31], v9 offset:0
    ds_read_b128 v[32:35], v9 offset:4096
    ds_read_b128 v[36:39], v9 offset:8192
    ds_read_b128 v[40:43], v9 offset:12288
    v_mfma_f32_16x16x32_bf16 v[136:139], v[88:91], v[112:115], v[136:139]
    ds_read_b64_tr_b16 v[56:57], v3 offset:2568
    ds_read_b64_tr_b16 v[58:59], v3 offset:2560
    v_mfma_f32_16x16x32_bf16 v[140:143], v[88:91], v[52:55], 0
    v_mfma_f32_16x16x32_bf16 v[132:135], v[80:83], v[148:151], v[132:135]
    s_waitcnt lgkmcnt(4)
    v_add_f32 v60, v60, v28
    v_add_f32 v61, v61, v29
    v_add_f32 v62, v62, v30
    v_add_f32 v63, v63, v31
    v_add_f32 v60, v60, v32
    v_add_f32 v61, v61, v33
    v_add_f32 v62, v62, v34
    v_mfma_f32_16x16x32_bf16 v[136:139], v[80:83], v[156:159], v[136:139]
    ds_read_b64_tr_b16 v[48:49], v3 offset:3080
    ds_read_b64_tr_b16 v[50:51], v3 offset:3072
    v_add_f32 v63, v63, v35
    v_max_u32 v61, s54, v61
    v_max_i32 v61, 0xa0000000, v61
    s_waitcnt lgkmcnt(4)
    v_add_f32 v64, v64, v36
    v_add_f32 v65, v65, v37
    v_add_f32 v66, v66, v38
    v_add_f32 v67, v67, v39
    v_mfma_f32_16x16x32_bf16 v[140:143], v[80:83], v[112:115], v[140:143]
    v_add_f32 v64, v64, v40
    v_add_f32 v65, v65, v41
    v_add_f32 v66, v66, v42
    v_add_f32 v67, v67, v43
    v_cvt_pk_bf16_f32 v28, v60, v61
    v_cvt_pk_bf16_f32 v29, v62, v63
    v_cvt_pk_bf16_f32 v30, v64, v65
    v_cvt_pk_bf16_f32 v31, v66, v67
    v_mfma_f32_16x16x32_bf16 v[144:147], v[80:83], v[52:55], 0
    ds_read_b64_tr_b16 v[152:153], v3 offset:3592
    ds_read_b64_tr_b16 v[154:155], v3 offset:3584
    v_xor_b32 v28, s54, v28
    s_add_u32 s66, s7, 0
    buffer_store_dwordx4 v[28:31], v10, s[44:47], s66 offen sc1
    s_waitcnt lgkmcnt(4)
    v_mfma_f32_16x16x32_bf16 v[136:139], v[56:59], v[148:151], v[136:139]
    ds_read_b64_tr_b16 v[84:85], v3 offset:584
    v_mfma_f32_16x16x32_bf16 v[140:143], v[56:59], v[156:159], v[140:143]
    ds_read_b64_tr_b16 v[86:87], v3 offset:576
    ds_read_b128 v[76:79], v4 offset:1664
    s_mov_b32 s64, 8699904
    s_add_u32 s65, s6, 1081344
    buffer_load_dwordx4 v[92:95], v6, s[44:47], s64 offen offset:0 sc1
    buffer_load_dwordx4 v[96:99], v6, s[44:47], s64 offen offset:1024 sc1
    buffer_load_dwordx4 v[100:103], v6, s[44:47], s64 offen offset:2048 sc1
    buffer_load_dwordx4 v[104:107], v6, s[44:47], s64 offen offset:3072 sc1
    buffer_load_dwordx4 v[108:111], v5, s[44:47], s65 offen sc1
    v_mfma_f32_16x16x32_bf16 v[144:147], v[56:59], v[112:115], v[144:147]
    ds_read_b64_tr_b16 v[88:89], v3 offset:1096
    ds_read_b64_tr_b16 v[90:91], v3 offset:1088
    s_waitcnt lgkmcnt(7)
    v_mfma_f32_16x16x32_bf16 v[140:143], v[48:51], v[148:151], v[140:143]
    ds_read_b128 v[80:83], v4 offset:1152
    v_mfma_f32_16x16x32_bf16 v[144:147], v[48:51], v[156:159], v[144:147]
    ds_read_b64_tr_b16 v[52:53], v3 offset:1608
    ds_read_b64_tr_b16 v[54:55], v3 offset:1600
    s_waitcnt lgkmcnt(8)
    v_mfma_f32_16x16x32_bf16 v[144:147], v[152:155], v[148:151], v[144:147]
    ds_read_b128 v[56:59], v4 offset:640
    s_waitcnt lgkmcnt(6)
    v_mfma_f32_16x16x32_bf16 v[132:135], v[84:87], v[76:79], v[132:135]
    ds_read_b64_tr_b16 v[112:113], v3 offset:2120
    s_waitcnt lgkmcnt(4)
    v_mfma_f32_16x16x32_bf16 v[132:135], v[88:91], v[80:83], v[132:135]
    ds_read_b64_tr_b16 v[114:115], v3 offset:2112
    v_mfma_f32_16x16x32_bf16 v[136:139], v[88:91], v[76:79], v[136:139]
    ds_read_b128 v[156:159], v4 offset:128
    s_waitcnt lgkmcnt(3)
    v_mfma_f32_16x16x32_bf16 v[132:135], v[52:55], v[56:59], v[132:135]
    v_mfma_f32_16x16x32_bf16 v[136:139], v[52:55], v[80:83], v[136:139]
    ds_read_b64_tr_b16 v[48:49], v3 offset:2632
    ds_read_b64_tr_b16 v[50:51], v3 offset:2624
    v_mfma_f32_16x16x32_bf16 v[140:143], v[52:55], v[76:79], v[140:143]
    s_waitcnt lgkmcnt(2)
    v_mfma_f32_16x16x32_bf16 v[132:135], v[112:115], v[156:159], v[132:135]
    v_mfma_f32_16x16x32_bf16 v[136:139], v[112:115], v[56:59], v[136:139]
    ds_read_b64_tr_b16 v[152:153], v3 offset:3144
    ds_read_b64_tr_b16 v[154:155], v3 offset:3136
    v_mfma_f32_16x16x32_bf16 v[140:143], v[112:115], v[80:83], v[140:143]
    v_mfma_f32_16x16x32_bf16 v[144:147], v[112:115], v[76:79], v[144:147]
    ds_read_b64_tr_b16 v[148:149], v3 offset:3656
    ds_read_b64_tr_b16 v[150:151], v3 offset:3648
    s_waitcnt lgkmcnt(4)
    v_mfma_f32_16x16x32_bf16 v[136:139], v[48:51], v[156:159], v[136:139]
    ds_read_b64_tr_b16 v[84:85], v3 offset:648
    v_mfma_f32_16x16x32_bf16 v[140:143], v[48:51], v[56:59], v[140:143]
    ds_read_b64_tr_b16 v[86:87], v3 offset:640
    ds_read_b128 v[88:91], v4 offset:1600
    v_mfma_f32_16x16x32_bf16 v[144:147], v[48:51], v[80:83], v[144:147]
    ds_read_b64_tr_b16 v[52:53], v3 offset:1160
    ds_read_b64_tr_b16 v[54:55], v3 offset:1152
    s_waitcnt lgkmcnt(7)
    v_mfma_f32_16x16x32_bf16 v[140:143], v[152:155], v[156:159], v[140:143]
    ds_read_b128 v[112:115], v4 offset:1088
    v_mfma_f32_16x16x32_bf16 v[144:147], v[152:155], v[56:59], v[144:147]
    ds_read_b64_tr_b16 v[76:77], v3 offset:1672
    ds_read_b64_tr_b16 v[78:79], v3 offset:1664
    s_waitcnt lgkmcnt(8)
    v_mfma_f32_16x16x32_bf16 v[144:147], v[148:151], v[156:159], v[144:147]
    ds_read_b128 v[48:51], v4 offset:576
    s_waitcnt lgkmcnt(6)
    v_mfma_f32_16x16x32_bf16 v[132:135], v[84:87], v[88:91], v[132:135]
    ds_read_b64_tr_b16 v[80:81], v3 offset:2184
    s_waitcnt lgkmcnt(4)
    v_mfma_f32_16x16x32_bf16 v[132:135], v[52:55], v[112:115], v[132:135]
    ds_read_b64_tr_b16 v[82:83], v3 offset:2176
    v_mfma_f32_16x16x32_bf16 v[136:139], v[52:55], v[88:91], v[136:139]
    ds_read_b128 v[56:59], v4 offset:64
    s_waitcnt lgkmcnt(3)
    v_mfma_f32_16x16x32_bf16 v[132:135], v[76:79], v[48:51], v[132:135]
    v_mfma_f32_16x16x32_bf16 v[136:139], v[76:79], v[112:115], v[136:139]
    ds_read_b64_tr_b16 v[152:153], v3 offset:2696
    ds_read_b64_tr_b16 v[154:155], v3 offset:2688
    v_mfma_f32_16x16x32_bf16 v[140:143], v[76:79], v[88:91], v[140:143]
    s_waitcnt lgkmcnt(2)
    v_mfma_f32_16x16x32_bf16 v[132:135], v[80:83], v[56:59], v[132:135]
    v_mfma_f32_16x16x32_bf16 v[136:139], v[80:83], v[48:51], v[136:139]
    ds_read_b64_tr_b16 v[156:157], v3 offset:3208
    ds_read_b64_tr_b16 v[158:159], v3 offset:3200
    v_mfma_f32_16x16x32_bf16 v[140:143], v[80:83], v[112:115], v[140:143]
    v_mfma_f32_16x16x32_bf16 v[144:147], v[80:83], v[88:91], v[144:147]
    ds_read_b64_tr_b16 v[148:149], v3 offset:3720
    ds_read_b64_tr_b16 v[150:151], v3 offset:3712
    s_waitcnt lgkmcnt(4)
    v_mfma_f32_16x16x32_bf16 v[136:139], v[152:155], v[56:59], v[136:139]
    ds_read_b64_tr_b16 v[84:85], v3 offset:712
    v_mfma_f32_16x16x32_bf16 v[140:143], v[152:155], v[48:51], v[140:143]
    ds_read_b64_tr_b16 v[86:87], v3 offset:704
    ds_read_b128 v[52:55], v4 offset:1536
    v_mfma_f32_16x16x32_bf16 v[144:147], v[152:155], v[112:115], v[144:147]
    ds_read_b64_tr_b16 v[76:77], v3 offset:1224
    ds_read_b64_tr_b16 v[78:79], v3 offset:1216
    s_waitcnt lgkmcnt(7)
    v_mfma_f32_16x16x32_bf16 v[140:143], v[156:159], v[56:59], v[140:143]
    ds_read_b128 v[80:83], v4 offset:1024
    v_mfma_f32_16x16x32_bf16 v[144:147], v[156:159], v[48:51], v[144:147]
    ds_read_b64_tr_b16 v[88:89], v3 offset:1736
    ds_read_b64_tr_b16 v[90:91], v3 offset:1728
    s_waitcnt lgkmcnt(8)
    v_mfma_f32_16x16x32_bf16 v[144:147], v[148:151], v[56:59], v[144:147]
    ds_read_b128 v[152:155], v4 offset:512
    s_waitcnt lgkmcnt(6)
    v_mfma_f32_16x16x32_bf16 v[132:135], v[84:87], v[52:55], v[132:135]
    ds_read_b64_tr_b16 v[112:113], v3 offset:2248
    s_waitcnt lgkmcnt(4)
    v_mfma_f32_16x16x32_bf16 v[132:135], v[76:79], v[80:83], v[132:135]
    ds_read_b64_tr_b16 v[114:115], v3 offset:2240
    v_mfma_f32_16x16x32_bf16 v[136:139], v[76:79], v[52:55], v[136:139]
    ds_read_b128 v[156:159], v4 offset:0
    s_waitcnt lgkmcnt(3)
    v_mfma_f32_16x16x32_bf16 v[132:135], v[88:91], v[152:155], v[132:135]
    v_mfma_f32_16x16x32_bf16 v[136:139], v[88:91], v[80:83], v[136:139]
    ds_read_b64_tr_b16 v[48:49], v3 offset:2760
    ds_read_b64_tr_b16 v[50:51], v3 offset:2752
    v_mfma_f32_16x16x32_bf16 v[140:143], v[88:91], v[52:55], v[140:143]
    s_waitcnt lgkmcnt(2)
    v_mfma_f32_16x16x32_bf16 v[132:135], v[112:115], v[156:159], v[132:135]
    v_mfma_f32_16x16x32_bf16 v[136:139], v[112:115], v[152:155], v[136:139]
    ds_read_b64_tr_b16 v[56:57], v3 offset:3272
    ds_read_b64_tr_b16 v[58:59], v3 offset:3264
    v_mfma_f32_16x16x32_bf16 v[140:143], v[112:115], v[80:83], v[140:143]
    v_mfma_f32_16x16x32_bf16 v[144:147], v[112:115], v[52:55], v[144:147]
    ds_read_b64_tr_b16 v[148:149], v3 offset:3784
    ds_read_b64_tr_b16 v[150:151], v3 offset:3776
    s_waitcnt lgkmcnt(4)
    v_mfma_f32_16x16x32_bf16 v[136:139], v[48:51], v[156:159], v[136:139]
    v_mfma_f32_16x16x32_bf16 v[140:143], v[48:51], v[152:155], v[140:143]
    v_mfma_f32_16x16x32_bf16 v[144:147], v[48:51], v[80:83], v[144:147]
    s_waitcnt vmcnt(0)
    v_min3_f32 v95, v94, v98, v102
    v_min_f32 v95, v95, v106
    v_cmp_gt_f32 s[62:63], s39, v95
    v_xor_b32 v108, s54, v108
    v_cmp_le_f32 s[70:71], s55, |v108|
    v_cmp_gt_f32 vcc, s54, |v108|
    s_nop 0
    s_or_b64 vcc, vcc, s[70:71]
    s_or_b64 vcc, vcc, s[62:63]
    s_cbranch_vccnz L_m_s64
L_m_r65:
    s_waitcnt lgkmcnt(2)
    v_mfma_f32_16x16x32_bf16 v[140:143], v[56:59], v[156:159], v[140:143]
    v_mul_f32 v94, s20, v92
    v_mfma_f32_16x16x32_bf16 v[144:147], v[56:59], v[152:155], v[144:147]
    v_mul_f32 v95, s20, v96
    v_mul_f32 v98, s20, v100
    s_waitcnt lgkmcnt(0)
    v_mfma_f32_16x16x32_bf16 v[144:147], v[148:151], v[156:159], v[144:147]
    v_mul_f32 v99, s20, v104
    v_mov_b32 v68, s22
    v_fma_f32 v102, v93, s20, v68
    v_fma_f32 v103, v97, s20, v68
    v_fma_f32 v106, v101, s20, v68
    v_fma_f32 v107, v105, s20, v68
    v_fma_f32 v102, -v94, v94, v102
    v_fma_f32 v103, -v95, v95, v103
    v_fma_f32 v106, -v98, v98, v106
    v_fma_f32 v107, -v99, v99, v107
    v_max_f32 v102, s22, v102
    v_max_f32 v103, s22, v103
    v_max_f32 v106, s22, v106
    v_max_f32 v107, s22, v107
    v_rsq_f32 v102, v102
    v_rsq_f32 v103, v103
    v_rsq_f32 v106, v106
    v_rsq_f32 v107, v107
    v_lshlrev_b32 v68, 16, v108
    v_and_b32 v72, 0xffff0000, v108
    v_lshlrev_b32 v69, 16, v109
    v_and_b32 v73, 0xffff0000, v109
    v_lshlrev_b32 v70, 16, v110
    v_and_b32 v74, 0xffff0000, v110
    v_lshlrev_b32 v71, 16, v111
    v_and_b32 v75, 0xffff0000, v111
    v_mul_f32 v94, -v94, v102
    v_mul_f32 v95, -v95, v103
    v_mul_f32 v98, -v98, v106
    v_mul_f32 v99, -v99, v107
    v_fma_f32 v92, v68, v102, v94
    v_fma_f32 v93, v69, v103, v95
    v_fma_f32 v96, v70, v106, v98
    v_fma_f32 v97, v71, v107, v99
    v_fma_f32 v100, v72, v102, v94
    v_fma_f32 v101, v73, v103, v95
    v_fma_f32 v104, v74, v106, v98
    v_fma_f32 v105, v75, v107, v99
    v_cvt_pk_bf16_f32 v108, v92, v93
    v_cvt_pk_bf16_f32 v109, v96, v97
    ds_write_b64 v7, v[108:109] offset:2048
    v_cvt_pk_bf16_f32 v110, v100, v101
    v_cvt_pk_bf16_f32 v111, v104, v105
    ds_write_b64 v7, v[110:111] offset:6656
    v_fma_f32 v68, v92, s24, v68
    v_fma_f32 v69, v93, s24, v69
    v_fma_f32 v70, v96, s24, v70
    v_fma_f32 v71, v97, s24, v71
    v_fma_f32 v72, v100, s26, v72
    v_fma_f32 v73, v101, s26, v73
    v_fma_f32 v74, v104, s26, v74
    v_fma_f32 v75, v105, s26, v75
    s_waitcnt lgkmcnt(0)
    s_barrier
    ds_read_b64_tr_b16 v[84:85], v3 offset:1544
    ds_read_b64_tr_b16 v[86:87], v3 offset:1536
    ds_read_b128 v[76:79], v4 offset:2240
    ds_read_b64_tr_b16 v[88:89], v3 offset:1032
    ds_read_b64_tr_b16 v[90:91], v3 offset:1024
    ds_read_b128 v[112:115], v4 offset:2752
    ds_read_b64_tr_b16 v[52:53], v3 offset:520
    ds_read_b64_tr_b16 v[54:55], v3 offset:512
    ds_read_b128 v[80:83], v4 offset:3264
    ds_read_b64_tr_b16 v[48:49], v3 offset:8
    ds_read_b64_tr_b16 v[50:51], v3 offset:0
    s_waitcnt lgkmcnt(8)
    v_mfma_f32_16x16x32_bf16 v[144:147], v[84:87], v[76:79], v[144:147]
    s_waitcnt lgkmcnt(6)
    v_mfma_f32_16x16x32_bf16 v[140:143], v[88:91], v[76:79], v[140:143]
    s_waitcnt lgkmcnt(5)
    v_mfma_f32_16x16x32_bf16 v[144:147], v[88:91], v[112:115], v[144:147]
    s_waitcnt lgkmcnt(3)
    v_mfma_f32_16x16x32_bf16 v[136:139], v[52:55], v[76:79], v[136:139]
    ds_read_b128 v[56:59], v4 offset:3776
    v_mfma_f32_16x16x32_bf16 v[140:143], v[52:55], v[112:115], v[140:143]
    ds_read_b64_tr_b16 v[152:153], v3 offset:1608
    ds_read_b64_tr_b16 v[154:155], v3 offset:1600
    s_waitcnt lgkmcnt(5)
    v_mfma_f32_16x16x32_bf16 v[144:147], v[52:55], v[80:83], v[144:147]
    ds_read_b128 v[156:159], v4 offset:2176
    s_waitcnt lgkmcnt(4)
    v_mfma_f32_16x16x32_bf16 v[132:135], v[48:51], v[76:79], v[132:135]
    ds_read_b64_tr_b16 v[148:149], v3 offset:1096
    v_mfma_f32_16x16x32_bf16 v[136:139], v[48:51], v[112:115], v[136:139]
    ds_read_b64_tr_b16 v[150:151], v3 offset:1088
    ds_read_b128 v[84:87], v4 offset:2688
    v_mfma_f32_16x16x32_bf16 v[140:143], v[48:51], v[80:83], v[140:143]
    ds_read_b64_tr_b16 v[88:89], v3 offset:584
    ds_read_b64_tr_b16 v[90:91], v3 offset:576
    s_add_u32 s64, s8, 2162688
    buffer_load_dwordx4 v[28:31], v2, s[44:47], s64 offen sc1
    s_waitcnt lgkmcnt(8)
    v_mfma_f32_16x16x32_bf16 v[144:147], v[48:51], v[56:59], v[144:147]
    ds_read_b128 v[52:55], v4 offset:3200
    s_add_u32 s64, s8, 2166784
    buffer_load_dwordx4 v[32:35], v2, s[44:47], s64 offen sc1
    s_waitcnt lgkmcnt(6)
    v_mfma_f32_16x16x32_bf16 v[144:147], v[152:155], v[156:159], v[144:147]
    ds_read_b64_tr_b16 v[76:77], v3 offset:72
    s_add_u32 s64, s8, 2170880
    buffer_load_dwordx4 v[60:63], v2, s[44:47], s64 offen sc1
    s_waitcnt lgkmcnt(5)
    v_mfma_f32_16x16x32_bf16 v[140:143], v[148:151], v[156:159], v[140:143]
    ds_read_b64_tr_b16 v[78:79], v3 offset:64
    s_add_u32 s64, s8, 2174976
    buffer_load_dwordx4 v[64:67], v2, s[44:47], s64 offen sc1
    s_waitcnt lgkmcnt(5)
    v_mfma_f32_16x16x32_bf16 v[144:147], v[148:151], v[84:87], v[144:147]
    s_add_u32 s64, s8, 2179072
    buffer_load_dwordx4 v[116:119], v2, s[44:47], s64 offen sc1
    s_waitcnt lgkmcnt(3)
    v_mfma_f32_16x16x32_bf16 v[136:139], v[88:91], v[156:159], v[136:139]
    ds_read_b128 v[112:115], v4 offset:3712
    s_add_u32 s64, s8, 2183168
    buffer_load_dwordx4 v[120:123], v2, s[44:47], s64 offen sc1
    v_mfma_f32_16x16x32_bf16 v[140:143], v[88:91], v[84:87], v[140:143]
    ds_read_b64_tr_b16 v[80:81], v3 offset:1672
    ds_read_b64_tr_b16 v[82:83], v3 offset:1664
    s_add_u32 s64, s8, 2187264
    buffer_load_dwordx4 v[124:127], v2, s[44:47], s64 offen sc1
    s_waitcnt lgkmcnt(5)
    v_mfma_f32_16x16x32_bf16 v[144:147], v[88:91], v[52:55], v[144:147]
    ds_read_b128 v[48:51], v4 offset:2112
    s_add_u32 s64, s8, 2191360
    buffer_load_dwordx4 v[128:131], v2, s[44:47], s64 offen sc1
    s_waitcnt lgkmcnt(4)
    v_mfma_f32_16x16x32_bf16 v[132:135], v[76:79], v[156:159], v[132:135]
    ds_read_b64_tr_b16 v[56:57], v3 offset:1160
    v_mfma_f32_16x16x32_bf16 v[136:139], v[76:79], v[84:87], v[136:139]
    ds_read_b64_tr_b16 v[58:59], v3 offset:1152
    ds_read_b128 v[152:155], v4 offset:2624
    v_mfma_f32_16x16x32_bf16 v[140:143], v[76:79], v[52:55], v[140:143]
    ds_read_b64_tr_b16 v[148:149], v3 offset:648
    ds_read_b64_tr_b16 v[150:151], v3 offset:640
    s_waitcnt lgkmcnt(8)
    v_mfma_f32_16x16x32_bf16 v[144:147], v[76:79], v[112:115], v[144:147]
    ds_read_b128 v[88:91], v4 offset:3136
    s_waitcnt lgkmcnt(6)
    v_mfma_f32_16x16x32_bf16 v[144:147], v[80:83], v[48:51], v[144:147]
    ds_read_b64_tr_b16 v[156:157], v3 offset:136
    s_waitcnt lgkmcnt(5)
    v_mfma_f32_16x16x32_bf16 v[140:143], v[56:59], v[48:51], v[140:143]
    ds_read_b64_tr_b16 v[158:159], v3 offset:128
    s_waitcnt lgkmcnt(5)
    v_mfma_f32_16x16x32_bf16 v[144:147], v[56:59], v[152:155], v[144:147]
    s_waitcnt lgkmcnt(3)
    v_mfma_f32_16x16x32_bf16 v[136:139], v[148:151], v[48:51], v[136:139]
    ds_read_b128 v[84:87], v4 offset:3648
    v_mfma_f32_16x16x32_bf16 v[140:143], v[148:151], v[152:155], v[140:143]
    ds_read_b64_tr_b16 v[52:53], v3 offset:1736
    ds_read_b64_tr_b16 v[54:55], v3 offset:1728
    s_waitcnt lgkmcnt(5)
    v_mfma_f32_16x16x32_bf16 v[144:147], v[148:151], v[88:91], v[144:147]
    ds_read_b128 v[76:79], v4 offset:2048
    s_waitcnt lgkmcnt(4)
    v_mfma_f32_16x16x32_bf16 v[132:135], v[156:159], v[48:51], v[132:135]
    ds_read_b64_tr_b16 v[112:113], v3 offset:1224
    v_mfma_f32_16x16x32_bf16 v[136:139], v[156:159], v[152:155], v[136:139]
    ds_read_b64_tr_b16 v[114:115], v3 offset:1216
    ds_read_b128 v[80:83], v4 offset:2560
    v_mfma_f32_16x16x32_bf16 v[140:143], v[156:159], v[88:91], v[140:143]
    ds_read_b64_tr_b16 v[56:57], v3 offset:712
    ds_read_b64_tr_b16 v[58:59], v3 offset:704
    s_waitcnt lgkmcnt(8)
    v_mfma_f32_16x16x32_bf16 v[144:147], v[156:159], v[84:87], v[144:147]
    ds_read_b128 v[148:151], v4 offset:3072
    s_waitcnt lgkmcnt(6)
    v_mfma_f32_16x16x32_bf16 v[144:147], v[52:55], v[76:79], v[144:147]
    ds_read_b64_tr_b16 v[48:49], v3 offset:200
    s_waitcnt lgkmcnt(5)
    v_mfma_f32_16x16x32_bf16 v[140:143], v[112:115], v[76:79], v[140:143]
    ds_read_b64_tr_b16 v[50:51], v3 offset:192
    s_waitcnt lgkmcnt(5)
    v_mfma_f32_16x16x32_bf16 v[144:147], v[112:115], v[80:83], v[144:147]
    s_waitcnt lgkmcnt(3)
    v_mfma_f32_16x16x32_bf16 v[136:139], v[56:59], v[76:79], v[136:139]
    ds_read_b128 v[152:155], v4 offset:3584
    v_mfma_f32_16x16x32_bf16 v[140:143], v[56:59], v[80:83], v[140:143]
    s_waitcnt lgkmcnt(3)
    v_mfma_f32_16x16x32_bf16 v[144:147], v[56:59], v[148:151], v[144:147]
    s_waitcnt lgkmcnt(1)
    v_mfma_f32_16x16x32_bf16 v[132:135], v[48:51], v[76:79], v[132:135]
    v_mfma_f32_16x16x32_bf16 v[136:139], v[48:51], v[80:83], v[136:139]
    v_mfma_f32_16x16x32_bf16 v[140:143], v[48:51], v[148:151], v[140:143]
    s_waitcnt lgkmcnt(0)
    v_mfma_f32_16x16x32_bf16 v[144:147], v[48:51], v[152:155], v[144:147]
    s_nop 3
    ds_write_b128 v8, v[132:135] offset:0
    ds_write_b128 v8, v[136:139] offset:1024
    ds_write_b128 v8, v[140:143] offset:2048
    s_nop 0
    ds_write_b128 v8, v[144:147] offset:3072
    s_waitcnt lgkmcnt(0)
    s_barrier
    ds_read_b128 v[92:95], v9 offset:0
    ds_read_b128 v[96:99], v9 offset:4096
    ds_read_b128 v[100:103], v9 offset:8192
    ds_read_b128 v[104:107], v9 offset:12288
    s_waitcnt lgkmcnt(2)
    v_add_f32 v68, v68, v92
    v_add_f32 v69, v69, v93
    v_add_f32 v70, v70, v94
    v_add_f32 v71, v71, v95
    v_add_f32 v68, v68, v96
    v_add_f32 v69, v69, v97
    v_add_f32 v70, v70, v98
    v_add_f32 v71, v71, v99
    v_max_u32 v69, s54, v69
    v_max_i32 v69, 0xa0000000, v69
    s_waitcnt lgkmcnt(0)
    v_add_f32 v72, v72, v100
    v_add_f32 v73, v73, v101
    v_add_f32 v74, v74, v102
    v_add_f32 v75, v75, v103
    v_add_f32 v72, v72, v104
    v_add_f32 v73, v73, v105
    v_add_f32 v74, v74, v106
    v_add_f32 v75, v75, v107
    v_cvt_pk_bf16_f32 v92, v68, v69
    v_cvt_pk_bf16_f32 v93, v70, v71
    v_cvt_pk_bf16_f32 v94, v72, v73
    v_cvt_pk_bf16_f32 v95, v74, v75
    v_xor_b32 v92, s54, v92
    s_add_u32 s66, s7, 1052672
    buffer_store_dwordx4 v[92:95], v10, s[44:47], s66 offen sc1
    s_waitcnt vmcnt(1)
    v_xor_b32 v28, s54, v28
    v_xor_b32 v32, s54, v32
    v_xor_b32 v60, s54, v60
    v_xor_b32 v64, s54, v64
    v_xor_b32 v116, s54, v116
    v_xor_b32 v120, s54, v120
    v_xor_b32 v124, s54, v124
    v_xor_b32 v128, s54, v128
    v_min3_f32 v112, |v28|, |v32|, |v60|
    v_min3_f32 v112, v112, |v64|, |v116|
    v_min3_f32 v112, v112, |v120|, |v124|
    v_min_f32 v112, v112, |v128|
    v_max3_f32 v113, |v28|, |v32|, |v60|
    v_max3_f32 v113, v113, |v64|, |v116|
    v_max3_f32 v113, v113, |v120|, |v124|
    v_max_f32 v113, v113, |v128|
    v_cmp_le_f32 s[70:71], s55, v113
    v_cmp_gt_f32 vcc, s54, v112
    s_nop 0
    s_or_b64 vcc, vcc, s[70:71]
    s_cbranch_vccnz L_m_s66
L_m_r67:
    ds_write_b128 v11, v[28:31] offset:0
    ds_write_b128 v11, v[32:35] offset:4096
    ds_write_b128 v11, v[60:63] offset:8192
    ds_write_b128 v11, v[64:67] offset:12288
    s_waitcnt lgkmcnt(0)
    s_barrier
L_m_g11:
    s_cmp_eq_u32 s3, 3
    s_cbranch_scc1 L_m_w368
    ds_read_b64_tr_b16 v[92:93], v12 offset:0
    ds_read_b64_tr_b16 v[94:95], v12 offset:256
    ds_read_b128 v[96:99], v13 offset:0
    ds_read_b64_tr_b16 v[100:101], v12 offset:1024
    ds_read_b64_tr_b16 v[102:103], v12 offset:1280
    ds_read_b128 v[104:107], v13 offset:1024
    ds_read_b64_tr_b16 v[108:109], v12 offset:2048
    ds_read_b64_tr_b16 v[110:111], v12 offset:2304
    s_waitcnt lgkmcnt(6)
    v_mfma_f32_32x32x16_bf16 v[28:43], a[0:3], v[92:95], 0
    ds_write_b128 v11, v[116:119] offset:16384
    s_waitcnt lgkmcnt(6)
    v_mfma_f32_32x32x16_bf16 v[44:59], v[96:99], v[92:95], 0
    ds_read_b128 v[112:115], v13 offset:2048
    ds_write_b128 v11, v[120:123] offset:20480
    s_waitcnt lgkmcnt(6)
    v_mfma_f32_32x32x16_bf16 v[28:43], a[4:7], v[100:103], v[28:43]
    ds_read_b64_tr_b16 v[92:93], v12 offset:3072
    ds_read_b64_tr_b16 v[94:95], v12 offset:3328
    ds_write_b128 v11, v[124:127] offset:24576
    s_waitcnt lgkmcnt(8)
    v_mfma_f32_32x32x16_bf16 v[44:59], v[104:107], v[100:103], v[44:59]
    ds_read_b128 v[96:99], v13 offset:3072
    ds_write_b128 v11, v[128:131] offset:28672
    s_waitcnt lgkmcnt(8)
    v_mfma_f32_32x32x16_bf16 v[28:43], a[8:11], v[108:111], v[28:43]
    ds_read_b64_tr_b16 v[100:101], v12 offset:4096
    ds_read_b64_tr_b16 v[102:103], v12 offset:4352
    s_waitcnt lgkmcnt(8)
    v_mfma_f32_32x32x16_bf16 v[44:59], v[112:115], v[108:111], v[44:59]
    ds_read_b128 v[104:107], v13 offset:4096
    s_waitcnt lgkmcnt(6)
    v_mfma_f32_32x32x16_bf16 v[28:43], a[12:15], v[92:95], v[28:43]
    ds_read_b64_tr_b16 v[108:109], v12 offset:5120
    ds_read_b64_tr_b16 v[110:111], v12 offset:5376
    s_waitcnt lgkmcnt(6)
    v_mfma_f32_32x32x16_bf16 v[44:59], v[96:99], v[92:95], v[44:59]
    ds_read_b128 v[112:115], v13 offset:5120
    s_waitcnt lgkmcnt(4)
    v_mfma_f32_32x32x16_bf16 v[28:43], a[16:19], v[100:103], v[28:43]
    ds_read_b64_tr_b16 v[92:93], v12 offset:6144
    ds_read_b64_tr_b16 v[94:95], v12 offset:6400
    s_waitcnt lgkmcnt(5)
    v_mfma_f32_32x32x16_bf16 v[44:59], v[104:107], v[100:103], v[44:59]
    ds_read_b128 v[96:99], v13 offset:6144
    s_waitcnt lgkmcnt(4)
    v_mfma_f32_32x32x16_bf16 v[28:43], a[20:23], v[108:111], v[28:43]
    ds_read_b64_tr_b16 v[104:105], v12 offset:7168
    ds_read_b64_tr_b16 v[106:107], v12 offset:7424
    s_waitcnt lgkmcnt(5)
    v_mfma_f32_32x32x16_bf16 v[44:59], v[112:115], v[108:111], v[44:59]
    ds_read_b128 v[100:103], v13 offset:7168
    s_barrier
    s_waitcnt lgkmcnt(4)
    v_mfma_f32_32x32x16_bf16 v[28:43], a[24:27], v[92:95], v[28:43]
    ds_read_b64_tr_b16 v[112:113], v12 offset:8192
    ds_read_b64_tr_b16 v[114:115], v12 offset:8448
    s_waitcnt lgkmcnt(5)
    v_mfma_f32_32x32x16_bf16 v[44:59], v[96:99], v[92:95], v[44:59]
    ds_read_b128 v[108:111], v13 offset:8192
    s_waitcnt lgkmcnt(4)
    v_mfma_f32_32x32x16_bf16 v[28:43], a[28:31], v[104:107], v[28:43]
    ds_read_b64_tr_b16 v[92:93], v12 offset:9216
    ds_read_b64_tr_b16 v[94:95], v12 offset:9472
    ds_read_b128 v[148:151], v19 offset:0
    s_waitcnt lgkmcnt(6)
    v_mfma_f32_32x32x16_bf16 v[44:59], v[100:103], v[104:107], v[44:59]
    ds_read_b128 v[96:99], v13 offset:9216
    s_waitcnt lgkmcnt(5)
    v_mfma_f32_32x32x16_bf16 v[28:43], a[32:35], v[112:115], v[28:43]
    ds_read_b64_tr_b16 v[104:105], v12 offset:10240
    ds_read_b64_tr_b16 v[106:107], v12 offset:10496
    s_waitcnt lgkmcnt(6)
    v_mfma_f32_32x32x16_bf16 v[44:59], v[108:111], v[112:115], v[44:59]
    ds_read_b128 v[100:103], v13 offset:10240
    s_waitcnt lgkmcnt(5)
    v_mfma_f32_32x32x16_bf16 v[28:43], a[36:39], v[92:95], v[28:43]
    ds_read_b64_tr_b16 v[112:113], v12 offset:11264
    ds_read_b64_tr_b16 v[114:115], v12 offset:11520
    s_waitcnt lgkmcnt(5)
    v_mfma_f32_32x32x16_bf16 v[44:59], v[96:99], v[92:95], v[44:59]
    ds_read_b128 v[108:111], v13 offset:11264
    s_waitcnt lgkmcnt(4)
    v_mfma_f32_32x32x16_bf16 v[28:43], a[40:43], v[104:107], v[28:43]
    ds_read_b64_tr_b16 v[92:93], v12 offset:12288
    ds_read_b64_tr_b16 v[94:95], v12 offset:12544
    v_perm_b32 v158, v150, v148, s18
    v_perm_b32 v159, v150, v148, s19
    v_perm_b32 v150, v151, v149, s18
    s_waitcnt lgkmcnt(5)
    v_mfma_f32_32x32x16_bf16 v[44:59], v[100:103], v[104:107], v[44:59]
    ds_read_b128 v[96:99], v13 offset:12288
    v_perm_b32 v151, v151, v149, s19
    v_mov_b32 v148, v158
    v_mov_b32 v149, v159
    v_permlane16_swap_b32 v150, v151
    s_waitcnt lgkmcnt(4)
    v_mfma_f32_32x32x16_bf16 v[28:43], a[44:47], v[112:115], v[28:43]
    ds_read_b64_tr_b16 v[100:101], v12 offset:13312
    ds_read_b64_tr_b16 v[102:103], v12 offset:13568
    v_permlane16_swap_b32 v148, v149
    s_nop 1
    v_permlane32_swap_b32 v148, v150
    v_permlane32_swap_b32 v149, v151
    s_waitcnt lgkmcnt(5)
    v_mfma_f32_32x32x16_bf16 v[44:59], v[108:111], v[112:115], v[44:59]
    ds_read_b128 v[104:107], v13 offset:13312
    s_waitcnt lgkmcnt(4)
    v_mfma_f32_32x32x16_bf16 v[28:43], a[48:51], v[92:95], v[28:43]
    ds_read_b64_tr_b16 v[108:109], v12 offset:14336
    ds_read_b64_tr_b16 v[110:111], v12 offset:14592
    s_waitcnt lgkmcnt(5)
    v_mfma_f32_32x32x16_bf16 v[44:59], v[96:99], v[92:95], v[44:59]
    ds_read_b128 v[112:115], v13 offset:14336
    s_waitcnt lgkmcnt(4)
    v_mfma_f32_32x32x16_bf16 v[28:43], a[52:55], v[100:103], v[28:43]
    ds_read_b64_tr_b16 v[92:93], v12 offset:15360
    ds_read_b64_tr_b16 v[94:95], v12 offset:15616
    s_waitcnt lgkmcnt(5)
    v_mfma_f32_32x32x16_bf16 v[44:59], v[104:107], v[100:103], v[44:59]
    ds_read_b128 v[96:99], v13 offset:15360
    s_waitcnt lgkmcnt(4)
    v_mfma_f32_32x32x16_bf16 v[28:43], a[56:59], v[108:111], v[28:43]
    ds_read_b64_tr_b16 v[100:101], v12 offset:16384
    ds_read_b64_tr_b16 v[102:103], v12 offset:16640
    s_waitcnt lgkmcnt(5)
    v_mfma_f32_32x32x16_bf16 v[44:59], v[112:115], v[108:111], v[44:59]
    ds_read_b128 v[104:107], v13 offset:16384
    s_waitcnt lgkmcnt(4)
    v_mfma_f32_32x32x16_bf16 v[28:43], a[60:63], v[92:95], v[28:43]
    ds_read_b64_tr_b16 v[108:109], v12 offset:17408
    ds_read_b64_tr_b16 v[110:111], v12 offset:17664
    s_waitcnt lgkmcnt(5)
    v_mfma_f32_32x32x16_bf16 v[44:59], v[96:99], v[92:95], v[44:59]
    ds_read_b128 v[112:115], v13 offset:17408
    s_waitcnt lgkmcnt(4)
    v_mfma_f32_32x32x16_bf16 v[28:43], a[64:67], v[100:103], v[28:43]
    ds_read_b64_tr_b16 v[96:97], v12 offset:18432
    ds_read_b64_tr_b16 v[98:99], v12 offset:18688
    s_waitcnt lgkmcnt(5)
    v_mfma_f32_32x32x16_bf16 v[44:59], v[104:107], v[100:103], v[44:59]
    ds_read_b128 v[92:95], v13 offset:18432
    s_waitcnt lgkmcnt(4)
    v_mfma_f32_32x32x16_bf16 v[28:43], a[68:71], v[108:111], v[28:43]
    ds_read_b64_tr_b16 v[104:105], v12 offset:19456
    ds_read_b64_tr_b16 v[106:107], v12 offset:19712
    s_waitcnt lgkmcnt(5)
    v_mfma_f32_32x32x16_bf16 v[44:59], v[112:115], v[108:111], v[44:59]
    ds_read_b128 v[100:103], v13 offset:19456
    s_waitcnt lgkmcnt(4)
    v_mfma_f32_32x32x16_bf16 v[28:43], a[72:75], v[96:99], v[28:43]
    ds_read_b64_tr_b16 v[108:109], v12 offset:20480
    ds_read_b64_tr_b16 v[110:111], v12 offset:20736
    s_add_u32 s64, s8, 3215360
    buffer_load_dwordx4 v[60:63], v2, s[44:47], s64 offen sc1
    s_waitcnt lgkmcnt(5)
    v_mfma_f32_32x32x16_bf16 v[44:59], v[92:95], v[96:99], v[44:59]
    ds_read_b128 v[112:115], v13 offset:20480
    s_add_u32 s64, s8, 3219456
    buffer_load_dwordx4 v[64:67], v2, s[44:47], s64 offen sc1
    s_add_u32 s64, s8, 3223552
    buffer_load_dwordx4 v[68:71], v2, s[44:47], s64 offen sc1
    s_waitcnt lgkmcnt(4)
    v_mfma_f32_32x32x16_bf16 v[28:43], a[76:79], v[104:107], v[28:43]
    ds_read_b64_tr_b16 v[96:97], v12 offset:21504
    ds_read_b64_tr_b16 v[98:99], v12 offset:21760
    s_add_u32 s64, s8, 3227648
    buffer_load_dwordx4 v[72:75], v2, s[44:47], s64 offen sc1
    s_waitcnt lgkmcnt(5)
    v_mfma_f32_32x32x16_bf16 v[44:59], v[100:103], v[104:107], v[44:59]
    ds_read_b128 v[92:95], v13 offset:21504
    s_add_u32 s64, s8, 3231744
    buffer_load_dwordx4 v[76:79], v2, s[44:47], s64 offen sc1
    s_add_u32 s64, s8, 3235840
    buffer_load_dwordx4 v[80:83], v2, s[44:47], s64 offen sc1
    s_waitcnt lgkmcnt(4)
    v_mfma_f32_32x32x16_bf16 v[28:43], a[80:83], v[108:111], v[28:43]
    ds_read_b64_tr_b16 v[104:105], v12 offset:22528
    ds_read_b64_tr_b16 v[106:107], v12 offset:22784
    s_add_u32 s64, s8, 3239936
    buffer_load_dwordx4 v[84:87], v2, s[44:47], s64 offen sc1
    s_waitcnt lgkmcnt(5)
    v_mfma_f32_32x32x16_bf16 v[44:59], v[112:115], v[108:111], v[44:59]
    ds_read_b128 v[100:103], v13 offset:22528
    s_add_u32 s64, s8, 3244032
    buffer_load_dwordx4 v[88:91], v2, s[44:47], s64 offen sc1
    s_waitcnt lgkmcnt(4)
    v_mfma_f32_32x32x16_bf16 v[28:43], a[84:87], v[96:99], v[28:43]
    ds_read_b64_tr_b16 v[108:109], v12 offset:23552
    ds_read_b64_tr_b16 v[110:111], v12 offset:23808
    s_waitcnt lgkmcnt(5)
    v_mfma_f32_32x32x16_bf16 v[44:59], v[92:95], v[96:99], v[44:59]
    ds_read_b128 v[112:115], v13 offset:23552
    s_waitcnt lgkmcnt(4)
    v_mfma_f32_32x32x16_bf16 v[28:43], a[88:91], v[104:107], v[28:43]
    ds_read_b64_tr_b16 v[92:93], v12 offset:24576
    ds_read_b64_tr_b16 v[94:95], v12 offset:24832
    s_waitcnt lgkmcnt(5)
    v_mfma_f32_32x32x16_bf16 v[44:59], v[100:103], v[104:107], v[44:59]
    ds_read_b128 v[96:99], v13 offset:24576
    s_waitcnt lgkmcnt(4)
    v_mfma_f32_32x32x16_bf16 v[28:43], a[92:95], v[108:111], v[28:43]
    ds_read_b64_tr_b16 v[100:101], v12 offset:25600
    ds_read_b64_tr_b16 v[102:103], v12 offset:25856
    s_waitcnt lgkmcnt(5)
    v_mfma_f32_32x32x16_bf16 v[44:59], v[112:115], v[108:111], v[44:59]
    ds_read_b128 v[104:107], v13 offset:25600
    s_waitcnt lgkmcnt(4)
    v_mfma_f32_32x32x16_bf16 v[28:43], a[96:99], v[92:95], v[28:43]
    ds_read_b64_tr_b16 v[108:109], v12 offset:26624
    ds_read_b64_tr_b16 v[110:111], v12 offset:26880
    s_waitcnt lgkmcnt(5)
    v_mfma_f32_32x32x16_bf16 v[44:59], v[96:99], v[92:95], v[44:59]
    ds_read_b128 v[112:115], v13 offset:26624
    s_waitcnt lgkmcnt(4)
    v_mfma_f32_32x32x16_bf16 v[28:43], a[100:103], v[100:103], v[28:43]
    ds_read_b64_tr_b16 v[92:93], v12 offset:27648
    ds_read_b64_tr_b16 v[94:95], v12 offset:27904
    s_waitcnt lgkmcnt(5)
    v_mfma_f32_32x32x16_bf16 v[44:59], v[104:107], v[100:103], v[44:59]
    ds_read_b128 v[96:99], v13 offset:27648
    s_waitcnt lgkmcnt(4)
    v_mfma_f32_32x32x16_bf16 v[28:43], a[104:107], v[108:111], v[28:43]
    ds_read_b64_tr_b16 v[100:101], v12 offset:28672
    ds_read_b64_tr_b16 v[102:103], v12 offset:28928
    s_waitcnt lgkmcnt(5)
    v_mfma_f32_32x32x16_bf16 v[44:59], v[112:115], v[108:111], v[44:59]
    ds_read_b128 v[104:107], v13 offset:28672
    s_waitcnt lgkmcnt(4)
    v_mfma_f32_32x32x16_bf16 v[28:43], a[108:111], v[92:95], v[28:43]
    ds_read_b64_tr_b16 v[108:109], v12 offset:29696
    ds_read_b64_tr_b16 v[110:111], v12 offset:29952
    s_waitcnt lgkmcnt(5)
    v_mfma_f32_32x32x16_bf16 v[44:59], v[96:99], v[92:95], v[44:59]
    ds_read_b128 v[112:115], v13 offset:29696
    s_waitcnt lgkmcnt(4)
    v_mfma_f32_32x32x16_bf16 v[28:43], a[112:115], v[100:103], v[28:43]
    ds_read_b64_tr_b16 v[96:97], v12 offset:30720
    ds_read_b64_tr_b16 v[98:99], v12 offset:30976
    s_waitcnt lgkmcnt(5)
    v_mfma_f32_32x32x16_bf16 v[44:59], v[104:107], v[100:103], v[44:59]
    ds_read_b128 v[92:95], v13 offset:30720
    s_waitcnt lgkmcnt(4)
    v_mfma_f32_32x32x16_bf16 v[28:43], a[116:119], v[108:111], v[28:43]
    ds_read_b64_tr_b16 v[104:105], v12 offset:31744
    ds_read_b64_tr_b16 v[106:107], v12 offset:32000
    s_waitcnt vmcnt(0)
    v_xor_b32 v60, s54, v60
    v_xor_b32 v64, s54, v64
    v_xor_b32 v68, s54, v68
    v_xor_b32 v72, s54, v72
    v_xor_b32 v76, s54, v76
    v_xor_b32 v80, s54, v80
    v_xor_b32 v84, s54, v84
    v_xor_b32 v88, s54, v88
    v_min3_f32 v136, |v60|, |v64|, |v68|
    v_min3_f32 v136, v136, |v72|, |v76|
    v_min3_f32 v136, v136, |v80|, |v84|
    v_min_f32 v136, v136, |v88|
    v_max3_f32 v137, |v60|, |v64|, |v68|
    v_max3_f32 v137, v137, |v72|, |v76|
    v_max3_f32 v137, v137, |v80|, |v84|
    v_max_f32 v137, v137, |v88|
    v_cmp_le_f32 s[70:71], s55, v137
    v_cmp_gt_f32 vcc, s54, v136
    s_nop 0
    s_or_b64 vcc, vcc, s[70:71]
    s_cbranch_vccnz L_m_s70
L_m_r71:
    s_waitcnt lgkmcnt(5)
    v_mfma_f32_32x32x16_bf16 v[44:59], v[112:115], v[108:111], v[44:59]
    ds_write_b128 v11, v[60:63] offset:32768
    ds_write_b128 v11, v[64:67] offset:36864
    s_waitcnt lgkmcnt(5)
    v_mfma_f32_32x32x16_bf16 v[28:43], a[120:123], v[96:99], v[28:43]
    ds_write_b128 v11, v[68:71] offset:40960
    ds_write_b128 v11, v[72:75] offset:45056
    s_waitcnt lgkmcnt(6)
    v_mfma_f32_32x32x16_bf16 v[44:59], v[92:95], v[96:99], v[44:59]
    ds_write_b128 v11, v[76:79] offset:49152
    ds_write_b128 v11, v[80:83] offset:53248
    s_waitcnt lgkmcnt(6)
    v_mfma_f32_32x32x16_bf16 v[28:43], a[124:127], v[104:107], v[28:43]
    ds_write_b128 v11, v[84:87] offset:57344
    ds_write_b128 v11, v[88:91] offset:61440
    v_mfma_f32_32x32x16_bf16 v[44:59], v[24:27], v[104:107], v[44:59]
    s_waitcnt lgkmcnt(0)
    s_barrier
    ds_read_b64_tr_b16 v[92:93], v12 offset:32768
    ds_read_b64_tr_b16 v[94:95], v12 offset:33024
    ds_read_b128 v[96:99], v13 offset:0
    ds_read_b64_tr_b16 v[100:101], v12 offset:33792
    ds_read_b64_tr_b16 v[102:103], v12 offset:34048
    ds_read_b128 v[104:107], v13 offset:1024
    ds_read_b64_tr_b16 v[108:109], v12 offset:34816
    ds_read_b64_tr_b16 v[110:111], v12 offset:35072
    s_waitcnt lgkmcnt(6)
    v_mfma_f32_32x32x16_bf16 v[60:75], a[0:3], v[92:95], 0
    ds_read_b128 v[152:155], v19 offset:32768
    ds_read_b64 v[156:157], v15 offset:0
    ds_read_b128 v[116:119], v14 offset:0
    ds_read_b128 v[120:123], v14 offset:32
    ds_read_b128 v[124:127], v14 offset:896
    s_waitcnt lgkmcnt(10)
    v_mfma_f32_32x32x16_bf16 v[76:91], v[96:99], v[92:95], 0
    ds_read_b128 v[112:115], v13 offset:2048
    ds_read_b128 v[128:131], v14 offset:928
    ds_read_b128 v[132:135], v14 offset:64
    ds_read_b128 v[136:139], v14 offset:96
    ds_read_b128 v[140:143], v14 offset:960
    s_waitcnt lgkmcnt(13)
    v_mfma_f32_32x32x16_bf16 v[60:75], a[4:7], v[100:103], v[60:75]
    ds_read_b64_tr_b16 v[96:97], v12 offset:35840
    ds_read_b128 v[144:147], v14 offset:992
    s_waitcnt lgkmcnt(5)
    v_fmac_f32 v124, v116, v157
    v_fmac_f32 v125, v117, v157
    v_mfma_f32_32x32x16_bf16 v[76:91], v[104:107], v[100:103], v[76:91]
    ds_read_b64_tr_b16 v[98:99], v12 offset:36096
    ds_read_b128 v[92:95], v13 offset:3072
    v_fmac_f32 v126, v118, v157
    v_fmac_f32 v127, v119, v157
    v_fmac_f32 v128, v120, v157
    v_fmac_f32 v129, v121, v157
    v_mfma_f32_32x32x16_bf16 v[60:75], a[8:11], v[108:111], v[60:75]
    ds_read_b64_tr_b16 v[100:101], v12 offset:36864
    ds_read_b64_tr_b16 v[102:103], v12 offset:37120
    v_fmac_f32 v130, v122, v157
    v_fmac_f32 v131, v123, v157
    v_fmac_f32 v124, v28, v156
    v_fmac_f32 v125, v29, v156
    v_mfma_f32_32x32x16_bf16 v[76:91], v[112:115], v[108:111], v[76:91]
    ds_read_b128 v[104:107], v13 offset:4096
    v_fmac_f32 v126, v30, v156
    v_fmac_f32 v127, v31, v156
    v_fmac_f32 v128, v32, v156
    v_fmac_f32 v129, v33, v156
    v_fmac_f32 v130, v34, v156
    s_waitcnt lgkmcnt(4)
    v_mfma_f32_32x32x16_bf16 v[60:75], a[12:15], v[96:99], v[60:75]
    ds_read_b64_tr_b16 v[108:109], v12 offset:37888
    ds_read_b64_tr_b16 v[110:111], v12 offset:38144
    v_fmac_f32 v131, v35, v156
    v_exp_f32 v28, v124
    s_waitcnt lgkmcnt(5)
    v_mfma_f32_32x32x16_bf16 v[76:91], v[92:95], v[96:99], v[76:91]
    ds_read_b128 v[112:115], v13 offset:5120
    v_exp_f32 v29, v125
    v_exp_f32 v30, v126
    s_waitcnt lgkmcnt(4)
    v_mfma_f32_32x32x16_bf16 v[60:75], a[16:19], v[100:103], v[60:75]
    ds_read_b64_tr_b16 v[96:97], v12 offset:38912
    ds_read_b64_tr_b16 v[98:99], v12 offset:39168
    v_exp_f32 v31, v127
    v_exp_f32 v32, v128
    s_waitcnt lgkmcnt(5)
    v_mfma_f32_32x32x16_bf16 v[76:91], v[104:107], v[100:103], v[76:91]
    ds_read_b128 v[92:95], v13 offset:6144
    v_exp_f32 v33, v129
    v_exp_f32 v34, v130
    s_waitcnt lgkmcnt(4)
    v_mfma_f32_32x32x16_bf16 v[60:75], a[20:23], v[108:111], v[60:75]
    ds_read_b64_tr_b16 v[100:101], v12 offset:39936
    ds_read_b64_tr_b16 v[102:103], v12 offset:40192
    v_exp_f32 v35, v131
    v_fma_f32 v116, v28, 0.5, 1.0
    s_waitcnt lgkmcnt(5)
    v_mfma_f32_32x32x16_bf16 v[76:91], v[112:115], v[108:111], v[76:91]
    ds_read_b128 v[104:107], v13 offset:7168
    v_fma_f32 v117, v29, 0.5, 1.0
    v_fma_f32 v118, v30, 0.5, 1.0
    v_fma_f32 v119, v31, 0.5, 1.0
    v_fma_f32 v120, v32, 0.5, 1.0
    s_waitcnt lgkmcnt(4)
    v_mfma_f32_32x32x16_bf16 v[60:75], a[24:27], v[96:99], v[60:75]
    ds_read_b64_tr_b16 v[112:113], v12 offset:40960
    ds_read_b64_tr_b16 v[114:115], v12 offset:41216
    v_fma_f32 v121, v33, 0.5, 1.0
    v_fma_f32 v122, v34, 0.5, 1.0
    v_fma_f32 v123, v35, 0.5, 1.0
    s_waitcnt lgkmcnt(5)
    v_mfma_f32_32x32x16_bf16 v[76:91], v[92:95], v[96:99], v[76:91]
    ds_read_b128 v[108:111], v13 offset:8192
    v_fma_f32 v28, -v28, v116, -1.0
    v_fma_f32 v29, -v29, v117, -1.0
    v_fma_f32 v30, -v30, v118, -1.0
    v_fma_f32 v31, -v31, v119, -1.0
    s_waitcnt lgkmcnt(4)
    v_mfma_f32_32x32x16_bf16 v[60:75], a[28:31], v[100:103], v[60:75]
    ds_read_b64_tr_b16 v[92:93], v12 offset:41984
    ds_read_b64_tr_b16 v[94:95], v12 offset:42240
    v_fma_f32 v32, -v32, v120, -1.0
    v_fma_f32 v33, -v33, v121, -1.0
    v_fma_f32 v34, -v34, v122, -1.0
    s_waitcnt lgkmcnt(5)
    v_mfma_f32_32x32x16_bf16 v[76:91], v[104:107], v[100:103], v[76:91]
    ds_read_b128 v[96:99], v13 offset:9216
    v_fma_f32 v35, -v35, v123, -1.0
    v_rcp_f32 v28, v28
    v_rcp_f32 v29, v29
    s_waitcnt lgkmcnt(4)
    v_mfma_f32_32x32x16_bf16 v[60:75], a[32:35], v[112:115], v[60:75]
    ds_read_b64_tr_b16 v[100:101], v12 offset:43008
    ds_read_b64_tr_b16 v[102:103], v12 offset:43264
    v_rcp_f32 v30, v30
    v_rcp_f32 v31, v31
    s_waitcnt lgkmcnt(5)
    v_mfma_f32_32x32x16_bf16 v[76:91], v[108:111], v[112:115], v[76:91]
    ds_read_b128 v[104:107], v13 offset:10240
    v_rcp_f32 v32, v32
    v_rcp_f32 v33, v33
    s_waitcnt lgkmcnt(4)
    v_mfma_f32_32x32x16_bf16 v[60:75], a[36:39], v[92:95], v[60:75]
    ds_read_b64_tr_b16 v[112:113], v12 offset:44032
    ds_read_b64_tr_b16 v[114:115], v12 offset:44288
    v_rcp_f32 v34, v34
    v_rcp_f32 v35, v35
    s_waitcnt lgkmcnt(5)
    v_mfma_f32_32x32x16_bf16 v[76:91], v[96:99], v[92:95], v[76:91]
    ds_read_b128 v[108:111], v13 offset:11264
    v_fmac_f32 v124, v28, v124
    v_fmac_f32 v125, v29, v125
    v_fmac_f32 v126, v30, v126
    v_fmac_f32 v127, v31, v127
    s_waitcnt lgkmcnt(4)
    v_mfma_f32_32x32x16_bf16 v[60:75], a[40:43], v[100:103], v[60:75]
    ds_read_b64_tr_b16 v[92:93], v12 offset:45056
    ds_read_b64_tr_b16 v[94:95], v12 offset:45312
    v_fmac_f32 v128, v32, v128
    v_fmac_f32 v129, v33, v129
    v_fmac_f32 v130, v34, v130
    s_waitcnt lgkmcnt(5)
    v_mfma_f32_32x32x16_bf16 v[76:91], v[104:107], v[100:103], v[76:91]
    ds_read_b128 v[96:99], v13 offset:12288
    v_fmac_f32 v131, v35, v131
    v_max_u32 v125, s54, v125
    v_max_i32 v125, 0xa0000000, v125
    v_cvt_pk_bf16_f32 v117, v126, v127
    s_waitcnt lgkmcnt(4)
    v_mfma_f32_32x32x16_bf16 v[60:75], a[44:47], v[112:115], v[60:75]
    ds_read_b64_tr_b16 v[104:105], v12 offset:46080
    ds_read_b64_tr_b16 v[106:107], v12 offset:46336
    v_cvt_pk_bf16_f32 v118, v128, v129
    v_cvt_pk_bf16_f32 v119, v130, v131
    v_cvt_pk_bf16_f32 v116, v124, v125
    s_waitcnt lgkmcnt(5)
    v_mfma_f32_32x32x16_bf16 v[76:91], v[108:111], v[112:115], v[76:91]
    ds_read_b128 v[100:103], v13 offset:13312
    v_xor_b32 v116, s54, v116
    s_add_u32 s66, s9, 0
    buffer_store_dwordx4 v[116:119], v2, s[44:47], s66 offen offset:0 sc1
    s_waitcnt lgkmcnt(4)
    v_mfma_f32_32x32x16_bf16 v[60:75], a[48:51], v[92:95], v[60:75]
    ds_read_b64_tr_b16 v[108:109], v12 offset:47104
    ds_read_b64_tr_b16 v[110:111], v12 offset:47360
    ds_read_b128 v[116:119], v14 offset:512
    ds_read_b128 v[120:123], v14 offset:544
    ds_read_b128 v[124:127], v14 offset:1408
    s_waitcnt lgkmcnt(8)
    v_mfma_f32_32x32x16_bf16 v[76:91], v[96:99], v[92:95], v[76:91]
    ds_read_b128 v[112:115], v13 offset:14336
    ds_read_b128 v[128:131], v14 offset:1440
    v_fmac_f32 v140, v132, v157
    v_fmac_f32 v141, v133, v157
    v_fmac_f32 v142, v134, v157
    s_waitcnt lgkmcnt(8)
    v_mfma_f32_32x32x16_bf16 v[60:75], a[52:55], v[104:107], v[60:75]
    ds_read_b64_tr_b16 v[92:93], v12 offset:48128
    ds_read_b64_tr_b16 v[94:95], v12 offset:48384
    v_fmac_f32 v143, v135, v157
    v_fmac_f32 v144, v136, v157
    v_fmac_f32 v145, v137, v157
    s_waitcnt lgkmcnt(9)
    v_mfma_f32_32x32x16_bf16 v[76:91], v[100:103], v[104:107], v[76:91]
    ds_read_b128 v[96:99], v13 offset:15360
    v_fmac_f32 v146, v138, v157
    v_fmac_f32 v147, v139, v157
    v_fmac_f32 v140, v36, v156
    v_fmac_f32 v141, v37, v156
    s_waitcnt lgkmcnt(8)
    v_mfma_f32_32x32x16_bf16 v[60:75], a[56:59], v[108:111], v[60:75]
    ds_read_b64_tr_b16 v[104:105], v12 offset:49152
    ds_read_b64_tr_b16 v[106:107], v12 offset:49408
    v_fmac_f32 v142, v38, v156
    v_fmac_f32 v143, v39, v156
    v_fmac_f32 v144, v40, v156
    s_waitcnt lgkmcnt(6)
    v_mfma_f32_32x32x16_bf16 v[76:91], v[112:115], v[108:111], v[76:91]
    ds_read_b128 v[100:103], v13 offset:16384
    v_fmac_f32 v145, v41, v156
    v_fmac_f32 v146, v42, v156
    v_fmac_f32 v147, v43, v156
    v_exp_f32 v36, v140
    s_waitcnt lgkmcnt(4)
    v_mfma_f32_32x32x16_bf16 v[60:75], a[60:63], v[92:95], v[60:75]
    ds_read_b64_tr_b16 v[108:109], v12 offset:50176
    ds_read_b64_tr_b16 v[110:111], v12 offset:50432
    v_exp_f32 v37, v141
    v_exp_f32 v38, v142
    s_waitcnt lgkmcnt(5)
    v_mfma_f32_32x32x16_bf16 v[76:91], v[96:99], v[92:95], v[76:91]
    ds_read_b128 v[112:115], v13 offset:17408
    v_exp_f32 v39, v143
    v_exp_f32 v40, v144
    s_waitcnt lgkmcnt(4)
    v_mfma_f32_32x32x16_bf16 v[60:75], a[64:67], v[104:107], v[60:75]
    ds_read_b64_tr_b16 v[92:93], v12 offset:51200
    ds_read_b64_tr_b16 v[94:95], v12 offset:51456
    v_exp_f32 v41, v145
    v_exp_f32 v42, v146
    s_waitcnt lgkmcnt(5)
    v_mfma_f32_32x32x16_bf16 v[76:91], v[100:103], v[104:107], v[76:91]
    ds_read_b128 v[96:99], v13 offset:18432
    v_exp_f32 v43, v147
    v_fma_f32 v132, v36, 0.5, 1.0
    v_fma_f32 v133, v37, 0.5, 1.0
    s_waitcnt lgkmcnt(4)
    v_mfma_f32_32x32x16_bf16 v[60:75], a[68:71], v[108:111], v[60:75]
    ds_read_b64_tr_b16 v[100:101], v12 offset:52224
    ds_read_b64_tr_b16 v[102:103], v12 offset:52480
    v_fma_f32 v134, v38, 0.5, 1.0
    v_fma_f32 v135, v39, 0.5, 1.0
    v_fma_f32 v136, v40, 0.5, 1.0
    s_waitcnt lgkmcnt(5)
    v_mfma_f32_32x32x16_bf16 v[76:91], v[112:115], v[108:111], v[76:91]
    ds_read_b128 v[104:107], v13 offset:19456
    v_fma_f32 v137, v41, 0.5, 1.0
    v_fma_f32 v138, v42, 0.5, 1.0
    v_fma_f32 v139, v43, 0.5, 1.0
    v_fma_f32 v36, -v36, v132, -1.0
    s_waitcnt lgkmcnt(4)
    v_mfma_f32_32x32x16_bf16 v[60:75], a[72:75], v[92:95], v[60:75]
    ds_read_b64_tr_b16 v[112:113], v12 offset:53248
    ds_read_b64_tr_b16 v[114:115], v12 offset:53504
    v_fma_f32 v37, -v37, v133, -1.0
    v_fma_f32 v38, -v38, v134, -1.0
    v_fma_f32 v39, -v39, v135, -1.0
    s_waitcnt lgkmcnt(5)
    v_mfma_f32_32x32x16_bf16 v[76:91], v[96:99], v[92:95], v[76:91]
    ds_read_b128 v[108:111], v13 offset:20480
    v_fma_f32 v40, -v40, v136, -1.0
    v_fma_f32 v41, -v41, v137, -1.0
    v_fma_f32 v42, -v42, v138, -1.0
    v_fma_f32 v43, -v43, v139, -1.0
    s_waitcnt lgkmcnt(4)
    v_mfma_f32_32x32x16_bf16 v[60:75], a[76:79], v[100:103], v[60:75]
    ds_read_b64_tr_b16 v[92:93], v12 offset:54272
    ds_read_b64_tr_b16 v[94:95], v12 offset:54528
    v_rcp_f32 v36, v36
    v_rcp_f32 v37, v37
    s_waitcnt lgkmcnt(5)
    v_mfma_f32_32x32x16_bf16 v[76:91], v[104:107], v[100:103], v[76:91]
    ds_read_b128 v[96:99], v13 offset:21504
    v_rcp_f32 v38, v38
    v_rcp_f32 v39, v39
    s_waitcnt lgkmcnt(4)
    v_mfma_f32_32x32x16_bf16 v[60:75], a[80:83], v[112:115], v[60:75]
    ds_read_b64_tr_b16 v[100:101], v12 offset:55296
    ds_read_b64_tr_b16 v[102:103], v12 offset:55552
    v_rcp_f32 v40, v40
    v_rcp_f32 v41, v41
    s_waitcnt lgkmcnt(5)
    v_mfma_f32_32x32x16_bf16 v[76:91], v[108:111], v[112:115], v[76:91]
    ds_read_b128 v[104:107], v13 offset:22528
    v_rcp_f32 v42, v42
    v_rcp_f32 v43, v43
    s_waitcnt lgkmcnt(4)
    v_mfma_f32_32x32x16_bf16 v[60:75], a[84:87], v[92:95], v[60:75]
    ds_read_b64_tr_b16 v[112:113], v12 offset:56320
    ds_read_b64_tr_b16 v[114:115], v12 offset:56576
    v_fmac_f32 v140, v36, v140
    v_fmac_f32 v141, v37, v141
    v_fmac_f32 v142, v38, v142
    s_waitcnt lgkmcnt(5)
    v_mfma_f32_32x32x16_bf16 v[76:91], v[96:99], v[92:95], v[76:91]
    ds_read_b128 v[108:111], v13 offset:23552
    v_fmac_f32 v143, v39, v143
    v_fmac_f32 v144, v40, v144
    v_fmac_f32 v145, v41, v145
    v_fmac_f32 v146, v42, v146
    s_waitcnt lgkmcnt(4)
    v_mfma_f32_32x32x16_bf16 v[60:75], a[88:91], v[100:103], v[60:75]
    ds_read_b64_tr_b16 v[92:93], v12 offset:57344
    ds_read_b64_tr_b16 v[94:95], v12 offset:57600
    v_fmac_f32 v147, v43, v147
    v_max_u32 v141, s54, v141
    v_max_i32 v141, 0xa0000000, v141
    s_waitcnt lgkmcnt(5)
    v_mfma_f32_32x32x16_bf16 v[76:91], v[104:107], v[100:103], v[76:91]
    ds_read_b128 v[96:99], v13 offset:24576
    v_cvt_pk_bf16_f32 v133, v142, v143
    v_cvt_pk_bf16_f32 v134, v144, v145
    v_cvt_pk_bf16_f32 v135, v146, v147
    v_cvt_pk_bf16_f32 v132, v140, v141
    s_waitcnt lgkmcnt(4)
    v_mfma_f32_32x32x16_bf16 v[60:75], a[92:95], v[112:115], v[60:75]
    ds_read_b64_tr_b16 v[104:105], v12 offset:58368
    ds_read_b64_tr_b16 v[106:107], v12 offset:58624
    v_xor_b32 v132, s54, v132
    s_add_u32 s66, s9, 0
    buffer_store_dwordx4 v[132:135], v2, s[44:47], s66 offen offset:1024 sc1
    s_waitcnt lgkmcnt(5)
    v_mfma_f32_32x32x16_bf16 v[76:91], v[108:111], v[112:115], v[76:91]
    ds_read_b128 v[100:103], v13 offset:25600
    ds_read_b128 v[132:135], v14 offset:576
    ds_read_b128 v[136:139], v14 offset:608
    ds_read_b128 v[140:143], v14 offset:1472
    ds_read_b128 v[144:147], v14 offset:1504
    s_waitcnt lgkmcnt(8)
    v_mfma_f32_32x32x16_bf16 v[60:75], a[96:99], v[92:95], v[60:75]
    ds_read_b64_tr_b16 v[108:109], v12 offset:59392
    ds_read_b64_tr_b16 v[110:111], v12 offset:59648
    v_fmac_f32 v124, v116, v157
    v_fmac_f32 v125, v117, v157
    v_fmac_f32 v126, v118, v157
    s_waitcnt lgkmcnt(9)
    v_mfma_f32_32x32x16_bf16 v[76:91], v[96:99], v[92:95], v[76:91]
    ds_read_b128 v[112:115], v13 offset:26624
    v_fmac_f32 v127, v119, v157
    v_fmac_f32 v128, v120, v157
    v_fmac_f32 v129, v121, v157
    v_fmac_f32 v130, v122, v157
    s_waitcnt lgkmcnt(8)
    v_mfma_f32_32x32x16_bf16 v[60:75], a[100:103], v[104:107], v[60:75]
    ds_read_b64_tr_b16 v[92:93], v12 offset:60416
    ds_read_b64_tr_b16 v[94:95], v12 offset:60672
    v_fmac_f32 v131, v123, v157
    v_fmac_f32 v124, v44, v156
    v_fmac_f32 v125, v45, v156
    s_waitcnt lgkmcnt(9)
    v_mfma_f32_32x32x16_bf16 v[76:91], v[100:103], v[104:107], v[76:91]
    ds_read_b128 v[96:99], v13 offset:27648
    v_fmac_f32 v126, v46, v156
    v_fmac_f32 v127, v47, v156
    v_fmac_f32 v128, v48, v156
    v_fmac_f32 v129, v49, v156
    s_waitcnt lgkmcnt(4)
    v_mfma_f32_32x32x16_bf16 v[60:75], a[104:107], v[108:111], v[60:75]
    ds_read_b64_tr_b16 v[104:105], v12 offset:61440
    ds_read_b64_tr_b16 v[106:107], v12 offset:61696
    v_fmac_f32 v130, v50, v156
    v_fmac_f32 v131, v51, v156
    v_exp_f32 v44, v124
    s_waitcnt lgkmcnt(5)
    v_mfma_f32_32x32x16_bf16 v[76:91], v[112:115], v[108:111], v[76:91]
    ds_read_b128 v[100:103], v13 offset:28672
    v_exp_f32 v45, v125
    v_exp_f32 v46, v126
    s_waitcnt lgkmcnt(4)
    v_mfma_f32_32x32x16_bf16 v[60:75], a[108:111], v[92:95], v[60:75]
    ds_read_b64_tr_b16 v[108:109], v12 offset:62464
    ds_read_b64_tr_b16 v[110:111], v12 offset:62720
    v_exp_f32 v47, v127
    v_exp_f32 v48, v128
    s_waitcnt lgkmcnt(5)
    v_mfma_f32_32x32x16_bf16 v[76:91], v[96:99], v[92:95], v[76:91]
    ds_read_b128 v[112:115], v13 offset:29696
    v_exp_f32 v49, v129
    v_exp_f32 v50, v130
    s_waitcnt lgkmcnt(4)
    v_mfma_f32_32x32x16_bf16 v[60:75], a[112:115], v[104:107], v[60:75]
    ds_read_b64_tr_b16 v[96:97], v12 offset:63488
    ds_read_b64_tr_b16 v[98:99], v12 offset:63744
    v_exp_f32 v51, v131
    v_fma_f32 v116, v44, 0.5, 1.0
    s_waitcnt lgkmcnt(5)
    v_mfma_f32_32x32x16_bf16 v[76:91], v[100:103], v[104:107], v[76:91]
    ds_read_b128 v[92:95], v13 offset:30720
    v_fma_f32 v117, v45, 0.5, 1.0
    v_fma_f32 v118, v46, 0.5, 1.0
    v_fma_f32 v119, v47, 0.5, 1.0
    v_fma_f32 v120, v48, 0.5, 1.0
    s_waitcnt lgkmcnt(4)
    v_mfma_f32_32x32x16_bf16 v[60:75], a[116:119], v[108:111], v[60:75]
    ds_read_b64_tr_b16 v[100:101], v12 offset:64512
    ds_read_b64_tr_b16 v[102:103], v12 offset:64768
    v_fma_f32 v121, v49, 0.5, 1.0
    v_fma_f32 v122, v50, 0.5, 1.0
    v_fma_f32 v123, v51, 0.5, 1.0
    s_waitcnt lgkmcnt(5)
    v_mfma_f32_32x32x16_bf16 v[76:91], v[112:115], v[108:111], v[76:91]
    v_fma_f32 v44, -v44, v116, -1.0
    v_fma_f32 v45, -v45, v117, -1.0
    v_fma_f32 v46, -v46, v118, -1.0
    v_fma_f32 v47, -v47, v119, -1.0
    v_fma_f32 v48, -v48, v120, -1.0
    s_waitcnt lgkmcnt(3)
    v_mfma_f32_32x32x16_bf16 v[60:75], a[120:123], v[96:99], v[60:75]
    v_fma_f32 v49, -v49, v121, -1.0
    v_fma_f32 v50, -v50, v122, -1.0
    v_fma_f32 v51, -v51, v123, -1.0
    v_rcp_f32 v44, v44
    s_waitcnt lgkmcnt(2)
    v_mfma_f32_32x32x16_bf16 v[76:91], v[92:95], v[96:99], v[76:91]
    v_rcp_f32 v45, v45
    v_rcp_f32 v46, v46
    v_rcp_f32 v47, v47
    s_waitcnt lgkmcnt(0)
    v_mfma_f32_32x32x16_bf16 v[60:75], a[124:127], v[100:103], v[60:75]
    v_rcp_f32 v48, v48
    v_rcp_f32 v49, v49
    v_rcp_f32 v50, v50
    v_mfma_f32_32x32x16_bf16 v[76:91], v[24:27], v[100:103], v[76:91]
    v_rcp_f32 v51, v51
    v_fmac_f32 v124, v44, v124
    v_fmac_f32 v125, v45, v125
    v_fmac_f32 v126, v46, v126
    v_fmac_f32 v127, v47, v127
    s_add_u32 s69, s78, 0
    buffer_load_dwordx4 v[92:95], v2, s[44:47], s69 offen sc1
    v_fmac_f32 v128, v48, v128
    v_fmac_f32 v129, v49, v129
    v_fmac_f32 v130, v50, v130
    v_fmac_f32 v131, v51, v131
    v_max_u32 v125, s54, v125
    v_max_i32 v125, 0xa0000000, v125
    v_cvt_pk_bf16_f32 v117, v126, v127
    v_cvt_pk_bf16_f32 v118, v128, v129
    v_cvt_pk_bf16_f32 v119, v130, v131
    v_cvt_pk_bf16_f32 v116, v124, v125
    v_xor_b32 v116, s54, v116
    s_add_u32 s66, s10, 0
    buffer_store_dwordx4 v[116:119], v2, s[44:47], s66 offen offset:0 sc1
    v_fmac_f32 v140, v132, v157
    s_add_u32 s69, s80, 0
    buffer_load_dwordx4 v[96:99], v2, s[44:47], s69 offen sc1
    v_fmac_f32 v141, v133, v157
    v_fmac_f32 v142, v134, v157
    v_fmac_f32 v143, v135, v157
    v_fmac_f32 v144, v136, v157
    v_fmac_f32 v145, v137, v157
    v_fmac_f32 v146, v138, v157
    v_fmac_f32 v147, v139, v157
    v_fmac_f32 v140, v52, v156
    v_fmac_f32 v141, v53, v156
    v_fmac_f32 v142, v54, v156
    v_fmac_f32 v143, v55, v156
    v_fmac_f32 v144, v56, v156
    v_fmac_f32 v145, v57, v156
    v_fmac_f32 v146, v58, v156
    v_fmac_f32 v147, v59, v156
    s_add_u32 s69, s78, 4096
    buffer_load_dwordx4 v[100:103], v2, s[44:47], s69 offen sc1
    v_exp_f32 v52, v140
    v_exp_f32 v53, v141
    v_exp_f32 v54, v142
    v_exp_f32 v55, v143
    v_exp_f32 v56, v144
    v_exp_f32 v57, v145
    v_exp_f32 v58, v146
    v_exp_f32 v59, v147
    v_fma_f32 v132, v52, 0.5, 1.0
    v_fma_f32 v133, v53, 0.5, 1.0
    v_fma_f32 v134, v54, 0.5, 1.0
    v_fma_f32 v135, v55, 0.5, 1.0
    v_fma_f32 v136, v56, 0.5, 1.0
    v_fma_f32 v137, v57, 0.5, 1.0
    v_fma_f32 v138, v58, 0.5, 1.0
    s_add_u32 s69, s80, 12288
    buffer_load_dwordx4 v[104:107], v2, s[44:47], s69 offen sc1
    v_fma_f32 v139, v59, 0.5, 1.0
    v_fma_f32 v52, -v52, v132, -1.0
    v_fma_f32 v53, -v53, v133, -1.0
    v_fma_f32 v54, -v54, v134, -1.0
    v_fma_f32 v55, -v55, v135, -1.0
    v_fma_f32 v56, -v56, v136, -1.0
    v_fma_f32 v57, -v57, v137, -1.0
    v_fma_f32 v58, -v58, v138, -1.0
    v_fma_f32 v59, -v59, v139, -1.0
    v_rcp_f32 v52, v52
    v_rcp_f32 v53, v53
    v_rcp_f32 v54, v54
    v_rcp_f32 v55, v55
    v_rcp_f32 v56, v56
    s_add_u32 s69, s78, 16384
    buffer_load_dwordx4 v[108:111], v2, s[44:47], s69 offen sc1
    v_rcp_f32 v57, v57
    v_rcp_f32 v58, v58
    v_rcp_f32 v59, v59
    v_fmac_f32 v140, v52, v140
    v_fmac_f32 v141, v53, v141
    v_fmac_f32 v142, v54, v142
    v_fmac_f32 v143, v55, v143
    v_fmac_f32 v144, v56, v144
    v_fmac_f32 v145, v57, v145
    v_fmac_f32 v146, v58, v146
    v_fmac_f32 v147, v59, v147
    v_max_u32 v141, s54, v141
    v_max_i32 v141, 0xa0000000, v141
    v_cvt_pk_bf16_f32 v133, v142, v143
    v_cvt_pk_bf16_f32 v134, v144, v145
    s_add_u32 s69, s80, 16384
    buffer_load_dwordx4 v[112:115], v2, s[44:47], s69 offen sc1
    v_cvt_pk_bf16_f32 v135, v146, v147
    v_cvt_pk_bf16_f32 v132, v140, v141
    v_xor_b32 v132, s54, v132
    s_add_u32 s66, s10, 0
    buffer_store_dwordx4 v[132:135], v2, s[44:47], s66 offen offset:1024 sc1
    v_perm_b32 v158, v154, v152, s18
    v_perm_b32 v159, v154, v152, s19
    v_perm_b32 v154, v155, v153, s18
    v_perm_b32 v155, v155, v153, s19
    v_mov_b32 v152, v158
    v_mov_b32 v153, v159
    v_permlane16_swap_b32 v154, v155
    s_nop 0
    v_permlane16_swap_b32 v152, v153
    s_nop 1
    v_permlane32_swap_b32 v152, v154
    v_permlane32_swap_b32 v153, v155
    s_barrier
    s_add_u32 s69, s79, 0
    buffer_load_dwordx4 v[28:31], v2, s[44:47], s69 offen sc1
    ds_read_b64 v[158:159], v15 offset:256
    ds_read_b128 v[116:119], v14 offset:0
    ds_read_b128 v[120:123], v14 offset:32
    ds_read_b128 v[124:127], v14 offset:896
    ds_read_b128 v[128:131], v14 offset:928
    ds_read_b128 v[132:135], v14 offset:64
    ds_read_b128 v[136:139], v14 offset:96
    ds_read_b128 v[140:143], v14 offset:960
    ds_read_b128 v[144:147], v14 offset:992
    s_waitcnt lgkmcnt(4)
    v_pk_fma_f32 v[124:125], v[116:117], v[158:159], v[124:125] op_sel:[0,1,0] op_sel_hi:[1,1,1]
    v_pk_fma_f32 v[126:127], v[118:119], v[158:159], v[126:127] op_sel:[0,1,0] op_sel_hi:[1,1,1]
    v_pk_fma_f32 v[128:129], v[120:121], v[158:159], v[128:129] op_sel:[0,1,0] op_sel_hi:[1,1,1]
    v_pk_fma_f32 v[130:131], v[122:123], v[158:159], v[130:131] op_sel:[0,1,0] op_sel_hi:[1,1,1]
    v_pk_fma_f32 v[124:125], v[60:61], v[158:159], v[124:125] op_sel:[0,0,0] op_sel_hi:[1,0,1]
    v_pk_fma_f32 v[126:127], v[62:63], v[158:159], v[126:127] op_sel:[0,0,0] op_sel_hi:[1,0,1]
    v_pk_fma_f32 v[128:129], v[64:65], v[158:159], v[128:129] op_sel:[0,0,0] op_sel_hi:[1,0,1]
    v_pk_fma_f32 v[130:131], v[66:67], v[158:159], v[130:131] op_sel:[0,0,0] op_sel_hi:[1,0,1]
    v_exp_f32 v60, v124
    v_exp_f32 v61, v125
    v_exp_f32 v62, v126
    v_exp_f32 v63, v127
    v_exp_f32 v64, v128
    v_exp_f32 v65, v129
    v_exp_f32 v66, v130
    s_add_u32 s69, s81, 0
    buffer_load_dwordx4 v[32:35], v2, s[44:47], s69 offen sc1
    v_exp_f32 v67, v131
    v_pk_fma_f32 v[116:117], v[60:61], 0.5, 1.0 op_sel_hi:[1,0,0]
    v_pk_fma_f32 v[118:119], v[62:63], 0.5, 1.0 op_sel_hi:[1,0,0]
    v_pk_fma_f32 v[120:121], v[64:65], 0.5, 1.0 op_sel_hi:[1,0,0]
    v_pk_fma_f32 v[122:123], v[66:67], 0.5, 1.0 op_sel_hi:[1,0,0]
    v_pk_fma_f32 v[60:61], v[60:61], v[116:117], 1.0 op_sel_hi:[1,1,0]
    v_pk_fma_f32 v[62:63], v[62:63], v[118:119], 1.0 op_sel_hi:[1,1,0]
    v_pk_fma_f32 v[64:65], v[64:65], v[120:121], 1.0 op_sel_hi:[1,1,0]
    v_pk_fma_f32 v[66:67], v[66:67], v[122:123], 1.0 op_sel_hi:[1,1,0]
    v_rcp_f32 v60, v60
    v_rcp_f32 v61, v61
    v_rcp_f32 v62, v62
    v_rcp_f32 v63, v63
    v_rcp_f32 v64, v64
    v_rcp_f32 v65, v65
    v_rcp_f32 v66, v66
    v_rcp_f32 v67, v67
    v_pk_fma_f32 v[124:125], v[60:61], v[124:125], v[124:125] neg_lo:[1,0,0] neg_hi:[1,0,0]
    v_pk_fma_f32 v[126:127], v[62:63], v[126:127], v[126:127] neg_lo:[1,0,0] neg_hi:[1,0,0]
    v_pk_fma_f32 v[128:129], v[64:65], v[128:129], v[128:129] neg_lo:[1,0,0] neg_hi:[1,0,0]
    v_pk_fma_f32 v[130:131], v[66:67], v[130:131], v[130:131] neg_lo:[1,0,0] neg_hi:[1,0,0]
    v_max_u32 v125, s54, v125
    v_max_i32 v125, 0xa0000000, v125
    v_cvt_pk_bf16_f32 v117, v126, v127
    s_add_u32 s69, s79, 4096
    buffer_load_dwordx4 v[36:39], v2, s[44:47], s69 offen sc1
    v_cvt_pk_bf16_f32 v118, v128, v129
    v_cvt_pk_bf16_f32 v119, v130, v131
    v_cvt_pk_bf16_f32 v116, v124, v125
    v_xor_b32 v116, s54, v116
    s_add_u32 s66, s9, 3670016
    buffer_store_dwordx4 v[116:119], v2, s[44:47], s66 offen offset:0 sc1
    s_nop 0
    ds_read_b128 v[116:119], v14 offset:512
    ds_read_b128 v[120:123], v14 offset:544
    ds_read_b128 v[124:127], v14 offset:1408
    ds_read_b128 v[128:131], v14 offset:1440
    s_waitcnt lgkmcnt(4)
    v_pk_fma_f32 v[140:141], v[132:133], v[158:159], v[140:141] op_sel:[0,1,0] op_sel_hi:[1,1,1]
    v_pk_fma_f32 v[142:143], v[134:135], v[158:159], v[142:143] op_sel:[0,1,0] op_sel_hi:[1,1,1]
    v_pk_fma_f32 v[144:145], v[136:137], v[158:159], v[144:145] op_sel:[0,1,0] op_sel_hi:[1,1,1]
    v_pk_fma_f32 v[146:147], v[138:139], v[158:159], v[146:147] op_sel:[0,1,0] op_sel_hi:[1,1,1]
    v_pk_fma_f32 v[140:141], v[68:69], v[158:159], v[140:141] op_sel:[0,0,0] op_sel_hi:[1,0,1]
    v_pk_fma_f32 v[142:143], v[70:71], v[158:159], v[142:143] op_sel:[0,0,0] op_sel_hi:[1,0,1]
    v_pk_fma_f32 v[144:145], v[72:73], v[158:159], v[144:145] op_sel:[0,0,0] op_sel_hi:[1,0,1]
    v_pk_fma_f32 v[146:147], v[74:75], v[158:159], v[146:147] op_sel:[0,0,0] op_sel_hi:[1,0,1]
    v_exp_f32 v68, v140
    v_exp_f32 v69, v141
    v_exp_f32 v70, v142
    v_exp_f32 v71, v143
    v_exp_f32 v72, v144
    v_exp_f32 v73, v145
    v_exp_f32 v74, v146
    s_add_u32 s69, s81, 12288
    buffer_load_dwordx4 v[40:43], v2, s[44:47], s69 offen sc1
    v_exp_f32 v75, v147
    v_pk_fma_f32 v[132:133], v[68:69], 0.5, 1.0 op_sel_hi:[1,0,0]
    v_pk_fma_f32 v[134:135], v[70:71], 0.5, 1.0 op_sel_hi:[1,0,0]
    v_pk_fma_f32 v[136:137], v[72:73], 0.5, 1.0 op_sel_hi:[1,0,0]
    v_pk_fma_f32 v[138:139], v[74:75], 0.5, 1.0 op_sel_hi:[1,0,0]
    v_pk_fma_f32 v[68:69], v[68:69], v[132:133], 1.0 op_sel_hi:[1,1,0]
    v_pk_fma_f32 v[70:71], v[70:71], v[134:135], 1.0 op_sel_hi:[1,1,0]
    v_pk_fma_f32 v[72:73], v[72:73], v[136:137], 1.0 op_sel_hi:[1,1,0]
    v_pk_fma_f32 v[74:75], v[74:75], v[138:139], 1.0 op_sel_hi:[1,1,0]
    v_rcp_f32 v68, v68
    v_rcp_f32 v69, v69
    v_rcp_f32 v70, v70
    v_rcp_f32 v71, v71
    v_rcp_f32 v72, v72
    v_rcp_f32 v73, v73
    v_rcp_f32 v74, v74
    v_rcp_f32 v75, v75
    v_pk_fma_f32 v[140:141], v[68:69], v[140:141], v[140:141] neg_lo:[1,0,0] neg_hi:[1,0,0]
    v_pk_fma_f32 v[142:143], v[70:71], v[142:143], v[142:143] neg_lo:[1,0,0] neg_hi:[1,0,0]
    v_pk_fma_f32 v[144:145], v[72:73], v[144:145], v[144:145] neg_lo:[1,0,0] neg_hi:[1,0,0]
    v_pk_fma_f32 v[146:147], v[74:75], v[146:147], v[146:147] neg_lo:[1,0,0] neg_hi:[1,0,0]
    v_max_u32 v141, s54, v141
    v_max_i32 v141, 0xa0000000, v141
    v_cvt_pk_bf16_f32 v133, v142, v143
    s_add_u32 s69, s79, 16384
    buffer_load_dwordx4 v[44:47], v2, s[44:47], s69 offen sc1
    v_cvt_pk_bf16_f32 v134, v144, v145
    v_cvt_pk_bf16_f32 v135, v146, v147
    v_cvt_pk_bf16_f32 v132, v140, v141
    v_xor_b32 v132, s54, v132
    s_add_u32 s66, s9, 3670016
    buffer_store_dwordx4 v[132:135], v2, s[44:47], s66 offen offset:1024 sc1
    s_nop 0
    ds_read_b128 v[132:135], v14 offset:576
    ds_read_b128 v[136:139], v14 offset:608
    ds_read_b128 v[140:143], v14 offset:1472
    ds_read_b128 v[144:147], v14 offset:1504
    s_waitcnt lgkmcnt(4)
    v_pk_fma_f32 v[124:125], v[116:117], v[158:159], v[124:125] op_sel:[0,1,0] op_sel_hi:[1,1,1]
    v_pk_fma_f32 v[126:127], v[118:119], v[158:159], v[126:127] op_sel:[0,1,0] op_sel_hi:[1,1,1]
    v_pk_fma_f32 v[128:129], v[120:121], v[158:159], v[128:129] op_sel:[0,1,0] op_sel_hi:[1,1,1]
    v_pk_fma_f32 v[130:131], v[122:123], v[158:159], v[130:131] op_sel:[0,1,0] op_sel_hi:[1,1,1]
    v_pk_fma_f32 v[124:125], v[76:77], v[158:159], v[124:125] op_sel:[0,0,0] op_sel_hi:[1,0,1]
    v_pk_fma_f32 v[126:127], v[78:79], v[158:159], v[126:127] op_sel:[0,0,0] op_sel_hi:[1,0,1]
    v_pk_fma_f32 v[128:129], v[80:81], v[158:159], v[128:129] op_sel:[0,0,0] op_sel_hi:[1,0,1]
    v_pk_fma_f32 v[130:131], v[82:83], v[158:159], v[130:131] op_sel:[0,0,0] op_sel_hi:[1,0,1]
    v_exp_f32 v76, v124
    v_exp_f32 v77, v125
    v_exp_f32 v78, v126
    v_exp_f32 v79, v127
    v_exp_f32 v80, v128
    v_exp_f32 v81, v129
    v_exp_f32 v82, v130
    s_add_u32 s69, s81, 16384
    buffer_load_dwordx4 v[48:51], v2, s[44:47], s69 offen sc1
    v_exp_f32 v83, v131
    v_pk_fma_f32 v[116:117], v[76:77], 0.5, 1.0 op_sel_hi:[1,0,0]
    v_pk_fma_f32 v[118:119], v[78:79], 0.5, 1.0 op_sel_hi:[1,0,0]
    v_pk_fma_f32 v[120:121], v[80:81], 0.5, 1.0 op_sel_hi:[1,0,0]
    v_pk_fma_f32 v[122:123], v[82:83], 0.5, 1.0 op_sel_hi:[1,0,0]
    v_pk_fma_f32 v[76:77], v[76:77], v[116:117], 1.0 op_sel_hi:[1,1,0]
    v_pk_fma_f32 v[78:79], v[78:79], v[118:119], 1.0 op_sel_hi:[1,1,0]
    v_pk_fma_f32 v[80:81], v[80:81], v[120:121], 1.0 op_sel_hi:[1,1,0]
    v_pk_fma_f32 v[82:83], v[82:83], v[122:123], 1.0 op_sel_hi:[1,1,0]
    v_rcp_f32 v76, v76
    v_rcp_f32 v77, v77
    v_rcp_f32 v78, v78
    v_rcp_f32 v79, v79
    v_rcp_f32 v80, v80
    v_rcp_f32 v81, v81
    v_rcp_f32 v82, v82
    v_rcp_f32 v83, v83
    v_pk_fma_f32 v[124:125], v[76:77], v[124:125], v[124:125] neg_lo:[1,0,0] neg_hi:[1,0,0]
    v_pk_fma_f32 v[126:127], v[78:79], v[126:127], v[126:127] neg_lo:[1,0,0] neg_hi:[1,0,0]
    v_pk_fma_f32 v[128:129], v[80:81], v[128:129], v[128:129] neg_lo:[1,0,0] neg_hi:[1,0,0]
    v_pk_fma_f32 v[130:131], v[82:83], v[130:131], v[130:131] neg_lo:[1,0,0] neg_hi:[1,0,0]
    v_max_u32 v125, s54, v125
    v_max_i32 v125, 0xa0000000, v125
    v_cvt_pk_bf16_f32 v117, v126, v127
    s_add_u32 s69, s80, 4096
    buffer_load_dwordx4 v[52:55], v2, s[44:47], s69 offen sc1
    v_cvt_pk_bf16_f32 v118, v128, v129
    v_cvt_pk_bf16_f32 v119, v130, v131
    v_cvt_pk_bf16_f32 v116, v124, v125
    v_xor_b32 v116, s54, v116
    s_add_u32 s66, s10, 3670016
    buffer_store_dwordx4 v[116:119], v2, s[44:47], s66 offen offset:0 sc1
    s_waitcnt lgkmcnt(0)
    v_pk_fma_f32 v[140:141], v[132:133], v[158:159], v[140:141] op_sel:[0,1,0] op_sel_hi:[1,1,1]
    v_pk_fma_f32 v[142:143], v[134:135], v[158:159], v[142:143] op_sel:[0,1,0] op_sel_hi:[1,1,1]
    v_pk_fma_f32 v[144:145], v[136:137], v[158:159], v[144:145] op_sel:[0,1,0] op_sel_hi:[1,1,1]
    v_pk_fma_f32 v[146:147], v[138:139], v[158:159], v[146:147] op_sel:[0,1,0] op_sel_hi:[1,1,1]
    v_pk_fma_f32 v[140:141], v[84:85], v[158:159], v[140:141] op_sel:[0,0,0] op_sel_hi:[1,0,1]
    v_pk_fma_f32 v[142:143], v[86:87], v[158:159], v[142:143] op_sel:[0,0,0] op_sel_hi:[1,0,1]
    v_pk_fma_f32 v[144:145], v[88:89], v[158:159], v[144:145] op_sel:[0,0,0] op_sel_hi:[1,0,1]
    v_pk_fma_f32 v[146:147], v[90:91], v[158:159], v[146:147] op_sel:[0,0,0] op_sel_hi:[1,0,1]
    v_exp_f32 v84, v140
    v_exp_f32 v85, v141
    v_exp_f32 v86, v142
    v_exp_f32 v87, v143
    v_exp_f32 v88, v144
    v_exp_f32 v89, v145
    v_exp_f32 v90, v146
    v_exp_f32 v91, v147
    v_pk_fma_f32 v[132:133], v[84:85], 0.5, 1.0 op_sel_hi:[1,0,0]
    v_pk_fma_f32 v[134:135], v[86:87], 0.5, 1.0 op_sel_hi:[1,0,0]
    v_pk_fma_f32 v[136:137], v[88:89], 0.5, 1.0 op_sel_hi:[1,0,0]
    s_add_u32 s69, s78, 8192
    buffer_load_dwordx4 v[56:59], v2, s[44:47], s69 offen sc1
    v_pk_fma_f32 v[138:139], v[90:91], 0.5, 1.0 op_sel_hi:[1,0,0]
    v_pk_fma_f32 v[84:85], v[84:85], v[132:133], 1.0 op_sel_hi:[1,1,0]
    v_pk_fma_f32 v[86:87], v[86:87], v[134:135], 1.0 op_sel_hi:[1,1,0]
    v_pk_fma_f32 v[88:89], v[88:89], v[136:137], 1.0 op_sel_hi:[1,1,0]
    v_pk_fma_f32 v[90:91], v[90:91], v[138:139], 1.0 op_sel_hi:[1,1,0]
    v_rcp_f32 v84, v84
    v_rcp_f32 v85, v85
    v_rcp_f32 v86, v86
    v_rcp_f32 v87, v87
    v_rcp_f32 v88, v88
    v_rcp_f32 v89, v89
    v_rcp_f32 v90, v90
    v_rcp_f32 v91, v91
    v_pk_fma_f32 v[140:141], v[84:85], v[140:141], v[140:141] neg_lo:[1,0,0] neg_hi:[1,0,0]
    v_pk_fma_f32 v[142:143], v[86:87], v[142:143], v[142:143] neg_lo:[1,0,0] neg_hi:[1,0,0]
    v_pk_fma_f32 v[144:145], v[88:89], v[144:145], v[144:145] neg_lo:[1,0,0] neg_hi:[1,0,0]
    v_pk_fma_f32 v[146:147], v[90:91], v[146:147], v[146:147] neg_lo:[1,0,0] neg_hi:[1,0,0]
    v_max_u32 v141, s54, v141
    v_max_i32 v141, 0xa0000000, v141
    v_cvt_pk_bf16_f32 v133, v142, v143
    v_cvt_pk_bf16_f32 v134, v144, v145
    v_cvt_pk_bf16_f32 v135, v146, v147
    v_cvt_pk_bf16_f32 v132, v140, v141
    v_xor_b32 v132, s54, v132
    s_add_u32 s66, s10, 3670016
    buffer_store_dwordx4 v[132:135], v2, s[44:47], s66 offen offset:1024 sc1
    s_branch L_m_j69
L_m_w368:
    v_mov_b32 v24, s38
    v_mov_b32 v25, s38
    v_mov_b32 v26, s38
    v_mov_b32 v27, s38
    ds_read_b64_tr_b16 v[92:93], v13 offset:0
    ds_read_b64_tr_b16 v[94:95], v13 offset:256
    ds_read_b64_tr_b16 v[96:97], v13 offset:64
    ds_read_b64_tr_b16 v[98:99], v13 offset:320
    ds_read_b64_tr_b16 v[100:101], v13 offset:2048
    ds_read_b64_tr_b16 v[102:103], v13 offset:2304
    ds_read_b64_tr_b16 v[104:105], v13 offset:2112
    ds_read_b64_tr_b16 v[106:107], v13 offset:2368
    ds_read_b64_tr_b16 v[108:109], v13 offset:4096
    ds_read_b64_tr_b16 v[110:111], v13 offset:4352
    s_waitcnt lgkmcnt(8)
    v_mfma_f32_16x16x32_bf16 v[44:47], v[24:27], v[92:95], 0
    ds_write_b128 v11, v[116:119] offset:16384
    v_mfma_f32_16x16x32_bf16 v[52:55], v[92:95], v[92:95], 0
    s_waitcnt lgkmcnt(7)
    v_mfma_f32_16x16x32_bf16 v[48:51], v[24:27], v[96:99], 0
    ds_read_b64_tr_b16 v[112:113], v13 offset:4160
    ds_write_b128 v11, v[120:123] offset:20480
    v_mfma_f32_16x16x32_bf16 v[56:59], v[96:99], v[96:99], 0
    ds_read_b64_tr_b16 v[114:115], v13 offset:4416
    s_waitcnt lgkmcnt(8)
    v_mfma_f32_16x16x32_bf16 v[44:47], v[24:27], v[100:103], v[44:47]
    ds_read_b64_tr_b16 v[92:93], v13 offset:6144
    ds_write_b128 v11, v[124:127] offset:24576
    v_mfma_f32_16x16x32_bf16 v[52:55], v[100:103], v[100:103], v[52:55]
    ds_read_b64_tr_b16 v[94:95], v13 offset:6400
    s_waitcnt lgkmcnt(9)
    v_mfma_f32_16x16x32_bf16 v[48:51], v[24:27], v[104:107], v[48:51]
    ds_read_b64_tr_b16 v[96:97], v13 offset:6208
    ds_write_b128 v11, v[128:131] offset:28672
    v_mfma_f32_16x16x32_bf16 v[56:59], v[104:107], v[104:107], v[56:59]
    ds_read_b64_tr_b16 v[98:99], v13 offset:6464
    s_waitcnt lgkmcnt(10)
    v_mfma_f32_16x16x32_bf16 v[44:47], v[24:27], v[108:111], v[44:47]
    ds_read_b64_tr_b16 v[100:101], v13 offset:8192
    v_mfma_f32_16x16x32_bf16 v[52:55], v[108:111], v[108:111], v[52:55]
    ds_read_b64_tr_b16 v[102:103], v13 offset:8448
    s_waitcnt lgkmcnt(8)
    v_mfma_f32_16x16x32_bf16 v[48:51], v[24:27], v[112:115], v[48:51]
    ds_read_b64_tr_b16 v[104:105], v13 offset:8256
    v_mfma_f32_16x16x32_bf16 v[56:59], v[112:115], v[112:115], v[56:59]
    ds_read_b64_tr_b16 v[106:107], v13 offset:8512
    s_waitcnt lgkmcnt(7)
    v_mfma_f32_16x16x32_bf16 v[44:47], v[24:27], v[92:95], v[44:47]
    ds_read_b64_tr_b16 v[108:109], v13 offset:10240
    v_mfma_f32_16x16x32_bf16 v[52:55], v[92:95], v[92:95], v[52:55]
    ds_read_b64_tr_b16 v[110:111], v13 offset:10496
    s_waitcnt lgkmcnt(6)
    v_mfma_f32_16x16x32_bf16 v[48:51], v[24:27], v[96:99], v[48:51]
    ds_read_b64_tr_b16 v[112:113], v13 offset:10304
    v_mfma_f32_16x16x32_bf16 v[56:59], v[96:99], v[96:99], v[56:59]
    ds_read_b64_tr_b16 v[114:115], v13 offset:10560
    s_waitcnt lgkmcnt(6)
    v_mfma_f32_16x16x32_bf16 v[44:47], v[24:27], v[100:103], v[44:47]
    ds_read_b64_tr_b16 v[92:93], v13 offset:12288
    v_mfma_f32_16x16x32_bf16 v[52:55], v[100:103], v[100:103], v[52:55]
    ds_read_b64_tr_b16 v[94:95], v13 offset:12544
    s_waitcnt lgkmcnt(6)
    v_mfma_f32_16x16x32_bf16 v[48:51], v[24:27], v[104:107], v[48:51]
    ds_read_b64_tr_b16 v[96:97], v13 offset:12352
    v_mfma_f32_16x16x32_bf16 v[56:59], v[104:107], v[104:107], v[56:59]
    ds_read_b64_tr_b16 v[98:99], v13 offset:12608
    s_waitcnt lgkmcnt(6)
    v_mfma_f32_16x16x32_bf16 v[44:47], v[24:27], v[108:111], v[44:47]
    ds_read_b64_tr_b16 v[100:101], v13 offset:14336
    v_mfma_f32_16x16x32_bf16 v[52:55], v[108:111], v[108:111], v[52:55]
    ds_read_b64_tr_b16 v[102:103], v13 offset:14592
    s_waitcnt lgkmcnt(6)
    v_mfma_f32_16x16x32_bf16 v[48:51], v[24:27], v[112:115], v[48:51]
    ds_read_b64_tr_b16 v[104:105], v13 offset:14400
    s_barrier
    v_mfma_f32_16x16x32_bf16 v[56:59], v[112:115], v[112:115], v[56:59]
    ds_read_b64_tr_b16 v[106:107], v13 offset:14656
    s_waitcnt lgkmcnt(6)
    v_mfma_f32_16x16x32_bf16 v[44:47], v[24:27], v[92:95], v[44:47]
    ds_read_b64_tr_b16 v[108:109], v13 offset:16384
    v_mfma_f32_16x16x32_bf16 v[52:55], v[92:95], v[92:95], v[52:55]
    ds_read_b64_tr_b16 v[110:111], v13 offset:16640
    s_waitcnt lgkmcnt(6)
    v_mfma_f32_16x16x32_bf16 v[48:51], v[24:27], v[96:99], v[48:51]
    ds_read_b64_tr_b16 v[112:113], v13 offset:16448
    v_mfma_f32_16x16x32_bf16 v[56:59], v[96:99], v[96:99], v[56:59]
    ds_read_b64_tr_b16 v[114:115], v13 offset:16704
    s_waitcnt lgkmcnt(6)
    v_mfma_f32_16x16x32_bf16 v[44:47], v[24:27], v[100:103], v[44:47]
    ds_read_b64_tr_b16 v[92:93], v13 offset:18432
    v_mfma_f32_16x16x32_bf16 v[52:55], v[100:103], v[100:103], v[52:55]
    ds_read_b64_tr_b16 v[94:95], v13 offset:18688
    ds_read_b128 v[148:151], v19 offset:0
    s_waitcnt lgkmcnt(7)
    v_mfma_f32_16x16x32_bf16 v[48:51], v[24:27], v[104:107], v[48:51]
    ds_read_b64_tr_b16 v[96:97], v13 offset:18496
    v_mfma_f32_16x16x32_bf16 v[56:59], v[104:107], v[104:107], v[56:59]
    ds_read_b64_tr_b16 v[98:99], v13 offset:18752
    s_waitcnt lgkmcnt(7)
    v_mfma_f32_16x16x32_bf16 v[44:47], v[24:27], v[108:111], v[44:47]
    ds_read_b64_tr_b16 v[100:101], v13 offset:20480
    v_mfma_f32_16x16x32_bf16 v[52:55], v[108:111], v[108:111], v[52:55]
    ds_read_b64_tr_b16 v[102:103], v13 offset:20736
    s_waitcnt lgkmcnt(7)
    v_mfma_f32_16x16x32_bf16 v[48:51], v[24:27], v[112:115], v[48:51]
    ds_read_b64_tr_b16 v[104:105], v13 offset:20544
    v_mfma_f32_16x16x32_bf16 v[56:59], v[112:115], v[112:115], v[56:59]
    ds_read_b64_tr_b16 v[106:107], v13 offset:20800
    s_waitcnt lgkmcnt(7)
    v_mfma_f32_16x16x32_bf16 v[44:47], v[24:27], v[92:95], v[44:47]
    ds_read_b64_tr_b16 v[108:109], v13 offset:22528
    v_mfma_f32_16x16x32_bf16 v[52:55], v[92:95], v[92:95], v[52:55]
    ds_read_b64_tr_b16 v[110:111], v13 offset:22784
    s_waitcnt lgkmcnt(6)
    v_mfma_f32_16x16x32_bf16 v[48:51], v[24:27], v[96:99], v[48:51]
    ds_read_b64_tr_b16 v[112:113], v13 offset:22592
    v_mfma_f32_16x16x32_bf16 v[56:59], v[96:99], v[96:99], v[56:59]
    ds_read_b64_tr_b16 v[114:115], v13 offset:22848
    s_waitcnt lgkmcnt(6)
    v_mfma_f32_16x16x32_bf16 v[44:47], v[24:27], v[100:103], v[44:47]
    ds_read_b64_tr_b16 v[92:93], v13 offset:24576
    v_mfma_f32_16x16x32_bf16 v[52:55], v[100:103], v[100:103], v[52:55]
    ds_read_b64_tr_b16 v[94:95], v13 offset:24832
    v_perm_b32 v158, v150, v148, s18
    s_waitcnt lgkmcnt(6)
    v_mfma_f32_16x16x32_bf16 v[48:51], v[24:27], v[104:107], v[48:51]
    ds_read_b64_tr_b16 v[96:97], v13 offset:24640
    v_mfma_f32_16x16x32_bf16 v[56:59], v[104:107], v[104:107], v[56:59]
    ds_read_b64_tr_b16 v[98:99], v13 offset:24896
    v_perm_b32 v159, v150, v148, s19
    s_waitcnt lgkmcnt(6)
    v_mfma_f32_16x16x32_bf16 v[44:47], v[24:27], v[108:111], v[44:47]
    ds_read_b64_tr_b16 v[100:101], v13 offset:26624
    v_mfma_f32_16x16x32_bf16 v[52:55], v[108:111], v[108:111], v[52:55]
    ds_read_b64_tr_b16 v[102:103], v13 offset:26880
    v_perm_b32 v150, v151, v149, s18
    s_waitcnt lgkmcnt(6)
    v_mfma_f32_16x16x32_bf16 v[48:51], v[24:27], v[112:115], v[48:51]
    ds_read_b64_tr_b16 v[104:105], v13 offset:26688
    v_mfma_f32_16x16x32_bf16 v[56:59], v[112:115], v[112:115], v[56:59]
    ds_read_b64_tr_b16 v[106:107], v13 offset:26944
    v_perm_b32 v151, v151, v149, s19
    s_waitcnt lgkmcnt(6)
    v_mfma_f32_16x16x32_bf16 v[44:47], v[24:27], v[92:95], v[44:47]
    ds_read_b64_tr_b16 v[108:109], v13 offset:28672
    v_mfma_f32_16x16x32_bf16 v[52:55], v[92:95], v[92:95], v[52:55]
    ds_read_b64_tr_b16 v[110:111], v13 offset:28928
    v_mov_b32 v148, v158
    s_waitcnt lgkmcnt(6)
    v_mfma_f32_16x16x32_bf16 v[48:51], v[24:27], v[96:99], v[48:51]
    ds_read_b64_tr_b16 v[112:113], v13 offset:28736
    v_mfma_f32_16x16x32_bf16 v[56:59], v[96:99], v[96:99], v[56:59]
    ds_read_b64_tr_b16 v[114:115], v13 offset:28992
    v_mov_b32 v149, v159
    s_waitcnt lgkmcnt(6)
    v_mfma_f32_16x16x32_bf16 v[44:47], v[24:27], v[100:103], v[44:47]
    ds_read_b64_tr_b16 v[92:93], v13 offset:30720
    v_mfma_f32_16x16x32_bf16 v[52:55], v[100:103], v[100:103], v[52:55]
    ds_read_b64_tr_b16 v[94:95], v13 offset:30976
    v_permlane16_swap_b32 v150, v151
    s_waitcnt lgkmcnt(6)
    v_mfma_f32_16x16x32_bf16 v[48:51], v[24:27], v[104:107], v[48:51]
    ds_read_b64_tr_b16 v[96:97], v13 offset:30784
    v_mfma_f32_16x16x32_bf16 v[56:59], v[104:107], v[104:107], v[56:59]
    ds_read_b64_tr_b16 v[98:99], v13 offset:31040
    v_permlane16_swap_b32 v148, v149
    s_waitcnt lgkmcnt(6)
    v_mfma_f32_16x16x32_bf16 v[44:47], v[24:27], v[108:111], v[44:47]
    v_permlane32_swap_b32 v148, v150
    v_mfma_f32_16x16x32_bf16 v[52:55], v[108:111], v[108:111], v[52:55]
    v_permlane32_swap_b32 v149, v151
    s_waitcnt lgkmcnt(4)
    v_mfma_f32_16x16x32_bf16 v[48:51], v[24:27], v[112:115], v[48:51]
    v_mfma_f32_16x16x32_bf16 v[56:59], v[112:115], v[112:115], v[56:59]
    s_waitcnt lgkmcnt(2)
    v_mfma_f32_16x16x32_bf16 v[44:47], v[24:27], v[92:95], v[44:47]
    v_mfma_f32_16x16x32_bf16 v[52:55], v[92:95], v[92:95], v[52:55]
    s_waitcnt lgkmcnt(0)
    v_mfma_f32_16x16x32_bf16 v[48:51], v[24:27], v[96:99], v[48:51]
    v_mfma_f32_16x16x32_bf16 v[56:59], v[96:99], v[96:99], v[56:59]
    ds_read_b64_tr_b16 v[100:101], v12 offset:0
    ds_read_b64_tr_b16 v[102:103], v12 offset:256
    ds_read_b64_tr_b16 v[104:105], v12 offset:1024
    ds_read_b64_tr_b16 v[106:107], v12 offset:1280
    ds_read_b64_tr_b16 v[108:109], v12 offset:2048
    ds_read_b64_tr_b16 v[110:111], v12 offset:2304
    ds_read_b64_tr_b16 v[112:113], v12 offset:3072
    ds_read_b64_tr_b16 v[114:115], v12 offset:3328
    s_waitcnt lgkmcnt(6)
    v_mfma_f32_32x32x16_bf16 v[28:43], a[0:3], v[100:103], 0
    s_waitcnt lgkmcnt(4)
    v_mfma_f32_32x32x16_bf16 v[28:43], a[4:7], v[104:107], v[28:43]
    ds_read_b64_tr_b16 v[92:93], v12 offset:4096
    ds_read_b64_tr_b16 v[94:95], v12 offset:4352
    v_cndmask_b32 v52, v52, v53, s[30:31]
    v_cndmask_b32 v54, v54, v55, s[30:31]
    v_cndmask_b32 v56, v56, v57, s[30:31]
    s_waitcnt lgkmcnt(4)
    v_mfma_f32_32x32x16_bf16 v[28:43], a[8:11], v[108:111], v[28:43]
    ds_read_b64_tr_b16 v[96:97], v12 offset:5120
    ds_read_b64_tr_b16 v[98:99], v12 offset:5376
    v_cndmask_b32 v58, v58, v59, s[30:31]
    v_mov_b32 v45, s22
    v_cndmask_b32 v52, v52, v54, s[32:33]
    s_waitcnt lgkmcnt(4)
    v_mfma_f32_32x32x16_bf16 v[28:43], a[12:15], v[112:115], v[28:43]
    ds_read_b64_tr_b16 v[100:101], v12 offset:6144
    ds_read_b64_tr_b16 v[102:103], v12 offset:6400
    v_cndmask_b32 v56, v56, v58, s[32:33]
    v_mul_f32 v44, s20, v44
    v_fma_f32 v52, v52, s20, v45
    s_waitcnt lgkmcnt(4)
    v_mfma_f32_32x32x16_bf16 v[28:43], a[16:19], v[92:95], v[28:43]
    ds_read_b64_tr_b16 v[104:105], v12 offset:7168
    ds_read_b64_tr_b16 v[106:107], v12 offset:7424
    v_mul_f32 v48, s20, v48
    v_fma_f32 v56, v56, s20, v45
    v_fma_f32 v52, -v44, v44, v52
    s_waitcnt lgkmcnt(4)
    v_mfma_f32_32x32x16_bf16 v[28:43], a[20:23], v[96:99], v[28:43]
    ds_read_b64_tr_b16 v[108:109], v12 offset:8192
    ds_read_b64_tr_b16 v[110:111], v12 offset:8448
    v_fma_f32 v56, -v48, v48, v56
    v_max_f32 v52, s22, v52
    v_max_f32 v56, s22, v56
    s_waitcnt lgkmcnt(4)
    v_mfma_f32_32x32x16_bf16 v[28:43], a[24:27], v[100:103], v[28:43]
    ds_read_b64_tr_b16 v[112:113], v12 offset:9216
    ds_read_b64_tr_b16 v[114:115], v12 offset:9472
    v_rsq_f32 v52, v52
    v_rsq_f32 v56, v56
    s_waitcnt lgkmcnt(4)
    v_mfma_f32_32x32x16_bf16 v[28:43], a[28:31], v[104:107], v[28:43]
    ds_read_b64_tr_b16 v[92:93], v12 offset:10240
    ds_read_b64_tr_b16 v[94:95], v12 offset:10496
    v_and_b32 v46, 15, v1
    v_lshlrev_b32 v46, 3, v46
    v_add_u32 v46, 97024, v46
    s_waitcnt lgkmcnt(4)
    v_mfma_f32_32x32x16_bf16 v[28:43], a[32:35], v[108:111], v[28:43]
    ds_read_b64_tr_b16 v[96:97], v12 offset:11264
    ds_read_b64_tr_b16 v[98:99], v12 offset:11520
    v_mul_f32 v45, -v44, v52
    v_mul_f32 v44, s23, v52
    v_mul_f32 v49, -v48, v56
    s_waitcnt lgkmcnt(4)
    v_mfma_f32_32x32x16_bf16 v[28:43], a[36:39], v[112:115], v[28:43]
    ds_read_b64_tr_b16 v[100:101], v12 offset:12288
    ds_read_b64_tr_b16 v[102:103], v12 offset:12544
    v_mul_f32 v48, s23, v56
    s_mov_b64 exec, s[34:35]
    ds_write_b64 v46, v[44:45] offset:0
    ds_write_b64 v46, v[48:49] offset:128
    s_mov_b64 exec, -1
    s_waitcnt lgkmcnt(6)
    v_mfma_f32_32x32x16_bf16 v[28:43], a[40:43], v[92:95], v[28:43]
    ds_read_b64_tr_b16 v[104:105], v12 offset:13312
    ds_read_b64_tr_b16 v[106:107], v12 offset:13568
    s_add_u32 s64, s8, 3215360
    buffer_load_dwordx4 v[60:63], v2, s[44:47], s64 offen sc1
    s_waitcnt lgkmcnt(6)
    v_mfma_f32_32x32x16_bf16 v[28:43], a[44:47], v[96:99], v[28:43]
    ds_read_b64_tr_b16 v[108:109], v12 offset:14336
    ds_read_b64_tr_b16 v[110:111], v12 offset:14592
    s_add_u32 s64, s8, 3219456
    buffer_load_dwordx4 v[64:67], v2, s[44:47], s64 offen sc1
    s_waitcnt lgkmcnt(6)
    v_mfma_f32_32x32x16_bf16 v[28:43], a[48:51], v[100:103], v[28:43]
    ds_read_b64_tr_b16 v[112:113], v12 offset:15360
    ds_read_b64_tr_b16 v[114:115], v12 offset:15616
    s_add_u32 s64, s8, 3223552
    buffer_load_dwordx4 v[68:71], v2, s[44:47], s64 offen sc1
    s_waitcnt lgkmcnt(4)
    v_mfma_f32_32x32x16_bf16 v[28:43], a[52:55], v[104:107], v[28:43]
    ds_read_b64_tr_b16 v[92:93], v12 offset:16384
    ds_read_b64_tr_b16 v[94:95], v12 offset:16640
    s_add_u32 s64, s8, 3227648
    buffer_load_dwordx4 v[72:75], v2, s[44:47], s64 offen sc1
    s_waitcnt lgkmcnt(4)
    v_mfma_f32_32x32x16_bf16 v[28:43], a[56:59], v[108:111], v[28:43]
    ds_read_b64_tr_b16 v[96:97], v12 offset:17408
    ds_read_b64_tr_b16 v[98:99], v12 offset:17664
    s_add_u32 s64, s8, 3231744
    buffer_load_dwordx4 v[76:79], v2, s[44:47], s64 offen sc1
    s_waitcnt lgkmcnt(4)
    v_mfma_f32_32x32x16_bf16 v[28:43], a[60:63], v[112:115], v[28:43]
    ds_read_b64_tr_b16 v[100:101], v12 offset:18432
    ds_read_b64_tr_b16 v[102:103], v12 offset:18688
    s_add_u32 s64, s8, 3235840
    buffer_load_dwordx4 v[80:83], v2, s[44:47], s64 offen sc1
    s_waitcnt lgkmcnt(4)
    v_mfma_f32_32x32x16_bf16 v[28:43], a[64:67], v[92:95], v[28:43]
    ds_read_b64_tr_b16 v[104:105], v12 offset:19456
    ds_read_b64_tr_b16 v[106:107], v12 offset:19712
    s_add_u32 s64, s8, 3239936
    buffer_load_dwordx4 v[84:87], v2, s[44:47], s64 offen sc1
    s_waitcnt lgkmcnt(4)
    v_mfma_f32_32x32x16_bf16 v[28:43], a[68:71], v[96:99], v[28:43]
    ds_read_b64_tr_b16 v[108:109], v12 offset:20480
    ds_read_b64_tr_b16 v[110:111], v12 offset:20736
    s_add_u32 s64, s8, 3244032
    buffer_load_dwordx4 v[88:91], v2, s[44:47], s64 offen sc1
    s_waitcnt lgkmcnt(4)
    v_mfma_f32_32x32x16_bf16 v[28:43], a[72:75], v[100:103], v[28:43]
    ds_read_b64_tr_b16 v[112:113], v12 offset:21504
    ds_read_b64_tr_b16 v[114:115], v12 offset:21760
    s_waitcnt lgkmcnt(4)
    v_mfma_f32_32x32x16_bf16 v[28:43], a[76:79], v[104:107], v[28:43]
    ds_read_b64_tr_b16 v[92:93], v12 offset:22528
    ds_read_b64_tr_b16 v[94:95], v12 offset:22784
    s_waitcnt lgkmcnt(4)
    v_mfma_f32_32x32x16_bf16 v[28:43], a[80:83], v[108:111], v[28:43]
    ds_read_b64_tr_b16 v[96:97], v12 offset:23552
    ds_read_b64_tr_b16 v[98:99], v12 offset:23808
    s_waitcnt lgkmcnt(4)
    v_mfma_f32_32x32x16_bf16 v[28:43], a[84:87], v[112:115], v[28:43]
    ds_read_b64_tr_b16 v[100:101], v12 offset:24576
    ds_read_b64_tr_b16 v[102:103], v12 offset:24832
    s_waitcnt lgkmcnt(4)
    v_mfma_f32_32x32x16_bf16 v[28:43], a[88:91], v[92:95], v[28:43]
    ds_read_b64_tr_b16 v[104:105], v12 offset:25600
    ds_read_b64_tr_b16 v[106:107], v12 offset:25856
    s_waitcnt lgkmcnt(4)
    v_mfma_f32_32x32x16_bf16 v[28:43], a[92:95], v[96:99], v[28:43]
    ds_read_b64_tr_b16 v[108:109], v12 offset:26624
    ds_read_b64_tr_b16 v[110:111], v12 offset:26880
    s_waitcnt lgkmcnt(4)
    v_mfma_f32_32x32x16_bf16 v[28:43], a[96:99], v[100:103], v[28:43]
    ds_read_b64_tr_b16 v[112:113], v12 offset:27648
    ds_read_b64_tr_b16 v[114:115], v12 offset:27904
    s_waitcnt lgkmcnt(4)
    v_mfma_f32_32x32x16_bf16 v[28:43], a[100:103], v[104:107], v[28:43]
    ds_read_b64_tr_b16 v[92:93], v12 offset:28672
    ds_read_b64_tr_b16 v[94:95], v12 offset:28928
    s_waitcnt lgkmcnt(4)
    v_mfma_f32_32x32x16_bf16 v[28:43], a[104:107], v[108:111], v[28:43]
    ds_read_b64_tr_b16 v[96:97], v12 offset:29696
    ds_read_b64_tr_b16 v[98:99], v12 offset:29952
    s_waitcnt vmcnt(0)
    v_xor_b32 v60, s54, v60
    v_xor_b32 v64, s54, v64
    v_xor_b32 v68, s54, v68
    v_xor_b32 v72, s54, v72
    v_xor_b32 v76, s54, v76
    v_xor_b32 v80, s54, v80
    v_xor_b32 v84, s54, v84
    v_xor_b32 v88, s54, v88
    v_min3_f32 v136, |v60|, |v64|, |v68|
    v_min3_f32 v136, v136, |v72|, |v76|
    v_min3_f32 v136, v136, |v80|, |v84|
    v_min_f32 v136, v136, |v88|
    v_max3_f32 v137, |v60|, |v64|, |v68|
    v_max3_f32 v137, v137, |v72|, |v76|
    v_max3_f32 v137, v137, |v80|, |v84|
    v_max_f32 v137, v137, |v88|
    v_cmp_le_f32 s[70:71], s55, v137
    v_cmp_gt_f32 vcc, s54, v136
    s_nop 0
    s_or_b64 vcc, vcc, s[70:71]
    s_cbranch_vccnz L_m_s72
L_m_r73:
    s_waitcnt lgkmcnt(4)
    v_mfma_f32_32x32x16_bf16 v[28:43], a[108:111], v[112:115], v[28:43]
    ds_read_b64_tr_b16 v[100:101], v12 offset:30720
    ds_read_b64_tr_b16 v[102:103], v12 offset:30976
    ds_write_b128 v11, v[60:63] offset:32768
    s_waitcnt lgkmcnt(5)
    v_mfma_f32_32x32x16_bf16 v[28:43], a[112:115], v[92:95], v[28:43]
    ds_read_b64_tr_b16 v[104:105], v12 offset:31744
    ds_read_b64_tr_b16 v[106:107], v12 offset:32000
    ds_write_b128 v11, v[64:67] offset:36864
    s_waitcnt lgkmcnt(6)
    v_mfma_f32_32x32x16_bf16 v[28:43], a[116:119], v[96:99], v[28:43]
    ds_write_b128 v11, v[68:71] offset:40960
    ds_write_b128 v11, v[72:75] offset:45056
    s_waitcnt lgkmcnt(6)
    v_mfma_f32_32x32x16_bf16 v[28:43], a[120:123], v[100:103], v[28:43]
    ds_write_b128 v11, v[76:79] offset:49152
    ds_write_b128 v11, v[80:83] offset:53248
    s_waitcnt lgkmcnt(5)
    v_mfma_f32_32x32x16_bf16 v[28:43], a[124:127], v[104:107], v[28:43]
    ds_write_b128 v11, v[84:87] offset:57344
    ds_write_b128 v11, v[88:91] offset:61440
    s_waitcnt lgkmcnt(0)
    s_barrier
    ds_read_b64_tr_b16 v[92:93], v13 offset:32768
    ds_read_b64_tr_b16 v[94:95], v13 offset:33024
    ds_read_b64_tr_b16 v[96:97], v13 offset:32832
    ds_read_b64_tr_b16 v[98:99], v13 offset:33088
    ds_read_b64_tr_b16 v[100:101], v13 offset:34816
    ds_read_b64_tr_b16 v[102:103], v13 offset:35072
    ds_read_b64_tr_b16 v[104:105], v13 offset:34880
    ds_read_b64_tr_b16 v[106:107], v13 offset:35136
    ds_read_b64_tr_b16 v[108:109], v13 offset:36864
    ds_read_b64_tr_b16 v[110:111], v13 offset:37120
    s_waitcnt lgkmcnt(8)
    v_mfma_f32_16x16x32_bf16 v[76:79], v[24:27], v[92:95], 0
    ds_read_b128 v[152:155], v19 offset:32768
    v_mfma_f32_16x16x32_bf16 v[84:87], v[92:95], v[92:95], 0
    ds_read_b64 v[156:157], v15 offset:0
    ds_read_b128 v[116:119], v14 offset:0
    s_waitcnt lgkmcnt(9)
    v_mfma_f32_16x16x32_bf16 v[80:83], v[24:27], v[96:99], 0
    ds_read_b64_tr_b16 v[112:113], v13 offset:36928
    v_mfma_f32_16x16x32_bf16 v[88:91], v[96:99], v[96:99], 0
    ds_read_b64_tr_b16 v[114:115], v13 offset:37184
    ds_read_b128 v[120:123], v14 offset:32
    s_waitcnt lgkmcnt(10)
    v_mfma_f32_16x16x32_bf16 v[76:79], v[24:27], v[100:103], v[76:79]
    ds_read_b64_tr_b16 v[92:93], v13 offset:38912
    v_mfma_f32_16x16x32_bf16 v[84:87], v[100:103], v[100:103], v[84:87]
    ds_read_b64_tr_b16 v[94:95], v13 offset:39168
    ds_read_b128 v[124:127], v14 offset:896
    s_waitcnt lgkmcnt(11)
    v_mfma_f32_16x16x32_bf16 v[80:83], v[24:27], v[104:107], v[80:83]
    ds_read_b64_tr_b16 v[96:97], v13 offset:38976
    v_mfma_f32_16x16x32_bf16 v[88:91], v[104:107], v[104:107], v[88:91]
    ds_read_b64_tr_b16 v[98:99], v13 offset:39232
    ds_read_b128 v[128:131], v14 offset:928
    s_waitcnt lgkmcnt(12)
    v_mfma_f32_16x16x32_bf16 v[76:79], v[24:27], v[108:111], v[76:79]
    ds_read_b64_tr_b16 v[100:101], v13 offset:40960
    v_mfma_f32_16x16x32_bf16 v[84:87], v[108:111], v[108:111], v[84:87]
    ds_read_b64_tr_b16 v[102:103], v13 offset:41216
    ds_read_b128 v[132:135], v14 offset:64
    s_waitcnt lgkmcnt(10)
    v_mfma_f32_16x16x32_bf16 v[80:83], v[24:27], v[112:115], v[80:83]
    ds_read_b64_tr_b16 v[104:105], v13 offset:41024
    v_mfma_f32_16x16x32_bf16 v[88:91], v[112:115], v[112:115], v[88:91]
    ds_read_b64_tr_b16 v[106:107], v13 offset:41280
    ds_read_b128 v[136:139], v14 offset:96
    s_waitcnt lgkmcnt(10)
    v_mfma_f32_16x16x32_bf16 v[76:79], v[24:27], v[92:95], v[76:79]
    ds_read_b64_tr_b16 v[108:109], v13 offset:43008
    v_mfma_f32_16x16x32_bf16 v[84:87], v[92:95], v[92:95], v[84:87]
    ds_read_b64_tr_b16 v[110:111], v13 offset:43264
    ds_read_b128 v[140:143], v14 offset:960
    s_waitcnt lgkmcnt(10)
    v_mfma_f32_16x16x32_bf16 v[80:83], v[24:27], v[96:99], v[80:83]
    ds_read_b64_tr_b16 v[112:113], v13 offset:43072
    v_mfma_f32_16x16x32_bf16 v[88:91], v[96:99], v[96:99], v[88:91]
    ds_read_b64_tr_b16 v[114:115], v13 offset:43328
    ds_read_b128 v[144:147], v14 offset:992
    s_waitcnt lgkmcnt(10)
    v_mfma_f32_16x16x32_bf16 v[76:79], v[24:27], v[100:103], v[76:79]
    ds_read_b64_tr_b16 v[92:93], v13 offset:45056
    v_mfma_f32_16x16x32_bf16 v[84:87], v[100:103], v[100:103], v[84:87]
    ds_read_b64_tr_b16 v[94:95], v13 offset:45312
    v_fmac_f32 v124, v116, v157
    s_waitcnt lgkmcnt(9)
    v_mfma_f32_16x16x32_bf16 v[80:83], v[24:27], v[104:107], v[80:83]
    ds_read_b64_tr_b16 v[96:97], v13 offset:45120
    v_mfma_f32_16x16x32_bf16 v[88:91], v[104:107], v[104:107], v[88:91]
    ds_read_b64_tr_b16 v[98:99], v13 offset:45376
    v_fmac_f32 v125, v117, v157
    s_waitcnt lgkmcnt(8)
    v_mfma_f32_16x16x32_bf16 v[76:79], v[24:27], v[108:111], v[76:79]
    ds_read_b64_tr_b16 v[100:101], v13 offset:47104
    v_mfma_f32_16x16x32_bf16 v[84:87], v[108:111], v[108:111], v[84:87]
    ds_read_b64_tr_b16 v[102:103], v13 offset:47360
    v_fmac_f32 v126, v118, v157
    s_waitcnt lgkmcnt(7)
    v_mfma_f32_16x16x32_bf16 v[80:83], v[24:27], v[112:115], v[80:83]
    ds_read_b64_tr_b16 v[104:105], v13 offset:47168
    v_mfma_f32_16x16x32_bf16 v[88:91], v[112:115], v[112:115], v[88:91]
    ds_read_b64_tr_b16 v[106:107], v13 offset:47424
    v_fmac_f32 v127, v119, v157
    s_waitcnt lgkmcnt(6)
    v_mfma_f32_16x16x32_bf16 v[76:79], v[24:27], v[92:95], v[76:79]
    ds_read_b64_tr_b16 v[108:109], v13 offset:49152
    v_mfma_f32_16x16x32_bf16 v[84:87], v[92:95], v[92:95], v[84:87]
    ds_read_b64_tr_b16 v[110:111], v13 offset:49408
    v_fmac_f32 v128, v120, v157
    s_waitcnt lgkmcnt(6)
    v_mfma_f32_16x16x32_bf16 v[80:83], v[24:27], v[96:99], v[80:83]
    ds_read_b64_tr_b16 v[112:113], v13 offset:49216
    v_mfma_f32_16x16x32_bf16 v[88:91], v[96:99], v[96:99], v[88:91]
    ds_read_b64_tr_b16 v[114:115], v13 offset:49472
    v_fmac_f32 v129, v121, v157
    s_waitcnt lgkmcnt(6)
    v_mfma_f32_16x16x32_bf16 v[76:79], v[24:27], v[100:103], v[76:79]
    ds_read_b64_tr_b16 v[92:93], v13 offset:51200
    v_mfma_f32_16x16x32_bf16 v[84:87], v[100:103], v[100:103], v[84:87]
    ds_read_b64_tr_b16 v[94:95], v13 offset:51456
    v_fmac_f32 v130, v122, v157
    s_waitcnt lgkmcnt(6)
    v_mfma_f32_16x16x32_bf16 v[80:83], v[24:27], v[104:107], v[80:83]
    ds_read_b64_tr_b16 v[96:97], v13 offset:51264
    v_mfma_f32_16x16x32_bf16 v[88:91], v[104:107], v[104:107], v[88:91]
    ds_read_b64_tr_b16 v[98:99], v13 offset:51520
    v_fmac_f32 v131, v123, v157
    s_waitcnt lgkmcnt(6)
    v_mfma_f32_16x16x32_bf16 v[76:79], v[24:27], v[108:111], v[76:79]
    ds_read_b64_tr_b16 v[100:101], v13 offset:53248
    v_mfma_f32_16x16x32_bf16 v[84:87], v[108:111], v[108:111], v[84:87]
    ds_read_b64_tr_b16 v[102:103], v13 offset:53504
    v_fmac_f32 v124, v28, v156
    s_waitcnt lgkmcnt(6)
    v_mfma_f32_16x16x32_bf16 v[80:83], v[24:27], v[112:115], v[80:83]
    ds_read_b64_tr_b16 v[104:105], v13 offset:53312
    v_mfma_f32_16x16x32_bf16 v[88:91], v[112:115], v[112:115], v[88:91]
    ds_read_b64_tr_b16 v[106:107], v13 offset:53568
    v_fmac_f32 v125, v29, v156
    s_waitcnt lgkmcnt(6)
    v_mfma_f32_16x16x32_bf16 v[76:79], v[24:27], v[92:95], v[76:79]
    ds_read_b64_tr_b16 v[108:109], v13 offset:55296
    v_mfma_f32_16x16x32_bf16 v[84:87], v[92:95], v[92:95], v[84:87]
    ds_read_b64_tr_b16 v[110:111], v13 offset:55552
    v_fmac_f32 v126, v30, v156
    s_waitcnt lgkmcnt(6)
    v_mfma_f32_16x16x32_bf16 v[80:83], v[24:27], v[96:99], v[80:83]
    ds_read_b64_tr_b16 v[112:113], v13 offset:55360
    v_mfma_f32_16x16x32_bf16 v[88:91], v[96:99], v[96:99], v[88:91]
    ds_read_b64_tr_b16 v[114:115], v13 offset:55616
    v_fmac_f32 v127, v31, v156
    s_waitcnt lgkmcnt(6)
    v_mfma_f32_16x16x32_bf16 v[76:79], v[24:27], v[100:103], v[76:79]
    ds_read_b64_tr_b16 v[92:93], v13 offset:57344
    v_mfma_f32_16x16x32_bf16 v[84:87], v[100:103], v[100:103], v[84:87]
    ds_read_b64_tr_b16 v[94:95], v13 offset:57600
    v_fmac_f32 v128, v32, v156
    s_waitcnt lgkmcnt(6)
    v_mfma_f32_16x16x32_bf16 v[80:83], v[24:27], v[104:107], v[80:83]
    ds_read_b64_tr_b16 v[96:97], v13 offset:57408
    v_mfma_f32_16x16x32_bf16 v[88:91], v[104:107], v[104:107], v[88:91]
    ds_read_b64_tr_b16 v[98:99], v13 offset:57664
    v_fmac_f32 v129, v33, v156
    s_waitcnt lgkmcnt(6)
    v_mfma_f32_16x16x32_bf16 v[76:79], v[24:27], v[108:111], v[76:79]
    ds_read_b64_tr_b16 v[100:101], v13 offset:59392
    v_mfma_f32_16x16x32_bf16 v[84:87], v[108:111], v[108:111], v[84:87]
    ds_read_b64_tr_b16 v[102:103], v13 offset:59648
    v_fmac_f32 v130, v34, v156
    s_waitcnt lgkmcnt(6)
    v_mfma_f32_16x16x32_bf16 v[80:83], v[24:27], v[112:115], v[80:83]
    ds_read_b64_tr_b16 v[104:105], v13 offset:59456
    v_mfma_f32_16x16x32_bf16 v[88:91], v[112:115], v[112:115], v[88:91]
    ds_read_b64_tr_b16 v[106:107], v13 offset:59712
    v_fmac_f32 v131, v35, v156
    s_waitcnt lgkmcnt(6)
    v_mfma_f32_16x16x32_bf16 v[76:79], v[24:27], v[92:95], v[76:79]
    ds_read_b64_tr_b16 v[108:109], v13 offset:61440
    v_mfma_f32_16x16x32_bf16 v[84:87], v[92:95], v[92:95], v[84:87]
    ds_read_b64_tr_b16 v[110:111], v13 offset:61696
    v_exp_f32 v28, v124
    s_waitcnt lgkmcnt(6)
    v_mfma_f32_16x16x32_bf16 v[80:83], v[24:27], v[96:99], v[80:83]
    ds_read_b64_tr_b16 v[112:113], v13 offset:61504
    v_mfma_f32_16x16x32_bf16 v[88:91], v[96:99], v[96:99], v[88:91]
    ds_read_b64_tr_b16 v[114:115], v13 offset:61760
    v_exp_f32 v29, v125
    s_waitcnt lgkmcnt(6)
    v_mfma_f32_16x16x32_bf16 v[76:79], v[24:27], v[100:103], v[76:79]
    ds_read_b64_tr_b16 v[92:93], v13 offset:63488
    v_mfma_f32_16x16x32_bf16 v[84:87], v[100:103], v[100:103], v[84:87]
    ds_read_b64_tr_b16 v[94:95], v13 offset:63744
    v_exp_f32 v30, v126
    s_waitcnt lgkmcnt(6)
    v_mfma_f32_16x16x32_bf16 v[80:83], v[24:27], v[104:107], v[80:83]
    ds_read_b64_tr_b16 v[96:97], v13 offset:63552
    v_mfma_f32_16x16x32_bf16 v[88:91], v[104:107], v[104:107], v[88:91]
    ds_read_b64_tr_b16 v[98:99], v13 offset:63808
    v_exp_f32 v31, v127
    s_waitcnt lgkmcnt(6)
    v_mfma_f32_16x16x32_bf16 v[76:79], v[24:27], v[108:111], v[76:79]
    v_exp_f32 v32, v128
    v_mfma_f32_16x16x32_bf16 v[84:87], v[108:111], v[108:111], v[84:87]
    v_exp_f32 v33, v129
    s_waitcnt lgkmcnt(4)
    v_mfma_f32_16x16x32_bf16 v[80:83], v[24:27], v[112:115], v[80:83]
    v_exp_f32 v34, v130
    v_mfma_f32_16x16x32_bf16 v[88:91], v[112:115], v[112:115], v[88:91]
    v_exp_f32 v35, v131
    s_waitcnt lgkmcnt(2)
    v_mfma_f32_16x16x32_bf16 v[76:79], v[24:27], v[92:95], v[76:79]
    v_fma_f32 v116, v28, 0.5, 1.0
    v_mfma_f32_16x16x32_bf16 v[84:87], v[92:95], v[92:95], v[84:87]
    v_fma_f32 v117, v29, 0.5, 1.0
    v_fma_f32 v118, v30, 0.5, 1.0
    s_waitcnt lgkmcnt(0)
    v_mfma_f32_16x16x32_bf16 v[80:83], v[24:27], v[96:99], v[80:83]
    v_fma_f32 v119, v31, 0.5, 1.0
    v_mfma_f32_16x16x32_bf16 v[88:91], v[96:99], v[96:99], v[88:91]
    v_fma_f32 v120, v32, 0.5, 1.0
    v_fma_f32 v121, v33, 0.5, 1.0
    ds_read_b64_tr_b16 v[100:101], v12 offset:32768
    ds_read_b64_tr_b16 v[102:103], v12 offset:33024
    ds_read_b64_tr_b16 v[104:105], v12 offset:33792
    ds_read_b64_tr_b16 v[106:107], v12 offset:34048
    ds_read_b64_tr_b16 v[108:109], v12 offset:34816
    ds_read_b64_tr_b16 v[110:111], v12 offset:35072
    ds_read_b64_tr_b16 v[112:113], v12 offset:35840
    ds_read_b64_tr_b16 v[114:115], v12 offset:36096
    s_waitcnt lgkmcnt(6)
    v_mfma_f32_32x32x16_bf16 v[60:75], a[0:3], v[100:103], 0
    v_fma_f32 v122, v34, 0.5, 1.0
    v_fma_f32 v123, v35, 0.5, 1.0
    v_fma_f32 v28, -v28, v116, -1.0
    v_fma_f32 v29, -v29, v117, -1.0
    v_fma_f32 v30, -v30, v118, -1.0
    s_waitcnt lgkmcnt(4)
    v_mfma_f32_32x32x16_bf16 v[60:75], a[4:7], v[104:107], v[60:75]
    ds_read_b64_tr_b16 v[92:93], v12 offset:36864
    ds_read_b64_tr_b16 v[94:95], v12 offset:37120
    v_cndmask_b32 v84, v84, v85, s[30:31]
    v_cndmask_b32 v86, v86, v87, s[30:31]
    v_cndmask_b32 v88, v88, v89, s[30:31]
    s_waitcnt lgkmcnt(4)
    v_mfma_f32_32x32x16_bf16 v[60:75], a[8:11], v[108:111], v[60:75]
    ds_read_b64_tr_b16 v[96:97], v12 offset:37888
    ds_read_b64_tr_b16 v[98:99], v12 offset:38144
    v_cndmask_b32 v90, v90, v91, s[30:31]
    v_mov_b32 v77, s22
    v_cndmask_b32 v84, v84, v86, s[32:33]
    s_waitcnt lgkmcnt(4)
    v_mfma_f32_32x32x16_bf16 v[60:75], a[12:15], v[112:115], v[60:75]
    ds_read_b64_tr_b16 v[100:101], v12 offset:38912
    ds_read_b64_tr_b16 v[102:103], v12 offset:39168
    v_cndmask_b32 v88, v88, v90, s[32:33]
    v_mul_f32 v76, s20, v76
    v_fma_f32 v84, v84, s20, v77
    s_waitcnt lgkmcnt(4)
    v_mfma_f32_32x32x16_bf16 v[60:75], a[16:19], v[92:95], v[60:75]
    ds_read_b64_tr_b16 v[104:105], v12 offset:39936
    ds_read_b64_tr_b16 v[106:107], v12 offset:40192
    v_mul_f32 v80, s20, v80
    v_fma_f32 v88, v88, s20, v77
    v_fma_f32 v84, -v76, v76, v84
    s_waitcnt lgkmcnt(4)
    v_mfma_f32_32x32x16_bf16 v[60:75], a[20:23], v[96:99], v[60:75]
    ds_read_b64_tr_b16 v[108:109], v12 offset:40960
    ds_read_b64_tr_b16 v[110:111], v12 offset:41216
    v_fma_f32 v88, -v80, v80, v88
    v_max_f32 v84, s22, v84
    v_max_f32 v88, s22, v88
    s_waitcnt lgkmcnt(4)
    v_mfma_f32_32x32x16_bf16 v[60:75], a[24:27], v[100:103], v[60:75]
    ds_read_b64_tr_b16 v[112:113], v12 offset:41984
    ds_read_b64_tr_b16 v[114:115], v12 offset:42240
    v_rsq_f32 v84, v84
    v_rsq_f32 v88, v88
    s_waitcnt lgkmcnt(4)
    v_mfma_f32_32x32x16_bf16 v[60:75], a[28:31], v[104:107], v[60:75]
    ds_read_b64_tr_b16 v[92:93], v12 offset:43008
    ds_read_b64_tr_b16 v[94:95], v12 offset:43264
    v_and_b32 v78, 15, v1
    v_lshlrev_b32 v78, 3, v78
    v_add_u32 v78, 97024, v78
    s_waitcnt lgkmcnt(4)
    v_mfma_f32_32x32x16_bf16 v[60:75], a[32:35], v[108:111], v[60:75]
    ds_read_b64_tr_b16 v[96:97], v12 offset:44032
    ds_read_b64_tr_b16 v[98:99], v12 offset:44288
    v_mul_f32 v77, -v76, v84
    v_mul_f32 v76, s23, v84
    v_mul_f32 v81, -v80, v88
    s_waitcnt lgkmcnt(4)
    v_mfma_f32_32x32x16_bf16 v[60:75], a[36:39], v[112:115], v[60:75]
    ds_read_b64_tr_b16 v[100:101], v12 offset:45056
    ds_read_b64_tr_b16 v[102:103], v12 offset:45312
    v_mul_f32 v80, s23, v88
    s_mov_b64 exec, s[34:35]
    ds_write_b64 v78, v[76:77] offset:256
    ds_write_b64 v78, v[80:81] offset:384
    s_mov_b64 exec, -1
    s_waitcnt lgkmcnt(6)
    v_mfma_f32_32x32x16_bf16 v[60:75], a[40:43], v[92:95], v[60:75]
    ds_read_b64_tr_b16 v[104:105], v12 offset:46080
    ds_read_b64_tr_b16 v[106:107], v12 offset:46336
    v_fma_f32 v31, -v31, v119, -1.0
    v_fma_f32 v32, -v32, v120, -1.0
    v_fma_f32 v33, -v33, v121, -1.0
    s_waitcnt lgkmcnt(6)
    v_mfma_f32_32x32x16_bf16 v[60:75], a[44:47], v[96:99], v[60:75]
    ds_read_b64_tr_b16 v[108:109], v12 offset:47104
    ds_read_b64_tr_b16 v[110:111], v12 offset:47360
    v_fma_f32 v34, -v34, v122, -1.0
    v_fma_f32 v35, -v35, v123, -1.0
    v_rcp_f32 v28, v28
    s_waitcnt lgkmcnt(6)
    v_mfma_f32_32x32x16_bf16 v[60:75], a[48:51], v[100:103], v[60:75]
    ds_read_b64_tr_b16 v[112:113], v12 offset:48128
    ds_read_b64_tr_b16 v[114:115], v12 offset:48384
    v_rcp_f32 v29, v29
    v_rcp_f32 v30, v30
    s_waitcnt lgkmcnt(4)
    v_mfma_f32_32x32x16_bf16 v[60:75], a[52:55], v[104:107], v[60:75]
    ds_read_b64_tr_b16 v[92:93], v12 offset:49152
    ds_read_b64_tr_b16 v[94:95], v12 offset:49408
    v_rcp_f32 v31, v31
    v_rcp_f32 v32, v32
    s_waitcnt lgkmcnt(4)
    v_mfma_f32_32x32x16_bf16 v[60:75], a[56:59], v[108:111], v[60:75]
    ds_read_b64_tr_b16 v[96:97], v12 offset:50176
    ds_read_b64_tr_b16 v[98:99], v12 offset:50432
    v_rcp_f32 v33, v33
    v_rcp_f32 v34, v34
    s_waitcnt lgkmcnt(4)
    v_mfma_f32_32x32x16_bf16 v[60:75], a[60:63], v[112:115], v[60:75]
    ds_read_b64_tr_b16 v[100:101], v12 offset:51200
    ds_read_b64_tr_b16 v[102:103], v12 offset:51456
    v_rcp_f32 v35, v35
    v_fmac_f32 v124, v28, v124
    s_waitcnt lgkmcnt(4)
    v_mfma_f32_32x32x16_bf16 v[60:75], a[64:67], v[92:95], v[60:75]
    ds_read_b64_tr_b16 v[104:105], v12 offset:52224
    ds_read_b64_tr_b16 v[106:107], v12 offset:52480
    v_fmac_f32 v125, v29, v125
    v_fmac_f32 v126, v30, v126
    v_fmac_f32 v127, v31, v127
    s_waitcnt lgkmcnt(4)
    v_mfma_f32_32x32x16_bf16 v[60:75], a[68:71], v[96:99], v[60:75]
    ds_read_b64_tr_b16 v[108:109], v12 offset:53248
    ds_read_b64_tr_b16 v[110:111], v12 offset:53504
    v_fmac_f32 v128, v32, v128
    v_fmac_f32 v129, v33, v129
    v_fmac_f32 v130, v34, v130
    s_waitcnt lgkmcnt(4)
    v_mfma_f32_32x32x16_bf16 v[60:75], a[72:75], v[100:103], v[60:75]
    ds_read_b64_tr_b16 v[112:113], v12 offset:54272
    ds_read_b64_tr_b16 v[114:115], v12 offset:54528
    v_fmac_f32 v131, v35, v131
    v_max_u32 v125, s54, v125
    v_max_i32 v125, 0xa0000000, v125
    s_waitcnt lgkmcnt(4)
    v_mfma_f32_32x32x16_bf16 v[60:75], a[76:79], v[104:107], v[60:75]
    ds_read_b64_tr_b16 v[92:93], v12 offset:55296
    ds_read_b64_tr_b16 v[94:95], v12 offset:55552
    v_cvt_pk_bf16_f32 v117, v126, v127
    v_cvt_pk_bf16_f32 v118, v128, v129
    v_cvt_pk_bf16_f32 v119, v130, v131
    s_waitcnt lgkmcnt(4)
    v_mfma_f32_32x32x16_bf16 v[60:75], a[80:83], v[108:111], v[60:75]
    ds_read_b64_tr_b16 v[96:97], v12 offset:56320
    ds_read_b64_tr_b16 v[98:99], v12 offset:56576
    v_cvt_pk_bf16_f32 v116, v124, v125
    v_xor_b32 v116, s54, v116
    s_add_u32 s66, s9, 0
    buffer_store_dwordx4 v[116:119], v2, s[44:47], s66 offen offset:0 sc1
    s_waitcnt lgkmcnt(4)
    v_mfma_f32_32x32x16_bf16 v[60:75], a[84:87], v[112:115], v[60:75]
    ds_read_b64_tr_b16 v[100:101], v12 offset:57344
    ds_read_b64_tr_b16 v[102:103], v12 offset:57600
    v_fmac_f32 v140, v132, v157
    v_fmac_f32 v141, v133, v157
    v_fmac_f32 v142, v134, v157
    s_waitcnt lgkmcnt(4)
    v_mfma_f32_32x32x16_bf16 v[60:75], a[88:91], v[92:95], v[60:75]
    ds_read_b64_tr_b16 v[104:105], v12 offset:58368
    ds_read_b64_tr_b16 v[106:107], v12 offset:58624
    v_fmac_f32 v143, v135, v157
    v_fmac_f32 v144, v136, v157
    v_fmac_f32 v145, v137, v157
    s_waitcnt lgkmcnt(4)
    v_mfma_f32_32x32x16_bf16 v[60:75], a[92:95], v[96:99], v[60:75]
    ds_read_b64_tr_b16 v[108:109], v12 offset:59392
    ds_read_b64_tr_b16 v[110:111], v12 offset:59648
    v_fmac_f32 v146, v138, v157
    v_fmac_f32 v147, v139, v157
    v_fmac_f32 v140, v36, v156
    s_waitcnt lgkmcnt(4)
    v_mfma_f32_32x32x16_bf16 v[60:75], a[96:99], v[100:103], v[60:75]
    ds_read_b64_tr_b16 v[112:113], v12 offset:60416
    ds_read_b64_tr_b16 v[114:115], v12 offset:60672
    v_fmac_f32 v141, v37, v156
    v_fmac_f32 v142, v38, v156
    v_fmac_f32 v143, v39, v156
    s_waitcnt lgkmcnt(4)
    v_mfma_f32_32x32x16_bf16 v[60:75], a[100:103], v[104:107], v[60:75]
    ds_read_b64_tr_b16 v[92:93], v12 offset:61440
    ds_read_b64_tr_b16 v[94:95], v12 offset:61696
    v_fmac_f32 v144, v40, v156
    v_fmac_f32 v145, v41, v156
    v_fmac_f32 v146, v42, v156
    s_waitcnt lgkmcnt(4)
    v_mfma_f32_32x32x16_bf16 v[60:75], a[104:107], v[108:111], v[60:75]
    ds_read_b64_tr_b16 v[96:97], v12 offset:62464
    ds_read_b64_tr_b16 v[98:99], v12 offset:62720
    v_fmac_f32 v147, v43, v156
    v_exp_f32 v36, v140
    s_waitcnt lgkmcnt(4)
    v_mfma_f32_32x32x16_bf16 v[60:75], a[108:111], v[112:115], v[60:75]
    ds_read_b64_tr_b16 v[100:101], v12 offset:63488
    ds_read_b64_tr_b16 v[102:103], v12 offset:63744
    v_exp_f32 v37, v141
    v_exp_f32 v38, v142
    s_waitcnt lgkmcnt(4)
    v_mfma_f32_32x32x16_bf16 v[60:75], a[112:115], v[92:95], v[60:75]
    ds_read_b64_tr_b16 v[104:105], v12 offset:64512
    ds_read_b64_tr_b16 v[106:107], v12 offset:64768
    v_exp_f32 v39, v143
    v_exp_f32 v40, v144
    s_waitcnt lgkmcnt(4)
    v_mfma_f32_32x32x16_bf16 v[60:75], a[116:119], v[96:99], v[60:75]
    v_exp_f32 v41, v145
    v_exp_f32 v42, v146
    v_exp_f32 v43, v147
    s_waitcnt lgkmcnt(2)
    v_mfma_f32_32x32x16_bf16 v[60:75], a[120:123], v[100:103], v[60:75]
    v_fma_f32 v132, v36, 0.5, 1.0
    v_fma_f32 v133, v37, 0.5, 1.0
    v_fma_f32 v134, v38, 0.5, 1.0
    v_fma_f32 v135, v39, 0.5, 1.0
    v_fma_f32 v136, v40, 0.5, 1.0
    s_waitcnt lgkmcnt(0)
    v_mfma_f32_32x32x16_bf16 v[60:75], a[124:127], v[104:107], v[60:75]
    v_fma_f32 v137, v41, 0.5, 1.0
    v_fma_f32 v138, v42, 0.5, 1.0
    v_fma_f32 v139, v43, 0.5, 1.0
    v_fma_f32 v36, -v36, v132, -1.0
    v_fma_f32 v37, -v37, v133, -1.0
    s_add_u32 s69, s78, 0
    buffer_load_dwordx4 v[92:95], v2, s[44:47], s69 offen sc1
    v_fma_f32 v38, -v38, v134, -1.0
    v_fma_f32 v39, -v39, v135, -1.0
    v_fma_f32 v40, -v40, v136, -1.0
    v_fma_f32 v41, -v41, v137, -1.0
    v_fma_f32 v42, -v42, v138, -1.0
    v_fma_f32 v43, -v43, v139, -1.0
    s_add_u32 s69, s80, 0
    buffer_load_dwordx4 v[96:99], v2, s[44:47], s69 offen sc1
    v_rcp_f32 v36, v36
    v_rcp_f32 v37, v37
    v_rcp_f32 v38, v38
    v_rcp_f32 v39, v39
    v_rcp_f32 v40, v40
    v_rcp_f32 v41, v41
    v_rcp_f32 v42, v42
    s_add_u32 s69, s78, 4096
    buffer_load_dwordx4 v[100:103], v2, s[44:47], s69 offen sc1
    v_rcp_f32 v43, v43
    v_fmac_f32 v140, v36, v140
    v_fmac_f32 v141, v37, v141
    v_fmac_f32 v142, v38, v142
    v_fmac_f32 v143, v39, v143
    v_fmac_f32 v144, v40, v144
    v_fmac_f32 v145, v41, v145
    s_add_u32 s69, s80, 12288
    buffer_load_dwordx4 v[104:107], v2, s[44:47], s69 offen sc1
    v_fmac_f32 v146, v42, v146
    v_fmac_f32 v147, v43, v147
    v_max_u32 v141, s54, v141
    v_max_i32 v141, 0xa0000000, v141
    v_cvt_pk_bf16_f32 v133, v142, v143
    v_cvt_pk_bf16_f32 v134, v144, v145
    v_cvt_pk_bf16_f32 v135, v146, v147
    s_add_u32 s69, s78, 16384
    buffer_load_dwordx4 v[108:111], v2, s[44:47], s69 offen sc1
    v_cvt_pk_bf16_f32 v132, v140, v141
    v_xor_b32 v132, s54, v132
    s_add_u32 s66, s9, 0
    buffer_store_dwordx4 v[132:135], v2, s[44:47], s66 offen offset:1024 sc1
    v_perm_b32 v158, v154, v152, s18
    v_perm_b32 v159, v154, v152, s19
    v_perm_b32 v154, v155, v153, s18
    s_add_u32 s69, s80, 16384
    buffer_load_dwordx4 v[112:115], v2, s[44:47], s69 offen sc1
    v_perm_b32 v155, v155, v153, s19
    v_mov_b32 v152, v158
    v_mov_b32 v153, v159
    v_permlane16_swap_b32 v154, v155
    s_nop 0
    v_permlane16_swap_b32 v152, v153
    s_nop 1
    v_permlane32_swap_b32 v152, v154
    v_permlane32_swap_b32 v153, v155
    s_barrier
    s_add_u32 s69, s79, 0
    buffer_load_dwordx4 v[28:31], v2, s[44:47], s69 offen sc1
    ds_read_b64 v[158:159], v15 offset:256
    ds_read_b128 v[116:119], v14 offset:0
    ds_read_b128 v[120:123], v14 offset:32
    ds_read_b128 v[124:127], v14 offset:896
    ds_read_b128 v[128:131], v14 offset:928
    ds_read_b128 v[132:135], v14 offset:64
    ds_read_b128 v[136:139], v14 offset:96
    ds_read_b128 v[140:143], v14 offset:960
    ds_read_b128 v[144:147], v14 offset:992
    s_waitcnt lgkmcnt(4)
    v_pk_fma_f32 v[124:125], v[116:117], v[158:159], v[124:125] op_sel:[0,1,0] op_sel_hi:[1,1,1]
    v_pk_fma_f32 v[126:127], v[118:119], v[158:159], v[126:127] op_sel:[0,1,0] op_sel_hi:[1,1,1]
    s_add_u32 s69, s81, 0
    buffer_load_dwordx4 v[32:35], v2, s[44:47], s69 offen sc1
    v_pk_fma_f32 v[128:129], v[120:121], v[158:159], v[128:129] op_sel:[0,1,0] op_sel_hi:[1,1,1]
    v_pk_fma_f32 v[130:131], v[122:123], v[158:159], v[130:131] op_sel:[0,1,0] op_sel_hi:[1,1,1]
    v_pk_fma_f32 v[124:125], v[60:61], v[158:159], v[124:125] op_sel:[0,0,0] op_sel_hi:[1,0,1]
    v_pk_fma_f32 v[126:127], v[62:63], v[158:159], v[126:127] op_sel:[0,0,0] op_sel_hi:[1,0,1]
    v_pk_fma_f32 v[128:129], v[64:65], v[158:159], v[128:129] op_sel:[0,0,0] op_sel_hi:[1,0,1]
    v_pk_fma_f32 v[130:131], v[66:67], v[158:159], v[130:131] op_sel:[0,0,0] op_sel_hi:[1,0,1]
    v_exp_f32 v60, v124
    v_exp_f32 v61, v125
    v_exp_f32 v62, v126
    v_exp_f32 v63, v127
    v_exp_f32 v64, v128
    v_exp_f32 v65, v129
    v_exp_f32 v66, v130
    s_add_u32 s69, s79, 4096
    buffer_load_dwordx4 v[36:39], v2, s[44:47], s69 offen sc1
    v_exp_f32 v67, v131
    v_pk_fma_f32 v[116:117], v[60:61], 0.5, 1.0 op_sel_hi:[1,0,0]
    v_pk_fma_f32 v[118:119], v[62:63], 0.5, 1.0 op_sel_hi:[1,0,0]
    v_pk_fma_f32 v[120:121], v[64:65], 0.5, 1.0 op_sel_hi:[1,0,0]
    v_pk_fma_f32 v[122:123], v[66:67], 0.5, 1.0 op_sel_hi:[1,0,0]
    v_pk_fma_f32 v[60:61], v[60:61], v[116:117], 1.0 op_sel_hi:[1,1,0]
    v_pk_fma_f32 v[62:63], v[62:63], v[118:119], 1.0 op_sel_hi:[1,1,0]
    v_pk_fma_f32 v[64:65], v[64:65], v[120:121], 1.0 op_sel_hi:[1,1,0]
    v_pk_fma_f32 v[66:67], v[66:67], v[122:123], 1.0 op_sel_hi:[1,1,0]
    v_rcp_f32 v60, v60
    v_rcp_f32 v61, v61
    v_rcp_f32 v62, v62
    s_add_u32 s69, s81, 12288
    buffer_load_dwordx4 v[40:43], v2, s[44:47], s69 offen sc1
    v_rcp_f32 v63, v63
    v_rcp_f32 v64, v64
    v_rcp_f32 v65, v65
    v_rcp_f32 v66, v66
    v_rcp_f32 v67, v67
    v_pk_fma_f32 v[124:125], v[60:61], v[124:125], v[124:125] neg_lo:[1,0,0] neg_hi:[1,0,0]
    v_pk_fma_f32 v[126:127], v[62:63], v[126:127], v[126:127] neg_lo:[1,0,0] neg_hi:[1,0,0]
    v_pk_fma_f32 v[128:129], v[64:65], v[128:129], v[128:129] neg_lo:[1,0,0] neg_hi:[1,0,0]
    v_pk_fma_f32 v[130:131], v[66:67], v[130:131], v[130:131] neg_lo:[1,0,0] neg_hi:[1,0,0]
    v_max_u32 v125, s54, v125
    v_max_i32 v125, 0xa0000000, v125
    v_cvt_pk_bf16_f32 v117, v126, v127
    s_add_u32 s69, s79, 16384
    buffer_load_dwordx4 v[44:47], v2, s[44:47], s69 offen sc1
    v_cvt_pk_bf16_f32 v118, v128, v129
    v_cvt_pk_bf16_f32 v119, v130, v131
    v_cvt_pk_bf16_f32 v116, v124, v125
    v_xor_b32 v116, s54, v116
    s_add_u32 s66, s9, 3670016
    buffer_store_dwordx4 v[116:119], v2, s[44:47], s66 offen offset:0 sc1
    s_waitcnt lgkmcnt(0)
    v_pk_fma_f32 v[140:141], v[132:133], v[158:159], v[140:141] op_sel:[0,1,0] op_sel_hi:[1,1,1]
    v_pk_fma_f32 v[142:143], v[134:135], v[158:159], v[142:143] op_sel:[0,1,0] op_sel_hi:[1,1,1]
    v_pk_fma_f32 v[144:145], v[136:137], v[158:159], v[144:145] op_sel:[0,1,0] op_sel_hi:[1,1,1]
    v_pk_fma_f32 v[146:147], v[138:139], v[158:159], v[146:147] op_sel:[0,1,0] op_sel_hi:[1,1,1]
    v_pk_fma_f32 v[140:141], v[68:69], v[158:159], v[140:141] op_sel:[0,0,0] op_sel_hi:[1,0,1]
    v_pk_fma_f32 v[142:143], v[70:71], v[158:159], v[142:143] op_sel:[0,0,0] op_sel_hi:[1,0,1]
    v_pk_fma_f32 v[144:145], v[72:73], v[158:159], v[144:145] op_sel:[0,0,0] op_sel_hi:[1,0,1]
    s_add_u32 s69, s81, 16384
    buffer_load_dwordx4 v[48:51], v2, s[44:47], s69 offen sc1
    v_pk_fma_f32 v[146:147], v[74:75], v[158:159], v[146:147] op_sel:[0,0,0] op_sel_hi:[1,0,1]
    v_exp_f32 v68, v140
    v_exp_f32 v69, v141
    v_exp_f32 v70, v142
    v_exp_f32 v71, v143
    v_exp_f32 v72, v144
    v_exp_f32 v73, v145
    v_exp_f32 v74, v146
    v_exp_f32 v75, v147
    v_pk_fma_f32 v[132:133], v[68:69], 0.5, 1.0 op_sel_hi:[1,0,0]
    v_pk_fma_f32 v[134:135], v[70:71], 0.5, 1.0 op_sel_hi:[1,0,0]
    v_pk_fma_f32 v[136:137], v[72:73], 0.5, 1.0 op_sel_hi:[1,0,0]
    s_add_u32 s69, s80, 4096
    buffer_load_dwordx4 v[52:55], v2, s[44:47], s69 offen sc1
    v_pk_fma_f32 v[138:139], v[74:75], 0.5, 1.0 op_sel_hi:[1,0,0]
    v_pk_fma_f32 v[68:69], v[68:69], v[132:133], 1.0 op_sel_hi:[1,1,0]
    v_pk_fma_f32 v[70:71], v[70:71], v[134:135], 1.0 op_sel_hi:[1,1,0]
    v_pk_fma_f32 v[72:73], v[72:73], v[136:137], 1.0 op_sel_hi:[1,1,0]
    v_pk_fma_f32 v[74:75], v[74:75], v[138:139], 1.0 op_sel_hi:[1,1,0]
    v_rcp_f32 v68, v68
    v_rcp_f32 v69, v69
    v_rcp_f32 v70, v70
    v_rcp_f32 v71, v71
    v_rcp_f32 v72, v72
    v_rcp_f32 v73, v73
    v_rcp_f32 v74, v74
    v_rcp_f32 v75, v75
    s_add_u32 s69, s78, 8192
    buffer_load_dwordx4 v[56:59], v2, s[44:47], s69 offen sc1
    v_pk_fma_f32 v[140:141], v[68:69], v[140:141], v[140:141] neg_lo:[1,0,0] neg_hi:[1,0,0]
    v_pk_fma_f32 v[142:143], v[70:71], v[142:143], v[142:143] neg_lo:[1,0,0] neg_hi:[1,0,0]
    v_pk_fma_f32 v[144:145], v[72:73], v[144:145], v[144:145] neg_lo:[1,0,0] neg_hi:[1,0,0]
    v_pk_fma_f32 v[146:147], v[74:75], v[146:147], v[146:147] neg_lo:[1,0,0] neg_hi:[1,0,0]
    v_max_u32 v141, s54, v141
    v_max_i32 v141, 0xa0000000, v141
    v_cvt_pk_bf16_f32 v133, v142, v143
    v_cvt_pk_bf16_f32 v134, v144, v145
    v_cvt_pk_bf16_f32 v135, v146, v147
    v_cvt_pk_bf16_f32 v132, v140, v141
    v_xor_b32 v132, s54, v132
    s_add_u32 s66, s9, 3670016
    buffer_store_dwordx4 v[132:135], v2, s[44:47], s66 offen offset:1024 sc1
L_m_j69:
L_m_g21:
    s_waitcnt vmcnt(13)
    v_xor_b32 v92, s54, v92
    v_xor_b32 v96, s54, v96
    v_xor_b32 v100, s54, v100
    v_xor_b32 v104, s54, v104
    v_min3_f32 v156, |v92|, |v96|, |v100|
    v_min_f32 v156, v156, |v104|
    v_max3_f32 v157, |v92|, |v96|, |v100|
    v_max_f32 v157, v157, |v104|
    v_cmp_le_f32 s[70:71], s55, v157
    v_cmp_gt_f32 s[60:61], s54, v156
    s_nop 0
    s_or_b64 s[60:61], s[60:61], s[70:71]
    s_cbranch_scc1 L_m_s74
L_m_r75:
    v_mfma_f32_32x32x16_bf16 v[116:131], a[128:131], v[92:95], 0
    v_mfma_f32_32x32x16_bf16 v[132:147], a[132:135], v[92:95], 0
    s_add_u32 s69, s80, 8192
    buffer_load_dwordx4 v[92:95], v2, s[44:47], s69 offen sc1
    v_mfma_f32_32x32x16_bf16 v[116:131], a[144:147], v[96:99], v[116:131]
    v_mfma_f32_32x32x16_bf16 v[132:147], a[148:151], v[96:99], v[132:147]
    s_add_u32 s69, s78, 12288
    buffer_load_dwordx4 v[96:99], v2, s[44:47], s69 offen sc1
    s_waitcnt vmcnt(10)
    v_xor_b32 v108, s54, v108
    v_mfma_f32_32x32x16_bf16 v[116:131], a[160:163], v[100:103], v[116:131]
    v_xor_b32 v112, s54, v112
    v_xor_b32 v28, s54, v28
    v_xor_b32 v32, s54, v32
    v_min3_f32 v156, |v108|, |v112|, |v28|
    v_min_f32 v156, v156, |v32|
    v_mfma_f32_32x32x16_bf16 v[132:147], a[164:167], v[100:103], v[132:147]
    s_add_u32 s69, s78, 20480
    buffer_load_dwordx4 v[100:103], v2, s[44:47], s69 offen sc1
    v_max3_f32 v157, |v108|, |v112|, |v28|
    v_max_f32 v157, v157, |v32|
    v_mfma_f32_32x32x16_bf16 v[116:131], a[240:243], v[104:107], v[116:131]
    v_cmp_le_f32 s[70:71], s55, v157
    v_cmp_gt_f32 s[60:61], s54, v156
    s_nop 0
    s_or_b64 s[60:61], s[60:61], s[70:71]
    s_cbranch_scc1 L_m_s76
L_m_r77:
    v_mfma_f32_32x32x16_bf16 v[132:147], a[244:247], v[104:107], v[132:147]
    s_add_u32 s69, s80, 20480
    buffer_load_dwordx4 v[104:107], v2, s[44:47], s69 offen sc1
    v_mfma_f32_32x32x16_bf16 v[116:131], v[160:163], v[108:111], v[116:131]
    v_mfma_f32_32x32x16_bf16 v[132:147], v[164:167], v[108:111], v[132:147]
    s_add_u32 s69, s78, 24576
    buffer_load_dwordx4 v[108:111], v2, s[44:47], s69 offen sc1
    v_mfma_f32_32x32x16_bf16 v[116:131], v[176:179], v[112:115], v[116:131]
    v_mfma_f32_32x32x16_bf16 v[132:147], v[180:183], v[112:115], v[132:147]
    s_add_u32 s69, s80, 24576
    buffer_load_dwordx4 v[112:115], v2, s[44:47], s69 offen sc1
    s_waitcnt vmcnt(9)
    v_xor_b32 v36, s54, v36
    v_mfma_f32_32x32x16_bf16 v[116:131], a[136:139], v[28:31], v[116:131]
    v_xor_b32 v40, s54, v40
    v_xor_b32 v44, s54, v44
    v_xor_b32 v48, s54, v48
    v_min3_f32 v156, |v36|, |v40|, |v44|
    v_min_f32 v156, v156, |v48|
    v_mfma_f32_32x32x16_bf16 v[132:147], a[140:143], v[28:31], v[132:147]
    s_add_u32 s69, s81, 4096
    buffer_load_dwordx4 v[28:31], v2, s[44:47], s69 offen sc1
    v_max3_f32 v157, |v36|, |v40|, |v44|
    v_max_f32 v157, v157, |v48|
    v_mfma_f32_32x32x16_bf16 v[116:131], a[152:155], v[32:35], v[116:131]
    v_cmp_le_f32 s[70:71], s55, v157
    v_cmp_gt_f32 s[60:61], s54, v156
    s_nop 0
    s_or_b64 s[60:61], s[60:61], s[70:71]
    s_cbranch_scc1 L_m_s78
L_m_r79:
    v_mfma_f32_32x32x16_bf16 v[132:147], a[156:159], v[32:35], v[132:147]
    s_add_u32 s69, s79, 8192
    buffer_load_dwordx4 v[32:35], v2, s[44:47], s69 offen sc1
    v_mfma_f32_32x32x16_bf16 v[116:131], a[168:171], v[36:39], v[116:131]
    v_mfma_f32_32x32x16_bf16 v[132:147], a[172:175], v[36:39], v[132:147]
    s_add_u32 s69, s81, 8192
    buffer_load_dwordx4 v[36:39], v2, s[44:47], s69 offen sc1
    v_mfma_f32_32x32x16_bf16 v[116:131], a[248:251], v[40:43], v[116:131]
    v_mfma_f32_32x32x16_bf16 v[132:147], a[252:255], v[40:43], v[132:147]
    s_add_u32 s69, s79, 12288
    buffer_load_dwordx4 v[40:43], v2, s[44:47], s69 offen sc1
    s_waitcnt vmcnt(8)
    v_xor_b32 v52, s54, v52
    v_mfma_f32_32x32x16_bf16 v[116:131], v[168:171], v[44:47], v[116:131]
    v_xor_b32 v56, s54, v56
    v_xor_b32 v92, s54, v92
    v_xor_b32 v96, s54, v96
    v_min3_f32 v156, |v52|, |v56|, |v92|
    v_min_f32 v156, v156, |v96|
    v_mfma_f32_32x32x16_bf16 v[132:147], v[172:175], v[44:47], v[132:147]
    s_add_u32 s69, s79, 20480
    buffer_load_dwordx4 v[44:47], v2, s[44:47], s69 offen sc1
    v_max3_f32 v157, |v52|, |v56|, |v92|
    v_max_f32 v157, v157, |v96|
    v_mfma_f32_32x32x16_bf16 v[116:131], v[184:187], v[48:51], v[116:131]
    v_cmp_le_f32 s[70:71], s55, v157
    v_cmp_gt_f32 s[60:61], s54, v156
    s_nop 0
    s_or_b64 s[60:61], s[60:61], s[70:71]
    s_cbranch_scc1 L_m_s80
L_m_r81:
    v_mfma_f32_32x32x16_bf16 v[132:147], v[188:191], v[48:51], v[132:147]
    s_add_u32 s69, s81, 20480
    buffer_load_dwordx4 v[48:51], v2, s[44:47], s69 offen sc1
    v_mfma_f32_32x32x16_bf16 v[116:131], a[176:179], v[52:55], v[116:131]
    v_mfma_f32_32x32x16_bf16 v[132:147], a[180:183], v[52:55], v[132:147]
    s_add_u32 s69, s79, 24576
    buffer_load_dwordx4 v[52:55], v2, s[44:47], s69 offen sc1
    v_mfma_f32_32x32x16_bf16 v[116:131], a[192:195], v[56:59], v[116:131]
    v_mfma_f32_32x32x16_bf16 v[132:147], a[196:199], v[56:59], v[132:147]
    s_add_u32 s69, s81, 24576
    buffer_load_dwordx4 v[56:59], v2, s[44:47], s69 offen sc1
    s_waitcnt vmcnt(8)
    v_xor_b32 v100, s54, v100
    v_mfma_f32_32x32x16_bf16 v[116:131], a[208:211], v[92:95], v[116:131]
    v_xor_b32 v104, s54, v104
    v_xor_b32 v108, s54, v108
    v_xor_b32 v112, s54, v112
    v_min3_f32 v156, |v100|, |v104|, |v108|
    v_min_f32 v156, v156, |v112|
    v_mfma_f32_32x32x16_bf16 v[132:147], a[212:215], v[92:95], v[132:147]
    s_add_u32 s69, s78, 3670016
    buffer_load_dwordx4 v[92:95], v2, s[44:47], s69 offen sc1
    v_max3_f32 v157, |v100|, |v104|, |v108|
    v_max_f32 v157, v157, |v112|
    v_mfma_f32_32x32x16_bf16 v[116:131], a[224:227], v[96:99], v[116:131]
    v_cmp_le_f32 s[70:71], s55, v157
    v_cmp_gt_f32 s[60:61], s54, v156
    s_nop 0
    s_or_b64 s[60:61], s[60:61], s[70:71]
    s_cbranch_scc1 L_m_s82
L_m_r83:
    v_mfma_f32_32x32x16_bf16 v[132:147], a[228:231], v[96:99], v[132:147]
    s_add_u32 s69, s80, 3670016
    buffer_load_dwordx4 v[96:99], v2, s[44:47], s69 offen sc1
    v_mfma_f32_32x32x16_bf16 v[116:131], v[192:195], v[100:103], v[116:131]
    v_mfma_f32_32x32x16_bf16 v[132:147], v[196:199], v[100:103], v[132:147]
    s_add_u32 s69, s78, 3674112
    buffer_load_dwordx4 v[100:103], v2, s[44:47], s69 offen sc1
    v_mfma_f32_32x32x16_bf16 v[116:131], v[208:211], v[104:107], v[116:131]
    v_mfma_f32_32x32x16_bf16 v[132:147], v[212:215], v[104:107], v[132:147]
    s_add_u32 s69, s80, 3682304
    buffer_load_dwordx4 v[104:107], v2, s[44:47], s69 offen sc1
    s_waitcnt vmcnt(8)
    v_xor_b32 v28, s54, v28
    v_mfma_f32_32x32x16_bf16 v[116:131], v[224:227], v[108:111], v[116:131]
    v_xor_b32 v32, s54, v32
    v_xor_b32 v36, s54, v36
    v_xor_b32 v40, s54, v40
    v_min3_f32 v156, |v28|, |v32|, |v36|
    v_min_f32 v156, v156, |v40|
    v_mfma_f32_32x32x16_bf16 v[132:147], v[228:231], v[108:111], v[132:147]
    s_add_u32 s69, s78, 3686400
    buffer_load_dwordx4 v[108:111], v2, s[44:47], s69 offen sc1
    v_max3_f32 v157, |v28|, |v32|, |v36|
    v_max_f32 v157, v157, |v40|
    v_mfma_f32_32x32x16_bf16 v[116:131], v[240:243], v[112:115], v[116:131]
    v_cmp_le_f32 s[70:71], s55, v157
    v_cmp_gt_f32 s[60:61], s54, v156
    s_nop 0
    s_or_b64 s[60:61], s[60:61], s[70:71]
    s_cbranch_scc1 L_m_s84
L_m_r85:
    v_mfma_f32_32x32x16_bf16 v[132:147], v[244:247], v[112:115], v[132:147]
    s_add_u32 s69, s80, 3686400
    buffer_load_dwordx4 v[112:115], v2, s[44:47], s69 offen sc1
    v_mfma_f32_32x32x16_bf16 v[116:131], a[184:187], v[28:31], v[116:131]
    v_mfma_f32_32x32x16_bf16 v[132:147], a[188:191], v[28:31], v[132:147]
    s_add_u32 s69, s79, 3670016
    buffer_load_dwordx4 v[28:31], v2, s[44:47], s69 offen sc1
    v_mfma_f32_32x32x16_bf16 v[116:131], a[200:203], v[32:35], v[116:131]
    v_mfma_f32_32x32x16_bf16 v[132:147], a[204:207], v[32:35], v[132:147]
    s_add_u32 s69, s81, 3670016
    buffer_load_dwordx4 v[32:35], v2, s[44:47], s69 offen sc1
    s_waitcnt vmcnt(8)
    v_xor_b32 v44, s54, v44
    v_mfma_f32_32x32x16_bf16 v[116:131], a[216:219], v[36:39], v[116:131]
    v_xor_b32 v48, s54, v48
    v_xor_b32 v52, s54, v52
    v_xor_b32 v56, s54, v56
    v_min3_f32 v156, |v44|, |v48|, |v52|
    v_min_f32 v156, v156, |v56|
    v_mfma_f32_32x32x16_bf16 v[132:147], a[220:223], v[36:39], v[132:147]
    s_add_u32 s69, s79, 3674112
    buffer_load_dwordx4 v[36:39], v2, s[44:47], s69 offen sc1
    v_max3_f32 v157, |v44|, |v48|, |v52|
    v_max_f32 v157, v157, |v56|
    v_mfma_f32_32x32x16_bf16 v[116:131], a[232:235], v[40:43], v[116:131]
    v_cmp_le_f32 s[70:71], s55, v157
    v_cmp_gt_f32 s[60:61], s54, v156
    s_nop 0
    s_or_b64 s[60:61], s[60:61], s[70:71]
    s_cbranch_scc1 L_m_s86
L_m_r87:
    v_mfma_f32_32x32x16_bf16 v[132:147], a[236:239], v[40:43], v[132:147]
    s_add_u32 s69, s81, 3682304
    buffer_load_dwordx4 v[40:43], v2, s[44:47], s69 offen sc1
    v_mfma_f32_32x32x16_bf16 v[116:131], v[200:203], v[44:47], v[116:131]
    v_mfma_f32_32x32x16_bf16 v[132:147], v[204:207], v[44:47], v[132:147]
    s_add_u32 s69, s79, 3686400
    buffer_load_dwordx4 v[44:47], v2, s[44:47], s69 offen sc1
    v_mfma_f32_32x32x16_bf16 v[116:131], v[216:219], v[48:51], v[116:131]
    v_mfma_f32_32x32x16_bf16 v[132:147], v[220:223], v[48:51], v[132:147]
    s_add_u32 s69, s81, 3686400
    buffer_load_dwordx4 v[48:51], v2, s[44:47], s69 offen sc1
    s_waitcnt vmcnt(8)
    v_xor_b32 v92, s54, v92
    v_mfma_f32_32x32x16_bf16 v[116:131], v[232:235], v[52:55], v[116:131]
    v_xor_b32 v96, s54, v96
    v_xor_b32 v100, s54, v100
    v_xor_b32 v104, s54, v104
    v_min3_f32 v156, |v92|, |v96|, |v100|
    v_min_f32 v156, v156, |v104|
    v_mfma_f32_32x32x16_bf16 v[132:147], v[236:239], v[52:55], v[132:147]
    s_add_u32 s69, s80, 3674112
    buffer_load_dwordx4 v[52:55], v2, s[44:47], s69 offen sc1
    v_max3_f32 v157, |v92|, |v96|, |v100|
    v_max_f32 v157, v157, |v104|
    v_mfma_f32_32x32x16_bf16 v[116:131], v[248:251], v[56:59], v[116:131]
    v_cmp_le_f32 s[70:71], s55, v157
    v_cmp_gt_f32 s[60:61], s54, v156
    s_nop 0
    s_or_b64 s[60:61], s[60:61], s[70:71]
    s_cbranch_scc1 L_m_s88
L_m_r89:
    v_mfma_f32_32x32x16_bf16 v[132:147], v[252:255], v[56:59], v[132:147]
    s_add_u32 s69, s78, 3678208
    buffer_load_dwordx4 v[56:59], v2, s[44:47], s69 offen sc1
    v_mfma_f32_32x32x16_bf16 v[60:75], a[128:131], v[92:95], 0
    v_mfma_f32_32x32x16_bf16 v[76:91], a[132:135], v[92:95], 0
    s_add_u32 s69, s80, 3678208
    buffer_load_dwordx4 v[92:95], v2, s[44:47], s69 offen sc1
    ds_write_b128 v16, v[116:119] offset:0
    v_mfma_f32_32x32x16_bf16 v[60:75], a[144:147], v[96:99], v[60:75]
    ds_write_b128 v16, v[120:123] offset:1024
    ds_write_b128 v17, v[124:127] offset:2048
    v_mfma_f32_32x32x16_bf16 v[76:91], a[148:151], v[96:99], v[76:91]
    s_add_u32 s69, s78, 3682304
    buffer_load_dwordx4 v[96:99], v2, s[44:47], s69 offen sc1
    s_waitcnt vmcnt(8)
    v_xor_b32 v108, s54, v108
    v_mfma_f32_32x32x16_bf16 v[60:75], a[160:163], v[100:103], v[60:75]
    v_xor_b32 v112, s54, v112
    v_xor_b32 v28, s54, v28
    v_xor_b32 v32, s54, v32
    v_min3_f32 v156, |v108|, |v112|, |v28|
    v_min_f32 v156, v156, |v32|
    v_mfma_f32_32x32x16_bf16 v[76:91], a[164:167], v[100:103], v[76:91]
    s_add_u32 s69, s78, 3690496
    buffer_load_dwordx4 v[100:103], v2, s[44:47], s69 offen sc1
    v_max3_f32 v157, |v108|, |v112|, |v28|
    v_max_f32 v157, v157, |v32|
    v_mfma_f32_32x32x16_bf16 v[60:75], a[240:243], v[104:107], v[60:75]
    v_cmp_le_f32 s[70:71], s55, v157
    v_cmp_gt_f32 s[60:61], s54, v156
    s_nop 0
    s_or_b64 s[60:61], s[60:61], s[70:71]
    s_cbranch_scc1 L_m_s90
L_m_r91:
    ds_write_b128 v17, v[128:131] offset:3072
    v_mfma_f32_32x32x16_bf16 v[76:91], a[244:247], v[104:107], v[76:91]
    s_add_u32 s69, s80, 3690496
    buffer_load_dwordx4 v[104:107], v2, s[44:47], s69 offen sc1
    ds_write_b128 v16, v[132:135] offset:4096
    v_mfma_f32_32x32x16_bf16 v[60:75], v[160:163], v[108:111], v[60:75]
    ds_write_b128 v16, v[136:139] offset:5120
    ds_write_b128 v17, v[140:143] offset:6144
    v_mfma_f32_32x32x16_bf16 v[76:91], v[164:167], v[108:111], v[76:91]
    s_add_u32 s69, s78, 3694592
    buffer_load_dwordx4 v[108:111], v2, s[44:47], s69 offen sc1
    ds_write_b128 v17, v[144:147] offset:7168
    v_mfma_f32_32x32x16_bf16 v[60:75], v[176:179], v[112:115], v[60:75]
    s_waitcnt lgkmcnt(0)
    s_barrier
    ds_read_b128 v[116:119], v18 offset:0
    ds_read_b128 v[120:123], v18 offset:1024
    ds_read_b128 v[124:127], v18 offset:8192
    v_mfma_f32_32x32x16_bf16 v[76:91], v[180:183], v[112:115], v[76:91]
    s_add_u32 s69, s80, 3694592
    buffer_load_dwordx4 v[112:115], v2, s[44:47], s69 offen sc1
    s_waitcnt vmcnt(8)
    v_xor_b32 v36, s54, v36
    v_mfma_f32_32x32x16_bf16 v[60:75], a[136:139], v[28:31], v[60:75]
    v_xor_b32 v40, s54, v40
    v_xor_b32 v44, s54, v44
    v_xor_b32 v48, s54, v48
    v_min3_f32 v156, |v36|, |v40|, |v44|
    v_min_f32 v156, v156, |v48|
    v_mfma_f32_32x32x16_bf16 v[76:91], a[140:143], v[28:31], v[76:91]
    s_add_u32 s69, s81, 3674112
    buffer_load_dwordx4 v[28:31], v2, s[44:47], s69 offen sc1
    v_max3_f32 v157, |v36|, |v40|, |v44|
    v_max_f32 v157, v157, |v48|
    v_mfma_f32_32x32x16_bf16 v[60:75], a[152:155], v[32:35], v[60:75]
    v_cmp_le_f32 s[70:71], s55, v157
    v_cmp_gt_f32 s[60:61], s54, v156
    s_nop 0
    s_or_b64 s[60:61], s[60:61], s[70:71]
    s_cbranch_scc1 L_m_s92
L_m_r93:
    ds_read_b128 v[128:131], v18 offset:9216
    v_mfma_f32_32x32x16_bf16 v[76:91], a[156:159], v[32:35], v[76:91]
    s_add_u32 s69, s79, 3678208
    buffer_load_dwordx4 v[32:35], v2, s[44:47], s69 offen sc1
    ds_read_b128 v[132:135], v18 offset:16384
    ds_read_b128 v[136:139], v18 offset:17408
    v_mfma_f32_32x32x16_bf16 v[60:75], a[168:171], v[36:39], v[60:75]
    ds_read_b128 v[140:143], v18 offset:24576
    ds_read_b128 v[144:147], v18 offset:25600
    s_waitcnt lgkmcnt(4)
    v_add_f32 v116, v116, v124
    v_add_f32 v117, v117, v125
    v_mfma_f32_32x32x16_bf16 v[76:91], a[172:175], v[36:39], v[76:91]
    s_add_u32 s69, s81, 3678208
    buffer_load_dwordx4 v[36:39], v2, s[44:47], s69 offen sc1
    v_add_f32 v118, v118, v126
    v_add_f32 v119, v119, v127
    v_mfma_f32_32x32x16_bf16 v[60:75], a[248:251], v[40:43], v[60:75]
    v_add_f32 v120, v120, v128
    v_add_f32 v121, v121, v129
    v_add_f32 v122, v122, v130
    v_add_f32 v123, v123, v131
    v_lshlrev_b32 v124, 16, v148
    v_mfma_f32_32x32x16_bf16 v[76:91], a[252:255], v[40:43], v[76:91]
    s_add_u32 s69, s79, 3682304
    buffer_load_dwordx4 v[40:43], v2, s[44:47], s69 offen sc1
    s_waitcnt vmcnt(8)
    v_xor_b32 v52, s54, v52
    v_mfma_f32_32x32x16_bf16 v[60:75], v[168:171], v[44:47], v[60:75]
    v_xor_b32 v56, s54, v56
    v_xor_b32 v92, s54, v92
    v_xor_b32 v96, s54, v96
    v_min3_f32 v156, |v52|, |v56|, |v92|
    v_min_f32 v156, v156, |v96|
    v_mfma_f32_32x32x16_bf16 v[76:91], v[172:175], v[44:47], v[76:91]
    s_add_u32 s69, s79, 3690496
    buffer_load_dwordx4 v[44:47], v2, s[44:47], s69 offen sc1
    v_max3_f32 v157, |v52|, |v56|, |v92|
    v_max_f32 v157, v157, |v96|
    v_mfma_f32_32x32x16_bf16 v[60:75], v[184:187], v[48:51], v[60:75]
    v_cmp_le_f32 s[70:71], s55, v157
    v_cmp_gt_f32 s[60:61], s54, v156
    s_nop 0
    s_or_b64 s[60:61], s[60:61], s[70:71]
    s_cbranch_scc1 L_m_s94
L_m_r95:
    v_and_b32 v125, 0xffff0000, v148
    v_mfma_f32_32x32x16_bf16 v[76:91], v[188:191], v[48:51], v[76:91]
    s_add_u32 s69, s81, 3690496
    buffer_load_dwordx4 v[48:51], v2, s[44:47], s69 offen sc1
    v_lshlrev_b32 v126, 16, v149
    v_and_b32 v127, 0xffff0000, v149
    v_mfma_f32_32x32x16_bf16 v[60:75], a[176:179], v[52:55], v[60:75]
    v_lshlrev_b32 v128, 16, v150
    v_and_b32 v129, 0xffff0000, v150
    v_lshlrev_b32 v130, 16, v151
    v_and_b32 v131, 0xffff0000, v151
    s_waitcnt lgkmcnt(0)
    v_mfma_f32_32x32x16_bf16 v[76:91], a[180:183], v[52:55], v[76:91]
    s_add_u32 s69, s79, 3694592
    buffer_load_dwordx4 v[52:55], v2, s[44:47], s69 offen sc1
    v_add_f32 v132, v132, v140
    v_add_f32 v133, v133, v141
    v_mfma_f32_32x32x16_bf16 v[60:75], a[192:195], v[56:59], v[60:75]
    v_add_f32 v134, v134, v142
    v_add_f32 v135, v135, v143
    v_add_f32 v136, v136, v144
    v_add_f32 v137, v137, v145
    v_add_f32 v138, v138, v146
    v_mfma_f32_32x32x16_bf16 v[76:91], a[196:199], v[56:59], v[76:91]
    s_add_u32 s69, s81, 3694592
    buffer_load_dwordx4 v[56:59], v2, s[44:47], s69 offen sc1
    s_waitcnt vmcnt(8)
    v_xor_b32 v100, s54, v100
    v_mfma_f32_32x32x16_bf16 v[60:75], a[208:211], v[92:95], v[60:75]
    v_xor_b32 v104, s54, v104
    v_xor_b32 v108, s54, v108
    v_xor_b32 v112, s54, v112
    v_min3_f32 v156, |v100|, |v104|, |v108|
    v_min_f32 v156, v156, |v112|
    v_mfma_f32_32x32x16_bf16 v[76:91], a[212:215], v[92:95], v[76:91]
    v_max3_f32 v157, |v100|, |v104|, |v108|
    v_max_f32 v157, v157, |v112|
    v_cmp_le_f32 s[70:71], s55, v157
    v_cmp_gt_f32 s[60:61], s54, v156
    s_nop 0
    s_or_b64 s[60:61], s[60:61], s[70:71]
    s_cbranch_scc1 L_m_s96
L_m_r97:
    v_mfma_f32_32x32x16_bf16 v[60:75], a[224:227], v[96:99], v[60:75]
    v_add_f32 v139, v139, v147
    v_add_f32 v116, v116, v132
    v_add_f32 v117, v117, v133
    v_add_f32 v118, v118, v134
    v_add_f32 v119, v119, v135
    v_mfma_f32_32x32x16_bf16 v[76:91], a[228:231], v[96:99], v[76:91]
    v_add_f32 v120, v120, v136
    v_add_f32 v121, v121, v137
    v_add_f32 v122, v122, v138
    v_add_f32 v123, v123, v139
    v_fma_f32 v124, v116, s29, v124
    v_mfma_f32_32x32x16_bf16 v[60:75], v[192:195], v[100:103], v[60:75]
    v_fma_f32 v125, v117, s29, v125
    v_fma_f32 v126, v118, s29, v126
    v_fma_f32 v127, v119, s29, v127
    v_fma_f32 v128, v120, s29, v128
    v_fma_f32 v129, v121, s29, v129
    v_mfma_f32_32x32x16_bf16 v[76:91], v[196:199], v[100:103], v[76:91]
    v_fma_f32 v130, v122, s29, v130
    v_fma_f32 v131, v123, s29, v131
    v_cvt_pk_bf16_f32 v132, v124, v125
    v_cvt_pk_bf16_f32 v133, v126, v127
    v_cvt_pk_bf16_f32 v134, v128, v129
    v_mfma_f32_32x32x16_bf16 v[60:75], v[208:211], v[104:107], v[60:75]
    v_cvt_pk_bf16_f32 v135, v130, v131
    s_add_u32 s66, s14, 0
    buffer_store_dwordx4 v[132:135], v22, s[48:51], s66 offen sc1
    v_mfma_f32_32x32x16_bf16 v[76:91], v[212:215], v[104:107], v[76:91]
    s_waitcnt vmcnt(5)
    v_xor_b32 v28, s54, v28
    v_xor_b32 v32, s54, v32
    v_xor_b32 v36, s54, v36
    v_xor_b32 v40, s54, v40
    v_mfma_f32_32x32x16_bf16 v[60:75], v[224:227], v[108:111], v[60:75]
    v_min3_f32 v156, |v28|, |v32|, |v36|
    v_min_f32 v156, v156, |v40|
    v_max3_f32 v157, |v28|, |v32|, |v36|
    v_max_f32 v157, v157, |v40|
    v_cmp_le_f32 s[70:71], s55, v157
    v_mfma_f32_32x32x16_bf16 v[76:91], v[228:231], v[108:111], v[76:91]
    v_cmp_gt_f32 s[60:61], s54, v156
    s_nop 0
    s_or_b64 s[60:61], s[60:61], s[70:71]
    s_cbranch_scc1 L_m_s98
L_m_r99:
    v_mfma_f32_32x32x16_bf16 v[60:75], v[240:243], v[112:115], v[60:75]
    v_mfma_f32_32x32x16_bf16 v[76:91], v[244:247], v[112:115], v[76:91]
    v_mfma_f32_32x32x16_bf16 v[60:75], a[184:187], v[28:31], v[60:75]
    v_mfma_f32_32x32x16_bf16 v[76:91], a[188:191], v[28:31], v[76:91]
    v_mfma_f32_32x32x16_bf16 v[60:75], a[200:203], v[32:35], v[60:75]
    v_mfma_f32_32x32x16_bf16 v[76:91], a[204:207], v[32:35], v[76:91]
    s_waitcnt vmcnt(1)
    v_xor_b32 v44, s54, v44
    v_xor_b32 v48, s54, v48
    v_xor_b32 v52, s54, v52
    v_xor_b32 v56, s54, v56
    v_mfma_f32_32x32x16_bf16 v[60:75], a[216:219], v[36:39], v[60:75]
    v_min3_f32 v156, |v44|, |v48|, |v52|
    v_min_f32 v156, v156, |v56|
    v_max3_f32 v157, |v44|, |v48|, |v52|
    v_max_f32 v157, v157, |v56|
    v_cmp_le_f32 s[70:71], s55, v157
    v_mfma_f32_32x32x16_bf16 v[76:91], a[220:223], v[36:39], v[76:91]
    v_cmp_gt_f32 s[60:61], s54, v156
    s_nop 0
    s_or_b64 s[60:61], s[60:61], s[70:71]
    s_cbranch_scc1 L_m_s100
L_m_r101:
    v_mfma_f32_32x32x16_bf16 v[60:75], a[232:235], v[40:43], v[60:75]
    v_mfma_f32_32x32x16_bf16 v[76:91], a[236:239], v[40:43], v[76:91]
    v_mfma_f32_32x32x16_bf16 v[60:75], v[200:203], v[44:47], v[60:75]
    v_mfma_f32_32x32x16_bf16 v[76:91], v[204:207], v[44:47], v[76:91]
    v_mfma_f32_32x32x16_bf16 v[60:75], v[216:219], v[48:51], v[60:75]
    v_mfma_f32_32x32x16_bf16 v[76:91], v[220:223], v[48:51], v[76:91]
    v_mfma_f32_32x32x16_bf16 v[60:75], v[232:235], v[52:55], v[60:75]
    v_mfma_f32_32x32x16_bf16 v[76:91], v[236:239], v[52:55], v[76:91]
    v_mfma_f32_32x32x16_bf16 v[60:75], v[248:251], v[56:59], v[60:75]
    v_mfma_f32_32x32x16_bf16 v[76:91], v[252:255], v[56:59], v[76:91]
    s_barrier
    s_nop 9
    ds_write_b128 v16, v[60:63] offset:0
    ds_write_b128 v16, v[64:67] offset:1024
    ds_write_b128 v17, v[68:71] offset:2048
    ds_write_b128 v17, v[72:75] offset:3072
    ds_write_b128 v16, v[76:79] offset:4096
    ds_write_b128 v16, v[80:83] offset:5120
    ds_write_b128 v17, v[84:87] offset:6144
    ds_write_b128 v17, v[88:91] offset:7168
    s_waitcnt lgkmcnt(0)
    s_barrier
    ds_read_b128 v[116:119], v18 offset:0
    ds_read_b128 v[120:123], v18 offset:1024
    ds_read_b128 v[124:127], v18 offset:8192
    ds_read_b128 v[128:131], v18 offset:9216
    ds_read_b128 v[132:135], v18 offset:16384
    ds_read_b128 v[136:139], v18 offset:17408
    ds_read_b128 v[140:143], v18 offset:24576
    ds_read_b128 v[144:147], v18 offset:25600
    s_waitcnt lgkmcnt(4)
    v_pk_add_f32 v[116:117], v[116:117], v[124:125]
    v_pk_add_f32 v[118:119], v[118:119], v[126:127]
    v_pk_add_f32 v[120:121], v[120:121], v[128:129]
    v_pk_add_f32 v[122:123], v[122:123], v[130:131]
    v_lshlrev_b32 v124, 16, v152
    v_and_b32 v125, 0xffff0000, v152
    v_lshlrev_b32 v126, 16, v153
    v_and_b32 v127, 0xffff0000, v153
    v_lshlrev_b32 v128, 16, v154
    v_and_b32 v129, 0xffff0000, v154
    v_lshlrev_b32 v130, 16, v155
    v_and_b32 v131, 0xffff0000, v155
    s_waitcnt lgkmcnt(0)
    v_pk_add_f32 v[132:133], v[132:133], v[140:141]
    v_pk_add_f32 v[134:135], v[134:135], v[142:143]
    v_pk_add_f32 v[136:137], v[136:137], v[144:145]
    v_pk_add_f32 v[138:139], v[138:139], v[146:147]
    v_pk_add_f32 v[116:117], v[116:117], v[132:133]
    v_pk_add_f32 v[118:119], v[118:119], v[134:135]
    v_pk_add_f32 v[120:121], v[120:121], v[136:137]
    v_pk_add_f32 v[122:123], v[122:123], v[138:139]
    v_fma_f32 v124, v116, s29, v124
    v_fma_f32 v125, v117, s29, v125
    v_fma_f32 v126, v118, s29, v126
    v_fma_f32 v127, v119, s29, v127
    v_fma_f32 v128, v120, s29, v128
    v_fma_f32 v129, v121, s29, v129
    v_fma_f32 v130, v122, s29, v130
    v_fma_f32 v131, v123, s29, v131
    v_cvt_pk_bf16_f32 v132, v124, v125
    v_cvt_pk_bf16_f32 v133, v126, v127
    v_cvt_pk_bf16_f32 v134, v128, v129
    v_cvt_pk_bf16_f32 v135, v130, v131
    s_add_u32 s66, s14, 1048576
    buffer_store_dwordx4 v[132:135], v22, s[48:51], s66 offen sc1
L_m_end:
    s_endpgm
L_m_s14:
    s_sleep 1
    global_load_dword v114, v115, s[96:97] sc1
    s_waitcnt vmcnt(0)
    v_cmp_ne_u32 vcc, 16, v114
    s_sub_u32 s28, s28, 1
    s_cbranch_scc1 L_m_s14x
    s_cbranch_vccnz L_m_s14
    s_branch L_m_s14xy
L_m_s14x:
    s_mov_b32 s28, 0
L_m_s14xy:
    s_mov_b64 exec, -1
    s_nop 4
    s_branch L_m_r15
L_m_s16:
    s_mov_b64 exec, vcc
    s_sleep 3
    s_mov_b32 s64, 8650752
    s_add_u32 s65, s6, 0
    buffer_load_dwordx4 v[28:31], v6, s[44:47], s64 offen offset:0 sc1
    buffer_load_dwordx4 v[32:35], v6, s[44:47], s64 offen offset:16 sc1
    buffer_load_dwordx4 v[44:47], v5, s[44:47], s65 offen sc1
    s_waitcnt vmcnt(0)
    v_min3_f32 v36, |v28|, |v30|, |v32|
    v_min3_f32 v36, v36, |v34|, |v44|
    v_cmp_gt_f32 vcc, s54, v36
    s_sub_u32 s28, s28, 1
    s_cbranch_scc1 L_m_s16x
    s_cbranch_vccnz L_m_s16
    s_branch L_m_s16xy
L_m_s16x:
    s_mov_b32 s28, 0
L_m_s16xy:
    s_mov_b64 exec, -1
    s_nop 4
    s_branch L_m_r17
L_m_s18:
    s_sleep 2
    buffer_load_dword v248, v249, s[44:47], s68 offen sc1
    s_waitcnt vmcnt(0)
    v_cmp_ne_u32 vcc, 1, v248
    s_sub_u32 s28, s28, 1
    s_cbranch_scc1 L_m_s18x
    s_cbranch_vccnz L_m_s18
    s_branch L_m_s18xy
L_m_s18x:
    s_mov_b32 s28, 0
L_m_s18xy:
    s_mov_b64 exec, -1
    s_nop 4
    s_branch L_m_r19
L_m_s20:
    s_mov_b64 exec, vcc
    s_sleep 3
    s_mov_b32 s64, 8658944
    s_add_u32 s65, s6, 1081344
    buffer_load_dwordx4 v[92:95], v6, s[44:47], s64 offen offset:0 sc1
    buffer_load_dwordx4 v[96:99], v6, s[44:47], s64 offen offset:16 sc1
    buffer_load_dwordx4 v[108:111], v5, s[44:47], s65 offen sc1
    s_waitcnt vmcnt(0)
    v_min3_f32 v100, |v92|, |v94|, |v96|
    v_min3_f32 v100, v100, |v98|, |v108|
    v_cmp_gt_f32 vcc, s54, v100
    s_sub_u32 s28, s28, 1
    s_cbranch_scc1 L_m_s20x
    s_cbranch_vccnz L_m_s20
    s_branch L_m_s20xy
L_m_s20x:
    s_mov_b32 s28, 0
L_m_s20xy:
    s_mov_b64 exec, -1
    s_nop 4
    s_branch L_m_r21
L_m_s22:
    s_mov_b64 exec, vcc
    s_sleep 3
    buffer_load_dword v244, v241, s[44:47], s69 offen offset:0 sc1
    buffer_load_dword v245, v241, s[44:47], s69 offen offset:128 sc1
    buffer_load_dword v246, v241, s[44:47], s69 offen offset:256 sc1
    buffer_load_dword v247, v241, s[44:47], s69 offen offset:384 sc1
    s_waitcnt vmcnt(0)
    v_min3_f32 v242, |v244|, |v245|, |v246|
    v_min_f32 v242, v242, |v247|
    v_cmp_gt_f32 vcc, s54, v242
    s_sub_u32 s28, s28, 1
    s_cbranch_scc1 L_m_s22x
    s_cbranch_vccnz L_m_s22
    s_branch L_m_s22xy
L_m_s22x:
    s_mov_b32 s28, 0
L_m_s22xy:
    s_mov_b64 exec, -1
    s_nop 4
    s_branch L_m_r23
L_m_s25:
    s_mov_b64 exec, vcc
    s_sleep 3
    s_add_u32 s64, s8, 2162688
    buffer_load_dwordx4 v[28:31], v2, s[44:47], s64 offen sc1
    s_add_u32 s64, s8, 2166784
    buffer_load_dwordx4 v[32:35], v2, s[44:47], s64 offen sc1
    s_add_u32 s64, s8, 2170880
    buffer_load_dwordx4 v[60:63], v2, s[44:47], s64 offen sc1
    s_add_u32 s64, s8, 2174976
    buffer_load_dwordx4 v[64:67], v2, s[44:47], s64 offen sc1
    s_add_u32 s64, s8, 2179072
    buffer_load_dwordx4 v[116:119], v2, s[44:47], s64 offen sc1
    s_add_u32 s64, s8, 2183168
    buffer_load_dwordx4 v[120:123], v2, s[44:47], s64 offen sc1
    s_add_u32 s64, s8, 2187264
    buffer_load_dwordx4 v[124:127], v2, s[44:47], s64 offen sc1
    s_add_u32 s64, s8, 2191360
    buffer_load_dwordx4 v[128:131], v2, s[44:47], s64 offen sc1
    s_waitcnt vmcnt(0)
    v_min3_f32 v112, |v28|, |v32|, |v60|
    v_min3_f32 v112, v112, |v64|, |v116|
    v_min3_f32 v112, v112, |v120|, |v124|
    v_min_f32 v112, v112, |v128|
    v_cmp_gt_f32 vcc, s54, v112
    s_sub_u32 s28, s28, 1
    s_cbranch_scc1 L_m_s25x
    s_cbranch_vccnz L_m_s25
    s_branch L_m_s25xy
L_m_s25x:
    s_mov_b32 s28, 0
L_m_s25xy:
    s_mov_b64 exec, -1
    s_nop 4
    s_branch L_m_r26
L_m_s29:
    s_mov_b64 exec, vcc
    s_sleep 3
    s_add_u32 s64, s8, 3215360
    buffer_load_dwordx4 v[60:63], v2, s[44:47], s64 offen sc1
    s_add_u32 s64, s8, 3219456
    buffer_load_dwordx4 v[64:67], v2, s[44:47], s64 offen sc1
    s_add_u32 s64, s8, 3223552
    buffer_load_dwordx4 v[68:71], v2, s[44:47], s64 offen sc1
    s_add_u32 s64, s8, 3227648
    buffer_load_dwordx4 v[72:75], v2, s[44:47], s64 offen sc1
    s_add_u32 s64, s8, 3231744
    buffer_load_dwordx4 v[76:79], v2, s[44:47], s64 offen sc1
    s_add_u32 s64, s8, 3235840
    buffer_load_dwordx4 v[80:83], v2, s[44:47], s64 offen sc1
    s_add_u32 s64, s8, 3239936
    buffer_load_dwordx4 v[84:87], v2, s[44:47], s64 offen sc1
    s_add_u32 s64, s8, 3244032
    buffer_load_dwordx4 v[88:91], v2, s[44:47], s64 offen sc1
    s_waitcnt vmcnt(0)
    v_min3_f32 v136, |v60|, |v64|, |v68|
    v_min3_f32 v136, v136, |v72|, |v76|
    v_min3_f32 v136, v136, |v80|, |v84|
    v_min_f32 v136, v136, |v88|
    v_cmp_gt_f32 vcc, s54, v136
    s_sub_u32 s28, s28, 1
    s_cbranch_scc1 L_m_s29x
    s_cbranch_vccnz L_m_s29
    s_branch L_m_s29xy
L_m_s29x:
    s_mov_b32 s28, 0
L_m_s29xy:
    s_mov_b64 exec, -1
    s_nop 4
    s_branch L_m_r30
L_m_s31:
    s_mov_b64 exec, vcc
    s_sleep 3
    s_add_u32 s64, s8, 3215360
    buffer_load_dwordx4 v[60:63], v2, s[44:47], s64 offen sc1
    s_add_u32 s64, s8, 3219456
    buffer_load_dwordx4 v[64:67], v2, s[44:47], s64 offen sc1
    s_add_u32 s64, s8, 3223552
    buffer_load_dwordx4 v[68:71], v2, s[44:47], s64 offen sc1
    s_add_u32 s64, s8, 3227648
    buffer_load_dwordx4 v[72:75], v2, s[44:47], s64 offen sc1
    s_add_u32 s64, s8, 3231744
    buffer_load_dwordx4 v[76:79], v2, s[44:47], s64 offen sc1
    s_add_u32 s64, s8, 3235840
    buffer_load_dwordx4 v[80:83], v2, s[44:47], s64 offen sc1
    s_add_u32 s64, s8, 3239936
    buffer_load_dwordx4 v[84:87], v2, s[44:47], s64 offen sc1
    s_add_u32 s64, s8, 3244032
    buffer_load_dwordx4 v[88:91], v2, s[44:47], s64 offen sc1
    s_waitcnt vmcnt(0)
    v_min3_f32 v136, |v60|, |v64|, |v68|
    v_min3_f32 v136, v136, |v72|, |v76|
    v_min3_f32 v136, v136, |v80|, |v84|
    v_min_f32 v136, v136, |v88|
    v_cmp_gt_f32 vcc, s54, v136
    s_sub_u32 s28, s28, 1
    s_cbranch_scc1 L_m_s31x
    s_cbranch_vccnz L_m_s31
    s_branch L_m_s31xy
L_m_s31x:
    s_mov_b32 s28, 0
L_m_s31xy:
    s_mov_b64 exec, -1
    s_nop 4
    s_branch L_m_r32
L_m_s33:
    s_sleep 3
    s_add_u32 s69, s78, 0
    buffer_load_dwordx4 v[92:95], v2, s[44:47], s69 offen sc1
    s_add_u32 s69, s80, 0
    buffer_load_dwordx4 v[96:99], v2, s[44:47], s69 offen sc1
    s_add_u32 s69, s78, 4096
    buffer_load_dwordx4 v[100:103], v2, s[44:47], s69 offen sc1
    s_add_u32 s69, s80, 12288
    buffer_load_dwordx4 v[104:107], v2, s[44:47], s69 offen sc1
    s_add_u32 s69, s78, 16384
    buffer_load_dwordx4 v[108:111], v2, s[44:47], s69 offen sc1
    s_add_u32 s69, s80, 16384
    buffer_load_dwordx4 v[112:115], v2, s[44:47], s69 offen sc1
    s_add_u32 s69, s79, 0
    buffer_load_dwordx4 v[28:31], v2, s[44:47], s69 offen sc1
    s_add_u32 s69, s81, 0
    buffer_load_dwordx4 v[32:35], v2, s[44:47], s69 offen sc1
    s_add_u32 s69, s79, 4096
    buffer_load_dwordx4 v[36:39], v2, s[44:47], s69 offen sc1
    s_add_u32 s69, s81, 12288
    buffer_load_dwordx4 v[40:43], v2, s[44:47], s69 offen sc1
    s_add_u32 s69, s79, 16384
    buffer_load_dwordx4 v[44:47], v2, s[44:47], s69 offen sc1
    s_add_u32 s69, s81, 16384
    buffer_load_dwordx4 v[48:51], v2, s[44:47], s69 offen sc1
    s_add_u32 s69, s80, 4096
    buffer_load_dwordx4 v[52:55], v2, s[44:47], s69 offen sc1
    s_add_u32 s69, s78, 8192
    buffer_load_dwordx4 v[56:59], v2, s[44:47], s69 offen sc1
    s_waitcnt vmcnt(0)
    v_min3_f32 v156, |v92|, |v96|, |v100|
    v_min_f32 v156, v156, |v104|
    v_cmp_gt_f32 vcc, s54, v156
    s_sub_u32 s28, s28, 1
    s_cbranch_scc1 L_m_s33x
    s_cbranch_vccnz L_m_s33
    s_branch L_m_s33xy
L_m_s33x:
    s_mov_b32 s28, 0
L_m_s33xy:
    s_mov_b64 exec, -1
    s_nop 4
    s_branch L_m_r34
L_m_s35:
    s_sleep 3
    s_add_u32 s69, s78, 16384
    buffer_load_dwordx4 v[108:111], v2, s[44:47], s69 offen sc1
    s_add_u32 s69, s80, 16384
    buffer_load_dwordx4 v[112:115], v2, s[44:47], s69 offen sc1
    s_add_u32 s69, s79, 0
    buffer_load_dwordx4 v[28:31], v2, s[44:47], s69 offen sc1
    s_add_u32 s69, s81, 0
    buffer_load_dwordx4 v[32:35], v2, s[44:47], s69 offen sc1
    s_add_u32 s69, s79, 4096
    buffer_load_dwordx4 v[36:39], v2, s[44:47], s69 offen sc1
    s_add_u32 s69, s81, 12288
    buffer_load_dwordx4 v[40:43], v2, s[44:47], s69 offen sc1
    s_add_u32 s69, s79, 16384
    buffer_load_dwordx4 v[44:47], v2, s[44:47], s69 offen sc1
    s_add_u32 s69, s81, 16384
    buffer_load_dwordx4 v[48:51], v2, s[44:47], s69 offen sc1
    s_add_u32 s69, s80, 4096
    buffer_load_dwordx4 v[52:55], v2, s[44:47], s69 offen sc1
    s_add_u32 s69, s78, 8192
    buffer_load_dwordx4 v[56:59], v2, s[44:47], s69 offen sc1
    s_add_u32 s69, s80, 8192
    buffer_load_dwordx4 v[92:95], v2, s[44:47], s69 offen sc1
    s_add_u32 s69, s78, 12288
    buffer_load_dwordx4 v[96:99], v2, s[44:47], s69 offen sc1
    s_waitcnt vmcnt(0)
    v_min3_f32 v156, |v108|, |v112|, |v28|
    v_min_f32 v156, v156, |v32|
    v_cmp_gt_f32 vcc, s54, v156
    s_sub_u32 s28, s28, 1
    s_cbranch_scc1 L_m_s35x
    s_cbranch_vccnz L_m_s35
    s_branch L_m_s35xy
L_m_s35x:
    s_mov_b32 s28, 0
L_m_s35xy:
    s_mov_b64 exec, -1
    s_nop 4
    s_branch L_m_r36
L_m_s37:
    s_sleep 3
    s_add_u32 s69, s79, 4096
    buffer_load_dwordx4 v[36:39], v2, s[44:47], s69 offen sc1
    s_add_u32 s69, s81, 12288
    buffer_load_dwordx4 v[40:43], v2, s[44:47], s69 offen sc1
    s_add_u32 s69, s79, 16384
    buffer_load_dwordx4 v[44:47], v2, s[44:47], s69 offen sc1
    s_add_u32 s69, s81, 16384
    buffer_load_dwordx4 v[48:51], v2, s[44:47], s69 offen sc1
    s_add_u32 s69, s80, 4096
    buffer_load_dwordx4 v[52:55], v2, s[44:47], s69 offen sc1
    s_add_u32 s69, s78, 8192
    buffer_load_dwordx4 v[56:59], v2, s[44:47], s69 offen sc1
    s_add_u32 s69, s80, 8192
    buffer_load_dwordx4 v[92:95], v2, s[44:47], s69 offen sc1
    s_add_u32 s69, s78, 12288
    buffer_load_dwordx4 v[96:99], v2, s[44:47], s69 offen sc1
    s_add_u32 s69, s78, 20480
    buffer_load_dwordx4 v[100:103], v2, s[44:47], s69 offen sc1
    s_add_u32 s69, s80, 20480
    buffer_load_dwordx4 v[104:107], v2, s[44:47], s69 offen sc1
    s_add_u32 s69, s78, 24576
    buffer_load_dwordx4 v[108:111], v2, s[44:47], s69 offen sc1
    s_add_u32 s69, s80, 24576
    buffer_load_dwordx4 v[112:115], v2, s[44:47], s69 offen sc1
    s_waitcnt vmcnt(0)
    v_min3_f32 v156, |v36|, |v40|, |v44|
    v_min_f32 v156, v156, |v48|
    v_cmp_gt_f32 vcc, s54, v156
    s_sub_u32 s28, s28, 1
    s_cbranch_scc1 L_m_s37x
    s_cbranch_vccnz L_m_s37
    s_branch L_m_s37xy
L_m_s37x:
    s_mov_b32 s28, 0
L_m_s37xy:
    s_mov_b64 exec, -1
    s_nop 4
    s_branch L_m_r38
L_m_s39:
    s_sleep 3
    s_add_u32 s69, s80, 4096
    buffer_load_dwordx4 v[52:55], v2, s[44:47], s69 offen sc1
    s_add_u32 s69, s78, 8192
    buffer_load_dwordx4 v[56:59], v2, s[44:47], s69 offen sc1
    s_add_u32 s69, s80, 8192
    buffer_load_dwordx4 v[92:95], v2, s[44:47], s69 offen sc1
    s_add_u32 s69, s78, 12288
    buffer_load_dwordx4 v[96:99], v2, s[44:47], s69 offen sc1
    s_add_u32 s69, s78, 20480
    buffer_load_dwordx4 v[100:103], v2, s[44:47], s69 offen sc1
    s_add_u32 s69, s80, 20480
    buffer_load_dwordx4 v[104:107], v2, s[44:47], s69 offen sc1
    s_add_u32 s69, s78, 24576
    buffer_load_dwordx4 v[108:111], v2, s[44:47], s69 offen sc1
    s_add_u32 s69, s80, 24576
    buffer_load_dwordx4 v[112:115], v2, s[44:47], s69 offen sc1
    s_add_u32 s69, s81, 4096
    buffer_load_dwordx4 v[28:31], v2, s[44:47], s69 offen sc1
    s_add_u32 s69, s79, 8192
    buffer_load_dwordx4 v[32:35], v2, s[44:47], s69 offen sc1
    s_add_u32 s69, s81, 8192
    buffer_load_dwordx4 v[36:39], v2, s[44:47], s69 offen sc1
    s_add_u32 s69, s79, 12288
    buffer_load_dwordx4 v[40:43], v2, s[44:47], s69 offen sc1
    s_waitcnt vmcnt(0)
    v_min3_f32 v156, |v52|, |v56|, |v92|
    v_min_f32 v156, v156, |v96|
    v_cmp_gt_f32 vcc, s54, v156
    s_sub_u32 s28, s28, 1
    s_cbranch_scc1 L_m_s39x
    s_cbranch_vccnz L_m_s39
    s_branch L_m_s39xy
L_m_s39x:
    s_mov_b32 s28, 0
L_m_s39xy:
    s_mov_b64 exec, -1
    s_nop 4
    s_branch L_m_r40
L_m_s41:
    s_sleep 3
    s_add_u32 s69, s78, 20480
    buffer_load_dwordx4 v[100:103], v2, s[44:47], s69 offen sc1
    s_add_u32 s69, s80, 20480
    buffer_load_dwordx4 v[104:107], v2, s[44:47], s69 offen sc1
    s_add_u32 s69, s78, 24576
    buffer_load_dwordx4 v[108:111], v2, s[44:47], s69 offen sc1
    s_add_u32 s69, s80, 24576
    buffer_load_dwordx4 v[112:115], v2, s[44:47], s69 offen sc1
    s_add_u32 s69, s81, 4096
    buffer_load_dwordx4 v[28:31], v2, s[44:47], s69 offen sc1
    s_add_u32 s69, s79, 8192
    buffer_load_dwordx4 v[32:35], v2, s[44:47], s69 offen sc1
    s_add_u32 s69, s81, 8192
    buffer_load_dwordx4 v[36:39], v2, s[44:47], s69 offen sc1
    s_add_u32 s69, s79, 12288
    buffer_load_dwordx4 v[40:43], v2, s[44:47], s69 offen sc1
    s_add_u32 s69, s79, 20480
    buffer_load_dwordx4 v[44:47], v2, s[44:47], s69 offen sc1
    s_add_u32 s69, s81, 20480
    buffer_load_dwordx4 v[48:51], v2, s[44:47], s69 offen sc1
    s_add_u32 s69, s79, 24576
    buffer_load_dwordx4 v[52:55], v2, s[44:47], s69 offen sc1
    s_add_u32 s69, s81, 24576
    buffer_load_dwordx4 v[56:59], v2, s[44:47], s69 offen sc1
    s_waitcnt vmcnt(0)
    v_min3_f32 v156, |v100|, |v104|, |v108|
    v_min_f32 v156, v156, |v112|
    v_cmp_gt_f32 vcc, s54, v156
    s_sub_u32 s28, s28, 1
    s_cbranch_scc1 L_m_s41x
    s_cbranch_vccnz L_m_s41
    s_branch L_m_s41xy
L_m_s41x:
    s_mov_b32 s28, 0
L_m_s41xy:
    s_mov_b64 exec, -1
    s_nop 4
    s_branch L_m_r42
L_m_s43:
    s_sleep 3
    s_add_u32 s69, s81, 4096
    buffer_load_dwordx4 v[28:31], v2, s[44:47], s69 offen sc1
    s_add_u32 s69, s79, 8192
    buffer_load_dwordx4 v[32:35], v2, s[44:47], s69 offen sc1
    s_add_u32 s69, s81, 8192
    buffer_load_dwordx4 v[36:39], v2, s[44:47], s69 offen sc1
    s_add_u32 s69, s79, 12288
    buffer_load_dwordx4 v[40:43], v2, s[44:47], s69 offen sc1
    s_add_u32 s69, s79, 20480
    buffer_load_dwordx4 v[44:47], v2, s[44:47], s69 offen sc1
    s_add_u32 s69, s81, 20480
    buffer_load_dwordx4 v[48:51], v2, s[44:47], s69 offen sc1
    s_add_u32 s69, s79, 24576
    buffer_load_dwordx4 v[52:55], v2, s[44:47], s69 offen sc1
    s_add_u32 s69, s81, 24576
    buffer_load_dwordx4 v[56:59], v2, s[44:47], s69 offen sc1
    s_add_u32 s69, s78, 3670016
    buffer_load_dwordx4 v[92:95], v2, s[44:47], s69 offen sc1
    s_add_u32 s69, s80, 3670016
    buffer_load_dwordx4 v[96:99], v2, s[44:47], s69 offen sc1
    s_add_u32 s69, s78, 3674112
    buffer_load_dwordx4 v[100:103], v2, s[44:47], s69 offen sc1
    s_add_u32 s69, s80, 3682304
    buffer_load_dwordx4 v[104:107], v2, s[44:47], s69 offen sc1
    s_waitcnt vmcnt(0)
    v_min3_f32 v156, |v28|, |v32|, |v36|
    v_min_f32 v156, v156, |v40|
    v_cmp_gt_f32 vcc, s54, v156
    s_sub_u32 s28, s28, 1
    s_cbranch_scc1 L_m_s43x
    s_cbranch_vccnz L_m_s43
    s_branch L_m_s43xy
L_m_s43x:
    s_mov_b32 s28, 0
L_m_s43xy:
    s_mov_b64 exec, -1
    s_nop 4
    s_branch L_m_r44
L_m_s45:
    s_sleep 3
    s_add_u32 s69, s79, 20480
    buffer_load_dwordx4 v[44:47], v2, s[44:47], s69 offen sc1
    s_add_u32 s69, s81, 20480
    buffer_load_dwordx4 v[48:51], v2, s[44:47], s69 offen sc1
    s_add_u32 s69, s79, 24576
    buffer_load_dwordx4 v[52:55], v2, s[44:47], s69 offen sc1
    s_add_u32 s69, s81, 24576
    buffer_load_dwordx4 v[56:59], v2, s[44:47], s69 offen sc1
    s_add_u32 s69, s78, 3670016
    buffer_load_dwordx4 v[92:95], v2, s[44:47], s69 offen sc1
    s_add_u32 s69, s80, 3670016
    buffer_load_dwordx4 v[96:99], v2, s[44:47], s69 offen sc1
    s_add_u32 s69, s78, 3674112
    buffer_load_dwordx4 v[100:103], v2, s[44:47], s69 offen sc1
    s_add_u32 s69, s80, 3682304
    buffer_load_dwordx4 v[104:107], v2, s[44:47], s69 offen sc1
    s_add_u32 s69, s78, 3686400
    buffer_load_dwordx4 v[108:111], v2, s[44:47], s69 offen sc1
    s_add_u32 s69, s80, 3686400
    buffer_load_dwordx4 v[112:115], v2, s[44:47], s69 offen sc1
    s_add_u32 s69, s79, 3670016
    buffer_load_dwordx4 v[28:31], v2, s[44:47], s69 offen sc1
    s_add_u32 s69, s81, 3670016
    buffer_load_dwordx4 v[32:35], v2, s[44:47], s69 offen sc1
    s_waitcnt vmcnt(0)
    v_min3_f32 v156, |v44|, |v48|, |v52|
    v_min_f32 v156, v156, |v56|
    v_cmp_gt_f32 vcc, s54, v156
    s_sub_u32 s28, s28, 1
    s_cbranch_scc1 L_m_s45x
    s_cbranch_vccnz L_m_s45
    s_branch L_m_s45xy
L_m_s45x:
    s_mov_b32 s28, 0
L_m_s45xy:
    s_mov_b64 exec, -1
    s_nop 4
    s_branch L_m_r46
L_m_s47:
    s_sleep 3
    s_add_u32 s69, s78, 3670016
    buffer_load_dwordx4 v[92:95], v2, s[44:47], s69 offen sc1
    s_add_u32 s69, s80, 3670016
    buffer_load_dwordx4 v[96:99], v2, s[44:47], s69 offen sc1
    s_add_u32 s69, s78, 3674112
    buffer_load_dwordx4 v[100:103], v2, s[44:47], s69 offen sc1
    s_add_u32 s69, s80, 3682304
    buffer_load_dwordx4 v[104:107], v2, s[44:47], s69 offen sc1
    s_add_u32 s69, s78, 3686400
    buffer_load_dwordx4 v[108:111], v2, s[44:47], s69 offen sc1
    s_add_u32 s69, s80, 3686400
    buffer_load_dwordx4 v[112:115], v2, s[44:47], s69 offen sc1
    s_add_u32 s69, s79, 3670016
    buffer_load_dwordx4 v[28:31], v2, s[44:47], s69 offen sc1
    s_add_u32 s69, s81, 3670016
    buffer_load_dwordx4 v[32:35], v2, s[44:47], s69 offen sc1
    s_add_u32 s69, s79, 3674112
    buffer_load_dwordx4 v[36:39], v2, s[44:47], s69 offen sc1
    s_add_u32 s69, s81, 3682304
    buffer_load_dwordx4 v[40:43], v2, s[44:47], s69 offen sc1
    s_add_u32 s69, s79, 3686400
    buffer_load_dwordx4 v[44:47], v2, s[44:47], s69 offen sc1
    s_add_u32 s69, s81, 3686400
    buffer_load_dwordx4 v[48:51], v2, s[44:47], s69 offen sc1
    s_waitcnt vmcnt(0)
    v_min3_f32 v156, |v92|, |v96|, |v100|
    v_min_f32 v156, v156, |v104|
    v_cmp_gt_f32 vcc, s54, v156
    s_sub_u32 s28, s28, 1
    s_cbranch_scc1 L_m_s47x
    s_cbranch_vccnz L_m_s47
    s_branch L_m_s47xy
L_m_s47x:
    s_mov_b32 s28, 0
L_m_s47xy:
    s_mov_b64 exec, -1
    s_nop 4
    s_branch L_m_r48
L_m_s49:
    s_sleep 3
    s_add_u32 s69, s78, 3686400
    buffer_load_dwordx4 v[108:111], v2, s[44:47], s69 offen sc1
    s_add_u32 s69, s80, 3686400
    buffer_load_dwordx4 v[112:115], v2, s[44:47], s69 offen sc1
    s_add_u32 s69, s79, 3670016
    buffer_load_dwordx4 v[28:31], v2, s[44:47], s69 offen sc1
    s_add_u32 s69, s81, 3670016
    buffer_load_dwordx4 v[32:35], v2, s[44:47], s69 offen sc1
    s_add_u32 s69, s79, 3674112
    buffer_load_dwordx4 v[36:39], v2, s[44:47], s69 offen sc1
    s_add_u32 s69, s81, 3682304
    buffer_load_dwordx4 v[40:43], v2, s[44:47], s69 offen sc1
    s_add_u32 s69, s79, 3686400
    buffer_load_dwordx4 v[44:47], v2, s[44:47], s69 offen sc1
    s_add_u32 s69, s81, 3686400
    buffer_load_dwordx4 v[48:51], v2, s[44:47], s69 offen sc1
    s_add_u32 s69, s80, 3674112
    buffer_load_dwordx4 v[52:55], v2, s[44:47], s69 offen sc1
    s_add_u32 s69, s78, 3678208
    buffer_load_dwordx4 v[56:59], v2, s[44:47], s69 offen sc1
    s_add_u32 s69, s80, 3678208
    buffer_load_dwordx4 v[60:63], v2, s[44:47], s69 offen sc1
    s_add_u32 s69, s78, 3682304
    buffer_load_dwordx4 v[64:67], v2, s[44:47], s69 offen sc1
    s_add_u32 s69, s78, 3690496
    buffer_load_dwordx4 v[68:71], v2, s[44:47], s69 offen sc1
    s_add_u32 s69, s80, 3690496
    buffer_load_dwordx4 v[72:75], v2, s[44:47], s69 offen sc1
    s_add_u32 s69, s78, 3694592
    buffer_load_dwordx4 v[76:79], v2, s[44:47], s69 offen sc1
    s_add_u32 s69, s80, 3694592
    buffer_load_dwordx4 v[80:83], v2, s[44:47], s69 offen sc1
    s_add_u32 s69, s81, 3674112
    buffer_load_dwordx4 v[84:87], v2, s[44:47], s69 offen sc1
    s_add_u32 s69, s79, 3678208
    buffer_load_dwordx4 v[88:91], v2, s[44:47], s69 offen sc1
    s_add_u32 s69, s81, 3678208
    buffer_load_dwordx4 v[92:95], v2, s[44:47], s69 offen sc1
    s_add_u32 s69, s79, 3682304
    buffer_load_dwordx4 v[96:99], v2, s[44:47], s69 offen sc1
    s_waitcnt vmcnt(0)
    v_min3_f32 v156, |v108|, |v112|, |v28|
    v_min_f32 v156, v156, |v32|
    v_cmp_gt_f32 vcc, s54, v156
    s_sub_u32 s28, s28, 1
    s_cbranch_scc1 L_m_s49x
    s_cbranch_vccnz L_m_s49
    s_branch L_m_s49xy
L_m_s49x:
    s_mov_b32 s28, 0
L_m_s49xy:
    s_mov_b64 exec, -1
    s_nop 4
    s_branch L_m_r50
L_m_s52:
    s_sleep 3
    s_add_u32 s69, s79, 3674112
    buffer_load_dwordx4 v[36:39], v2, s[44:47], s69 offen sc1
    s_add_u32 s69, s81, 3682304
    buffer_load_dwordx4 v[40:43], v2, s[44:47], s69 offen sc1
    s_add_u32 s69, s79, 3686400
    buffer_load_dwordx4 v[44:47], v2, s[44:47], s69 offen sc1
    s_add_u32 s69, s81, 3686400
    buffer_load_dwordx4 v[48:51], v2, s[44:47], s69 offen sc1
    s_add_u32 s69, s80, 3674112
    buffer_load_dwordx4 v[52:55], v2, s[44:47], s69 offen sc1
    s_add_u32 s69, s78, 3678208
    buffer_load_dwordx4 v[56:59], v2, s[44:47], s69 offen sc1
    s_add_u32 s69, s80, 3678208
    buffer_load_dwordx4 v[60:63], v2, s[44:47], s69 offen sc1
    s_add_u32 s69, s78, 3682304
    buffer_load_dwordx4 v[64:67], v2, s[44:47], s69 offen sc1
    s_add_u32 s69, s78, 3690496
    buffer_load_dwordx4 v[68:71], v2, s[44:47], s69 offen sc1
    s_add_u32 s69, s80, 3690496
    buffer_load_dwordx4 v[72:75], v2, s[44:47], s69 offen sc1
    s_add_u32 s69, s78, 3694592
    buffer_load_dwordx4 v[76:79], v2, s[44:47], s69 offen sc1
    s_add_u32 s69, s80, 3694592
    buffer_load_dwordx4 v[80:83], v2, s[44:47], s69 offen sc1
    s_add_u32 s69, s81, 3674112
    buffer_load_dwordx4 v[84:87], v2, s[44:47], s69 offen sc1
    s_add_u32 s69, s79, 3678208
    buffer_load_dwordx4 v[88:91], v2, s[44:47], s69 offen sc1
    s_add_u32 s69, s81, 3678208
    buffer_load_dwordx4 v[92:95], v2, s[44:47], s69 offen sc1
    s_add_u32 s69, s79, 3682304
    buffer_load_dwordx4 v[96:99], v2, s[44:47], s69 offen sc1
    s_add_u32 s69, s79, 3690496
    buffer_load_dwordx4 v[100:103], v2, s[44:47], s69 offen sc1
    s_add_u32 s69, s81, 3690496
    buffer_load_dwordx4 v[104:107], v2, s[44:47], s69 offen sc1
    s_add_u32 s69, s79, 3694592
    buffer_load_dwordx4 v[108:111], v2, s[44:47], s69 offen sc1
    s_add_u32 s69, s81, 3694592
    buffer_load_dwordx4 v[112:115], v2, s[44:47], s69 offen sc1
    s_waitcnt vmcnt(0)
    v_min3_f32 v156, |v36|, |v40|, |v44|
    v_min_f32 v156, v156, |v48|
    v_cmp_gt_f32 vcc, s54, v156
    s_sub_u32 s28, s28, 1
    s_cbranch_scc1 L_m_s52x
    s_cbranch_vccnz L_m_s52
    s_branch L_m_s52xy
L_m_s52x:
    s_mov_b32 s28, 0
L_m_s52xy:
    s_mov_b64 exec, -1
    s_nop 4
    s_branch L_m_r53
L_m_s54:
    s_sleep 3
    s_add_u32 s69, s80, 3674112
    buffer_load_dwordx4 v[52:55], v2, s[44:47], s69 offen sc1
    s_add_u32 s69, s78, 3678208
    buffer_load_dwordx4 v[56:59], v2, s[44:47], s69 offen sc1
    s_add_u32 s69, s80, 3678208
    buffer_load_dwordx4 v[60:63], v2, s[44:47], s69 offen sc1
    s_add_u32 s69, s78, 3682304
    buffer_load_dwordx4 v[64:67], v2, s[44:47], s69 offen sc1
    s_add_u32 s69, s78, 3690496
    buffer_load_dwordx4 v[68:71], v2, s[44:47], s69 offen sc1
    s_add_u32 s69, s80, 3690496
    buffer_load_dwordx4 v[72:75], v2, s[44:47], s69 offen sc1
    s_add_u32 s69, s78, 3694592
    buffer_load_dwordx4 v[76:79], v2, s[44:47], s69 offen sc1
    s_add_u32 s69, s80, 3694592
    buffer_load_dwordx4 v[80:83], v2, s[44:47], s69 offen sc1
    s_add_u32 s69, s81, 3674112
    buffer_load_dwordx4 v[84:87], v2, s[44:47], s69 offen sc1
    s_add_u32 s69, s79, 3678208
    buffer_load_dwordx4 v[88:91], v2, s[44:47], s69 offen sc1
    s_add_u32 s69, s81, 3678208
    buffer_load_dwordx4 v[92:95], v2, s[44:47], s69 offen sc1
    s_add_u32 s69, s79, 3682304
    buffer_load_dwordx4 v[96:99], v2, s[44:47], s69 offen sc1
    s_add_u32 s69, s79, 3690496
    buffer_load_dwordx4 v[100:103], v2, s[44:47], s69 offen sc1
    s_add_u32 s69, s81, 3690496
    buffer_load_dwordx4 v[104:107], v2, s[44:47], s69 offen sc1
    s_add_u32 s69, s79, 3694592
    buffer_load_dwordx4 v[108:111], v2, s[44:47], s69 offen sc1
    s_add_u32 s69, s81, 3694592
    buffer_load_dwordx4 v[112:115], v2, s[44:47], s69 offen sc1
    s_waitcnt vmcnt(0)
    v_min3_f32 v156, |v52|, |v56|, |v60|
    v_min_f32 v156, v156, |v64|
    v_cmp_gt_f32 vcc, s54, v156
    s_sub_u32 s28, s28, 1
    s_cbranch_scc1 L_m_s54x
    s_cbranch_vccnz L_m_s54
    s_branch L_m_s54xy
L_m_s54x:
    s_mov_b32 s28, 0
L_m_s54xy:
    s_mov_b64 exec, -1
    s_nop 4
    s_branch L_m_r55
L_m_s56:
    s_sleep 3
    s_add_u32 s69, s78, 3690496
    buffer_load_dwordx4 v[68:71], v2, s[44:47], s69 offen sc1
    s_add_u32 s69, s80, 3690496
    buffer_load_dwordx4 v[72:75], v2, s[44:47], s69 offen sc1
    s_add_u32 s69, s78, 3694592
    buffer_load_dwordx4 v[76:79], v2, s[44:47], s69 offen sc1
    s_add_u32 s69, s80, 3694592
    buffer_load_dwordx4 v[80:83], v2, s[44:47], s69 offen sc1
    s_add_u32 s69, s81, 3674112
    buffer_load_dwordx4 v[84:87], v2, s[44:47], s69 offen sc1
    s_add_u32 s69, s79, 3678208
    buffer_load_dwordx4 v[88:91], v2, s[44:47], s69 offen sc1
    s_add_u32 s69, s81, 3678208
    buffer_load_dwordx4 v[92:95], v2, s[44:47], s69 offen sc1
    s_add_u32 s69, s79, 3682304
    buffer_load_dwordx4 v[96:99], v2, s[44:47], s69 offen sc1
    s_add_u32 s69, s79, 3690496
    buffer_load_dwordx4 v[100:103], v2, s[44:47], s69 offen sc1
    s_add_u32 s69, s81, 3690496
    buffer_load_dwordx4 v[104:107], v2, s[44:47], s69 offen sc1
    s_add_u32 s69, s79, 3694592
    buffer_load_dwordx4 v[108:111], v2, s[44:47], s69 offen sc1
    s_add_u32 s69, s81, 3694592
    buffer_load_dwordx4 v[112:115], v2, s[44:47], s69 offen sc1
    s_waitcnt vmcnt(0)
    v_min3_f32 v156, |v68|, |v72|, |v76|
    v_min_f32 v156, v156, |v80|
    v_cmp_gt_f32 vcc, s54, v156
    s_sub_u32 s28, s28, 1
    s_cbranch_scc1 L_m_s56x
    s_cbranch_vccnz L_m_s56
    s_branch L_m_s56xy
L_m_s56x:
    s_mov_b32 s28, 0
L_m_s56xy:
    s_mov_b64 exec, -1
    s_nop 4
    s_branch L_m_r57
L_m_s58:
    s_sleep 3
    s_add_u32 s69, s81, 3674112
    buffer_load_dwordx4 v[84:87], v2, s[44:47], s69 offen sc1
    s_add_u32 s69, s79, 3678208
    buffer_load_dwordx4 v[88:91], v2, s[44:47], s69 offen sc1
    s_add_u32 s69, s81, 3678208
    buffer_load_dwordx4 v[92:95], v2, s[44:47], s69 offen sc1
    s_add_u32 s69, s79, 3682304
    buffer_load_dwordx4 v[96:99], v2, s[44:47], s69 offen sc1
    s_add_u32 s69, s79, 3690496
    buffer_load_dwordx4 v[100:103], v2, s[44:47], s69 offen sc1
    s_add_u32 s69, s81, 3690496
    buffer_load_dwordx4 v[104:107], v2, s[44:47], s69 offen sc1
    s_add_u32 s69, s79, 3694592
    buffer_load_dwordx4 v[108:111], v2, s[44:47], s69 offen sc1
    s_add_u32 s69, s81, 3694592
    buffer_load_dwordx4 v[112:115], v2, s[44:47], s69 offen sc1
    s_waitcnt vmcnt(0)
    v_min3_f32 v156, |v84|, |v88|, |v92|
    v_min_f32 v156, v156, |v96|
    v_cmp_gt_f32 vcc, s54, v156
    s_sub_u32 s28, s28, 1
    s_cbranch_scc1 L_m_s58x
    s_cbranch_vccnz L_m_s58
    s_branch L_m_s58xy
L_m_s58x:
    s_mov_b32 s28, 0
L_m_s58xy:
    s_mov_b64 exec, -1
    s_nop 4
    s_branch L_m_r59
L_m_s60:
    s_sleep 3
    s_add_u32 s69, s79, 3690496
    buffer_load_dwordx4 v[100:103], v2, s[44:47], s69 offen sc1
    s_add_u32 s69, s81, 3690496
    buffer_load_dwordx4 v[104:107], v2, s[44:47], s69 offen sc1
    s_add_u32 s69, s79, 3694592
    buffer_load_dwordx4 v[108:111], v2, s[44:47], s69 offen sc1
    s_add_u32 s69, s81, 3694592
    buffer_load_dwordx4 v[112:115], v2, s[44:47], s69 offen sc1
    s_waitcnt vmcnt(0)
    v_min3_f32 v156, |v100|, |v104|, |v108|
    v_min_f32 v156, v156, |v112|
    v_cmp_gt_f32 vcc, s54, v156
    s_sub_u32 s28, s28, 1
    s_cbranch_scc1 L_m_s60x
    s_cbranch_vccnz L_m_s60
    s_branch L_m_s60xy
L_m_s60x:
    s_mov_b32 s28, 0
L_m_s60xy:
    s_mov_b64 exec, -1
    s_nop 4
    s_branch L_m_r61
L_m_s62:
    s_mov_b64 exec, vcc
    s_sleep 3
    s_mov_b32 s64, 8683520
    s_add_u32 s65, s6, 0
    buffer_load_dwordx4 v[28:31], v6, s[44:47], s64 offen offset:0 sc1
    buffer_load_dwordx4 v[32:35], v6, s[44:47], s64 offen offset:1024 sc1
    buffer_load_dwordx4 v[36:39], v6, s[44:47], s64 offen offset:2048 sc1
    buffer_load_dwordx4 v[40:43], v6, s[44:47], s64 offen offset:3072 sc1
    buffer_load_dwordx4 v[44:47], v5, s[44:47], s65 offen sc1
    s_waitcnt vmcnt(0)
    v_min3_f32 v31, v30, v34, v38
    v_min_f32 v31, v31, v42
    v_cmp_gt_f32 s[62:63], s39, v31
    v_xor_b32 v44, s54, v44
    v_cmp_le_f32 s[70:71], s55, |v44|
    v_cmp_gt_f32 vcc, s54, |v44|
    s_nop 0
    s_or_b64 vcc, vcc, s[70:71]
    s_or_b64 vcc, vcc, s[62:63]
    s_sub_u32 s28, s28, 1
    s_cbranch_scc1 L_m_s62x
    s_cbranch_vccnz L_m_s62
    s_branch L_m_s62xy
L_m_s62x:
    s_mov_b32 s28, 0
L_m_s62xy:
    s_mov_b64 exec, -1
    s_nop 4
    s_branch L_m_r63
L_m_s64:
    s_mov_b64 exec, vcc
    s_sleep 3
    s_mov_b32 s64, 8699904
    s_add_u32 s65, s6, 1081344
    buffer_load_dwordx4 v[92:95], v6, s[44:47], s64 offen offset:0 sc1
    buffer_load_dwordx4 v[96:99], v6, s[44:47], s64 offen offset:1024 sc1
    buffer_load_dwordx4 v[100:103], v6, s[44:47], s64 offen offset:2048 sc1
    buffer_load_dwordx4 v[104:107], v6, s[44:47], s64 offen offset:3072 sc1
    buffer_load_dwordx4 v[108:111], v5, s[44:47], s65 offen sc1
    s_waitcnt vmcnt(0)
    v_min3_f32 v95, v94, v98, v102
    v_min_f32 v95, v95, v106
    v_cmp_gt_f32 s[62:63], s39, v95
    v_xor_b32 v108, s54, v108
    v_cmp_le_f32 s[70:71], s55, |v108|
    v_cmp_gt_f32 vcc, s54, |v108|
    s_nop 0
    s_or_b64 vcc, vcc, s[70:71]
    s_or_b64 vcc, vcc, s[62:63]
    s_sub_u32 s28, s28, 1
    s_cbranch_scc1 L_m_s64x
    s_cbranch_vccnz L_m_s64
    s_branch L_m_s64xy
L_m_s64x:
    s_mov_b32 s28, 0
L_m_s64xy:
    s_mov_b64 exec, -1
    s_nop 4
    s_branch L_m_r65
L_m_s66:
    s_mov_b64 exec, vcc
    s_sleep 3
    s_add_u32 s64, s8, 2162688
    buffer_load_dwordx4 v[28:31], v2, s[44:47], s64 offen sc1
    s_add_u32 s64, s8, 2166784
    buffer_load_dwordx4 v[32:35], v2, s[44:47], s64 offen sc1
    s_add_u32 s64, s8, 2170880
    buffer_load_dwordx4 v[60:63], v2, s[44:47], s64 offen sc1
    s_add_u32 s64, s8, 2174976
    buffer_load_dwordx4 v[64:67], v2, s[44:47], s64 offen sc1
    s_add_u32 s64, s8, 2179072
    buffer_load_dwordx4 v[116:119], v2, s[44:47], s64 offen sc1
    s_add_u32 s64, s8, 2183168
    buffer_load_dwordx4 v[120:123], v2, s[44:47], s64 offen sc1
    s_add_u32 s64, s8, 2187264
    buffer_load_dwordx4 v[124:127], v2, s[44:47], s64 offen sc1
    s_add_u32 s64, s8, 2191360
    buffer_load_dwordx4 v[128:131], v2, s[44:47], s64 offen sc1
    s_waitcnt vmcnt(0)
    v_xor_b32 v28, s54, v28
    v_xor_b32 v32, s54, v32
    v_xor_b32 v60, s54, v60
    v_xor_b32 v64, s54, v64
    v_xor_b32 v116, s54, v116
    v_xor_b32 v120, s54, v120
    v_xor_b32 v124, s54, v124
    v_xor_b32 v128, s54, v128
    v_min3_f32 v112, |v28|, |v32|, |v60|
    v_min3_f32 v112, v112, |v64|, |v116|
    v_min3_f32 v112, v112, |v120|, |v124|
    v_min_f32 v112, v112, |v128|
    v_max3_f32 v113, |v28|, |v32|, |v60|
    v_max3_f32 v113, v113, |v64|, |v116|
    v_max3_f32 v113, v113, |v120|, |v124|
    v_max_f32 v113, v113, |v128|
    v_cmp_le_f32 s[70:71], s55, v113
    v_cmp_gt_f32 vcc, s54, v112
    s_nop 0
    s_or_b64 vcc, vcc, s[70:71]
    s_sub_u32 s28, s28, 1
    s_cbranch_scc1 L_m_s66x
    s_cbranch_vccnz L_m_s66
    s_branch L_m_s66xy
L_m_s66x:
    s_mov_b32 s28, 0
L_m_s66xy:
    s_mov_b64 exec, -1
    s_nop 4
    s_branch L_m_r67
L_m_s70:
    s_mov_b64 exec, vcc
    s_sleep 3
    s_add_u32 s64, s8, 3215360
    buffer_load_dwordx4 v[60:63], v2, s[44:47], s64 offen sc1
    s_add_u32 s64, s8, 3219456
    buffer_load_dwordx4 v[64:67], v2, s[44:47], s64 offen sc1
    s_add_u32 s64, s8, 3223552
    buffer_load_dwordx4 v[68:71], v2, s[44:47], s64 offen sc1
    s_add_u32 s64, s8, 3227648
    buffer_load_dwordx4 v[72:75], v2, s[44:47], s64 offen sc1
    s_add_u32 s64, s8, 3231744
    buffer_load_dwordx4 v[76:79], v2, s[44:47], s64 offen sc1
    s_add_u32 s64, s8, 3235840
    buffer_load_dwordx4 v[80:83], v2, s[44:47], s64 offen sc1
    s_add_u32 s64, s8, 3239936
    buffer_load_dwordx4 v[84:87], v2, s[44:47], s64 offen sc1
    s_add_u32 s64, s8, 3244032
    buffer_load_dwordx4 v[88:91], v2, s[44:47], s64 offen sc1
    s_waitcnt vmcnt(0)
    v_xor_b32 v60, s54, v60
    v_xor_b32 v64, s54, v64
    v_xor_b32 v68, s54, v68
    v_xor_b32 v72, s54, v72
    v_xor_b32 v76, s54, v76
    v_xor_b32 v80, s54, v80
    v_xor_b32 v84, s54, v84
    v_xor_b32 v88, s54, v88
    v_min3_f32 v136, |v60|, |v64|, |v68|
    v_min3_f32 v136, v136, |v72|, |v76|
    v_min3_f32 v136, v136, |v80|, |v84|
    v_min_f32 v136, v136, |v88|
    v_max3_f32 v137, |v60|, |v64|, |v68|
    v_max3_f32 v137, v137, |v72|, |v76|
    v_max3_f32 v137, v137, |v80|, |v84|
    v_max_f32 v137, v137, |v88|
    v_cmp_le_f32 s[70:71], s55, v137
    v_cmp_gt_f32 vcc, s54, v136
    s_nop 0
    s_or_b64 vcc, vcc, s[70:71]
    s_sub_u32 s28, s28, 1
    s_cbranch_scc1 L_m_s70x
    s_cbranch_vccnz L_m_s70
    s_branch L_m_s70xy
L_m_s70x:
    s_mov_b32 s28, 0
L_m_s70xy:
    s_mov_b64 exec, -1
    s_nop 4
    s_branch L_m_r71
L_m_s72:
    s_mov_b64 exec, vcc
    s_sleep 3
    s_add_u32 s64, s8, 3215360
    buffer_load_dwordx4 v[60:63], v2, s[44:47], s64 offen sc1
    s_add_u32 s64, s8, 3219456
    buffer_load_dwordx4 v[64:67], v2, s[44:47], s64 offen sc1
    s_add_u32 s64, s8, 3223552
    buffer_load_dwordx4 v[68:71], v2, s[44:47], s64 offen sc1
    s_add_u32 s64, s8, 3227648
    buffer_load_dwordx4 v[72:75], v2, s[44:47], s64 offen sc1
    s_add_u32 s64, s8, 3231744
    buffer_load_dwordx4 v[76:79], v2, s[44:47], s64 offen sc1
    s_add_u32 s64, s8, 3235840
    buffer_load_dwordx4 v[80:83], v2, s[44:47], s64 offen sc1
    s_add_u32 s64, s8, 3239936
    buffer_load_dwordx4 v[84:87], v2, s[44:47], s64 offen sc1
    s_add_u32 s64, s8, 3244032
    buffer_load_dwordx4 v[88:91], v2, s[44:47], s64 offen sc1
    s_waitcnt vmcnt(0)
    v_xor_b32 v60, s54, v60
    v_xor_b32 v64, s54, v64
    v_xor_b32 v68, s54, v68
    v_xor_b32 v72, s54, v72
    v_xor_b32 v76, s54, v76
    v_xor_b32 v80, s54, v80
    v_xor_b32 v84, s54, v84
    v_xor_b32 v88, s54, v88
    v_min3_f32 v136, |v60|, |v64|, |v68|
    v_min3_f32 v136, v136, |v72|, |v76|
    v_min3_f32 v136, v136, |v80|, |v84|
    v_min_f32 v136, v136, |v88|
    v_max3_f32 v137, |v60|, |v64|, |v68|
    v_max3_f32 v137, v137, |v72|, |v76|
    v_max3_f32 v137, v137, |v80|, |v84|
    v_max_f32 v137, v137, |v88|
    v_cmp_le_f32 s[70:71], s55, v137
    v_cmp_gt_f32 vcc, s54, v136
    s_nop 0
    s_or_b64 vcc, vcc, s[70:71]
    s_sub_u32 s28, s28, 1
    s_cbranch_scc1 L_m_s72x
    s_cbranch_vccnz L_m_s72
    s_branch L_m_s72xy
L_m_s72x:
    s_mov_b32 s28, 0
L_m_s72xy:
    s_mov_b64 exec, -1
    s_nop 4
    s_branch L_m_r73
L_m_s74:
    s_sleep 3
    s_add_u32 s69, s78, 0
    buffer_load_dwordx4 v[92:95], v2, s[44:47], s69 offen sc1
    s_add_u32 s69, s80, 0
    buffer_load_dwordx4 v[96:99], v2, s[44:47], s69 offen sc1
    s_add_u32 s69, s78, 4096
    buffer_load_dwordx4 v[100:103], v2, s[44:47], s69 offen sc1
    s_add_u32 s69, s80, 12288
    buffer_load_dwordx4 v[104:107], v2, s[44:47], s69 offen sc1
    s_add_u32 s69, s78, 16384
    buffer_load_dwordx4 v[108:111], v2, s[44:47], s69 offen sc1
    s_add_u32 s69, s80, 16384
    buffer_load_dwordx4 v[112:115], v2, s[44:47], s69 offen sc1
    s_add_u32 s69, s79, 0
    buffer_load_dwordx4 v[28:31], v2, s[44:47], s69 offen sc1
    s_add_u32 s69, s81, 0
    buffer_load_dwordx4 v[32:35], v2, s[44:47], s69 offen sc1
    s_add_u32 s69, s79, 4096
    buffer_load_dwordx4 v[36:39], v2, s[44:47], s69 offen sc1
    s_add_u32 s69, s81, 12288
    buffer_load_dwordx4 v[40:43], v2, s[44:47], s69 offen sc1
    s_add_u32 s69, s79, 16384
    buffer_load_dwordx4 v[44:47], v2, s[44:47], s69 offen sc1
    s_add_u32 s69, s81, 16384
    buffer_load_dwordx4 v[48:51], v2, s[44:47], s69 offen sc1
    s_add_u32 s69, s80, 4096
    buffer_load_dwordx4 v[52:55], v2, s[44:47], s69 offen sc1
    s_add_u32 s69, s78, 8192
    buffer_load_dwordx4 v[56:59], v2, s[44:47], s69 offen sc1
    s_waitcnt vmcnt(0)
    v_xor_b32 v92, s54, v92
    v_xor_b32 v96, s54, v96
    v_xor_b32 v100, s54, v100
    v_xor_b32 v104, s54, v104
    v_min3_f32 v156, |v92|, |v96|, |v100|
    v_min_f32 v156, v156, |v104|
    v_max3_f32 v157, |v92|, |v96|, |v100|
    v_max_f32 v157, v157, |v104|
    v_cmp_le_f32 s[70:71], s55, v157
    v_cmp_gt_f32 vcc, s54, v156
    s_nop 0
    s_or_b64 vcc, vcc, s[70:71]
    s_sub_u32 s28, s28, 1
    s_cbranch_scc1 L_m_s74x
    s_cbranch_vccnz L_m_s74
    s_branch L_m_s74xy
L_m_s74x:
    s_mov_b32 s28, 0
L_m_s74xy:
    s_mov_b64 exec, -1
    s_nop 4
    s_branch L_m_r75
L_m_s76:
    s_sleep 3
    s_add_u32 s69, s78, 16384
    buffer_load_dwordx4 v[108:111], v2, s[44:47], s69 offen sc1
    s_add_u32 s69, s80, 16384
    buffer_load_dwordx4 v[112:115], v2, s[44:47], s69 offen sc1
    s_add_u32 s69, s79, 0
    buffer_load_dwordx4 v[28:31], v2, s[44:47], s69 offen sc1
    s_add_u32 s69, s81, 0
    buffer_load_dwordx4 v[32:35], v2, s[44:47], s69 offen sc1
    s_add_u32 s69, s79, 4096
    buffer_load_dwordx4 v[36:39], v2, s[44:47], s69 offen sc1
    s_add_u32 s69, s81, 12288
    buffer_load_dwordx4 v[40:43], v2, s[44:47], s69 offen sc1
    s_add_u32 s69, s79, 16384
    buffer_load_dwordx4 v[44:47], v2, s[44:47], s69 offen sc1
    s_add_u32 s69, s81, 16384
    buffer_load_dwordx4 v[48:51], v2, s[44:47], s69 offen sc1
    s_add_u32 s69, s80, 4096
    buffer_load_dwordx4 v[52:55], v2, s[44:47], s69 offen sc1
    s_add_u32 s69, s78, 8192
    buffer_load_dwordx4 v[56:59], v2, s[44:47], s69 offen sc1
    s_add_u32 s69, s80, 8192
    buffer_load_dwordx4 v[92:95], v2, s[44:47], s69 offen sc1
    s_add_u32 s69, s78, 12288
    buffer_load_dwordx4 v[96:99], v2, s[44:47], s69 offen sc1
    s_add_u32 s69, s78, 20480
    buffer_load_dwordx4 v[100:103], v2, s[44:47], s69 offen sc1
    s_waitcnt vmcnt(0)
    v_xor_b32 v108, s54, v108
    v_xor_b32 v112, s54, v112
    v_xor_b32 v28, s54, v28
    v_xor_b32 v32, s54, v32
    v_min3_f32 v156, |v108|, |v112|, |v28|
    v_min_f32 v156, v156, |v32|
    v_max3_f32 v157, |v108|, |v112|, |v28|
    v_max_f32 v157, v157, |v32|
    v_cmp_le_f32 s[70:71], s55, v157
    v_cmp_gt_f32 vcc, s54, v156
    s_nop 0
    s_or_b64 vcc, vcc, s[70:71]
    s_sub_u32 s28, s28, 1
    s_cbranch_scc1 L_m_s76x
    s_cbranch_vccnz L_m_s76
    s_branch L_m_s76xy
L_m_s76x:
    s_mov_b32 s28, 0
L_m_s76xy:
    s_mov_b64 exec, -1
    s_nop 4
    s_branch L_m_r77
L_m_s78:
    s_sleep 3
    s_add_u32 s69, s79, 4096
    buffer_load_dwordx4 v[36:39], v2, s[44:47], s69 offen sc1
    s_add_u32 s69, s81, 12288
    buffer_load_dwordx4 v[40:43], v2, s[44:47], s69 offen sc1
    s_add_u32 s69, s79, 16384
    buffer_load_dwordx4 v[44:47], v2, s[44:47], s69 offen sc1
    s_add_u32 s69, s81, 16384
    buffer_load_dwordx4 v[48:51], v2, s[44:47], s69 offen sc1
    s_add_u32 s69, s80, 4096
    buffer_load_dwordx4 v[52:55], v2, s[44:47], s69 offen sc1
    s_add_u32 s69, s78, 8192
    buffer_load_dwordx4 v[56:59], v2, s[44:47], s69 offen sc1
    s_add_u32 s69, s80, 8192
    buffer_load_dwordx4 v[92:95], v2, s[44:47], s69 offen sc1
    s_add_u32 s69, s78, 12288
    buffer_load_dwordx4 v[96:99], v2, s[44:47], s69 offen sc1
    s_add_u32 s69, s78, 20480
    buffer_load_dwordx4 v[100:103], v2, s[44:47], s69 offen sc1
    s_add_u32 s69, s80, 20480
    buffer_load_dwordx4 v[104:107], v2, s[44:47], s69 offen sc1
    s_add_u32 s69, s78, 24576
    buffer_load_dwordx4 v[108:111], v2, s[44:47], s69 offen sc1
    s_add_u32 s69, s80, 24576
    buffer_load_dwordx4 v[112:115], v2, s[44:47], s69 offen sc1
    s_add_u32 s69, s81, 4096
    buffer_load_dwordx4 v[28:31], v2, s[44:47], s69 offen sc1
    s_waitcnt vmcnt(0)
    v_xor_b32 v36, s54, v36
    v_xor_b32 v40, s54, v40
    v_xor_b32 v44, s54, v44
    v_xor_b32 v48, s54, v48
    v_min3_f32 v156, |v36|, |v40|, |v44|
    v_min_f32 v156, v156, |v48|
    v_max3_f32 v157, |v36|, |v40|, |v44|
    v_max_f32 v157, v157, |v48|
    v_cmp_le_f32 s[70:71], s55, v157
    v_cmp_gt_f32 vcc, s54, v156
    s_nop 0
    s_or_b64 vcc, vcc, s[70:71]
    s_sub_u32 s28, s28, 1
    s_cbranch_scc1 L_m_s78x
    s_cbranch_vccnz L_m_s78
    s_branch L_m_s78xy
L_m_s78x:
    s_mov_b32 s28, 0
L_m_s78xy:
    s_mov_b64 exec, -1
    s_nop 4
    s_branch L_m_r79
L_m_s80:
    s_sleep 3
    s_add_u32 s69, s80, 4096
    buffer_load_dwordx4 v[52:55], v2, s[44:47], s69 offen sc1
    s_add_u32 s69, s78, 8192
    buffer_load_dwordx4 v[56:59], v2, s[44:47], s69 offen sc1
    s_add_u32 s69, s80, 8192
    buffer_load_dwordx4 v[92:95], v2, s[44:47], s69 offen sc1
    s_add_u32 s69, s78, 12288
    buffer_load_dwordx4 v[96:99], v2, s[44:47], s69 offen sc1
    s_add_u32 s69, s78, 20480
    buffer_load_dwordx4 v[100:103], v2, s[44:47], s69 offen sc1
    s_add_u32 s69, s80, 20480
    buffer_load_dwordx4 v[104:107], v2, s[44:47], s69 offen sc1
    s_add_u32 s69, s78, 24576
    buffer_load_dwordx4 v[108:111], v2, s[44:47], s69 offen sc1
    s_add_u32 s69, s80, 24576
    buffer_load_dwordx4 v[112:115], v2, s[44:47], s69 offen sc1
    s_add_u32 s69, s81, 4096
    buffer_load_dwordx4 v[28:31], v2, s[44:47], s69 offen sc1
    s_add_u32 s69, s79, 8192
    buffer_load_dwordx4 v[32:35], v2, s[44:47], s69 offen sc1
    s_add_u32 s69, s81, 8192
    buffer_load_dwordx4 v[36:39], v2, s[44:47], s69 offen sc1
    s_add_u32 s69, s79, 12288
    buffer_load_dwordx4 v[40:43], v2, s[44:47], s69 offen sc1
    s_add_u32 s69, s79, 20480
    buffer_load_dwordx4 v[44:47], v2, s[44:47], s69 offen sc1
    s_waitcnt vmcnt(0)
    v_xor_b32 v52, s54, v52
    v_xor_b32 v56, s54, v56
    v_xor_b32 v92, s54, v92
    v_xor_b32 v96, s54, v96
    v_min3_f32 v156, |v52|, |v56|, |v92|
    v_min_f32 v156, v156, |v96|
    v_max3_f32 v157, |v52|, |v56|, |v92|
    v_max_f32 v157, v157, |v96|
    v_cmp_le_f32 s[70:71], s55, v157
    v_cmp_gt_f32 vcc, s54, v156
    s_nop 0
    s_or_b64 vcc, vcc, s[70:71]
    s_sub_u32 s28, s28, 1
    s_cbranch_scc1 L_m_s80x
    s_cbranch_vccnz L_m_s80
    s_branch L_m_s80xy
L_m_s80x:
    s_mov_b32 s28, 0
L_m_s80xy:
    s_mov_b64 exec, -1
    s_nop 4
    s_branch L_m_r81
L_m_s82:
    s_sleep 3
    s_add_u32 s69, s78, 20480
    buffer_load_dwordx4 v[100:103], v2, s[44:47], s69 offen sc1
    s_add_u32 s69, s80, 20480
    buffer_load_dwordx4 v[104:107], v2, s[44:47], s69 offen sc1
    s_add_u32 s69, s78, 24576
    buffer_load_dwordx4 v[108:111], v2, s[44:47], s69 offen sc1
    s_add_u32 s69, s80, 24576
    buffer_load_dwordx4 v[112:115], v2, s[44:47], s69 offen sc1
    s_add_u32 s69, s81, 4096
    buffer_load_dwordx4 v[28:31], v2, s[44:47], s69 offen sc1
    s_add_u32 s69, s79, 8192
    buffer_load_dwordx4 v[32:35], v2, s[44:47], s69 offen sc1
    s_add_u32 s69, s81, 8192
    buffer_load_dwordx4 v[36:39], v2, s[44:47], s69 offen sc1
    s_add_u32 s69, s79, 12288
    buffer_load_dwordx4 v[40:43], v2, s[44:47], s69 offen sc1
    s_add_u32 s69, s79, 20480
    buffer_load_dwordx4 v[44:47], v2, s[44:47], s69 offen sc1
    s_add_u32 s69, s81, 20480
    buffer_load_dwordx4 v[48:51], v2, s[44:47], s69 offen sc1
    s_add_u32 s69, s79, 24576
    buffer_load_dwordx4 v[52:55], v2, s[44:47], s69 offen sc1
    s_add_u32 s69, s81, 24576
    buffer_load_dwordx4 v[56:59], v2, s[44:47], s69 offen sc1
    s_add_u32 s69, s78, 3670016
    buffer_load_dwordx4 v[92:95], v2, s[44:47], s69 offen sc1
    s_waitcnt vmcnt(0)
    v_xor_b32 v100, s54, v100
    v_xor_b32 v104, s54, v104
    v_xor_b32 v108, s54, v108
    v_xor_b32 v112, s54, v112
    v_min3_f32 v156, |v100|, |v104|, |v108|
    v_min_f32 v156, v156, |v112|
    v_max3_f32 v157, |v100|, |v104|, |v108|
    v_max_f32 v157, v157, |v112|
    v_cmp_le_f32 s[70:71], s55, v157
    v_cmp_gt_f32 vcc, s54, v156
    s_nop 0
    s_or_b64 vcc, vcc, s[70:71]
    s_sub_u32 s28, s28, 1
    s_cbranch_scc1 L_m_s82x
    s_cbranch_vccnz L_m_s82
    s_branch L_m_s82xy
L_m_s82x:
    s_mov_b32 s28, 0
L_m_s82xy:
    s_mov_b64 exec, -1
    s_nop 4
    s_branch L_m_r83
L_m_s84:
    s_sleep 3
    s_add_u32 s69, s81, 4096
    buffer_load_dwordx4 v[28:31], v2, s[44:47], s69 offen sc1
    s_add_u32 s69, s79, 8192
    buffer_load_dwordx4 v[32:35], v2, s[44:47], s69 offen sc1
    s_add_u32 s69, s81, 8192
    buffer_load_dwordx4 v[36:39], v2, s[44:47], s69 offen sc1
    s_add_u32 s69, s79, 12288
    buffer_load_dwordx4 v[40:43], v2, s[44:47], s69 offen sc1
    s_add_u32 s69, s79, 20480
    buffer_load_dwordx4 v[44:47], v2, s[44:47], s69 offen sc1
    s_add_u32 s69, s81, 20480
    buffer_load_dwordx4 v[48:51], v2, s[44:47], s69 offen sc1
    s_add_u32 s69, s79, 24576
    buffer_load_dwordx4 v[52:55], v2, s[44:47], s69 offen sc1
    s_add_u32 s69, s81, 24576
    buffer_load_dwordx4 v[56:59], v2, s[44:47], s69 offen sc1
    s_add_u32 s69, s78, 3670016
    buffer_load_dwordx4 v[92:95], v2, s[44:47], s69 offen sc1
    s_add_u32 s69, s80, 3670016
    buffer_load_dwordx4 v[96:99], v2, s[44:47], s69 offen sc1
    s_add_u32 s69, s78, 3674112
    buffer_load_dwordx4 v[100:103], v2, s[44:47], s69 offen sc1
    s_add_u32 s69, s80, 3682304
    buffer_load_dwordx4 v[104:107], v2, s[44:47], s69 offen sc1
    s_add_u32 s69, s78, 3686400
    buffer_load_dwordx4 v[108:111], v2, s[44:47], s69 offen sc1
    s_waitcnt vmcnt(0)
    v_xor_b32 v28, s54, v28
    v_xor_b32 v32, s54, v32
    v_xor_b32 v36, s54, v36
    v_xor_b32 v40, s54, v40
    v_min3_f32 v156, |v28|, |v32|, |v36|
    v_min_f32 v156, v156, |v40|
    v_max3_f32 v157, |v28|, |v32|, |v36|
    v_max_f32 v157, v157, |v40|
    v_cmp_le_f32 s[70:71], s55, v157
    v_cmp_gt_f32 vcc, s54, v156
    s_nop 0
    s_or_b64 vcc, vcc, s[70:71]
    s_sub_u32 s28, s28, 1
    s_cbranch_scc1 L_m_s84x
    s_cbranch_vccnz L_m_s84
    s_branch L_m_s84xy
L_m_s84x:
    s_mov_b32 s28, 0
L_m_s84xy:
    s_mov_b64 exec, -1
    s_nop 4
    s_branch L_m_r85
L_m_s86:
    s_sleep 3
    s_add_u32 s69, s79, 20480
    buffer_load_dwordx4 v[44:47], v2, s[44:47], s69 offen sc1
    s_add_u32 s69, s81, 20480
    buffer_load_dwordx4 v[48:51], v2, s[44:47], s69 offen sc1
    s_add_u32 s69, s79, 24576
    buffer_load_dwordx4 v[52:55], v2, s[44:47], s69 offen sc1
    s_add_u32 s69, s81, 24576
    buffer_load_dwordx4 v[56:59], v2, s[44:47], s69 offen sc1
    s_add_u32 s69, s78, 3670016
    buffer_load_dwordx4 v[92:95], v2, s[44:47], s69 offen sc1
    s_add_u32 s69, s80, 3670016
    buffer_load_dwordx4 v[96:99], v2, s[44:47], s69 offen sc1
    s_add_u32 s69, s78, 3674112
    buffer_load_dwordx4 v[100:103], v2, s[44:47], s69 offen sc1
    s_add_u32 s69, s80, 3682304
    buffer_load_dwordx4 v[104:107], v2, s[44:47], s69 offen sc1
    s_add_u32 s69, s78, 3686400
    buffer_load_dwordx4 v[108:111], v2, s[44:47], s69 offen sc1
    s_add_u32 s69, s80, 3686400
    buffer_load_dwordx4 v[112:115], v2, s[44:47], s69 offen sc1
    s_add_u32 s69, s79, 3670016
    buffer_load_dwordx4 v[28:31], v2, s[44:47], s69 offen sc1
    s_add_u32 s69, s81, 3670016
    buffer_load_dwordx4 v[32:35], v2, s[44:47], s69 offen sc1
    s_add_u32 s69, s79, 3674112
    buffer_load_dwordx4 v[36:39], v2, s[44:47], s69 offen sc1
    s_waitcnt vmcnt(0)
    v_xor_b32 v44, s54, v44
    v_xor_b32 v48, s54, v48
    v_xor_b32 v52, s54, v52
    v_xor_b32 v56, s54, v56
    v_min3_f32 v156, |v44|, |v48|, |v52|
    v_min_f32 v156, v156, |v56|
    v_max3_f32 v157, |v44|, |v48|, |v52|
    v_max_f32 v157, v157, |v56|
    v_cmp_le_f32 s[70:71], s55, v157
    v_cmp_gt_f32 vcc, s54, v156
    s_nop 0
    s_or_b64 vcc, vcc, s[70:71]
    s_sub_u32 s28, s28, 1
    s_cbranch_scc1 L_m_s86x
    s_cbranch_vccnz L_m_s86
    s_branch L_m_s86xy
L_m_s86x:
    s_mov_b32 s28, 0
L_m_s86xy:
    s_mov_b64 exec, -1
    s_nop 4
    s_branch L_m_r87
L_m_s88:
    s_sleep 3
    s_add_u32 s69, s78, 3670016
    buffer_load_dwordx4 v[92:95], v2, s[44:47], s69 offen sc1
    s_add_u32 s69, s80, 3670016
    buffer_load_dwordx4 v[96:99], v2, s[44:47], s69 offen sc1
    s_add_u32 s69, s78, 3674112
    buffer_load_dwordx4 v[100:103], v2, s[44:47], s69 offen sc1
    s_add_u32 s69, s80, 3682304
    buffer_load_dwordx4 v[104:107], v2, s[44:47], s69 offen sc1
    s_add_u32 s69, s78, 3686400
    buffer_load_dwordx4 v[108:111], v2, s[44:47], s69 offen sc1
    s_add_u32 s69, s80, 3686400
    buffer_load_dwordx4 v[112:115], v2, s[44:47], s69 offen sc1
    s_add_u32 s69, s79, 3670016
    buffer_load_dwordx4 v[28:31], v2, s[44:47], s69 offen sc1
    s_add_u32 s69, s81, 3670016
    buffer_load_dwordx4 v[32:35], v2, s[44:47], s69 offen sc1
    s_add_u32 s69, s79, 3674112
    buffer_load_dwordx4 v[36:39], v2, s[44:47], s69 offen sc1
    s_add_u32 s69, s81, 3682304
    buffer_load_dwordx4 v[40:43], v2, s[44:47], s69 offen sc1
    s_add_u32 s69, s79, 3686400
    buffer_load_dwordx4 v[44:47], v2, s[44:47], s69 offen sc1
    s_add_u32 s69, s81, 3686400
    buffer_load_dwordx4 v[48:51], v2, s[44:47], s69 offen sc1
    s_add_u32 s69, s80, 3674112
    buffer_load_dwordx4 v[52:55], v2, s[44:47], s69 offen sc1
    s_waitcnt vmcnt(0)
    v_xor_b32 v92, s54, v92
    v_xor_b32 v96, s54, v96
    v_xor_b32 v100, s54, v100
    v_xor_b32 v104, s54, v104
    v_min3_f32 v156, |v92|, |v96|, |v100|
    v_min_f32 v156, v156, |v104|
    v_max3_f32 v157, |v92|, |v96|, |v100|
    v_max_f32 v157, v157, |v104|
    v_cmp_le_f32 s[70:71], s55, v157
    v_cmp_gt_f32 vcc, s54, v156
    s_nop 0
    s_or_b64 vcc, vcc, s[70:71]
    s_sub_u32 s28, s28, 1
    s_cbranch_scc1 L_m_s88x
    s_cbranch_vccnz L_m_s88
    s_branch L_m_s88xy
L_m_s88x:
    s_mov_b32 s28, 0
L_m_s88xy:
    s_mov_b64 exec, -1
    s_nop 4
    s_branch L_m_r89
L_m_s90:
    s_sleep 3
    s_add_u32 s69, s78, 3686400
    buffer_load_dwordx4 v[108:111], v2, s[44:47], s69 offen sc1
    s_add_u32 s69, s80, 3686400
    buffer_load_dwordx4 v[112:115], v2, s[44:47], s69 offen sc1
    s_add_u32 s69, s79, 3670016
    buffer_load_dwordx4 v[28:31], v2, s[44:47], s69 offen sc1
    s_add_u32 s69, s81, 3670016
    buffer_load_dwordx4 v[32:35], v2, s[44:47], s69 offen sc1
    s_add_u32 s69, s79, 3674112
    buffer_load_dwordx4 v[36:39], v2, s[44:47], s69 offen sc1
    s_add_u32 s69, s81, 3682304
    buffer_load_dwordx4 v[40:43], v2, s[44:47], s69 offen sc1
    s_add_u32 s69, s79, 3686400
    buffer_load_dwordx4 v[44:47], v2, s[44:47], s69 offen sc1
    s_add_u32 s69, s81, 3686400
    buffer_load_dwordx4 v[48:51], v2, s[44:47], s69 offen sc1
    s_add_u32 s69, s80, 3674112
    buffer_load_dwordx4 v[52:55], v2, s[44:47], s69 offen sc1
    s_add_u32 s69, s78, 3678208
    buffer_load_dwordx4 v[56:59], v2, s[44:47], s69 offen sc1
    s_add_u32 s69, s80, 3678208
    buffer_load_dwordx4 v[92:95], v2, s[44:47], s69 offen sc1
    s_add_u32 s69, s78, 3682304
    buffer_load_dwordx4 v[96:99], v2, s[44:47], s69 offen sc1
    s_add_u32 s69, s78, 3690496
    buffer_load_dwordx4 v[100:103], v2, s[44:47], s69 offen sc1
    s_waitcnt vmcnt(0)
    v_xor_b32 v108, s54, v108
    v_xor_b32 v112, s54, v112
    v_xor_b32 v28, s54, v28
    v_xor_b32 v32, s54, v32
    v_min3_f32 v156, |v108|, |v112|, |v28|
    v_min_f32 v156, v156, |v32|
    v_max3_f32 v157, |v108|, |v112|, |v28|
    v_max_f32 v157, v157, |v32|
    v_cmp_le_f32 s[70:71], s55, v157
    v_cmp_gt_f32 vcc, s54, v156
    s_nop 0
    s_or_b64 vcc, vcc, s[70:71]
    s_sub_u32 s28, s28, 1
    s_cbranch_scc1 L_m_s90x
    s_cbranch_vccnz L_m_s90
    s_branch L_m_s90xy
L_m_s90x:
    s_mov_b32 s28, 0
L_m_s90xy:
    s_mov_b64 exec, -1
    s_nop 4
    s_branch L_m_r91
L_m_s92:
    s_sleep 3
    s_add_u32 s69, s79, 3674112
    buffer_load_dwordx4 v[36:39], v2, s[44:47], s69 offen sc1
    s_add_u32 s69, s81, 3682304
    buffer_load_dwordx4 v[40:43], v2, s[44:47], s69 offen sc1
    s_add_u32 s69, s79, 3686400
    buffer_load_dwordx4 v[44:47], v2, s[44:47], s69 offen sc1
    s_add_u32 s69, s81, 3686400
    buffer_load_dwordx4 v[48:51], v2, s[44:47], s69 offen sc1
    s_add_u32 s69, s80, 3674112
    buffer_load_dwordx4 v[52:55], v2, s[44:47], s69 offen sc1
    s_add_u32 s69, s78, 3678208
    buffer_load_dwordx4 v[56:59], v2, s[44:47], s69 offen sc1
    s_add_u32 s69, s80, 3678208
    buffer_load_dwordx4 v[92:95], v2, s[44:47], s69 offen sc1
    s_add_u32 s69, s78, 3682304
    buffer_load_dwordx4 v[96:99], v2, s[44:47], s69 offen sc1
    s_add_u32 s69, s78, 3690496
    buffer_load_dwordx4 v[100:103], v2, s[44:47], s69 offen sc1
    s_add_u32 s69, s80, 3690496
    buffer_load_dwordx4 v[104:107], v2, s[44:47], s69 offen sc1
    s_add_u32 s69, s78, 3694592
    buffer_load_dwordx4 v[108:111], v2, s[44:47], s69 offen sc1
    s_add_u32 s69, s80, 3694592
    buffer_load_dwordx4 v[112:115], v2, s[44:47], s69 offen sc1
    s_add_u32 s69, s81, 3674112
    buffer_load_dwordx4 v[28:31], v2, s[44:47], s69 offen sc1
    s_waitcnt vmcnt(0)
    v_xor_b32 v36, s54, v36
    v_xor_b32 v40, s54, v40
    v_xor_b32 v44, s54, v44
    v_xor_b32 v48, s54, v48
    v_min3_f32 v156, |v36|, |v40|, |v44|
    v_min_f32 v156, v156, |v48|
    v_max3_f32 v157, |v36|, |v40|, |v44|
    v_max_f32 v157, v157, |v48|
    v_cmp_le_f32 s[70:71], s55, v157
    v_cmp_gt_f32 vcc, s54, v156
    s_nop 0
    s_or_b64 vcc, vcc, s[70:71]
    s_sub_u32 s28, s28, 1
    s_cbranch_scc1 L_m_s92x
    s_cbranch_vccnz L_m_s92
    s_branch L_m_s92xy
L_m_s92x:
    s_mov_b32 s28, 0
L_m_s92xy:
    s_mov_b64 exec, -1
    s_nop 4
    s_branch L_m_r93
L_m_s94:
    s_sleep 3
    s_add_u32 s69, s80, 3674112
    buffer_load_dwordx4 v[52:55], v2, s[44:47], s69 offen sc1
    s_add_u32 s69, s78, 3678208
    buffer_load_dwordx4 v[56:59], v2, s[44:47], s69 offen sc1
    s_add_u32 s69, s80, 3678208
    buffer_load_dwordx4 v[92:95], v2, s[44:47], s69 offen sc1
    s_add_u32 s69, s78, 3682304
    buffer_load_dwordx4 v[96:99], v2, s[44:47], s69 offen sc1
    s_add_u32 s69, s78, 3690496
    buffer_load_dwordx4 v[100:103], v2, s[44:47], s69 offen sc1
    s_add_u32 s69, s80, 3690496
    buffer_load_dwordx4 v[104:107], v2, s[44:47], s69 offen sc1
    s_add_u32 s69, s78, 3694592
    buffer_load_dwordx4 v[108:111], v2, s[44:47], s69 offen sc1
    s_add_u32 s69, s80, 3694592
    buffer_load_dwordx4 v[112:115], v2, s[44:47], s69 offen sc1
    s_add_u32 s69, s81, 3674112
    buffer_load_dwordx4 v[28:31], v2, s[44:47], s69 offen sc1
    s_add_u32 s69, s79, 3678208
    buffer_load_dwordx4 v[32:35], v2, s[44:47], s69 offen sc1
    s_add_u32 s69, s81, 3678208
    buffer_load_dwordx4 v[36:39], v2, s[44:47], s69 offen sc1
    s_add_u32 s69, s79, 3682304
    buffer_load_dwordx4 v[40:43], v2, s[44:47], s69 offen sc1
    s_add_u32 s69, s79, 3690496
    buffer_load_dwordx4 v[44:47], v2, s[44:47], s69 offen sc1
    s_waitcnt vmcnt(0)
    v_xor_b32 v52, s54, v52
    v_xor_b32 v56, s54, v56
    v_xor_b32 v92, s54, v92
    v_xor_b32 v96, s54, v96
    v_min3_f32 v156, |v52|, |v56|, |v92|
    v_min_f32 v156, v156, |v96|
    v_max3_f32 v157, |v52|, |v56|, |v92|
    v_max_f32 v157, v157, |v96|
    v_cmp_le_f32 s[70:71], s55, v157
    v_cmp_gt_f32 vcc, s54, v156
    s_nop 0
    s_or_b64 vcc, vcc, s[70:71]
    s_sub_u32 s28, s28, 1
    s_cbranch_scc1 L_m_s94x
    s_cbranch_vccnz L_m_s94
    s_branch L_m_s94xy
L_m_s94x:
    s_mov_b32 s28, 0
L_m_s94xy:
    s_mov_b64 exec, -1
    s_nop 4
    s_branch L_m_r95
L_m_s96:
    s_sleep 3
    s_add_u32 s69, s78, 3690496
    buffer_load_dwordx4 v[100:103], v2, s[44:47], s69 offen sc1
    s_add_u32 s69, s80, 3690496
    buffer_load_dwordx4 v[104:107], v2, s[44:47], s69 offen sc1
    s_add_u32 s69, s78, 3694592
    buffer_load_dwordx4 v[108:111], v2, s[44:47], s69 offen sc1
    s_add_u32 s69, s80, 3694592
    buffer_load_dwordx4 v[112:115], v2, s[44:47], s69 offen sc1
    s_add_u32 s69, s81, 3674112
    buffer_load_dwordx4 v[28:31], v2, s[44:47], s69 offen sc1
    s_add_u32 s69, s79, 3678208
    buffer_load_dwordx4 v[32:35], v2, s[44:47], s69 offen sc1
    s_add_u32 s69, s81, 3678208
    buffer_load_dwordx4 v[36:39], v2, s[44:47], s69 offen sc1
    s_add_u32 s69, s79, 3682304
    buffer_load_dwordx4 v[40:43], v2, s[44:47], s69 offen sc1
    s_add_u32 s69, s79, 3690496
    buffer_load_dwordx4 v[44:47], v2, s[44:47], s69 offen sc1
    s_add_u32 s69, s81, 3690496
    buffer_load_dwordx4 v[48:51], v2, s[44:47], s69 offen sc1
    s_add_u32 s69, s79, 3694592
    buffer_load_dwordx4 v[52:55], v2, s[44:47], s69 offen sc1
    s_add_u32 s69, s81, 3694592
    buffer_load_dwordx4 v[56:59], v2, s[44:47], s69 offen sc1
    s_waitcnt vmcnt(0)
    v_xor_b32 v100, s54, v100
    v_xor_b32 v104, s54, v104
    v_xor_b32 v108, s54, v108
    v_xor_b32 v112, s54, v112
    v_min3_f32 v156, |v100|, |v104|, |v108|
    v_min_f32 v156, v156, |v112|
    v_max3_f32 v157, |v100|, |v104|, |v108|
    v_max_f32 v157, v157, |v112|
    v_cmp_le_f32 s[70:71], s55, v157
    v_cmp_gt_f32 vcc, s54, v156
    s_nop 0
    s_or_b64 vcc, vcc, s[70:71]
    s_sub_u32 s28, s28, 1
    s_cbranch_scc1 L_m_s96x
    s_cbranch_vccnz L_m_s96
    s_branch L_m_s96xy
L_m_s96x:
    s_mov_b32 s28, 0
L_m_s96xy:
    s_mov_b64 exec, -1
    s_nop 4
    s_branch L_m_r97
L_m_s98:
    s_sleep 3
    s_add_u32 s69, s81, 3674112
    buffer_load_dwordx4 v[28:31], v2, s[44:47], s69 offen sc1
    s_add_u32 s69, s79, 3678208
    buffer_load_dwordx4 v[32:35], v2, s[44:47], s69 offen sc1
    s_add_u32 s69, s81, 3678208
    buffer_load_dwordx4 v[36:39], v2, s[44:47], s69 offen sc1
    s_add_u32 s69, s79, 3682304
    buffer_load_dwordx4 v[40:43], v2, s[44:47], s69 offen sc1
    s_add_u32 s69, s79, 3690496
    buffer_load_dwordx4 v[44:47], v2, s[44:47], s69 offen sc1
    s_add_u32 s69, s81, 3690496
    buffer_load_dwordx4 v[48:51], v2, s[44:47], s69 offen sc1
    s_add_u32 s69, s79, 3694592
    buffer_load_dwordx4 v[52:55], v2, s[44:47], s69 offen sc1
    s_add_u32 s69, s81, 3694592
    buffer_load_dwordx4 v[56:59], v2, s[44:47], s69 offen sc1
    s_waitcnt vmcnt(0)
    v_xor_b32 v28, s54, v28
    v_xor_b32 v32, s54, v32
    v_xor_b32 v36, s54, v36
    v_xor_b32 v40, s54, v40
    v_min3_f32 v156, |v28|, |v32|, |v36|
    v_min_f32 v156, v156, |v40|
    v_max3_f32 v157, |v28|, |v32|, |v36|
    v_max_f32 v157, v157, |v40|
    v_cmp_le_f32 s[70:71], s55, v157
    v_cmp_gt_f32 vcc, s54, v156
    s_nop 0
    s_or_b64 vcc, vcc, s[70:71]
    s_sub_u32 s28, s28, 1
    s_cbranch_scc1 L_m_s98x
    s_cbranch_vccnz L_m_s98
    s_branch L_m_s98xy
L_m_s98x:
    s_mov_b32 s28, 0
L_m_s98xy:
    s_mov_b64 exec, -1
    s_nop 4
    s_branch L_m_r99
L_m_s100:
    s_sleep 3
    s_add_u32 s69, s79, 3690496
    buffer_load_dwordx4 v[44:47], v2, s[44:47], s69 offen sc1
    s_add_u32 s69, s81, 3690496
    buffer_load_dwordx4 v[48:51], v2, s[44:47], s69 offen sc1
    s_add_u32 s69, s79, 3694592
    buffer_load_dwordx4 v[52:55], v2, s[44:47], s69 offen sc1
    s_add_u32 s69, s81, 3694592
    buffer_load_dwordx4 v[56:59], v2, s[44:47], s69 offen sc1
    s_waitcnt vmcnt(0)
    v_xor_b32 v44, s54, v44
    v_xor_b32 v48, s54, v48
    v_xor_b32 v52, s54, v52
    v_xor_b32 v56, s54, v56
    v_min3_f32 v156, |v44|, |v48|, |v52|
    v_min_f32 v156, v156, |v56|
    v_max3_f32 v157, |v44|, |v48|, |v52|
    v_max_f32 v157, v157, |v56|
    v_cmp_le_f32 s[70:71], s55, v157
    v_cmp_gt_f32 vcc, s54, v156
    s_nop 0
    s_or_b64 vcc, vcc, s[70:71]
    s_sub_u32 s28, s28, 1
    s_cbranch_scc1 L_m_s100x
    s_cbranch_vccnz L_m_s100
    s_branch L_m_s100xy
L_m_s100x:
    s_mov_b32 s28, 0
L_m_s100xy:
    s_mov_b64 exec, -1
    s_nop 4
    s_branch L_m_r101
.p2align 4
L_code_end:
.section .rodata,"a"
.p2align 6
.amdhsa_kernel main_kernel
  .amdhsa_next_free_vgpr 512
  .amdhsa_next_free_sgpr 100
  .amdhsa_accum_offset 256
  .amdhsa_group_segment_fixed_size 0
  .amdhsa_kernarg_size 112
  .amdhsa_user_sgpr_count 2
  .amdhsa_user_sgpr_kernarg_segment_ptr 1
  .amdhsa_system_sgpr_workgroup_id_x 1
.end_amdhsa_kernel
```
